```python
import torch

def _softmax(x, axis=-1):
    return torch.softmax(x, dim=axis)
def _gelu(x):
    return torch.nn.functional.gelu(x, approximate="tanh")
def _silu(x):
    return torch.nn.functional.silu(x)
def _sigmoid(x):
    return torch.sigmoid(x)
def _layernorm(x, axis=-1, eps=1e-5):
    m = x.mean(dim=axis, keepdim=True)
    v = x.var(dim=axis, keepdim=True, unbiased=False)
    return (x - m) / torch.sqrt(v + eps)
def _scatter_add(tgt, idx, src, axis=0):
    return tgt.clone().index_add_(axis, idx, src)
def _segment_sum(src, seg, n):
    out = torch.zeros((n,) + src.shape[1:], dtype=src.dtype)
    return out.index_add_(0, seg, src)
def _pad(x, pw):
    flat = tuple(v for pair in reversed(pw) for v in pair)
    return torch.nn.functional.pad(x, flat)

kernel_name = 'recurrent_scan__mha_block__glu_gated_reglu__prompt'

def setup_inputs():

    _w = (lambda a: (lambda t: t.to(torch.bfloat16) if t.is_floating_point() else t)(torch.as_tensor(a)))
    def _A_setup():
        B, S, D, H = 1, 2048, 576, 32
        return {
            "x": _w((lambda *s: torch.randn(*s, dtype=torch.bfloat16) * 0.05)(B, S, D)),
            "wqkv": _w((lambda *s: torch.randn(*s, dtype=torch.bfloat16) * 0.2)(D, 3 * D)),
            "wo": _w((lambda *s: torch.randn(*s, dtype=torch.bfloat16) * 0.2)(D, D)),
        }
    _A_in = _A_setup()

    def _B_setup():
        B, S, D, F = 1, 2048, 576, 4608
        return {
            "x": _w((lambda *s: torch.randn(*s, dtype=torch.bfloat16) * 0.05)(B, S, D)),
            "W_gate": _w((lambda *s: torch.randn(*s, dtype=torch.bfloat16) * 0.1)(D, F) * (2.0 / D) ** 0.5),
            "W_up": _w((lambda *s: torch.randn(*s, dtype=torch.bfloat16) * 0.1)(D, F) * (2.0 / D) ** 0.5),
            "W_down": _w((lambda *s: torch.randn(*s, dtype=torch.bfloat16) * 0.1)(F, D) * (1.0 / F) ** 0.5),
        }
    _B_in = _B_setup()

    return {
        "A_x": _A_in["x"],
        "A_wqkv": _A_in["wqkv"],
        "A_wo": _A_in["wo"],
        "B_x": _B_in["x"],
        "B_W_gate": _B_in["W_gate"],
        "B_W_up": _B_in["W_up"],
        "B_W_down": _B_in["W_down"],
    }

def reference(A_x, A_wqkv, A_wo, B_x, B_W_gate, B_W_up, B_W_down):
    def _A_ref(x, wqkv, wo):
        B, S, D = x.shape
        H = 32
        Dh = D // H
        qkv = (lambda x, *d: x.permute(*d))((x @ wqkv).reshape(B, S, 3, H, Dh), 2, 0, 3, 1, 4)
        q, k, v = qkv[0], qkv[1], qkv[2]
        scores = torch.einsum("bhqd,bhkd->bhqk", q, k) * (Dh ** -0.5)
        p = _softmax(scores, axis=-1)
        o = torch.einsum("bhqk,bhkd->bhqd", p, v)
        return (lambda x, *d: x.permute(*d))(o, 0, 2, 1, 3).reshape(B, S, D) @ wo

    def _B_ref(x, W_gate, W_up, W_down):
        gate = torch.einsum("bsd,df->bsf", x, W_gate)
        up = torch.einsum("bsd,df->bsf", x, W_up)
        gate = gate * (lambda x, dt: x.to(dt))(gate > 0, gate.dtype)
        h = gate * up
        return torch.einsum("bsf,fd->bsd", h, W_down)

    x = A_x
    xn = _layernorm(x, axis=-1)
    s = _A_ref(xn, A_wqkv, A_wo)
    g = _silu(_B_ref(xn, B_W_gate, B_W_up, B_W_down))
    return x + s * g
```

```asm
; @launch grid=(256,1,1) block=(256,1,1) lds=163840
.amdgcn_target "amdgcn-amd-amdhsa--gfx950"
.text
.globl recurrent_scan__mha_block__glu_gated_reglu__prompt_kernel
.p2align 8
.type recurrent_scan__mha_block__glu_gated_reglu__prompt_kernel,@function
recurrent_scan__mha_block__glu_gated_reglu__prompt_kernel:
s_cmp_ge_u32 s2, 256
s_cbranch_scc1 L_end
s_load_dwordx2 s[8:9], s[0:1], 0
s_load_dwordx4 s[76:79], s[0:1], 8
s_load_dwordx8 s[80:87], s[0:1], 32
s_load_dwordx2 s[40:41], s[0:1], 64
s_load_dwordx2 s[28:29], s[0:1], 72
s_getpc_b64 s[4:5]
L_end_pc:
s_lshr_b32 s6, s2, 3
s_lshl_b32 s6, s6, 12
v_lshrrev_b32 v2, 3, v0
v_lshl_add_u32 v2, v2, 7, s6
v_min_u32 v2, L_end-L_end_pc, v2
v_mov_b32 v3, s5
v_add_co_u32 v2, vcc, s4, v2
s_nop 1
v_addc_co_u32 v3, vcc, 0, v3, vcc
global_load_dword v255, v[2:3], off
s_mov_b32 s10, 2359296
s_mov_b32 s11, 0x20000
v_and_b32 v1, 63, v0
v_lshrrev_b32 v32, 6, v0
s_and_b32 s70, s2, 7
s_lshr_b32 s71, s2, 3
v_readfirstlane_b32 s44, v32
v_lshlrev_b32 v10, 4, v1
s_lshl_b32 s58, s70, 2
s_and_b32 s59, s71, 3
s_add_u32 s59, s59, s58
s_and_b32 s46, s59, 15
s_xor_b32 s46, s46, 0
s_lshr_b32 s58, s58, 4
s_mul_i32 s58, s58, 8
s_lshr_b32 s45, s71, 2
s_add_u32 s45, s45, s58
s_lshl_b32 s47, s44, 10
s_and_b32 s7, s44, 1
s_lshl_b32 s58, s45, 2
s_add_u32 s58, s58, s44
s_mul_i32 s48, s58, 36864
s_add_u32 s49, s48, 18432
v_lshrrev_b32 v32, 3, v1
v_and_b32 v33, 7, v1
v_lshrrev_b32 v34, 1, v32
v_xor_b32 v35, v33, v34
v_lshlrev_b32 v35, 4, v35
v_mul_u32_u24 v36, 1152, v32
v_add_u32 v48, v35, v36
v_xor_b32 v35, 64, v35
v_add_u32 v49, v35, v36
v_add_u32 v49, 9216, v49
s_mul_i32 s59, s46, 2304
s_add_u32 s59, s59, s48
v_min_u32 v88, 17, v1
v_lshl_add_u32 v88, v88, 7, s59
s_bfe_u32 s90, s2, 0x40003
s_mov_b32 s88, 0x95554441
s_mov_b32 s89, 0x97726668
s_lshl_b32 s91, s90, 2
s_lshr_b64 s[88:89], s[88:89], s91
s_and_b32 s88, s88, 15
s_lshl_b32 s88, s88, 3
s_load_dwordx2 s[92:93], s[0:1], s88
s_lshl_b32 s90, s90, 1
s_lshr_b32 s91, 0x50902490, s90
s_and_b32 s91, s91, 3
s_mul_i32 s90, s91, 57671680
s_add_u32 s90, s90, 1152
s_lshl_b32 s91, s91, 21
s_cmp_eq_u32 s88, 72
s_cselect_b32 s91, s90, s91
s_add_u32 s91, s91, 128
v_lshrrev_b32 v37, 4, v1
v_and_b32 v36, 15, v1
v_lshrrev_b32 v34, 1, v36
v_xor_b32 v34, v34, v37
v_lshlrev_b32 v34, 4, v34
v_and_b32 v35, 7, v36
v_lshl_add_u32 v34, v35, 7, v34
v_lshrrev_b32 v35, 3, v36
v_lshl_add_u32 v34, v35, 12, v34
v_add_u32 v50, s47, v34
v_xor_b32 v51, 64, v50
v_xor_b32 v52, 0x400, v50
v_xor_b32 v53, 0x400, v51
v_mov_b32 v34, 0x3f803f80
v_accvgpr_write_b32 a96, v34
v_accvgpr_write_b32 a97, v34
v_accvgpr_write_b32 a98, v34
v_accvgpr_write_b32 a99, v34
s_mov_b32 s14, 1990656
s_mov_b32 s15, 0x20000
s_mov_b32 s34, 663552
s_mov_b32 s35, 0x20000
s_mov_b32 s18, 5308416
s_mov_b32 s19, 0x20000
s_mov_b32 s22, 5308416
s_mov_b32 s23, 0x20000
s_mov_b32 s26, 5308416
s_mov_b32 s27, 0x20000
s_mov_b32 s38, 2359296
s_mov_b32 s39, 0x20000
s_mov_b32 s42, 256
s_mov_b32 s43, 0x20000
s_mov_b32 s30, 268435456
s_mov_b32 s31, 0x20000
s_mul_i32 s59, s46, 216
s_lshr_b32 s61, s59, 4
s_lshl_b32 s60, s7, 3
v_lshrrev_b32 v34, 4, v1
v_lshl_add_u32 v35, v34, 1, s60
v_and_b32 v36, 15, v1
v_xor_b32 v36, v36, v35
v_subrev_u32 v36, s61, v36
v_and_b32 v36, 15, v36
v_cmp_gt_u32 vcc, 14, v36
v_add_u32 v36, s61, v36
s_lshl_b32 s60, s44, 3
v_add_u32 v34, s60, v34
v_mul_u32_u24 v34, 3456, v34
v_lshl_add_u32 v34, v36, 4, v34
v_mov_b32 v37, 2147483648
v_cndmask_b32 v8, v37, v34, vcc
s_mul_i32 s59, s46, 216
s_and_b32 s59, s59, 0xffffff80
s_mul_i32 s60, s58, 31104
s_add_u32 s59, s59, s60
v_mul_u32_u24 v40, 86, v1
v_lshrrev_b32 v40, 8, v40
v_mul_u32_u24 v41, 3072, v40
v_lshl_add_u32 v41, v1, 7, v41
v_cmp_gt_u32 vcc, 27, v1
v_add_u32 v41, s59, v41
v_mov_b32 v40, 2147483648
v_cndmask_b32 v111, v40, v41, vcc
s_lshr_b32 s59, s46, 1
s_mul_i32 s59, s59, 1152
s_and_b32 s60, s46, 1
s_mul_i32 s60, s60, 640
s_sub_u32 s4, 512, s60
s_add_u32 s59, s59, s60
s_mul_i32 s60, s58, 82944
s_add_u32 s59, s59, s60
v_lshrrev_b32 v40, 2, v1
v_min_u32 v40, 8, v40
v_mul_u32_u24 v40, 9216, v40
v_add_u32 v27, s59, v40
s_min_u32 s60, s2, 1
s_lshl_b32 s60, s60, 31
s_add_u32 s59, s60, 58720256
v_cmp_gt_u32 vcc, 80, v0
v_lshl_add_u32 v108, v0, 7, s59
v_lshl_add_u32 v109, v0, 8, s60
v_mov_b32 v110, 0
v_mov_b32 v29, 1
v_cndmask_b32 v108, v37, v108, vcc
v_cmp_eq_u32 vcc, 0, v0
s_mul_i32 s55, s46, 384
s_add_u32 s55, s55, s58
v_cndmask_b32 v28, v37, v110, vcc
s_mul_i32 s55, s55, 2432
s_mul_i32 s56, s58, 576
s_add_u32 s56, s56, s46
s_lshl_b32 s56, s56, 10
s_add_u32 s56, s56, 12582912
s_lshr_b32 s59, s46, 1
s_and_b32 s60, s46, 1
s_mul_i32 s59, s59, 1152
s_add_u32 s51, s59, 512
s_mul_i32 s61, s60, 640
s_add_u32 s50, s59, s61
s_lshl_b32 s61, s60, 6
s_add_u32 s51, s51, s61
s_mul_i32 s52, s50, 576
s_mul_i32 s53, s51, 576
v_and_b32 v34, 6, v32
v_xor_b32 v34, v33, v34
s_lshl_b32 s59, s44, 3
v_add_u32 v35, s59, v32
v_mul_u32_u24 v35, 1152, v35
v_lshl_add_u32 v7, v34, 4, v35
s_lshl_b32 s59, s7, 4
s_lshr_b32 s61, s44, 1
s_lshl_b32 s61, s61, 2
s_add_u32 s59, s59, s61
v_and_b32 v35, 4, v32
v_add_u32 v35, v35, v32
v_add_u32 v35, s59, v35
v_mul_u32_u24 v35, 9216, v35
v_lshl_add_u32 v6, v34, 4, v35
v_and_b32 v36, 3, v34
v_lshl_add_u32 v9, v36, 4, v35
v_lshrrev_b32 v36, 2, v34
v_mul_u32_u24 v36, 294912, v36
v_add3_u32 v9, v9, v36, s51
v_add_u32 v6, s50, v6
v_add_u32 v11, s53, v7
v_add_u32 v7, s52, v7
s_sub_u32 s59, 384, s50
s_bfe_u32 s60, s59, 0x10009
s_sub_u32 s60, s60, 1
s_and_b32 s59, s59, s60
s_and_b32 s5, s59, 384
s_mul_i32 s60, s5, 576
v_add_u32 v6, s5, v6
v_add_u32 v7, s60, v7
s_mul_i32 s59, s46, 216
s_waitcnt lgkmcnt(0)
buffer_load_dword v255, v88, s[8:11], 0 offen
s_load_dword s101, s[92:93], s91
s_add_u32 m0, s47, 81920
s_nop 0
buffer_load_dwordx4 v48, s[8:11], s48 offen lds
s_add_u32 m0, s47, 86016
s_nop 0
buffer_load_dwordx4 v49, s[8:11], s48 offen lds
s_add_u32 m0, s47, 90112
s_nop 0
buffer_load_dwordx4 v48, s[8:11], s49 offen lds
s_add_u32 m0, s47, 94208
s_nop 0
buffer_load_dwordx4 v49, s[8:11], s49 offen lds
s_mov_b64 s[12:13], s[76:77]
s_mov_b64 s[32:33], s[78:79]
s_mov_b64 s[16:17], s[80:81]
s_mov_b64 s[20:21], s[82:83]
s_mov_b64 s[24:25], s[84:85]
s_mov_b64 s[36:37], s[86:87]
s_nop 7
s_mov_b64 exec, 0
s_cmp_eq_u32 s44, 0
s_cbranch_scc1 L_pad0
s_cmp_eq_u32 s44, 1
s_cbranch_scc1 L_pad1
s_cmp_eq_u32 s44, 2
s_cbranch_scc1 L_pad2
s_branch L_pad3
L_hret0:
s_mov_b64 exec, -1
s_add_u32 m0, s47, 98176
s_nop 0
buffer_load_dwordx4 v48, s[8:11], s48 offen offset:128 lds
s_add_u32 m0, s47, 102272
s_nop 0
buffer_load_dwordx4 v49, s[8:11], s48 offen offset:128 lds
s_add_u32 m0, s47, 106368
s_nop 0
buffer_load_dwordx4 v48, s[8:11], s49 offen offset:128 lds
s_add_u32 m0, s47, 110464
s_nop 0
buffer_load_dwordx4 v49, s[8:11], s49 offen offset:128 lds
s_add_u32 m0, s47, 114432
s_nop 0
buffer_load_dwordx4 v48, s[8:11], s48 offen offset:256 lds
s_add_u32 m0, s47, 118528
s_nop 0
buffer_load_dwordx4 v49, s[8:11], s48 offen offset:256 lds
s_add_u32 m0, s47, 122624
s_nop 0
buffer_load_dwordx4 v48, s[8:11], s49 offen offset:256 lds
s_add_u32 m0, s47, 126720
s_nop 0
buffer_load_dwordx4 v49, s[8:11], s49 offen offset:256 lds
v_lshrrev_b32 v32, 4, v1
v_bfe_u32 v33, v1, 2, 2
v_and_b32 v34, 3, v1
v_bfe_u32 v35, v1, 2, 3
v_lshrrev_b32 v36, 5, v1
v_lshlrev_b32 v36, 10, v36
v_lshl_add_u32 v36, v35, 7, v36
v_lshl_add_u32 v36, v34, 3, v36
v_lshrrev_b32 v37, 1, v35
v_lshl_add_u32 v36, v37, 5, v36
s_lshl_b32 s60, s7, 6
s_lshl_b32 s61, s7, 5
v_xor_b32 v2, s60, v36
v_xor_b32 v3, 32, v2
v_xor_b32 v4, s61, v36
v_xor_b32 v5, 64, v4
v_lshlrev_b32 v36, 10, v32
v_lshl_add_u32 v36, v33, 8, v36
v_lshlrev_b32 v35, 5, v35
s_mul_i32 s60, s7, 40
s_add_u32 s60, s60, s59
v_lshl_add_u32 v37, v34, 3, s60
v_min_u32 v38, 2, v34
v_mul_u32_u24 v38, 72, v38
v_add_u32 v38, s59, v38
v_add_u32 v39, 0, v37
v_and_b32 v39, 0xff, v39
v_xor_b32 v39, v39, v35
v_add_u32 v104, v39, v36
v_add_u32 v39, 72, v37
v_and_b32 v39, 0xff, v39
v_xor_b32 v39, v39, v35
v_add_u32 v105, v39, v36
v_add_u32 v39, 144, v37
v_and_b32 v39, 0xff, v39
v_xor_b32 v39, v39, v35
v_add_u32 v106, v39, v36
v_add_u32 v39, 32, v38
v_and_b32 v39, 0xff, v39
v_xor_b32 v39, v39, v35
v_add_u32 v107, v39, v36
v_and_b32 v40, 15, v1
v_lshrrev_b32 v41, 4, v1
v_lshlrev_b32 v41, 2, v41
v_sub_u32 v40, v40, v41
v_and_b32 v41, 1, v40
v_lshlrev_b32 v41, 4, v41
v_mov_b32 v42, 0x3f80
v_lshlrev_b32 v41, v41, v42
v_lshrrev_b32 v42, 1, v40
v_cmp_eq_u32 vcc, 0, v42
s_nop 1
v_cndmask_b32 v43, 0, v41, vcc
v_cmp_eq_u32 vcc, 1, v42
v_mov_b32 v30, v43
s_nop 0
v_cndmask_b32 v31, 0, v41, vcc
v_cmp_eq_u32 s[62:63], 0, v40
v_cmp_eq_u32 s[64:65], 1, v40
v_cmp_eq_u32 s[66:67], 2, v40
v_cmp_eq_u32 s[68:69], 3, v40
v_and_b32 v32, 1, v1
v_lshlrev_b32 v32, 4, v32
v_mov_b32 v34, 0x3f80
v_lshlrev_b32 v32, v32, v34
v_bfe_i32 v35, v1, 1, 1
v_and_b32 v35, v35, v32
v_xor_b32 v34, v35, v32
v_accvgpr_write_b32 a104, v34
v_accvgpr_write_b32 a105, v35
v_add_u32 v50, 0x10000, v50
v_add_u32 v51, 0x10000, v51
v_add_u32 v52, 0x10000, v52
v_add_u32 v53, 0x10000, v53
s_waitcnt vmcnt(8)
s_barrier
ds_read_b128 v[112:115], v50 offset:16384
ds_read_b128 v[120:123], v51 offset:16384
ds_read_b128 v[116:119], v50 offset:24576
ds_read_b128 v[124:127], v51 offset:24576
ds_read_b128 a[112:115], v52 offset:16384
ds_read_b128 a[120:123], v53 offset:16384
ds_read_b128 a[116:119], v52 offset:24576
ds_read_b128 a[124:127], v53 offset:24576
s_add_u32 m0, s47, 130688
s_nop 0
buffer_load_dwordx4 v48, s[8:11], s48 offen offset:384 lds
s_add_u32 m0, s47, 134784
s_nop 0
buffer_load_dwordx4 v49, s[8:11], s48 offen offset:384 lds
s_add_u32 m0, s47, 138880
s_nop 0
buffer_load_dwordx4 v48, s[8:11], s49 offen offset:384 lds
s_add_u32 m0, s47, 142976
s_nop 0
buffer_load_dwordx4 v49, s[8:11], s49 offen offset:384 lds
s_waitcnt lgkmcnt(0)
v_mfma_f32_16x16x32_bf16 v[56:59], a[96:99], v[112:115], 0
v_mfma_f32_16x16x32_bf16 v[56:59], a[96:99], v[120:123], v[56:59]
v_mfma_f32_16x16x32_bf16 v[60:63], a[96:99], v[116:119], 0
v_mfma_f32_16x16x32_bf16 v[60:63], a[96:99], v[124:127], v[60:63]
s_waitcnt vmcnt(8)
s_barrier
v_mfma_f32_16x16x32_bf16 v[72:75], v[112:115], v[112:115], 0
s_add_u32 m0, s47, 146944
ds_read_b128 v[128:131], v50 offset:32768
v_mfma_f32_16x16x32_bf16 v[72:75], v[120:123], v[120:123], v[72:75]
ds_read_b128 v[136:139], v51 offset:32768
buffer_load_dwordx4 v48, s[8:11], s48 offen offset:512 lds
v_mfma_f32_16x16x32_bf16 v[76:79], v[116:119], v[116:119], 0
s_add_u32 m0, s47, 151040
ds_read_b128 v[132:135], v50 offset:40960
v_mfma_f32_16x16x32_bf16 v[76:79], v[124:127], v[124:127], v[76:79]
ds_read_b128 v[140:143], v51 offset:40960
buffer_load_dwordx4 v49, s[8:11], s48 offen offset:512 lds
v_mfma_f32_16x16x32_bf16 v[64:67], a[96:99], a[112:115], 0
s_add_u32 m0, s47, 155136
ds_read_b128 a[128:131], v52 offset:32768
v_mfma_f32_16x16x32_bf16 v[64:67], a[96:99], a[120:123], v[64:67]
ds_read_b128 a[136:139], v53 offset:32768
buffer_load_dwordx4 v48, s[8:11], s49 offen offset:512 lds
v_mfma_f32_16x16x32_bf16 v[68:71], a[96:99], a[116:119], 0
s_add_u32 m0, s47, 159232
ds_read_b128 a[132:135], v52 offset:40960
v_mfma_f32_16x16x32_bf16 v[68:71], a[96:99], a[124:127], v[68:71]
s_waitcnt lgkmcnt(5)
ds_read_b128 a[140:143], v53 offset:40960
buffer_load_dwordx4 v49, s[8:11], s49 offen offset:512 lds
v_mfma_f32_16x16x32_bf16 v[56:59], a[96:99], v[128:131], v[56:59]
v_mfma_f32_16x16x32_bf16 v[56:59], a[96:99], v[136:139], v[56:59]
s_waitcnt lgkmcnt(4)
v_mfma_f32_16x16x32_bf16 v[60:63], a[96:99], v[132:135], v[60:63]
v_mfma_f32_16x16x32_bf16 v[60:63], a[96:99], v[140:143], v[60:63]
s_waitcnt vmcnt(8) lgkmcnt(0)
s_barrier
v_mfma_f32_16x16x32_bf16 v[72:75], v[128:131], v[128:131], v[72:75]
s_add_u32 m0, s47, 0
s_add_u32 s100, s48, 640
ds_read_b128 v[144:147], v50 offset:49152
v_mfma_f32_16x16x32_bf16 v[72:75], v[136:139], v[136:139], v[72:75]
ds_read_b128 v[152:155], v51 offset:49152
buffer_load_dwordx4 v48, s[8:11], s100 offen lds
v_mfma_f32_16x16x32_bf16 v[76:79], v[132:135], v[132:135], v[76:79]
s_add_u32 m0, s47, 3456
ds_read_b128 v[148:151], v50 offset:57344
v_add_u32 v50, 0x10000, v50
v_mfma_f32_16x16x32_bf16 v[76:79], v[140:143], v[140:143], v[76:79]
ds_read_b128 v[156:159], v51 offset:57344
v_add_u32 v51, 0x10000, v51
v_mfma_f32_16x16x32_bf16 v[64:67], a[96:99], a[128:131], v[64:67]
ds_read_b128 a[144:147], v52 offset:49152
buffer_load_dwordx4 v49, s[8:11], s48 offen offset:640 lds
v_mfma_f32_16x16x32_bf16 v[64:67], a[96:99], a[136:139], v[64:67]
s_add_u32 m0, s47, 7552
ds_read_b128 a[152:155], v53 offset:49152
v_mfma_f32_16x16x32_bf16 v[68:71], a[96:99], a[132:135], v[68:71]
ds_read_b128 a[148:151], v52 offset:57344
v_add_u32 v52, 0x10000, v52
v_mfma_f32_16x16x32_bf16 v[68:71], a[96:99], a[140:143], v[68:71]
s_waitcnt lgkmcnt(5)
ds_read_b128 a[156:159], v53 offset:57344
v_add_u32 v53, 0x10000, v53
v_mfma_f32_16x16x32_bf16 v[56:59], a[96:99], v[144:147], v[56:59]
buffer_load_dwordx4 v48, s[8:11], s49 offen offset:640 lds
v_mfma_f32_16x16x32_bf16 v[56:59], a[96:99], v[152:155], v[56:59]
s_waitcnt lgkmcnt(4)
s_add_u32 m0, s47, 11648
v_mfma_f32_16x16x32_bf16 v[60:63], a[96:99], v[148:151], v[60:63]
buffer_load_dwordx4 v49, s[8:11], s49 offen offset:640 lds
v_mfma_f32_16x16x32_bf16 v[60:63], a[96:99], v[156:159], v[60:63]
s_waitcnt vmcnt(8) lgkmcnt(0)
s_barrier
v_mfma_f32_16x16x32_bf16 v[72:75], v[144:147], v[144:147], v[72:75]
s_add_u32 m0, s47, 15616
ds_read_b128 v[160:163], v50
v_mfma_f32_16x16x32_bf16 v[72:75], v[152:155], v[152:155], v[72:75]
ds_read_b128 v[168:171], v51
buffer_load_dwordx4 v48, s[8:11], s48 offen offset:768 lds
v_mfma_f32_16x16x32_bf16 v[76:79], v[148:151], v[148:151], v[76:79]
s_add_u32 m0, s47, 19712
ds_read_b128 v[164:167], v50 offset:8192
v_mfma_f32_16x16x32_bf16 v[76:79], v[156:159], v[156:159], v[76:79]
ds_read_b128 v[172:175], v51 offset:8192
buffer_load_dwordx4 v49, s[8:11], s48 offen offset:768 lds
v_mfma_f32_16x16x32_bf16 v[64:67], a[96:99], a[144:147], v[64:67]
s_add_u32 m0, s47, 23808
ds_read_b128 a[160:163], v52
v_mfma_f32_16x16x32_bf16 v[64:67], a[96:99], a[152:155], v[64:67]
ds_read_b128 a[168:171], v53
buffer_load_dwordx4 v48, s[8:11], s49 offen offset:768 lds
v_mfma_f32_16x16x32_bf16 v[68:71], a[96:99], a[148:151], v[68:71]
s_add_u32 m0, s47, 27904
ds_read_b128 a[164:167], v52 offset:8192
v_mfma_f32_16x16x32_bf16 v[68:71], a[96:99], a[156:159], v[68:71]
s_waitcnt lgkmcnt(5)
ds_read_b128 a[172:175], v53 offset:8192
buffer_load_dwordx4 v49, s[8:11], s49 offen offset:768 lds
v_mfma_f32_16x16x32_bf16 v[56:59], a[96:99], v[160:163], v[56:59]
v_mfma_f32_16x16x32_bf16 v[56:59], a[96:99], v[168:171], v[56:59]
s_waitcnt lgkmcnt(4)
v_mfma_f32_16x16x32_bf16 v[60:63], a[96:99], v[164:167], v[60:63]
v_mfma_f32_16x16x32_bf16 v[60:63], a[96:99], v[172:175], v[60:63]
s_branch L_main
.p2align 12
L_main:
L_pad0:
s_cbranch_execz L_pad4
s_waitcnt vmcnt(8) lgkmcnt(0)
s_barrier
v_mfma_f32_16x16x32_bf16 v[72:75], v[160:163], v[160:163], v[72:75]
s_add_u32 m0, s47, 31872
ds_read_b128 v[176:179], v50 offset:16384
v_mfma_f32_16x16x32_bf16 v[72:75], v[168:171], v[168:171], v[72:75]
ds_read_b128 v[184:187], v51 offset:16384
buffer_load_dwordx4 v48, s[8:11], s48 offen offset:896 lds
v_mfma_f32_16x16x32_bf16 v[76:79], v[164:167], v[164:167], v[76:79]
s_add_u32 m0, s47, 35968
ds_read_b128 v[180:183], v50 offset:24576
v_add_u32 v50, 0xfffe0000, v50
v_mfma_f32_16x16x32_bf16 v[76:79], v[172:175], v[172:175], v[76:79]
ds_read_b128 v[188:191], v51 offset:24576
v_add_u32 v51, 0xfffe0000, v51
v_mfma_f32_16x16x32_bf16 v[64:67], a[96:99], a[160:163], v[64:67]
ds_read_b128 a[176:179], v52 offset:16384
buffer_load_dwordx4 v49, s[8:11], s48 offen offset:896 lds
v_mfma_f32_16x16x32_bf16 v[64:67], a[96:99], a[168:171], v[64:67]
s_add_u32 m0, s47, 40064
ds_read_b128 a[184:187], v53 offset:16384
v_mfma_f32_16x16x32_bf16 v[68:71], a[96:99], a[164:167], v[68:71]
ds_read_b128 a[180:183], v52 offset:24576
v_add_u32 v52, 0xfffe0000, v52
v_mfma_f32_16x16x32_bf16 v[68:71], a[96:99], a[172:175], v[68:71]
s_waitcnt lgkmcnt(5)
ds_read_b128 a[188:191], v53 offset:24576
v_add_u32 v53, 0xfffe0000, v53
v_mfma_f32_16x16x32_bf16 v[56:59], a[96:99], v[176:179], v[56:59]
buffer_load_dwordx4 v48, s[8:11], s49 offen offset:896 lds
v_mfma_f32_16x16x32_bf16 v[56:59], a[96:99], v[184:187], v[56:59]
s_waitcnt lgkmcnt(4)
s_add_u32 m0, s47, 44160
v_mfma_f32_16x16x32_bf16 v[60:63], a[96:99], v[180:183], v[60:63]
buffer_load_dwordx4 v49, s[8:11], s49 offen offset:896 lds
v_mfma_f32_16x16x32_bf16 v[60:63], a[96:99], v[188:191], v[60:63]
s_waitcnt vmcnt(8) lgkmcnt(0)
s_barrier
v_mfma_f32_16x16x32_bf16 v[72:75], v[176:179], v[176:179], v[72:75]
s_add_u32 m0, s47, 48128
ds_read_b128 v[192:195], v50
v_mfma_f32_16x16x32_bf16 v[72:75], v[184:187], v[184:187], v[72:75]
ds_read_b128 v[200:203], v51
buffer_load_dwordx4 v48, s[8:11], s48 offen offset:1024 lds
v_mfma_f32_16x16x32_bf16 v[76:79], v[180:183], v[180:183], v[76:79]
s_add_u32 m0, s47, 52224
ds_read_b128 v[196:199], v50 offset:8192
v_mfma_f32_16x16x32_bf16 v[76:79], v[188:191], v[188:191], v[76:79]
ds_read_b128 v[204:207], v51 offset:8192
buffer_load_dwordx4 v49, s[8:11], s48 offen offset:1024 lds
v_mfma_f32_16x16x32_bf16 v[64:67], a[96:99], a[176:179], v[64:67]
s_add_u32 m0, s47, 56320
ds_read_b128 a[192:195], v52
v_mfma_f32_16x16x32_bf16 v[64:67], a[96:99], a[184:187], v[64:67]
ds_read_b128 a[200:203], v53
buffer_load_dwordx4 v48, s[8:11], s49 offen offset:1024 lds
v_mfma_f32_16x16x32_bf16 v[68:71], a[96:99], a[180:183], v[68:71]
s_add_u32 m0, s47, 60416
ds_read_b128 a[196:199], v52 offset:8192
v_mfma_f32_16x16x32_bf16 v[68:71], a[96:99], a[188:191], v[68:71]
s_waitcnt lgkmcnt(5)
ds_read_b128 a[204:207], v53 offset:8192
buffer_load_dwordx4 v49, s[8:11], s49 offen offset:1024 lds
v_mfma_f32_16x16x32_bf16 v[56:59], a[96:99], v[192:195], v[56:59]
v_mfma_f32_16x16x32_bf16 v[56:59], a[96:99], v[200:203], v[56:59]
s_waitcnt lgkmcnt(4)
buffer_load_dword v0, v27, s[16:19], s5 offen
v_mfma_f32_16x16x32_bf16 v[60:63], a[96:99], v[196:199], v[60:63]
v_mfma_f32_16x16x32_bf16 v[60:63], a[96:99], v[204:207], v[60:63]
buffer_load_dword v0, v27, s[20:23], s5 offen
s_waitcnt vmcnt(10) lgkmcnt(0)
s_barrier
v_mfma_f32_16x16x32_bf16 v[72:75], v[192:195], v[192:195], v[72:75]
s_add_u32 m0, s47, 65536
ds_read_b128 v[208:211], v50 offset:16384
v_mfma_f32_16x16x32_bf16 v[72:75], v[200:203], v[200:203], v[72:75]
ds_read_b128 v[216:219], v51 offset:16384
buffer_load_dwordx4 v6, s[16:19], 0 offen lds
v_mfma_f32_16x16x32_bf16 v[76:79], v[196:199], v[196:199], v[76:79]
s_add_u32 m0, s47, 69632
ds_read_b128 v[212:215], v50 offset:24576
v_mfma_f32_16x16x32_bf16 v[76:79], v[204:207], v[204:207], v[76:79]
ds_read_b128 v[220:223], v51 offset:24576
buffer_load_dwordx4 v6, s[20:23], 0 offen lds
v_mfma_f32_16x16x32_bf16 v[64:67], a[96:99], a[192:195], v[64:67]
ds_read_b128 a[208:211], v52 offset:16384
v_mfma_f32_16x16x32_bf16 v[64:67], a[96:99], a[200:203], v[64:67]
ds_read_b128 a[216:219], v53 offset:16384
v_mfma_f32_16x16x32_bf16 v[68:71], a[96:99], a[196:199], v[68:71]
ds_read_b128 a[212:215], v52 offset:24576
v_mfma_f32_16x16x32_bf16 v[68:71], a[96:99], a[204:207], v[68:71]
s_waitcnt lgkmcnt(5)
ds_read_b128 a[220:223], v53 offset:24576
v_mfma_f32_16x16x32_bf16 v[56:59], a[96:99], v[208:211], v[56:59]
v_mfma_f32_16x16x32_bf16 v[56:59], a[96:99], v[216:219], v[56:59]
s_waitcnt lgkmcnt(4)
v_mfma_f32_16x16x32_bf16 v[60:63], a[96:99], v[212:215], v[60:63]
v_mfma_f32_16x16x32_bf16 v[60:63], a[96:99], v[220:223], v[60:63]
s_waitcnt vmcnt(8) lgkmcnt(0)
s_barrier
v_mfma_f32_16x16x32_bf16 v[72:75], v[208:211], v[208:211], v[72:75]
ds_read_b128 v[224:227], v50 offset:32768
v_mfma_f32_16x16x32_bf16 v[72:75], v[216:219], v[216:219], v[72:75]
ds_read_b128 v[232:235], v51 offset:32768
v_mfma_f32_16x16x32_bf16 v[76:79], v[212:215], v[212:215], v[76:79]
ds_read_b128 v[228:231], v50 offset:40960
v_mfma_f32_16x16x32_bf16 v[76:79], v[220:223], v[220:223], v[76:79]
ds_read_b128 v[236:239], v51 offset:40960
v_mfma_f32_16x16x32_bf16 v[64:67], a[96:99], a[208:211], v[64:67]
ds_read_b128 a[224:227], v52 offset:32768
v_mfma_f32_16x16x32_bf16 v[64:67], a[96:99], a[216:219], v[64:67]
ds_read_b128 a[232:235], v53 offset:32768
v_mfma_f32_16x16x32_bf16 v[68:71], a[96:99], a[212:215], v[68:71]
ds_read_b128 a[228:231], v52 offset:40960
v_mfma_f32_16x16x32_bf16 v[68:71], a[96:99], a[220:223], v[68:71]
s_waitcnt lgkmcnt(5)
ds_read_b128 a[236:239], v53 offset:40960
v_mfma_f32_16x16x32_bf16 v[56:59], a[96:99], v[224:227], v[56:59]
v_mfma_f32_16x16x32_bf16 v[56:59], a[96:99], v[232:235], v[56:59]
s_waitcnt lgkmcnt(4)
v_mfma_f32_16x16x32_bf16 v[60:63], a[96:99], v[228:231], v[60:63]
v_mfma_f32_16x16x32_bf16 v[60:63], a[96:99], v[236:239], v[60:63]
s_waitcnt vmcnt(4) lgkmcnt(0)
s_barrier
v_mfma_f32_16x16x32_bf16 v[72:75], v[224:227], v[224:227], v[72:75]
ds_read_b128 v[240:243], v50 offset:49152
v_add_u32 v6, 0x48000, v6
v_mfma_f32_16x16x32_bf16 v[72:75], v[232:235], v[232:235], v[72:75]
s_add_u32 m0, s47, 73728
ds_read_b128 v[248:251], v51 offset:49152
v_mfma_f32_16x16x32_bf16 v[76:79], v[228:231], v[228:231], v[76:79]
ds_read_b128 v[244:247], v50 offset:57344
buffer_load_dwordx4 v6, s[16:19], 0 offen lds
v_mfma_f32_16x16x32_bf16 v[76:79], v[236:239], v[236:239], v[76:79]
s_add_u32 m0, s47, 77824
ds_read_b128 v[252:255], v51 offset:57344
v_mfma_f32_16x16x32_bf16 v[64:67], a[96:99], a[224:227], v[64:67]
ds_read_b128 a[240:243], v52 offset:49152
buffer_load_dwordx4 v6, s[20:23], 0 offen lds
v_mfma_f32_16x16x32_bf16 v[64:67], a[96:99], a[232:235], v[64:67]
ds_read_b128 a[248:251], v53 offset:49152
v_mfma_f32_16x16x32_bf16 v[68:71], a[96:99], a[228:231], v[68:71]
ds_read_b128 a[244:247], v52 offset:57344
v_mfma_f32_16x16x32_bf16 v[68:71], a[96:99], a[236:239], v[68:71]
s_waitcnt lgkmcnt(5)
ds_read_b128 a[252:255], v53 offset:57344
v_mfma_f32_16x16x32_bf16 v[56:59], a[96:99], v[240:243], v[56:59]
v_mfma_f32_16x16x32_bf16 v[56:59], a[96:99], v[248:251], v[56:59]
s_waitcnt lgkmcnt(4)
v_mfma_f32_16x16x32_bf16 v[60:63], a[96:99], v[244:247], v[60:63]
v_mfma_f32_16x16x32_bf16 v[60:63], a[96:99], v[252:255], v[60:63]
s_waitcnt lgkmcnt(3)
v_mfma_f32_16x16x32_bf16 v[64:67], a[96:99], a[240:243], v[64:67]
s_waitcnt lgkmcnt(2)
v_mfma_f32_16x16x32_bf16 v[64:67], a[96:99], a[248:251], v[64:67]
s_waitcnt lgkmcnt(1)
v_mfma_f32_16x16x32_bf16 v[68:71], a[96:99], a[244:247], v[68:71]
v_mul_f32 v56, 3135475257, v56
v_mul_f32 v57, 3135475257, v57
v_mul_f32 v58, 3135475257, v58
s_waitcnt lgkmcnt(0)
v_mfma_f32_16x16x32_bf16 v[68:71], a[96:99], a[252:255], v[68:71]
v_mul_f32 v59, 3135475257, v59
v_mul_f32 v60, 3135475257, v60
v_mul_f32 v61, 3135475257, v61
v_mfma_f32_16x16x32_bf16 v[72:75], v[240:243], v[240:243], v[72:75]
v_mul_f32 v62, 3135475257, v62
v_mul_f32 v63, 3135475257, v63
v_mul_f32 v64, 3135475257, v64
v_mfma_f32_16x16x32_bf16 v[72:75], v[248:251], v[248:251], v[72:75]
v_mul_f32 v65, 3135475257, v65
v_mul_f32 v66, 3135475257, v66
v_mul_f32 v67, 3135475257, v67
v_mfma_f32_16x16x32_bf16 v[76:79], v[244:247], v[244:247], v[76:79]
v_mul_f32 v68, 3135475257, v68
v_mul_f32 v69, 3135475257, v69
v_mul_f32 v70, 3135475257, v70
v_mfma_f32_16x16x32_bf16 v[76:79], v[252:255], v[252:255], v[76:79]
v_mul_f32 v71, 3135475257, v71
v_add_u32 v6, 0x48000, v6
s_add_u32 m0, s47, 81920
v_mfma_f32_4x4x4_16b_bf16 v[32:35], a[104:105], v[112:113], v[56:59]
buffer_load_dwordx4 v6, s[16:19], 0 offen lds
v_mfma_f32_4x4x4_16b_bf16 v[36:39], a[104:105], v[114:115], v[56:59]
s_add_u32 m0, s47, 86016
v_mfma_f32_4x4x4_16b_bf16 v[40:43], a[104:105], v[116:117], v[60:63]
buffer_load_dwordx4 v6, s[20:23], 0 offen lds
v_mfma_f32_4x4x4_16b_bf16 v[44:47], a[104:105], v[118:119], v[60:63]
v_cvt_pk_bf16_f32 v112, v32, v33
v_cvt_pk_bf16_f32 v113, v34, v35
v_add_u32 v6, 0x48000, v6
s_add_u32 m0, s47, 90112
v_mfma_f32_4x4x4_16b_bf16 v[88:91], a[104:105], a[112:113], v[64:67]
buffer_load_dwordx4 v6, s[16:19], 0 offen lds
v_cvt_pk_bf16_f32 v114, v36, v37
v_cvt_pk_bf16_f32 v115, v38, v39
v_mfma_f32_4x4x4_16b_bf16 v[92:95], a[104:105], a[114:115], v[64:67]
v_cvt_pk_bf16_f32 v116, v40, v41
v_cvt_pk_bf16_f32 v117, v42, v43
s_add_u32 m0, s47, 94208
v_mfma_f32_4x4x4_16b_bf16 v[96:99], a[104:105], a[116:117], v[68:71]
buffer_load_dwordx4 v6, s[20:23], 0 offen lds
v_cvt_pk_bf16_f32 v118, v44, v45
v_cvt_pk_bf16_f32 v119, v46, v47
v_mfma_f32_4x4x4_16b_bf16 v[100:103], a[104:105], a[118:119], v[68:71]
v_cvt_pk_bf16_f32 v88, v88, v89
v_cvt_pk_bf16_f32 v90, v90, v91
v_accvgpr_write_b32 a112, v88
v_accvgpr_write_b32 a113, v90
v_add_u32 v6, 0x48000, v6
s_add_u32 m0, s47, 98304
v_mfma_f32_4x4x4_16b_bf16 v[32:35], a[104:105], v[120:121], v[56:59]
buffer_load_dwordx4 v6, s[16:19], 0 offen lds
v_cvt_pk_bf16_f32 v92, v92, v93
v_cvt_pk_bf16_f32 v94, v94, v95
v_accvgpr_write_b32 a114, v92
v_accvgpr_write_b32 a115, v94
v_mfma_f32_4x4x4_16b_bf16 v[36:39], a[104:105], v[122:123], v[56:59]
v_cvt_pk_bf16_f32 v96, v96, v97
v_cvt_pk_bf16_f32 v98, v98, v99
v_accvgpr_write_b32 a116, v96
v_accvgpr_write_b32 a117, v98
s_add_u32 m0, s47, 102400
v_mfma_f32_4x4x4_16b_bf16 v[40:43], a[104:105], v[124:125], v[60:63]
buffer_load_dwordx4 v6, s[20:23], 0 offen lds
v_cvt_pk_bf16_f32 v100, v100, v101
v_cvt_pk_bf16_f32 v102, v102, v103
v_accvgpr_write_b32 a118, v100
v_accvgpr_write_b32 a119, v102
v_mfma_f32_4x4x4_16b_bf16 v[44:47], a[104:105], v[126:127], v[60:63]
v_cvt_pk_bf16_f32 v120, v32, v33
v_cvt_pk_bf16_f32 v121, v34, v35
v_mfma_f32_4x4x4_16b_bf16 v[88:91], a[104:105], a[120:121], v[64:67]
v_cvt_pk_bf16_f32 v122, v36, v37
s_waitcnt vmcnt(6)
s_barrier
v_add_u32 v2, 0x10000, v2
ds_read_b64_tr_b16 a[0:1], v2
ds_read_b64_tr_b16 a[2:3], v2 offset:2048
ds_read_b64_tr_b16 a[4:5], v2 offset:8192
ds_read_b64_tr_b16 a[6:7], v2 offset:10240
v_cvt_pk_bf16_f32 v123, v38, v39
v_mfma_f32_4x4x4_16b_bf16 v[92:95], a[104:105], a[122:123], v[64:67]
v_cvt_pk_bf16_f32 v124, v40, v41
v_cvt_pk_bf16_f32 v125, v42, v43
v_mfma_f32_4x4x4_16b_bf16 v[96:99], a[104:105], a[124:125], v[68:71]
v_cvt_pk_bf16_f32 v126, v44, v45
v_cvt_pk_bf16_f32 v127, v46, v47
v_mfma_f32_4x4x4_16b_bf16 v[100:103], a[104:105], a[126:127], v[68:71]
v_cvt_pk_bf16_f32 v88, v88, v89
v_cvt_pk_bf16_f32 v90, v90, v91
v_accvgpr_write_b32 a120, v88
v_accvgpr_write_b32 a121, v90
v_cvt_pk_bf16_f32 v92, v92, v93
v_cvt_pk_bf16_f32 v94, v94, v95
v_accvgpr_write_b32 a122, v92
v_accvgpr_write_b32 a123, v94
v_cvt_pk_bf16_f32 v96, v96, v97
v_cvt_pk_bf16_f32 v98, v98, v99
v_accvgpr_write_b32 a124, v96
v_accvgpr_write_b32 a125, v98
v_cvt_pk_bf16_f32 v100, v100, v101
v_cvt_pk_bf16_f32 v102, v102, v103
v_accvgpr_write_b32 a126, v100
v_accvgpr_write_b32 a127, v102
s_waitcnt lgkmcnt(0)
v_mfma_f32_16x16x32_bf16 a[32:35], a[0:3], v[112:115], 0
s_mul_i32 s50, s46, 6
ds_read_b64_tr_b16 a[16:17], v2 offset:4096
v_add_u32 v3, 0x10000, v3
v_mfma_f32_16x16x32_bf16 a[32:35], a[4:7], v[120:123], a[32:35]
s_nop 0
s_add_u32 m0, s47, 106496
ds_read_b64_tr_b16 a[18:19], v2 offset:6144
v_add_u32 v6, 0x48000, v6
v_mfma_f32_4x4x4_16b_bf16 v[32:35], a[104:105], v[128:129], v[56:59]
v_mfma_f32_4x4x4_16b_bf16 v[36:39], a[104:105], v[130:131], v[56:59]
v_mfma_f32_4x4x4_16b_bf16 v[40:43], a[104:105], v[132:133], v[60:63]
v_mfma_f32_4x4x4_16b_bf16 v[44:47], a[104:105], v[134:135], v[60:63]
v_mfma_f32_4x4x4_16b_bf16 v[88:91], a[104:105], a[128:129], v[64:67]
v_mfma_f32_4x4x4_16b_bf16 v[92:95], a[104:105], a[130:131], v[64:67]
v_cvt_pk_bf16_f32 v128, v32, v33
v_mfma_f32_4x4x4_16b_bf16 v[96:99], a[104:105], a[132:133], v[68:71]
v_cvt_pk_bf16_f32 v129, v34, v35
v_mfma_f32_4x4x4_16b_bf16 v[100:103], a[104:105], a[134:135], v[68:71]
v_cvt_pk_bf16_f32 v130, v36, v37
v_cvt_pk_bf16_f32 v131, v38, v39
v_mfma_f32_16x16x32_bf16 a[36:39], a[4:7], v[124:127], 0
s_mul_i32 s48, s7, 155648
ds_read_b64_tr_b16 a[20:21], v2 offset:12288
buffer_load_dwordx4 v6, s[16:19], 0 offen lds
v_mfma_f32_16x16x32_bf16 a[36:39], a[0:3], v[116:119], a[36:39]
s_add_u32 m0, s47, 110592
ds_read_b64_tr_b16 a[22:23], v2 offset:14336
v_cvt_pk_bf16_f32 v132, v40, v41
v_mfma_f32_16x16x32_bf16 a[40:43], a[0:3], a[112:115], 0
s_add_u32 s48, s48, s55
v_cvt_pk_bf16_f32 v133, v42, v43
v_cvt_pk_bf16_f32 v134, v44, v45
v_mfma_f32_16x16x32_bf16 a[40:43], a[4:7], a[120:123], a[40:43]
s_mul_i32 s49, s7, 0xffffed00
v_cvt_pk_bf16_f32 v135, v46, v47
v_cvt_pk_bf16_f32 v88, v88, v89
v_mfma_f32_16x16x32_bf16 a[44:47], a[4:7], a[124:127], 0
s_add_u32 s49, s49, 2432
buffer_load_dwordx4 v6, s[20:23], 0 offen lds
v_mfma_f32_16x16x32_bf16 a[44:47], a[0:3], a[116:119], a[44:47]
s_waitcnt lgkmcnt(0)
v_add_u32 v6, 0x48000, v6
v_cvt_pk_bf16_f32 v90, v90, v91
v_mfma_f32_16x16x32_bf16 a[48:51], a[16:19], v[112:115], 0
s_add_u32 m0, s47, 114688
ds_read_b64_tr_b16 a[0:1], v3
v_accvgpr_write_b32 a128, v88
v_mfma_f32_16x16x32_bf16 a[48:51], a[20:23], v[120:123], a[48:51]
ds_read_b64_tr_b16 a[2:3], v3 offset:2048
v_accvgpr_write_b32 a129, v90
v_mfma_f32_16x16x32_bf16 a[52:55], a[20:23], v[124:127], 0
ds_read_b64_tr_b16 a[4:5], v3 offset:8192
buffer_load_dwordx4 v6, s[16:19], 0 offen lds
v_mfma_f32_16x16x32_bf16 a[52:55], a[16:19], v[116:119], a[52:55]
s_add_u32 m0, s47, 118784
ds_read_b64_tr_b16 a[6:7], v3 offset:10240
v_cvt_pk_bf16_f32 v92, v92, v93
v_mfma_f32_16x16x32_bf16 a[56:59], a[16:19], a[112:115], 0
v_cvt_pk_bf16_f32 v94, v94, v95
v_accvgpr_write_b32 a130, v92
v_mfma_f32_16x16x32_bf16 a[56:59], a[20:23], a[120:123], a[56:59]
v_accvgpr_write_b32 a131, v94
v_cvt_pk_bf16_f32 v96, v96, v97
v_mfma_f32_16x16x32_bf16 a[60:63], a[20:23], a[124:127], 0
v_cvt_pk_bf16_f32 v98, v98, v99
v_accvgpr_write_b32 a132, v96
v_mfma_f32_16x16x32_bf16 a[60:63], a[16:19], a[116:119], a[60:63]
s_waitcnt lgkmcnt(0)
buffer_load_dwordx4 v6, s[20:23], 0 offen lds
v_mfma_f32_16x16x32_bf16 a[64:67], a[0:3], v[112:115], 0
s_add_u32 m0, s47, 122880
ds_read_b64_tr_b16 a[16:17], v3 offset:4096
v_add_u32 v6, 0x48000, v6
v_mfma_f32_16x16x32_bf16 a[64:67], a[4:7], v[120:123], a[64:67]
s_nop 0
ds_read_b64_tr_b16 a[18:19], v3 offset:6144
v_accvgpr_write_b32 a133, v98
v_mfma_f32_4x4x4_16b_bf16 v[32:35], a[104:105], v[136:137], v[56:59]
v_cvt_pk_bf16_f32 v100, v100, v101
v_mfma_f32_4x4x4_16b_bf16 v[36:39], a[104:105], v[138:139], v[56:59]
v_cvt_pk_bf16_f32 v102, v102, v103
v_mfma_f32_4x4x4_16b_bf16 v[40:43], a[104:105], v[140:141], v[60:63]
v_accvgpr_write_b32 a134, v100
v_mfma_f32_4x4x4_16b_bf16 v[44:47], a[104:105], v[142:143], v[60:63]
v_accvgpr_write_b32 a135, v102
v_mfma_f32_4x4x4_16b_bf16 v[88:91], a[104:105], a[136:137], v[64:67]
v_mfma_f32_4x4x4_16b_bf16 v[92:95], a[104:105], a[138:139], v[64:67]
v_cvt_pk_bf16_f32 v136, v32, v33
v_mfma_f32_4x4x4_16b_bf16 v[96:99], a[104:105], a[140:141], v[68:71]
v_cvt_pk_bf16_f32 v137, v34, v35
v_mfma_f32_4x4x4_16b_bf16 v[100:103], a[104:105], a[142:143], v[68:71]
v_cvt_pk_bf16_f32 v138, v36, v37
v_cvt_pk_bf16_f32 v139, v38, v39
v_mfma_f32_16x16x32_bf16 a[68:71], a[4:7], v[124:127], 0
ds_read_b64_tr_b16 a[20:21], v3 offset:12288
buffer_load_dwordx4 v6, s[16:19], 0 offen lds
v_mfma_f32_16x16x32_bf16 a[68:71], a[0:3], v[116:119], a[68:71]
s_add_u32 m0, s47, 126976
ds_read_b64_tr_b16 a[22:23], v3 offset:14336
v_cvt_pk_bf16_f32 v140, v40, v41
v_mfma_f32_16x16x32_bf16 a[72:75], a[0:3], a[112:115], 0
v_cvt_pk_bf16_f32 v141, v42, v43
v_cvt_pk_bf16_f32 v142, v44, v45
v_mfma_f32_16x16x32_bf16 a[72:75], a[4:7], a[120:123], a[72:75]
v_cvt_pk_bf16_f32 v143, v46, v47
v_cvt_pk_bf16_f32 v88, v88, v89
v_mfma_f32_16x16x32_bf16 a[76:79], a[4:7], a[124:127], 0
v_cvt_pk_bf16_f32 v90, v90, v91
v_accvgpr_write_b32 a136, v88
v_mfma_f32_16x16x32_bf16 a[76:79], a[0:3], a[116:119], a[76:79]
s_waitcnt vmcnt(7) lgkmcnt(0)
buffer_load_dwordx4 v6, s[20:23], 0 offen lds
v_mfma_f32_16x16x32_bf16 a[80:83], a[16:19], v[112:115], 0
s_barrier
ds_read_b64_tr_b16 a[0:1], v2 offset:16384
v_add_u32 v6, 0x48000, v6
v_mfma_f32_16x16x32_bf16 a[80:83], a[20:23], v[120:123], a[80:83]
s_add_u32 m0, s47, 131072
ds_read_b64_tr_b16 a[2:3], v2 offset:18432
v_accvgpr_write_b32 a137, v90
v_mfma_f32_16x16x32_bf16 a[84:87], a[20:23], v[124:127], 0
ds_read_b64_tr_b16 a[4:5], v2 offset:24576
v_cvt_pk_bf16_f32 v92, v92, v93
v_mfma_f32_16x16x32_bf16 a[84:87], a[16:19], v[116:119], a[84:87]
ds_read_b64_tr_b16 a[6:7], v2 offset:26624
v_cvt_pk_bf16_f32 v94, v94, v95
v_mfma_f32_16x16x32_bf16 a[88:91], a[16:19], a[112:115], 0
v_accvgpr_write_b32 a138, v92
v_accvgpr_write_b32 a139, v94
v_mfma_f32_16x16x32_bf16 a[88:91], a[20:23], a[120:123], a[88:91]
buffer_load_dwordx4 v6, s[16:19], 0 offen lds
v_mfma_f32_16x16x32_bf16 a[92:95], a[20:23], a[124:127], 0
s_add_u32 m0, s47, 135168
v_cvt_pk_bf16_f32 v96, v96, v97
v_cvt_pk_bf16_f32 v98, v98, v99
v_mfma_f32_16x16x32_bf16 a[92:95], a[16:19], a[116:119], a[92:95]
s_waitcnt lgkmcnt(0)
v_accvgpr_write_b32 a140, v96
v_accvgpr_write_b32 a141, v98
v_mfma_f32_16x16x32_bf16 a[32:35], a[0:3], v[128:131], a[32:35]
ds_read_b64_tr_b16 a[16:17], v2 offset:20480
v_cvt_pk_bf16_f32 v100, v100, v101
v_mfma_f32_16x16x32_bf16 a[32:35], a[4:7], v[136:139], a[32:35]
s_nop 0
ds_read_b64_tr_b16 a[18:19], v2 offset:22528
v_cvt_pk_bf16_f32 v102, v102, v103
v_mfma_f32_4x4x4_16b_bf16 v[32:35], a[104:105], v[144:145], v[56:59]
v_accvgpr_write_b32 a142, v100
v_mfma_f32_4x4x4_16b_bf16 v[36:39], a[104:105], v[146:147], v[56:59]
v_accvgpr_write_b32 a143, v102
v_mfma_f32_4x4x4_16b_bf16 v[40:43], a[104:105], v[148:149], v[60:63]
v_mfma_f32_4x4x4_16b_bf16 v[44:47], a[104:105], v[150:151], v[60:63]
v_mfma_f32_4x4x4_16b_bf16 v[88:91], a[104:105], a[144:145], v[64:67]
v_mfma_f32_4x4x4_16b_bf16 v[92:95], a[104:105], a[146:147], v[64:67]
v_cvt_pk_bf16_f32 v144, v32, v33
v_mfma_f32_4x4x4_16b_bf16 v[96:99], a[104:105], a[148:149], v[68:71]
v_cvt_pk_bf16_f32 v145, v34, v35
v_mfma_f32_4x4x4_16b_bf16 v[100:103], a[104:105], a[150:151], v[68:71]
v_cvt_pk_bf16_f32 v146, v36, v37
v_cvt_pk_bf16_f32 v147, v38, v39
v_mfma_f32_16x16x32_bf16 a[36:39], a[4:7], v[140:143], a[36:39]
ds_read_b64_tr_b16 a[20:21], v2 offset:28672
buffer_load_dwordx4 v6, s[20:23], 0 offen lds
v_mfma_f32_16x16x32_bf16 a[36:39], a[0:3], v[132:135], a[36:39]
s_add_u32 m0, s47, 139264
ds_read_b64_tr_b16 a[22:23], v2 offset:30720
v_add_u32 v6, 0x48000, v6
v_mfma_f32_16x16x32_bf16 a[40:43], a[0:3], a[128:131], a[40:43]
buffer_load_dword v0, v111, s[12:15], 0 offen
v_mfma_f32_16x16x32_bf16 a[40:43], a[4:7], a[136:139], a[40:43]
v_cvt_pk_bf16_f32 v148, v40, v41
v_cvt_pk_bf16_f32 v149, v42, v43
v_cvt_pk_bf16_f32 v96, v96, v97
v_mfma_f32_16x16x32_bf16 a[44:47], a[4:7], a[140:143], a[44:47]
v_cvt_pk_bf16_f32 v150, v44, v45
v_cvt_pk_bf16_f32 v151, v46, v47
v_cvt_pk_bf16_f32 v98, v98, v99
v_mfma_f32_16x16x32_bf16 a[44:47], a[0:3], a[132:135], a[44:47]
s_waitcnt lgkmcnt(0)
v_cvt_pk_bf16_f32 v88, v88, v89
v_cvt_pk_bf16_f32 v90, v90, v91
v_cvt_pk_bf16_f32 v100, v100, v101
v_mfma_f32_16x16x32_bf16 a[48:51], a[16:19], v[128:131], a[48:51]
ds_read_b64_tr_b16 a[0:1], v3 offset:16384
v_accvgpr_write_b32 a144, v88
v_cvt_pk_bf16_f32 v102, v102, v103
v_mfma_f32_16x16x32_bf16 a[48:51], a[20:23], v[136:139], a[48:51]
s_nop 0
ds_read_b64_tr_b16 a[2:3], v3 offset:18432
v_accvgpr_write_b32 a145, v90
v_accvgpr_write_b32 a150, v100
v_mfma_f32_4x4x4_16b_bf16 v[32:35], a[104:105], v[152:153], v[56:59]
v_cvt_pk_bf16_f32 v92, v92, v93
v_mfma_f32_4x4x4_16b_bf16 v[36:39], a[104:105], v[154:155], v[56:59]
v_cvt_pk_bf16_f32 v94, v94, v95
v_mfma_f32_4x4x4_16b_bf16 v[40:43], a[104:105], v[156:157], v[60:63]
v_accvgpr_write_b32 a146, v92
v_mfma_f32_4x4x4_16b_bf16 v[44:47], a[104:105], v[158:159], v[60:63]
v_accvgpr_write_b32 a147, v94
v_mfma_f32_4x4x4_16b_bf16 v[88:91], a[104:105], a[152:153], v[64:67]
v_accvgpr_write_b32 a148, v96
v_mfma_f32_4x4x4_16b_bf16 v[92:95], a[104:105], a[154:155], v[64:67]
v_accvgpr_write_b32 a149, v98
v_mfma_f32_4x4x4_16b_bf16 v[96:99], a[104:105], a[156:157], v[68:71]
v_accvgpr_write_b32 a151, v102
v_mfma_f32_4x4x4_16b_bf16 v[100:103], a[104:105], a[158:159], v[68:71]
v_cvt_pk_bf16_f32 v152, v32, v33
v_cvt_pk_bf16_f32 v153, v34, v35
v_mfma_f32_16x16x32_bf16 a[52:55], a[20:23], v[140:143], a[52:55]
ds_read_b64_tr_b16 a[4:5], v3 offset:24576
v_cvt_pk_bf16_f32 v154, v36, v37
v_mfma_f32_16x16x32_bf16 a[52:55], a[16:19], v[132:135], a[52:55]
ds_read_b64_tr_b16 a[6:7], v3 offset:26624
v_cvt_pk_bf16_f32 v155, v38, v39
v_mfma_f32_16x16x32_bf16 a[56:59], a[16:19], a[128:131], a[56:59]
v_cvt_pk_bf16_f32 v156, v40, v41
v_cvt_pk_bf16_f32 v157, v42, v43
v_mfma_f32_16x16x32_bf16 a[56:59], a[20:23], a[136:139], a[56:59]
v_cvt_pk_bf16_f32 v158, v44, v45
v_cvt_pk_bf16_f32 v159, v46, v47
v_cvt_pk_bf16_f32 v100, v100, v101
v_mfma_f32_16x16x32_bf16 a[60:63], a[20:23], a[140:143], a[60:63]
v_cvt_pk_bf16_f32 v88, v88, v89
v_cvt_pk_bf16_f32 v90, v90, v91
v_cvt_pk_bf16_f32 v102, v102, v103
v_mfma_f32_16x16x32_bf16 a[60:63], a[16:19], a[132:135], a[60:63]
s_waitcnt lgkmcnt(0)
v_accvgpr_write_b32 a152, v88
v_accvgpr_write_b32 a153, v90
v_accvgpr_write_b32 a158, v100
v_mfma_f32_16x16x32_bf16 a[64:67], a[0:3], v[128:131], a[64:67]
ds_read_b64_tr_b16 a[16:17], v3 offset:20480
v_cvt_pk_bf16_f32 v92, v92, v93
v_mfma_f32_16x16x32_bf16 a[64:67], a[4:7], v[136:139], a[64:67]
s_nop 0
ds_read_b64_tr_b16 a[18:19], v3 offset:22528
v_cvt_pk_bf16_f32 v94, v94, v95
v_mfma_f32_4x4x4_16b_bf16 v[32:35], a[104:105], v[160:161], v[56:59]
v_accvgpr_write_b32 a154, v92
v_mfma_f32_4x4x4_16b_bf16 v[36:39], a[104:105], v[162:163], v[56:59]
v_accvgpr_write_b32 a155, v94
v_mfma_f32_4x4x4_16b_bf16 v[40:43], a[104:105], v[164:165], v[60:63]
v_cvt_pk_bf16_f32 v96, v96, v97
v_mfma_f32_4x4x4_16b_bf16 v[44:47], a[104:105], v[166:167], v[60:63]
v_cvt_pk_bf16_f32 v98, v98, v99
v_mfma_f32_4x4x4_16b_bf16 v[88:91], a[104:105], a[160:161], v[64:67]
v_accvgpr_write_b32 a156, v96
v_mfma_f32_4x4x4_16b_bf16 v[92:95], a[104:105], a[162:163], v[64:67]
v_accvgpr_write_b32 a157, v98
v_mfma_f32_4x4x4_16b_bf16 v[96:99], a[104:105], a[164:165], v[68:71]
v_accvgpr_write_b32 a159, v102
v_mfma_f32_4x4x4_16b_bf16 v[100:103], a[104:105], a[166:167], v[68:71]
v_cvt_pk_bf16_f32 v160, v32, v33
v_cvt_pk_bf16_f32 v161, v34, v35
v_mfma_f32_16x16x32_bf16 a[68:71], a[4:7], v[140:143], a[68:71]
ds_read_b64_tr_b16 a[20:21], v3 offset:28672
v_cvt_pk_bf16_f32 v162, v36, v37
v_mfma_f32_16x16x32_bf16 a[68:71], a[0:3], v[132:135], a[68:71]
ds_read_b64_tr_b16 a[22:23], v3 offset:30720
v_cvt_pk_bf16_f32 v163, v38, v39
v_mfma_f32_16x16x32_bf16 a[72:75], a[0:3], a[128:131], a[72:75]
v_cvt_pk_bf16_f32 v164, v40, v41
v_cvt_pk_bf16_f32 v165, v42, v43
v_mfma_f32_16x16x32_bf16 a[72:75], a[4:7], a[136:139], a[72:75]
v_cvt_pk_bf16_f32 v166, v44, v45
L_pad1:
s_cbranch_execz L_pad5
v_cvt_pk_bf16_f32 v167, v46, v47
v_mfma_f32_16x16x32_bf16 a[76:79], a[4:7], a[140:143], a[76:79]
v_cvt_pk_bf16_f32 v88, v88, v89
v_cvt_pk_bf16_f32 v90, v90, v91
v_mfma_f32_16x16x32_bf16 a[76:79], a[0:3], a[132:135], a[76:79]
s_waitcnt vmcnt(5) lgkmcnt(0)
v_accvgpr_write_b32 a160, v88
v_accvgpr_write_b32 a161, v90
v_mfma_f32_16x16x32_bf16 a[80:83], a[16:19], v[128:131], a[80:83]
s_barrier
ds_read_b64_tr_b16 a[0:1], v2 offset:32768
v_cvt_pk_bf16_f32 v92, v92, v93
v_mfma_f32_16x16x32_bf16 a[80:83], a[20:23], v[136:139], a[80:83]
ds_read_b64_tr_b16 a[2:3], v2 offset:34816
v_cvt_pk_bf16_f32 v94, v94, v95
v_mfma_f32_16x16x32_bf16 a[84:87], a[20:23], v[140:143], a[84:87]
ds_read_b64_tr_b16 a[4:5], v2 offset:40960
v_accvgpr_write_b32 a162, v92
v_mfma_f32_16x16x32_bf16 a[84:87], a[16:19], v[132:135], a[84:87]
ds_read_b64_tr_b16 a[6:7], v2 offset:43008
buffer_load_dwordx4 v6, s[16:19], 0 offen lds
v_mfma_f32_16x16x32_bf16 a[88:91], a[16:19], a[128:131], a[88:91]
s_add_u32 m0, s47, 143360
ds_read_b64_tr_b16 a[8:9], v2 offset:49152
v_accvgpr_write_b32 a163, v94
v_mfma_f32_16x16x32_bf16 a[88:91], a[20:23], a[136:139], a[88:91]
ds_read_b64_tr_b16 a[10:11], v2 offset:51200
v_cvt_pk_bf16_f32 v96, v96, v97
v_mfma_f32_16x16x32_bf16 a[92:95], a[20:23], a[140:143], a[92:95]
v_cvt_pk_bf16_f32 v98, v98, v99
v_accvgpr_write_b32 a164, v96
v_mfma_f32_16x16x32_bf16 a[92:95], a[16:19], a[132:135], a[92:95]
s_waitcnt lgkmcnt(0)
v_accvgpr_write_b32 a165, v98
v_cvt_pk_bf16_f32 v100, v100, v101
v_mfma_f32_16x16x32_bf16 a[32:35], a[0:3], v[144:147], a[32:35]
ds_read_b64_tr_b16 a[16:17], v2 offset:36864
v_cvt_pk_bf16_f32 v102, v102, v103
v_mfma_f32_16x16x32_bf16 a[32:35], a[4:7], v[152:155], a[32:35]
ds_read_b64_tr_b16 a[18:19], v2 offset:38912
buffer_load_dwordx4 v6, s[20:23], 0 offen lds
v_mfma_f32_16x16x32_bf16 a[32:35], a[8:11], v[160:163], a[32:35]
s_add_u32 m0, s47, 147456
ds_read_b64_tr_b16 a[20:21], v2 offset:45056
v_add_u32 v6, 0x48000, v6
v_mfma_f32_4x4x4_16b_bf16 v[32:35], a[104:105], v[168:169], v[56:59]
v_accvgpr_write_b32 a166, v100
v_mfma_f32_4x4x4_16b_bf16 v[36:39], a[104:105], v[170:171], v[56:59]
v_accvgpr_write_b32 a167, v102
v_mfma_f32_4x4x4_16b_bf16 v[40:43], a[104:105], v[172:173], v[60:63]
v_mfma_f32_4x4x4_16b_bf16 v[44:47], a[104:105], v[174:175], v[60:63]
v_mfma_f32_4x4x4_16b_bf16 v[88:91], a[104:105], a[168:169], v[64:67]
v_mfma_f32_4x4x4_16b_bf16 v[92:95], a[104:105], a[170:171], v[64:67]
v_cvt_pk_bf16_f32 v168, v32, v33
v_mfma_f32_4x4x4_16b_bf16 v[96:99], a[104:105], a[172:173], v[68:71]
v_cvt_pk_bf16_f32 v169, v34, v35
v_mfma_f32_4x4x4_16b_bf16 v[100:103], a[104:105], a[174:175], v[68:71]
v_cvt_pk_bf16_f32 v170, v36, v37
v_cvt_pk_bf16_f32 v171, v38, v39
v_mfma_f32_16x16x32_bf16 a[36:39], a[8:11], v[164:167], a[36:39]
ds_read_b64_tr_b16 a[22:23], v2 offset:47104
buffer_load_dwordx4 v6, s[16:19], 0 offen lds
v_mfma_f32_16x16x32_bf16 a[36:39], a[4:7], v[156:159], a[36:39]
s_add_u32 m0, s47, 151552
ds_read_b64_tr_b16 a[24:25], v2 offset:53248
v_cvt_pk_bf16_f32 v172, v40, v41
v_mfma_f32_16x16x32_bf16 a[36:39], a[0:3], v[148:151], a[36:39]
ds_read_b64_tr_b16 a[26:27], v2 offset:55296
v_cvt_pk_bf16_f32 v173, v42, v43
v_mfma_f32_16x16x32_bf16 a[40:43], a[0:3], a[144:147], a[40:43]
v_cvt_pk_bf16_f32 v174, v44, v45
v_cvt_pk_bf16_f32 v175, v46, v47
v_mfma_f32_16x16x32_bf16 a[40:43], a[4:7], a[152:155], a[40:43]
v_cvt_pk_bf16_f32 v88, v88, v89
v_cvt_pk_bf16_f32 v90, v90, v91
v_mfma_f32_16x16x32_bf16 a[40:43], a[8:11], a[160:163], a[40:43]
v_accvgpr_write_b32 a168, v88
v_accvgpr_write_b32 a169, v90
v_mfma_f32_16x16x32_bf16 a[44:47], a[8:11], a[164:167], a[44:47]
buffer_load_dwordx4 v6, s[20:23], 0 offen lds
v_mfma_f32_16x16x32_bf16 a[44:47], a[4:7], a[156:159], a[44:47]
s_add_u32 m0, s47, 155648
v_add_u32 v6, 0x48000, v6
v_cvt_pk_bf16_f32 v92, v92, v93
v_mfma_f32_16x16x32_bf16 a[44:47], a[0:3], a[148:151], a[44:47]
s_waitcnt lgkmcnt(0)
v_cvt_pk_bf16_f32 v94, v94, v95
v_accvgpr_write_b32 a170, v92
v_mfma_f32_16x16x32_bf16 a[48:51], a[16:19], v[144:147], a[48:51]
ds_read_b64_tr_b16 a[0:1], v3 offset:32768
v_accvgpr_write_b32 a171, v94
v_mfma_f32_16x16x32_bf16 a[48:51], a[20:23], v[152:155], a[48:51]
ds_read_b64_tr_b16 a[2:3], v3 offset:34816
v_cvt_pk_bf16_f32 v96, v96, v97
v_mfma_f32_16x16x32_bf16 a[48:51], a[24:27], v[160:163], a[48:51]
s_nop 0
ds_read_b64_tr_b16 a[4:5], v3 offset:40960
v_cvt_pk_bf16_f32 v98, v98, v99
v_mfma_f32_4x4x4_16b_bf16 v[32:35], a[104:105], v[176:177], v[56:59]
v_accvgpr_write_b32 a172, v96
v_mfma_f32_4x4x4_16b_bf16 v[36:39], a[104:105], v[178:179], v[56:59]
v_accvgpr_write_b32 a173, v98
v_mfma_f32_4x4x4_16b_bf16 v[40:43], a[104:105], v[180:181], v[60:63]
v_cvt_pk_bf16_f32 v100, v100, v101
v_mfma_f32_4x4x4_16b_bf16 v[44:47], a[104:105], v[182:183], v[60:63]
v_cvt_pk_bf16_f32 v102, v102, v103
v_mfma_f32_4x4x4_16b_bf16 v[88:91], a[104:105], a[176:177], v[64:67]
v_accvgpr_write_b32 a174, v100
v_mfma_f32_4x4x4_16b_bf16 v[92:95], a[104:105], a[178:179], v[64:67]
v_accvgpr_write_b32 a175, v102
v_mfma_f32_4x4x4_16b_bf16 v[96:99], a[104:105], a[180:181], v[68:71]
v_cvt_pk_bf16_f32 v176, v32, v33
v_mfma_f32_4x4x4_16b_bf16 v[100:103], a[104:105], a[182:183], v[68:71]
v_cvt_pk_bf16_f32 v177, v34, v35
v_cvt_pk_bf16_f32 v178, v36, v37
v_mfma_f32_16x16x32_bf16 a[52:55], a[24:27], v[164:167], a[52:55]
ds_read_b64_tr_b16 a[6:7], v3 offset:43008
buffer_load_dwordx4 v6, s[16:19], 0 offen lds
v_mfma_f32_16x16x32_bf16 a[52:55], a[20:23], v[156:159], a[52:55]
s_add_u32 m0, s47, 159744
ds_read_b64_tr_b16 a[8:9], v3 offset:49152
v_cvt_pk_bf16_f32 v179, v38, v39
v_mfma_f32_16x16x32_bf16 a[52:55], a[16:19], v[148:151], a[52:55]
ds_read_b64_tr_b16 a[10:11], v3 offset:51200
v_cvt_pk_bf16_f32 v180, v40, v41
v_mfma_f32_16x16x32_bf16 a[56:59], a[16:19], a[144:147], a[56:59]
v_cvt_pk_bf16_f32 v181, v42, v43
v_cvt_pk_bf16_f32 v182, v44, v45
v_cvt_pk_bf16_f32 v100, v100, v101
v_mfma_f32_16x16x32_bf16 a[56:59], a[20:23], a[152:155], a[56:59]
buffer_load_dwordx4 v6, s[20:23], 0 offen lds
v_mfma_f32_16x16x32_bf16 a[56:59], a[24:27], a[160:163], a[56:59]
s_add_u32 m0, s47, 0
v_add_u32 v6, 0x48000, v6
v_cvt_pk_bf16_f32 v183, v46, v47
v_cvt_pk_bf16_f32 v102, v102, v103
v_mfma_f32_16x16x32_bf16 a[60:63], a[24:27], a[164:167], a[60:63]
v_cvt_pk_bf16_f32 v88, v88, v89
v_cvt_pk_bf16_f32 v90, v90, v91
v_mfma_f32_16x16x32_bf16 a[60:63], a[20:23], a[156:159], a[60:63]
v_accvgpr_write_b32 a176, v88
v_accvgpr_write_b32 a177, v90
v_mfma_f32_16x16x32_bf16 a[60:63], a[16:19], a[148:151], a[60:63]
s_waitcnt lgkmcnt(0)
buffer_load_dwordx4 v6, s[16:19], 0 offen lds
v_mfma_f32_16x16x32_bf16 a[64:67], a[0:3], v[144:147], a[64:67]
s_add_u32 m0, s47, 4096
ds_read_b64_tr_b16 a[16:17], v3 offset:36864
v_cvt_pk_bf16_f32 v92, v92, v93
v_mfma_f32_16x16x32_bf16 a[64:67], a[4:7], v[152:155], a[64:67]
ds_read_b64_tr_b16 a[18:19], v3 offset:38912
v_cvt_pk_bf16_f32 v94, v94, v95
v_mfma_f32_16x16x32_bf16 a[64:67], a[8:11], v[160:163], a[64:67]
ds_read_b64_tr_b16 a[20:21], v3 offset:45056
v_accvgpr_write_b32 a178, v92
v_mfma_f32_4x4x4_16b_bf16 v[32:35], a[104:105], v[184:185], v[56:59]
v_accvgpr_write_b32 a179, v94
v_mfma_f32_4x4x4_16b_bf16 v[36:39], a[104:105], v[186:187], v[56:59]
v_cvt_pk_bf16_f32 v96, v96, v97
v_mfma_f32_4x4x4_16b_bf16 v[40:43], a[104:105], v[188:189], v[60:63]
v_cvt_pk_bf16_f32 v98, v98, v99
v_mfma_f32_4x4x4_16b_bf16 v[44:47], a[104:105], v[190:191], v[60:63]
v_accvgpr_write_b32 a180, v96
v_mfma_f32_4x4x4_16b_bf16 v[88:91], a[104:105], a[184:185], v[64:67]
v_accvgpr_write_b32 a181, v98
v_mfma_f32_4x4x4_16b_bf16 v[92:95], a[104:105], a[186:187], v[64:67]
v_accvgpr_write_b32 a182, v100
v_mfma_f32_4x4x4_16b_bf16 v[96:99], a[104:105], a[188:189], v[68:71]
v_accvgpr_write_b32 a183, v102
v_mfma_f32_4x4x4_16b_bf16 v[100:103], a[104:105], a[190:191], v[68:71]
v_cvt_pk_bf16_f32 v184, v32, v33
v_cvt_pk_bf16_f32 v185, v34, v35
v_mfma_f32_16x16x32_bf16 a[68:71], a[8:11], v[164:167], a[68:71]
ds_read_b64_tr_b16 a[22:23], v3 offset:47104
buffer_load_dwordx4 v6, s[20:23], 0 offen lds
v_mfma_f32_16x16x32_bf16 a[68:71], a[4:7], v[156:159], a[68:71]
s_add_u32 m0, s47, 8192
ds_read_b64_tr_b16 a[24:25], v3 offset:53248
v_add_u32 v6, 0x48000, v6
v_mfma_f32_16x16x32_bf16 a[68:71], a[0:3], v[148:151], a[68:71]
ds_read_b64_tr_b16 a[26:27], v3 offset:55296
v_cvt_pk_bf16_f32 v186, v36, v37
v_mfma_f32_16x16x32_bf16 a[72:75], a[0:3], a[144:147], a[72:75]
v_cvt_pk_bf16_f32 v187, v38, v39
v_cvt_pk_bf16_f32 v188, v40, v41
v_mfma_f32_16x16x32_bf16 a[72:75], a[4:7], a[152:155], a[72:75]
buffer_load_dwordx4 v6, s[16:19], 0 offen lds
v_mfma_f32_16x16x32_bf16 a[72:75], a[8:11], a[160:163], a[72:75]
s_add_u32 m0, s47, 12288
v_cvt_pk_bf16_f32 v189, v42, v43
v_cvt_pk_bf16_f32 v190, v44, v45
v_mfma_f32_16x16x32_bf16 a[76:79], a[8:11], a[164:167], a[76:79]
v_cvt_pk_bf16_f32 v191, v46, v47
v_cvt_pk_bf16_f32 v88, v88, v89
v_mfma_f32_16x16x32_bf16 a[76:79], a[4:7], a[156:159], a[76:79]
v_cvt_pk_bf16_f32 v90, v90, v91
v_accvgpr_write_b32 a184, v88
v_mfma_f32_16x16x32_bf16 a[76:79], a[0:3], a[148:151], a[76:79]
s_waitcnt vmcnt(7) lgkmcnt(0)
v_accvgpr_write_b32 a185, v90
v_cvt_pk_bf16_f32 v92, v92, v93
v_mfma_f32_16x16x32_bf16 a[80:83], a[16:19], v[144:147], a[80:83]
s_barrier
ds_read_b64_tr_b16 a[0:1], v2 offset:57344
v_cvt_pk_bf16_f32 v94, v94, v95
v_mfma_f32_16x16x32_bf16 a[80:83], a[20:23], v[152:155], a[80:83]
ds_read_b64_tr_b16 a[2:3], v2 offset:59392
v_add_u32 v2, 0x10000, v2
v_mfma_f32_16x16x32_bf16 a[80:83], a[24:27], v[160:163], a[80:83]
ds_read_b64_tr_b16 a[4:5], v2
buffer_load_dwordx4 v6, s[20:23], 0 offen lds
v_mfma_f32_16x16x32_bf16 a[84:87], a[24:27], v[164:167], a[84:87]
s_add_u32 m0, s47, 16384
ds_read_b64_tr_b16 a[6:7], v2 offset:2048
v_add_u32 v6, 0x48000, v6
v_mfma_f32_16x16x32_bf16 a[84:87], a[20:23], v[156:159], a[84:87]
ds_read_b64_tr_b16 a[8:9], v2 offset:8192
v_accvgpr_write_b32 a186, v92
v_mfma_f32_16x16x32_bf16 a[84:87], a[16:19], v[148:151], a[84:87]
ds_read_b64_tr_b16 a[10:11], v2 offset:10240
v_add_u32 v2, 0xffff0000, v2
v_mfma_f32_16x16x32_bf16 a[88:91], a[16:19], a[144:147], a[88:91]
v_accvgpr_write_b32 a187, v94
v_cvt_pk_bf16_f32 v96, v96, v97
v_mfma_f32_16x16x32_bf16 a[88:91], a[20:23], a[152:155], a[88:91]
buffer_load_dwordx4 v6, s[16:19], 0 offen lds
v_mfma_f32_16x16x32_bf16 a[88:91], a[24:27], a[160:163], a[88:91]
s_add_u32 m0, s47, 20480
v_cvt_pk_bf16_f32 v98, v98, v99
v_accvgpr_write_b32 a188, v96
v_mfma_f32_16x16x32_bf16 a[92:95], a[24:27], a[164:167], a[92:95]
v_accvgpr_write_b32 a189, v98
v_cvt_pk_bf16_f32 v100, v100, v101
v_mfma_f32_16x16x32_bf16 a[92:95], a[20:23], a[156:159], a[92:95]
v_cvt_pk_bf16_f32 v102, v102, v103
v_accvgpr_write_b32 a190, v100
v_mfma_f32_16x16x32_bf16 a[92:95], a[16:19], a[148:151], a[92:95]
s_waitcnt lgkmcnt(0)
v_accvgpr_write_b32 a191, v102
v_mfma_f32_16x16x32_bf16 a[32:35], a[0:3], v[168:171], a[32:35]
ds_read_b64_tr_b16 a[16:17], v2 offset:61440
v_mfma_f32_16x16x32_bf16 a[32:35], a[4:7], v[176:179], a[32:35]
ds_read_b64_tr_b16 a[18:19], v2 offset:63488
v_add_u32 v2, 0x10000, v2
v_mfma_f32_16x16x32_bf16 a[32:35], a[8:11], v[184:187], a[32:35]
s_nop 0
ds_read_b64_tr_b16 a[20:21], v2 offset:4096
buffer_load_dwordx4 v6, s[20:23], 0 offen lds
v_mfma_f32_4x4x4_16b_bf16 v[32:35], a[104:105], v[192:193], v[56:59]
v_add_u32 v6, 0x48000, v6
v_mfma_f32_4x4x4_16b_bf16 v[36:39], a[104:105], v[194:195], v[56:59]
s_add_u32 m0, s47, 24576
v_mfma_f32_4x4x4_16b_bf16 v[40:43], a[104:105], v[196:197], v[60:63]
v_mfma_f32_4x4x4_16b_bf16 v[44:47], a[104:105], v[198:199], v[60:63]
v_mfma_f32_4x4x4_16b_bf16 v[88:91], a[104:105], a[192:193], v[64:67]
v_mfma_f32_4x4x4_16b_bf16 v[92:95], a[104:105], a[194:195], v[64:67]
v_cvt_pk_bf16_f32 v192, v32, v33
v_mfma_f32_4x4x4_16b_bf16 v[96:99], a[104:105], a[196:197], v[68:71]
v_cvt_pk_bf16_f32 v193, v34, v35
v_mfma_f32_4x4x4_16b_bf16 v[100:103], a[104:105], a[198:199], v[68:71]
v_cvt_pk_bf16_f32 v194, v36, v37
v_cvt_pk_bf16_f32 v195, v38, v39
v_mfma_f32_16x16x32_bf16 a[36:39], a[8:11], v[188:191], a[36:39]
ds_read_b64_tr_b16 a[22:23], v2 offset:6144
buffer_load_dwordx4 v6, s[16:19], 0 offen lds
v_mfma_f32_16x16x32_bf16 a[36:39], a[4:7], v[180:183], a[36:39]
s_add_u32 m0, s47, 28672
ds_read_b64_tr_b16 a[24:25], v2 offset:12288
v_cvt_pk_bf16_f32 v196, v40, v41
v_mfma_f32_16x16x32_bf16 a[36:39], a[0:3], v[172:175], a[36:39]
ds_read_b64_tr_b16 a[26:27], v2 offset:14336
v_cvt_pk_bf16_f32 v197, v42, v43
v_mfma_f32_16x16x32_bf16 a[40:43], a[0:3], a[168:171], a[40:43]
v_cvt_pk_bf16_f32 v198, v44, v45
v_cvt_pk_bf16_f32 v199, v46, v47
v_mfma_f32_16x16x32_bf16 a[40:43], a[4:7], a[176:179], a[40:43]
v_cvt_pk_bf16_f32 v88, v88, v89
v_cvt_pk_bf16_f32 v90, v90, v91
v_mfma_f32_16x16x32_bf16 a[40:43], a[8:11], a[184:187], a[40:43]
v_accvgpr_write_b32 a192, v88
v_accvgpr_write_b32 a193, v90
v_mfma_f32_16x16x32_bf16 a[44:47], a[8:11], a[188:191], a[44:47]
buffer_load_dwordx4 v6, s[20:23], 0 offen lds
v_mfma_f32_16x16x32_bf16 a[44:47], a[4:7], a[180:183], a[44:47]
s_add_u32 m0, s47, 32768
v_add_u32 v6, 0x48000, v6
v_cvt_pk_bf16_f32 v92, v92, v93
v_mfma_f32_16x16x32_bf16 a[44:47], a[0:3], a[172:175], a[44:47]
s_waitcnt lgkmcnt(0)
v_cvt_pk_bf16_f32 v94, v94, v95
v_accvgpr_write_b32 a194, v92
v_mfma_f32_16x16x32_bf16 a[48:51], a[16:19], v[168:171], a[48:51]
ds_read_b64_tr_b16 a[0:1], v3 offset:57344
v_accvgpr_write_b32 a195, v94
v_mfma_f32_16x16x32_bf16 a[48:51], a[20:23], v[176:179], a[48:51]
ds_read_b64_tr_b16 a[2:3], v3 offset:59392
v_add_u32 v3, 0x10000, v3
v_mfma_f32_16x16x32_bf16 a[48:51], a[24:27], v[184:187], a[48:51]
s_nop 0
ds_read_b64_tr_b16 a[4:5], v3
v_cvt_pk_bf16_f32 v96, v96, v97
v_mfma_f32_4x4x4_16b_bf16 v[32:35], a[104:105], v[200:201], v[56:59]
v_cvt_pk_bf16_f32 v98, v98, v99
v_mfma_f32_4x4x4_16b_bf16 v[36:39], a[104:105], v[202:203], v[56:59]
v_accvgpr_write_b32 a196, v96
v_mfma_f32_4x4x4_16b_bf16 v[40:43], a[104:105], v[204:205], v[60:63]
v_accvgpr_write_b32 a197, v98
v_mfma_f32_4x4x4_16b_bf16 v[44:47], a[104:105], v[206:207], v[60:63]
v_cvt_pk_bf16_f32 v100, v100, v101
v_mfma_f32_4x4x4_16b_bf16 v[88:91], a[104:105], a[200:201], v[64:67]
v_cvt_pk_bf16_f32 v102, v102, v103
v_mfma_f32_4x4x4_16b_bf16 v[92:95], a[104:105], a[202:203], v[64:67]
v_accvgpr_write_b32 a198, v100
v_mfma_f32_4x4x4_16b_bf16 v[96:99], a[104:105], a[204:205], v[68:71]
v_accvgpr_write_b32 a199, v102
v_mfma_f32_4x4x4_16b_bf16 v[100:103], a[104:105], a[206:207], v[68:71]
v_cvt_pk_bf16_f32 v200, v32, v33
v_cvt_pk_bf16_f32 v201, v34, v35
v_mfma_f32_16x16x32_bf16 a[52:55], a[24:27], v[188:191], a[52:55]
ds_read_b64_tr_b16 a[6:7], v3 offset:2048
buffer_load_dwordx4 v6, s[16:19], 0 offen lds
v_mfma_f32_16x16x32_bf16 a[52:55], a[20:23], v[180:183], a[52:55]
s_add_u32 m0, s47, 36864
ds_read_b64_tr_b16 a[8:9], v3 offset:8192
v_cvt_pk_bf16_f32 v202, v36, v37
v_mfma_f32_16x16x32_bf16 a[52:55], a[16:19], v[172:175], a[52:55]
ds_read_b64_tr_b16 a[10:11], v3 offset:10240
v_add_u32 v3, 0xffff0000, v3
v_cvt_pk_bf16_f32 v96, v96, v97
v_mfma_f32_16x16x32_bf16 a[56:59], a[16:19], a[168:171], a[56:59]
v_cvt_pk_bf16_f32 v203, v38, v39
v_cvt_pk_bf16_f32 v204, v40, v41
v_cvt_pk_bf16_f32 v98, v98, v99
v_mfma_f32_16x16x32_bf16 a[56:59], a[20:23], a[176:179], a[56:59]
buffer_load_dwordx4 v6, s[20:23], 0 offen lds
v_mfma_f32_16x16x32_bf16 a[56:59], a[24:27], a[184:187], a[56:59]
s_add_u32 m0, s47, 40960
v_add_u32 v6, 0x48000, v6
v_cvt_pk_bf16_f32 v205, v42, v43
v_cvt_pk_bf16_f32 v100, v100, v101
v_mfma_f32_16x16x32_bf16 a[60:63], a[24:27], a[188:191], a[60:63]
v_cvt_pk_bf16_f32 v206, v44, v45
v_cvt_pk_bf16_f32 v207, v46, v47
v_cvt_pk_bf16_f32 v102, v102, v103
v_mfma_f32_16x16x32_bf16 a[60:63], a[20:23], a[180:183], a[60:63]
v_cvt_pk_bf16_f32 v88, v88, v89
v_cvt_pk_bf16_f32 v90, v90, v91
v_accvgpr_write_b32 a206, v100
v_mfma_f32_16x16x32_bf16 a[60:63], a[16:19], a[172:175], a[60:63]
s_waitcnt lgkmcnt(0)
buffer_load_dwordx4 v6, s[16:19], 0 offen lds
v_mfma_f32_16x16x32_bf16 a[64:67], a[0:3], v[168:171], a[64:67]
s_add_u32 m0, s47, 45056
ds_read_b64_tr_b16 a[16:17], v3 offset:61440
v_accvgpr_write_b32 a200, v88
v_mfma_f32_16x16x32_bf16 a[64:67], a[4:7], v[176:179], a[64:67]
ds_read_b64_tr_b16 a[18:19], v3 offset:63488
v_add_u32 v3, 0x10000, v3
v_mfma_f32_16x16x32_bf16 a[64:67], a[8:11], v[184:187], a[64:67]
s_nop 0
ds_read_b64_tr_b16 a[20:21], v3 offset:4096
v_accvgpr_write_b32 a201, v90
v_mfma_f32_4x4x4_16b_bf16 v[32:35], a[104:105], v[208:209], v[56:59]
v_cvt_pk_bf16_f32 v92, v92, v93
v_mfma_f32_4x4x4_16b_bf16 v[36:39], a[104:105], v[210:211], v[56:59]
v_cvt_pk_bf16_f32 v94, v94, v95
v_mfma_f32_4x4x4_16b_bf16 v[40:43], a[104:105], v[212:213], v[60:63]
v_accvgpr_write_b32 a202, v92
v_mfma_f32_4x4x4_16b_bf16 v[44:47], a[104:105], v[214:215], v[60:63]
v_accvgpr_write_b32 a203, v94
v_mfma_f32_4x4x4_16b_bf16 v[88:91], a[104:105], a[208:209], v[64:67]
v_accvgpr_write_b32 a204, v96
v_mfma_f32_4x4x4_16b_bf16 v[92:95], a[104:105], a[210:211], v[64:67]
v_accvgpr_write_b32 a205, v98
v_mfma_f32_4x4x4_16b_bf16 v[96:99], a[104:105], a[212:213], v[68:71]
v_accvgpr_write_b32 a207, v102
v_mfma_f32_4x4x4_16b_bf16 v[100:103], a[104:105], a[214:215], v[68:71]
v_cvt_pk_bf16_f32 v208, v32, v33
v_cvt_pk_bf16_f32 v209, v34, v35
v_mfma_f32_16x16x32_bf16 a[68:71], a[8:11], v[188:191], a[68:71]
ds_read_b64_tr_b16 a[22:23], v3 offset:6144
buffer_load_dwordx4 v6, s[20:23], 0 offen lds
v_mfma_f32_16x16x32_bf16 a[68:71], a[4:7], v[180:183], a[68:71]
s_add_u32 m0, s47, 49152
ds_read_b64_tr_b16 a[24:25], v3 offset:12288
v_cvt_pk_bf16_f32 v210, v36, v37
v_mfma_f32_16x16x32_bf16 a[68:71], a[0:3], v[172:175], a[68:71]
ds_read_b64_tr_b16 a[26:27], v3 offset:14336
v_cvt_pk_bf16_f32 v211, v38, v39
v_mfma_f32_16x16x32_bf16 a[72:75], a[0:3], a[168:171], a[72:75]
v_cvt_pk_bf16_f32 v212, v40, v41
v_cvt_pk_bf16_f32 v213, v42, v43
v_cvt_pk_bf16_f32 v100, v100, v101
v_mfma_f32_16x16x32_bf16 a[72:75], a[4:7], a[176:179], a[72:75]
buffer_load_dwordx4 v8, s[12:15], 0 offen lds
v_mfma_f32_16x16x32_bf16 a[72:75], a[8:11], a[184:187], a[72:75]
s_add_u32 m0, s47, 53248
v_add_u32 v8, 0x3600, v8
v_cvt_pk_bf16_f32 v214, v44, v45
v_cvt_pk_bf16_f32 v102, v102, v103
v_mfma_f32_16x16x32_bf16 a[76:79], a[8:11], a[188:191], a[76:79]
v_cvt_pk_bf16_f32 v215, v46, v47
v_cvt_pk_bf16_f32 v88, v88, v89
v_accvgpr_write_b32 a214, v100
v_mfma_f32_16x16x32_bf16 a[76:79], a[4:7], a[180:183], a[76:79]
v_cvt_pk_bf16_f32 v90, v90, v91
v_accvgpr_write_b32 a208, v88
v_mfma_f32_16x16x32_bf16 a[76:79], a[0:3], a[172:175], a[76:79]
s_waitcnt vmcnt(9) lgkmcnt(0)
v_accvgpr_write_b32 a209, v90
v_cvt_pk_bf16_f32 v92, v92, v93
v_mfma_f32_16x16x32_bf16 a[80:83], a[16:19], v[168:171], a[80:83]
s_barrier
ds_read_b64_tr_b16 a[0:1], v2 offset:16384
v_cvt_pk_bf16_f32 v94, v94, v95
v_mfma_f32_16x16x32_bf16 a[80:83], a[20:23], v[176:179], a[80:83]
ds_read_b64_tr_b16 a[2:3], v2 offset:18432
v_accvgpr_write_b32 a210, v92
v_mfma_f32_16x16x32_bf16 a[80:83], a[24:27], v[184:187], a[80:83]
ds_read_b64_tr_b16 a[4:5], v2 offset:24576
buffer_load_dwordx4 v8, s[12:15], 0 offen lds
v_mfma_f32_4x4x4_16b_bf16 v[32:35], a[104:105], v[216:217], v[56:59]
v_add_u32 v8, 0x17a00, v8
v_mfma_f32_4x4x4_16b_bf16 v[36:39], a[104:105], v[218:219], v[56:59]
v_accvgpr_write_b32 a211, v94
v_mfma_f32_4x4x4_16b_bf16 v[40:43], a[104:105], v[220:221], v[60:63]
v_cvt_pk_bf16_f32 v96, v96, v97
v_mfma_f32_4x4x4_16b_bf16 v[44:47], a[104:105], v[222:223], v[60:63]
v_cvt_pk_bf16_f32 v98, v98, v99
v_mfma_f32_4x4x4_16b_bf16 v[88:91], a[104:105], a[216:217], v[64:67]
v_accvgpr_write_b32 a212, v96
v_mfma_f32_4x4x4_16b_bf16 v[92:95], a[104:105], a[218:219], v[64:67]
v_accvgpr_write_b32 a213, v98
v_mfma_f32_4x4x4_16b_bf16 v[96:99], a[104:105], a[220:221], v[68:71]
v_accvgpr_write_b32 a215, v102
v_mfma_f32_4x4x4_16b_bf16 v[100:103], a[104:105], a[222:223], v[68:71]
v_cvt_pk_bf16_f32 v216, v32, v33
v_cvt_pk_bf16_f32 v217, v34, v35
v_cvt_pk_bf16_f32 v222, v44, v45
v_mfma_f32_16x16x32_bf16 a[84:87], a[24:27], v[188:191], a[84:87]
s_add_u32 m0, s47, 57344
ds_read_b64_tr_b16 a[6:7], v2 offset:26624
v_add_u32 v2, 0xfffe0000, v2
v_cvt_pk_bf16_f32 v88, v88, v89
v_mfma_f32_16x16x32_bf16 a[84:87], a[20:23], v[180:183], a[84:87]
ds_read_b64_tr_b16 a[8:9], v2
v_cvt_pk_bf16_f32 v218, v36, v37
v_cvt_pk_bf16_f32 v92, v92, v93
v_mfma_f32_16x16x32_bf16 a[84:87], a[16:19], v[172:175], a[84:87]
ds_read_b64_tr_b16 a[10:11], v2 offset:2048
v_cvt_pk_bf16_f32 v219, v38, v39
v_cvt_pk_bf16_f32 v94, v94, v95
v_mfma_f32_16x16x32_bf16 a[88:91], a[16:19], a[168:171], a[88:91]
s_add_u32 s100, s5, 128
s_and_b32 s100, s100, 384
ds_read_b64_tr_b16 a[12:13], v2 offset:8192
v_accvgpr_write_b32 a218, v92
v_mfma_f32_16x16x32_bf16 a[88:91], a[20:23], a[176:179], a[88:91]
ds_read_b64_tr_b16 a[14:15], v2 offset:10240
v_add_u32 v2, 0x20000, v2
v_accvgpr_write_b32 a219, v94
v_mfma_f32_16x16x32_bf16 a[88:91], a[24:27], a[184:187], a[88:91]
buffer_load_dword v0, v27, s[16:19], s100 offen
buffer_load_dword v0, v27, s[20:23], s100 offen
v_mfma_f32_16x16x32_bf16 a[92:95], a[24:27], a[188:191], a[92:95]
s_add_u32 s100, s5, 256
s_and_b32 s100, s100, 384
buffer_load_dword v0, v27, s[16:19], s100 offen
v_mfma_f32_16x16x32_bf16 a[92:95], a[20:23], a[180:183], a[92:95]
buffer_load_dword v0, v27, s[20:23], s100 offen
v_mfma_f32_16x16x32_bf16 a[92:95], a[16:19], a[172:175], a[92:95]
s_waitcnt lgkmcnt(0)
buffer_store_dword v110, v108, s[28:31], 0 offen sc1
v_mfma_f32_16x16x32_bf16 a[32:35], a[0:3], v[192:195], a[32:35]
ds_read_b64_tr_b16 a[16:17], v2 offset:20480
v_cvt_pk_bf16_f32 v220, v40, v41
v_cvt_pk_bf16_f32 v96, v96, v97
v_mfma_f32_16x16x32_bf16 a[32:35], a[4:7], v[200:203], a[32:35]
ds_read_b64_tr_b16 a[18:19], v2 offset:22528
v_cvt_pk_bf16_f32 v221, v42, v43
v_cvt_pk_bf16_f32 v100, v100, v101
v_mfma_f32_16x16x32_bf16 a[32:35], a[8:11], v[208:211], a[32:35]
ds_read_b64_tr_b16 a[20:21], v2 offset:28672
v_cvt_pk_bf16_f32 v223, v46, v47
v_cvt_pk_bf16_f32 v102, v102, v103
v_mfma_f32_16x16x32_bf16 a[32:35], a[12:15], v[216:219], a[32:35]
s_nop 0
ds_read_b64_tr_b16 a[22:23], v2 offset:30720
v_add_u32 v2, 0xfffe0000, v2
v_accvgpr_write_b32 a222, v100
v_mfma_f32_4x4x4_16b_bf16 v[32:35], a[104:105], v[224:225], v[56:59]
v_cvt_pk_bf16_f32 v90, v90, v91
v_mfma_f32_4x4x4_16b_bf16 v[36:39], a[104:105], v[226:227], v[56:59]
v_accvgpr_write_b32 a216, v88
v_mfma_f32_4x4x4_16b_bf16 v[40:43], a[104:105], v[228:229], v[60:63]
v_accvgpr_write_b32 a217, v90
v_mfma_f32_4x4x4_16b_bf16 v[44:47], a[104:105], v[230:231], v[60:63]
v_cvt_pk_bf16_f32 v98, v98, v99
v_mfma_f32_4x4x4_16b_bf16 v[88:91], a[104:105], a[224:225], v[64:67]
v_accvgpr_write_b32 a220, v96
v_mfma_f32_4x4x4_16b_bf16 v[92:95], a[104:105], a[226:227], v[64:67]
v_accvgpr_write_b32 a221, v98
v_mfma_f32_4x4x4_16b_bf16 v[96:99], a[104:105], a[228:229], v[68:71]
v_accvgpr_write_b32 a223, v102
v_mfma_f32_4x4x4_16b_bf16 v[100:103], a[104:105], a[230:231], v[68:71]
v_cvt_pk_bf16_f32 v224, v32, v33
v_cvt_pk_bf16_f32 v225, v34, v35
v_mfma_f32_16x16x32_bf16 a[36:39], a[12:15], v[220:223], a[36:39]
ds_read_b64_tr_b16 a[24:25], v2 offset:4096
v_cvt_pk_bf16_f32 v226, v36, v37
v_mfma_f32_16x16x32_bf16 a[36:39], a[8:11], v[212:215], a[36:39]
ds_read_b64_tr_b16 a[26:27], v2 offset:6144
v_cvt_pk_bf16_f32 v227, v38, v39
v_mfma_f32_16x16x32_bf16 a[36:39], a[4:7], v[204:207], a[36:39]
ds_read_b64_tr_b16 a[28:29], v2 offset:12288
v_cvt_pk_bf16_f32 v228, v40, v41
v_mfma_f32_16x16x32_bf16 a[36:39], a[0:3], v[196:199], a[36:39]
ds_read_b64_tr_b16 a[30:31], v2 offset:14336
v_cvt_pk_bf16_f32 v229, v42, v43
v_mfma_f32_16x16x32_bf16 a[40:43], a[0:3], a[192:195], a[40:43]
v_cvt_pk_bf16_f32 v230, v44, v45
L_pad2:
s_cbranch_execz L_pad6
v_cvt_pk_bf16_f32 v231, v46, v47
v_mfma_f32_16x16x32_bf16 a[40:43], a[4:7], a[200:203], a[40:43]
v_cvt_pk_bf16_f32 v88, v88, v89
v_cvt_pk_bf16_f32 v90, v90, v91
v_mfma_f32_16x16x32_bf16 a[40:43], a[8:11], a[208:211], a[40:43]
v_accvgpr_write_b32 a224, v88
v_accvgpr_write_b32 a225, v90
v_mfma_f32_16x16x32_bf16 a[40:43], a[12:15], a[216:219], a[40:43]
v_cvt_pk_bf16_f32 v92, v92, v93
v_cvt_pk_bf16_f32 v94, v94, v95
v_mfma_f32_16x16x32_bf16 a[44:47], a[12:15], a[220:223], a[44:47]
v_accvgpr_write_b32 a226, v92
v_accvgpr_write_b32 a227, v94
v_mfma_f32_16x16x32_bf16 a[44:47], a[8:11], a[212:215], a[44:47]
v_cvt_pk_bf16_f32 v96, v96, v97
v_cvt_pk_bf16_f32 v98, v98, v99
v_mfma_f32_16x16x32_bf16 a[44:47], a[4:7], a[204:207], a[44:47]
v_accvgpr_write_b32 a228, v96
v_accvgpr_write_b32 a229, v98
v_mfma_f32_16x16x32_bf16 a[44:47], a[0:3], a[196:199], a[44:47]
s_waitcnt lgkmcnt(0)
v_cvt_pk_bf16_f32 v100, v100, v101
v_cvt_pk_bf16_f32 v102, v102, v103
v_mfma_f32_16x16x32_bf16 a[48:51], a[16:19], v[192:195], a[48:51]
ds_read_b64_tr_b16 a[0:1], v3 offset:16384
v_accvgpr_write_b32 a230, v100
v_mfma_f32_16x16x32_bf16 a[48:51], a[20:23], v[200:203], a[48:51]
ds_read_b64_tr_b16 a[2:3], v3 offset:18432
v_accvgpr_write_b32 a231, v102
v_mfma_f32_16x16x32_bf16 a[48:51], a[24:27], v[208:211], a[48:51]
ds_read_b64_tr_b16 a[4:5], v3 offset:24576
v_mfma_f32_16x16x32_bf16 a[48:51], a[28:31], v[216:219], a[48:51]
ds_read_b64_tr_b16 a[6:7], v3 offset:26624
v_add_u32 v3, 0xfffe0000, v3
v_mfma_f32_4x4x4_16b_bf16 v[32:35], a[104:105], v[232:233], v[56:59]
v_mfma_f32_4x4x4_16b_bf16 v[36:39], a[104:105], v[234:235], v[56:59]
v_mfma_f32_4x4x4_16b_bf16 v[40:43], a[104:105], v[236:237], v[60:63]
v_mfma_f32_4x4x4_16b_bf16 v[44:47], a[104:105], v[238:239], v[60:63]
v_mfma_f32_4x4x4_16b_bf16 v[88:91], a[104:105], a[232:233], v[64:67]
v_mfma_f32_4x4x4_16b_bf16 v[92:95], a[104:105], a[234:235], v[64:67]
v_cvt_pk_bf16_f32 v232, v32, v33
v_mfma_f32_4x4x4_16b_bf16 v[96:99], a[104:105], a[236:237], v[68:71]
v_cvt_pk_bf16_f32 v233, v34, v35
v_mfma_f32_4x4x4_16b_bf16 v[100:103], a[104:105], a[238:239], v[68:71]
v_cvt_pk_bf16_f32 v234, v36, v37
v_cvt_pk_bf16_f32 v235, v38, v39
v_mfma_f32_16x16x32_bf16 a[52:55], a[28:31], v[220:223], a[52:55]
ds_read_b64_tr_b16 a[8:9], v3
v_cvt_pk_bf16_f32 v236, v40, v41
v_mfma_f32_16x16x32_bf16 a[52:55], a[24:27], v[212:215], a[52:55]
ds_read_b64_tr_b16 a[10:11], v3 offset:2048
buffer_load_dwordx4 v8, s[12:15], 0 offen lds
v_mfma_f32_16x16x32_bf16 a[52:55], a[20:23], v[204:207], a[52:55]
s_add_u32 m0, s47, 61440
ds_read_b64_tr_b16 a[12:13], v3 offset:8192
v_add_u32 v8, 0x3600, v8
v_mfma_f32_16x16x32_bf16 a[52:55], a[16:19], v[196:199], a[52:55]
ds_read_b64_tr_b16 a[14:15], v3 offset:10240
v_add_u32 v3, 0x20000, v3
v_mfma_f32_16x16x32_bf16 a[56:59], a[16:19], a[192:195], a[56:59]
v_cvt_pk_bf16_f32 v237, v42, v43
v_cvt_pk_bf16_f32 v238, v44, v45
v_mfma_f32_16x16x32_bf16 a[56:59], a[20:23], a[200:203], a[56:59]
v_cvt_pk_bf16_f32 v239, v46, v47
v_cvt_pk_bf16_f32 v88, v88, v89
v_mfma_f32_16x16x32_bf16 a[56:59], a[24:27], a[208:211], a[56:59]
v_cvt_pk_bf16_f32 v90, v90, v91
v_accvgpr_write_b32 a232, v88
v_mfma_f32_16x16x32_bf16 a[56:59], a[28:31], a[216:219], a[56:59]
v_accvgpr_write_b32 a233, v90
v_cvt_pk_bf16_f32 v92, v92, v93
v_mfma_f32_16x16x32_bf16 a[60:63], a[28:31], a[220:223], a[60:63]
buffer_load_dwordx4 v8, s[12:15], 0 offen lds
v_mfma_f32_16x16x32_bf16 a[60:63], a[24:27], a[212:215], a[60:63]
s_add_u32 m0, s47, 65536
v_add_u32 v8, 0x17a00, v8
v_cvt_pk_bf16_f32 v94, v94, v95
v_mfma_f32_16x16x32_bf16 a[60:63], a[20:23], a[204:207], a[60:63]
v_accvgpr_write_b32 a234, v92
v_accvgpr_write_b32 a235, v94
v_mfma_f32_16x16x32_bf16 a[60:63], a[16:19], a[196:199], a[60:63]
s_waitcnt lgkmcnt(0)
v_cvt_pk_bf16_f32 v96, v96, v97
v_cvt_pk_bf16_f32 v98, v98, v99
v_mfma_f32_16x16x32_bf16 a[64:67], a[0:3], v[192:195], a[64:67]
ds_read_b64_tr_b16 a[16:17], v3 offset:20480
v_accvgpr_write_b32 a236, v96
v_mfma_f32_16x16x32_bf16 a[64:67], a[4:7], v[200:203], a[64:67]
ds_read_b64_tr_b16 a[18:19], v3 offset:22528
v_accvgpr_write_b32 a237, v98
v_mfma_f32_16x16x32_bf16 a[64:67], a[8:11], v[208:211], a[64:67]
ds_read_b64_tr_b16 a[20:21], v3 offset:28672
v_cvt_pk_bf16_f32 v100, v100, v101
v_mfma_f32_16x16x32_bf16 a[64:67], a[12:15], v[216:219], a[64:67]
s_nop 0
ds_read_b64_tr_b16 a[22:23], v3 offset:30720
v_add_u32 v3, 0xfffe0000, v3
v_mfma_f32_4x4x4_16b_bf16 v[32:35], a[104:105], v[240:241], v[56:59]
v_cvt_pk_bf16_f32 v102, v102, v103
v_mfma_f32_4x4x4_16b_bf16 v[36:39], a[104:105], v[242:243], v[56:59]
v_accvgpr_write_b32 a238, v100
v_mfma_f32_4x4x4_16b_bf16 v[40:43], a[104:105], v[244:245], v[60:63]
v_accvgpr_write_b32 a239, v102
v_mfma_f32_4x4x4_16b_bf16 v[44:47], a[104:105], v[246:247], v[60:63]
v_mfma_f32_4x4x4_16b_bf16 v[88:91], a[104:105], a[240:241], v[64:67]
v_mfma_f32_4x4x4_16b_bf16 v[92:95], a[104:105], a[242:243], v[64:67]
v_cvt_pk_bf16_f32 v240, v32, v33
v_mfma_f32_4x4x4_16b_bf16 v[96:99], a[104:105], a[244:245], v[68:71]
v_cvt_pk_bf16_f32 v241, v34, v35
v_mfma_f32_4x4x4_16b_bf16 v[100:103], a[104:105], a[246:247], v[68:71]
v_cvt_pk_bf16_f32 v242, v36, v37
v_cvt_pk_bf16_f32 v243, v38, v39
v_mfma_f32_16x16x32_bf16 a[68:71], a[12:15], v[220:223], a[68:71]
ds_read_b64_tr_b16 a[24:25], v3 offset:4096
buffer_load_dwordx4 v8, s[12:15], 0 offen lds
v_mfma_f32_16x16x32_bf16 a[68:71], a[8:11], v[212:215], a[68:71]
s_add_u32 m0, s47, 69632
ds_read_b64_tr_b16 a[26:27], v3 offset:6144
v_add_u32 v8, 0x3600, v8
v_mfma_f32_16x16x32_bf16 a[68:71], a[4:7], v[204:207], a[68:71]
ds_read_b64_tr_b16 a[28:29], v3 offset:12288
v_cvt_pk_bf16_f32 v244, v40, v41
v_mfma_f32_16x16x32_bf16 a[68:71], a[0:3], v[196:199], a[68:71]
ds_read_b64_tr_b16 a[30:31], v3 offset:14336
v_cvt_pk_bf16_f32 v245, v42, v43
v_mfma_f32_16x16x32_bf16 a[72:75], a[0:3], a[192:195], a[72:75]
buffer_load_dwordx4 v8, s[12:15], 0 offen lds
v_mfma_f32_16x16x32_bf16 a[72:75], a[4:7], a[200:203], a[72:75]
s_add_u32 m0, s47, 73728
v_add_u32 v8, 0x17a00, v8
v_cvt_pk_bf16_f32 v246, v44, v45
v_mfma_f32_16x16x32_bf16 a[72:75], a[8:11], a[208:211], a[72:75]
v_cvt_pk_bf16_f32 v247, v46, v47
v_cvt_pk_bf16_f32 v88, v88, v89
v_mfma_f32_16x16x32_bf16 a[72:75], a[12:15], a[216:219], a[72:75]
v_cvt_pk_bf16_f32 v90, v90, v91
v_accvgpr_write_b32 a240, v88
v_mfma_f32_16x16x32_bf16 a[76:79], a[12:15], a[220:223], a[76:79]
v_accvgpr_write_b32 a241, v90
v_cvt_pk_bf16_f32 v92, v92, v93
v_mfma_f32_16x16x32_bf16 a[76:79], a[8:11], a[212:215], a[76:79]
buffer_load_dwordx4 v8, s[12:15], 0 offen lds
v_mfma_f32_16x16x32_bf16 a[76:79], a[4:7], a[204:207], a[76:79]
s_add_u32 m0, s47, 77824
v_add_u32 v8, 0x3600, v8
v_cvt_pk_bf16_f32 v94, v94, v95
v_mfma_f32_16x16x32_bf16 a[76:79], a[0:3], a[196:199], a[76:79]
s_waitcnt vmcnt(12) lgkmcnt(0)
v_accvgpr_write_b32 a242, v92
v_accvgpr_write_b32 a243, v94
v_mfma_f32_16x16x32_bf16 a[80:83], a[16:19], v[192:195], a[80:83]
s_barrier
ds_read_b64_tr_b16 a[0:1], v2 offset:16384
v_cvt_pk_bf16_f32 v96, v96, v97
v_mfma_f32_16x16x32_bf16 a[80:83], a[20:23], v[200:203], a[80:83]
ds_read_b64_tr_b16 a[2:3], v2 offset:18432
v_cvt_pk_bf16_f32 v98, v98, v99
v_mfma_f32_16x16x32_bf16 a[80:83], a[24:27], v[208:211], a[80:83]
ds_read_b64_tr_b16 a[4:5], v2 offset:24576
v_accvgpr_write_b32 a244, v96
v_mfma_f32_16x16x32_bf16 a[80:83], a[28:31], v[216:219], a[80:83]
ds_read_b64_tr_b16 a[6:7], v2 offset:26624
v_accvgpr_write_b32 a245, v98
v_mfma_f32_4x4x4_16b_bf16 v[32:35], a[104:105], v[248:249], v[56:59]
v_cvt_pk_bf16_f32 v100, v100, v101
v_mfma_f32_4x4x4_16b_bf16 v[36:39], a[104:105], v[250:251], v[56:59]
v_cvt_pk_bf16_f32 v102, v102, v103
v_mfma_f32_4x4x4_16b_bf16 v[40:43], a[104:105], v[252:253], v[60:63]
v_accvgpr_write_b32 a246, v100
v_mfma_f32_4x4x4_16b_bf16 v[44:47], a[104:105], v[254:255], v[60:63]
v_accvgpr_write_b32 a247, v102
v_mfma_f32_4x4x4_16b_bf16 v[88:91], a[104:105], a[248:249], v[64:67]
v_mfma_f32_4x4x4_16b_bf16 v[92:95], a[104:105], a[250:251], v[64:67]
v_cvt_pk_bf16_f32 v248, v32, v33
v_mfma_f32_4x4x4_16b_bf16 v[96:99], a[104:105], a[252:253], v[68:71]
v_cvt_pk_bf16_f32 v249, v34, v35
v_mfma_f32_4x4x4_16b_bf16 v[100:103], a[104:105], a[254:255], v[68:71]
v_cvt_pk_bf16_f32 v250, v36, v37
v_cvt_pk_bf16_f32 v251, v38, v39
v_mfma_f32_16x16x32_bf16 a[84:87], a[28:31], v[220:223], a[84:87]
ds_read_b64_tr_b16 a[8:9], v2 offset:32768
buffer_load_dwordx4 v8, s[12:15], 0 offen lds
v_mfma_f32_16x16x32_bf16 a[84:87], a[24:27], v[212:215], a[84:87]
s_add_u32 m0, s47, 86016
ds_read_b64_tr_b16 a[10:11], v2 offset:34816
v_add_u32 v8, 0x17a00, v8
v_mfma_f32_16x16x32_bf16 a[84:87], a[20:23], v[204:207], a[84:87]
ds_read_b64_tr_b16 a[12:13], v2 offset:40960
v_cvt_pk_bf16_f32 v252, v40, v41
v_mfma_f32_16x16x32_bf16 a[84:87], a[16:19], v[196:199], a[84:87]
ds_read_b64_tr_b16 a[14:15], v2 offset:43008
v_cvt_pk_bf16_f32 v253, v42, v43
v_cvt_pk_bf16_f32 v100, v100, v101
v_mfma_f32_16x16x32_bf16 a[88:91], a[16:19], a[192:195], a[88:91]
buffer_load_dwordx4 v8, s[12:15], 0 offen lds
v_mfma_f32_16x16x32_bf16 a[88:91], a[20:23], a[200:203], a[88:91]
s_add_u32 m0, s47, 90112
v_add_u32 v8, 0x3600, v8
v_cvt_pk_bf16_f32 v254, v44, v45
v_mfma_f32_16x16x32_bf16 a[88:91], a[24:27], a[208:211], a[88:91]
v_cvt_pk_bf16_f32 v255, v46, v47
v_cvt_pk_bf16_f32 v88, v88, v89
v_mfma_f32_16x16x32_bf16 a[88:91], a[28:31], a[216:219], a[88:91]
s_mov_b32 s59, 987991609
v_cvt_pk_bf16_f32 v90, v90, v91
v_accvgpr_write_b32 a248, v88
v_mfma_f32_16x16x32_bf16 a[92:95], a[28:31], a[220:223], a[92:95]
s_mov_b32 s60, 925353388
v_accvgpr_write_b32 a249, v90
v_cvt_pk_bf16_f32 v92, v92, v93
v_mfma_f32_16x16x32_bf16 a[92:95], a[24:27], a[212:215], a[92:95]
v_cvt_pk_bf16_f32 v94, v94, v95
v_accvgpr_write_b32 a250, v92
v_mfma_f32_16x16x32_bf16 a[92:95], a[20:23], a[204:207], a[92:95]
buffer_load_dwordx4 v8, s[12:15], 0 offen lds
v_mfma_f32_16x16x32_bf16 a[92:95], a[16:19], a[196:199], a[92:95]
s_waitcnt lgkmcnt(0)
v_add_u32 v8, 0x17a00, v8
v_accvgpr_write_b32 a251, v94
v_mfma_f32_16x16x32_bf16 a[32:35], a[0:3], v[224:227], a[32:35]
s_add_u32 m0, s47, 94208
ds_read_b64_tr_b16 a[16:17], v2 offset:20480
v_cvt_pk_bf16_f32 v96, v96, v97
v_mfma_f32_16x16x32_bf16 a[32:35], a[4:7], v[232:235], a[32:35]
ds_read_b64_tr_b16 a[18:19], v2 offset:22528
v_cvt_pk_bf16_f32 v98, v98, v99
v_mfma_f32_16x16x32_bf16 a[32:35], a[8:11], v[240:243], a[32:35]
ds_read_b64_tr_b16 a[20:21], v2 offset:28672
v_accvgpr_write_b32 a252, v96
v_mfma_f32_16x16x32_bf16 a[32:35], a[12:15], v[248:251], a[32:35]
ds_read_b64_tr_b16 a[22:23], v2 offset:30720
v_accvgpr_write_b32 a253, v98
v_mfma_f32_16x16x32_bf16 a[36:39], a[12:15], v[252:255], a[36:39]
ds_read_b64_tr_b16 a[24:25], v2 offset:36864
v_add_u32 v25, s47, v10
v_mfma_f32_16x16x32_bf16 a[36:39], a[8:11], v[244:247], a[36:39]
ds_read_b64_tr_b16 a[26:27], v2 offset:38912
v_xor_b32 v26, 0x400, v25
v_mfma_f32_16x16x32_bf16 a[36:39], a[4:7], v[236:239], a[36:39]
ds_read_b64_tr_b16 a[28:29], v2 offset:45056
v_add_u32 v25, 0x10000, v25
v_mfma_f32_16x16x32_bf16 a[36:39], a[0:3], v[228:231], a[36:39]
ds_read_b64_tr_b16 a[30:31], v2 offset:47104
v_add_u32 v26, 0x10000, v26
v_mfma_f32_16x16x32_bf16 a[40:43], a[0:3], a[224:227], a[40:43]
buffer_load_dwordx4 v8, s[12:15], 0 offen lds
v_mfma_f32_16x16x32_bf16 a[40:43], a[4:7], a[232:235], a[40:43]
s_add_u32 m0, s47, 98304
v_add_u32 v8, 0x3600, v8
v_cvt_pk_bf16_f32 v102, v102, v103
v_mfma_f32_16x16x32_bf16 a[40:43], a[8:11], a[240:243], a[40:43]
v_accvgpr_write_b32 a254, v100
v_accvgpr_write_b32 a255, v102
v_mfma_f32_16x16x32_bf16 a[40:43], a[12:15], a[248:251], a[40:43]
v_mul_f32 v12, v56, v56
v_mul_f32 v13, v60, v60
v_mfma_f32_16x16x32_bf16 a[44:47], a[12:15], a[252:255], a[44:47]
buffer_load_dwordx4 v8, s[12:15], 0 offen lds
v_mfma_f32_16x16x32_bf16 a[44:47], a[8:11], a[244:247], a[44:47]
s_add_u32 m0, s47, 102400
v_add_u32 v8, 0x17a00, v8
v_cndmask_b32 v40, 0, v72, s[62:63]
v_mfma_f32_16x16x32_bf16 a[44:47], a[4:7], a[236:239], a[44:47]
v_cndmask_b32 v40, v40, v73, s[64:65]
v_cndmask_b32 v40, v40, v74, s[66:67]
v_mfma_f32_16x16x32_bf16 a[44:47], a[0:3], a[228:231], a[44:47]
s_waitcnt lgkmcnt(0)
v_cndmask_b32 v40, v40, v75, s[68:69]
v_cndmask_b32 v41, 0, v76, s[62:63]
v_mfma_f32_16x16x32_bf16 a[48:51], a[16:19], v[224:227], a[48:51]
ds_read_b64_tr_b16 a[0:1], v3 offset:16384
v_cndmask_b32 v41, v41, v77, s[64:65]
v_mfma_f32_16x16x32_bf16 a[48:51], a[20:23], v[232:235], a[48:51]
ds_read_b64_tr_b16 a[2:3], v3 offset:18432
v_cndmask_b32 v41, v41, v78, s[66:67]
v_mfma_f32_16x16x32_bf16 a[48:51], a[24:27], v[240:243], a[48:51]
ds_read_b64_tr_b16 a[4:5], v3 offset:24576
v_cndmask_b32 v41, v41, v79, s[68:69]
v_mfma_f32_16x16x32_bf16 a[48:51], a[28:31], v[248:251], a[48:51]
ds_read_b64_tr_b16 a[6:7], v3 offset:26624
buffer_load_dwordx4 v8, s[12:15], 0 offen lds
v_mfma_f32_16x16x32_bf16 a[52:55], a[28:31], v[252:255], a[52:55]
s_add_u32 m0, s47, 106496
ds_read_b64_tr_b16 a[8:9], v3 offset:32768
v_add_u32 v8, 0x3600, v8
v_mfma_f32_16x16x32_bf16 a[52:55], a[24:27], v[244:247], a[52:55]
ds_read_b64_tr_b16 a[10:11], v3 offset:34816
v_mov_b32 v44, v40
v_mfma_f32_16x16x32_bf16 a[52:55], a[20:23], v[236:239], a[52:55]
ds_read_b64_tr_b16 a[12:13], v3 offset:40960
v_mov_b32 v45, v41
v_mfma_f32_16x16x32_bf16 a[52:55], a[16:19], v[228:231], a[52:55]
ds_read_b64_tr_b16 a[14:15], v3 offset:43008
v_mfma_f32_16x16x32_bf16 a[56:59], a[16:19], a[224:227], a[56:59]
v_permlane16_swap_b32 v40, v44
v_mfma_f32_16x16x32_bf16 a[56:59], a[20:23], a[232:235], a[56:59]
v_permlane16_swap_b32 v41, v45
v_mfma_f32_16x16x32_bf16 a[56:59], a[24:27], a[240:243], a[56:59]
buffer_load_dwordx4 v8, s[12:15], 0 offen lds
v_mfma_f32_16x16x32_bf16 a[56:59], a[28:31], a[248:251], a[56:59]
s_add_u32 m0, s47, 110592
v_add_u32 v8, 0x17a00, v8
v_add_f32 v40, v40, v44
v_mfma_f32_16x16x32_bf16 a[60:63], a[28:31], a[252:255], a[60:63]
v_add_f32 v41, v41, v45
v_mov_b32 v44, v40
v_mfma_f32_16x16x32_bf16 a[60:63], a[24:27], a[244:247], a[60:63]
v_mov_b32 v45, v41
v_mfma_f32_16x16x32_bf16 a[60:63], a[20:23], a[236:239], a[60:63]
v_permlane32_swap_b32 v40, v44
v_mfma_f32_16x16x32_bf16 a[60:63], a[16:19], a[228:231], a[60:63]
s_waitcnt lgkmcnt(0)
v_permlane32_swap_b32 v41, v45
v_mfma_f32_16x16x32_bf16 a[64:67], a[0:3], v[224:227], a[64:67]
ds_read_b64_tr_b16 a[16:17], v3 offset:20480
v_add_f32 v40, v40, v44
v_mfma_f32_16x16x32_bf16 a[64:67], a[4:7], v[232:235], a[64:67]
ds_read_b64_tr_b16 a[18:19], v3 offset:22528
buffer_load_dwordx4 v8, s[12:15], 0 offen lds
v_mfma_f32_16x16x32_bf16 a[64:67], a[8:11], v[240:243], a[64:67]
s_add_u32 m0, s47, 114688
ds_read_b64_tr_b16 a[20:21], v3 offset:28672
v_add_u32 v8, 0x3600, v8
v_mfma_f32_16x16x32_bf16 a[64:67], a[12:15], v[248:251], a[64:67]
ds_read_b64_tr_b16 a[22:23], v3 offset:30720
v_add_f32 v41, v41, v45
v_mfma_f32_16x16x32_bf16 a[68:71], a[12:15], v[252:255], a[68:71]
ds_read_b64_tr_b16 a[24:25], v3 offset:36864
v_fma_f32 v40, v40, s59, -v12
v_mfma_f32_16x16x32_bf16 a[68:71], a[8:11], v[244:247], a[68:71]
ds_read_b64_tr_b16 a[26:27], v3 offset:38912
v_max_f32 v40, 0, v40
v_mfma_f32_16x16x32_bf16 a[68:71], a[4:7], v[236:239], a[68:71]
ds_read_b64_tr_b16 a[28:29], v3 offset:45056
v_add_f32 v40, s60, v40
v_mfma_f32_16x16x32_bf16 a[68:71], a[0:3], v[228:231], a[68:71]
ds_read_b64_tr_b16 a[30:31], v3 offset:47104
v_fma_f32 v41, v41, s59, -v13
v_mfma_f32_16x16x32_bf16 a[72:75], a[0:3], a[224:227], a[72:75]
buffer_load_dwordx4 v8, s[12:15], 0 offen lds
v_mfma_f32_16x16x32_bf16 a[72:75], a[4:7], a[232:235], a[72:75]
s_add_u32 m0, s47, 118784
v_add_u32 v8, 0x17a00, v8
v_max_f32 v41, 0, v41
v_mfma_f32_16x16x32_bf16 a[72:75], a[8:11], a[240:243], a[72:75]
v_add_f32 v41, s60, v41
v_mfma_f32_16x16x32_bf16 a[72:75], a[12:15], a[248:251], a[72:75]
v_rcp_f32 v12, v40
v_mfma_f32_16x16x32_bf16 a[76:79], a[12:15], a[252:255], a[76:79]
v_rcp_f32 v13, v41
v_mfma_f32_16x16x32_bf16 a[76:79], a[8:11], a[244:247], a[76:79]
v_accvgpr_read_b32 v32, a32
v_accvgpr_read_b32 v33, a33
v_mfma_f32_16x16x32_bf16 a[76:79], a[4:7], a[236:239], a[76:79]
v_accvgpr_read_b32 v34, a34
v_accvgpr_read_b32 v35, a35
v_mfma_f32_16x16x32_bf16 a[76:79], a[0:3], a[228:231], a[76:79]
s_waitcnt vmcnt(8) lgkmcnt(0)
v_accvgpr_read_b32 v36, a48
v_accvgpr_read_b32 v37, a49
v_mfma_f32_16x16x32_bf16 a[80:83], a[16:19], v[224:227], a[80:83]
s_barrier
ds_read_b64_tr_b16 a[0:1], v104 offset:49152
v_accvgpr_read_b32 v38, a50
v_mfma_f32_16x16x32_bf16 a[80:83], a[20:23], v[232:235], a[80:83]
ds_read_b64_tr_b16 a[2:3], v104 offset:53248
v_accvgpr_read_b32 v39, a51
v_mfma_f32_16x16x32_bf16 a[80:83], a[24:27], v[240:243], a[80:83]
ds_read_b64_tr_b16 a[4:5], v104 offset:57344
v_max_f32 v32, 0, v32
v_mfma_f32_16x16x32_bf16 a[80:83], a[28:31], v[248:251], a[80:83]
ds_read_b64_tr_b16 a[6:7], v104 offset:61440
v_add_u32 v104, 0x10000, v104
v_mfma_f32_16x16x32_bf16 a[84:87], a[28:31], v[252:255], a[84:87]
ds_read_b64_tr_b16 a[8:9], v105 offset:49152
v_max_f32 v33, 0, v33
v_mfma_f32_16x16x32_bf16 a[84:87], a[24:27], v[244:247], a[84:87]
ds_read_b64_tr_b16 a[10:11], v105 offset:53248
v_max_f32 v34, 0, v34
v_mfma_f32_16x16x32_bf16 a[84:87], a[20:23], v[236:239], a[84:87]
ds_read_b64_tr_b16 a[12:13], v105 offset:57344
v_max_f32 v35, 0, v35
v_mfma_f32_16x16x32_bf16 a[84:87], a[16:19], v[228:231], a[84:87]
ds_read_b64_tr_b16 a[14:15], v105 offset:61440
v_add_u32 v105, 0x10000, v105
v_mfma_f32_16x16x32_bf16 a[88:91], a[16:19], a[224:227], a[88:91]
buffer_store_dword v29, v109, s[40:43], 0 offen sc1
v_mfma_f32_16x16x32_bf16 a[88:91], a[20:23], a[232:235], a[88:91]
v_mul_f32 v32, v32, v36
v_mul_f32 v33, v33, v37
v_mfma_f32_16x16x32_bf16 a[88:91], a[24:27], a[240:243], a[88:91]
v_mul_f32 v34, v34, v38
v_mul_f32 v35, v35, v39
v_mfma_f32_16x16x32_bf16 a[88:91], a[28:31], a[248:251], a[88:91]
ds_write_b64 v25, v[12:13] offset:16384
v_mfma_f32_16x16x32_bf16 a[92:95], a[28:31], a[252:255], a[92:95]
buffer_load_dwordx4 v8, s[12:15], 0 offen lds
v_mfma_f32_16x16x32_bf16 a[92:95], a[24:27], a[244:247], a[92:95]
s_add_u32 m0, s47, 122880
v_add_u32 v8, 0x3600, v8
v_cvt_pk_bf16_f32 v36, v32, v33
v_mfma_f32_16x16x32_bf16 a[92:95], a[20:23], a[236:239], a[92:95]
v_cvt_pk_bf16_f32 v37, v34, v35
v_accvgpr_write_b32 a96, v36
v_mfma_f32_16x16x32_bf16 a[92:95], a[16:19], a[228:231], a[92:95]
s_waitcnt lgkmcnt(1)
v_accvgpr_write_b32 a97, v37
v_accvgpr_read_b32 v32, a36
v_mfma_f32_16x16x32_bf16 v[48:51], a[0:3], v[112:115], 0
ds_read_b64_tr_b16 a[16:17], v106 offset:49152
buffer_load_dwordx4 v8, s[12:15], 0 offen lds
v_mfma_f32_16x16x32_bf16 v[48:51], a[4:7], v[120:123], v[48:51]
s_add_u32 m0, s47, 126976
ds_read_b64_tr_b16 a[18:19], v106 offset:53248
v_add_u32 v8, 0x17a00, v8
v_mfma_f32_16x16x32_bf16 v[52:55], a[4:7], v[124:127], 0
ds_read_b64_tr_b16 a[20:21], v106 offset:57344
v_accvgpr_read_b32 v33, a37
v_mfma_f32_16x16x32_bf16 v[52:55], a[0:3], v[116:119], v[52:55]
ds_read_b64_tr_b16 a[22:23], v106 offset:61440
v_add_u32 v106, 0x10000, v106
v_mfma_f32_16x16x32_bf16 v[56:59], a[0:3], a[112:115], 0
ds_read_b64_tr_b16 a[24:25], v107 offset:49152
buffer_load_dwordx4 v8, s[12:15], 0 offen lds
v_mfma_f32_16x16x32_bf16 v[56:59], a[4:7], a[120:123], v[56:59]
s_add_u32 m0, s47, 131072
ds_read_b64_tr_b16 a[26:27], v107 offset:53248
v_add_u32 v8, 0x3600, v8
v_mfma_f32_16x16x32_bf16 v[60:63], a[4:7], a[124:127], 0
ds_read_b64_tr_b16 a[28:29], v107 offset:57344
v_accvgpr_read_b32 v34, a38
v_mfma_f32_16x16x32_bf16 v[60:63], a[0:3], a[116:119], v[60:63]
ds_read_b64_tr_b16 a[30:31], v107 offset:61440
v_add_u32 v107, 0x10000, v107
v_mfma_f32_16x16x32_bf16 v[64:67], a[8:11], v[112:115], 0
buffer_load_dwordx4 v8, s[12:15], 0 offen lds
v_mfma_f32_16x16x32_bf16 v[64:67], a[12:15], v[120:123], v[64:67]
s_add_u32 m0, s47, 135168
v_add_u32 v8, 0x17a00, v8
v_accvgpr_read_b32 v35, a39
v_mfma_f32_16x16x32_bf16 v[68:71], a[12:15], v[124:127], 0
v_accvgpr_read_b32 v36, a52
v_accvgpr_read_b32 v37, a53
v_mfma_f32_16x16x32_bf16 v[68:71], a[8:11], v[116:119], v[68:71]
v_accvgpr_read_b32 v38, a54
v_accvgpr_read_b32 v39, a55
v_mfma_f32_16x16x32_bf16 v[72:75], a[8:11], a[112:115], 0
buffer_load_dwordx4 v8, s[12:15], 0 offen lds
v_mfma_f32_16x16x32_bf16 v[72:75], a[12:15], a[120:123], v[72:75]
s_add_u32 m0, s47, 139264
v_add_u32 v8, 0x3600, v8
v_max_f32 v32, 0, v32
v_mfma_f32_16x16x32_bf16 v[76:79], a[12:15], a[124:127], 0
v_max_f32 v33, 0, v33
v_max_f32 v34, 0, v34
v_mfma_f32_16x16x32_bf16 v[76:79], a[8:11], a[116:119], v[76:79]
s_waitcnt lgkmcnt(0)
v_max_f32 v35, 0, v35
v_mul_f32 v32, v32, v36
v_mfma_f32_16x16x32_bf16 v[80:83], a[16:19], v[112:115], 0
ds_read_b64_tr_b16 a[0:1], v104
v_mul_f32 v33, v33, v37
v_mfma_f32_16x16x32_bf16 v[80:83], a[20:23], v[120:123], v[80:83]
ds_read_b64_tr_b16 a[2:3], v104 offset:4096
v_mul_f32 v34, v34, v38
v_mfma_f32_16x16x32_bf16 v[84:87], a[20:23], v[124:127], 0
ds_read_b64_tr_b16 a[4:5], v104 offset:8192
buffer_load_dwordx4 v8, s[12:15], 0 offen lds
v_mfma_f32_16x16x32_bf16 v[84:87], a[16:19], v[116:119], v[84:87]
s_add_u32 m0, s47, 143360
ds_read_b64_tr_b16 a[6:7], v104 offset:12288
v_add_u32 v8, 0x17a00, v8
v_mfma_f32_16x16x32_bf16 v[88:91], a[16:19], a[112:115], 0
ds_read_b64_tr_b16 a[8:9], v105
v_mul_f32 v35, v35, v39
v_mfma_f32_16x16x32_bf16 v[88:91], a[20:23], a[120:123], v[88:91]
ds_read_b64_tr_b16 a[10:11], v105 offset:4096
v_cvt_pk_bf16_f32 v36, v32, v33
v_mfma_f32_16x16x32_bf16 v[92:95], a[20:23], a[124:127], 0
ds_read_b64_tr_b16 a[12:13], v105 offset:8192
v_cvt_pk_bf16_f32 v37, v34, v35
v_mfma_f32_16x16x32_bf16 v[92:95], a[16:19], a[116:119], v[92:95]
ds_read_b64_tr_b16 a[14:15], v105 offset:12288
v_accvgpr_write_b32 a100, v36
v_mfma_f32_16x16x32_bf16 v[96:99], a[24:27], v[112:115], 0
v_accvgpr_write_b32 a101, v37
v_accvgpr_read_b32 v32, a40
v_mfma_f32_16x16x32_bf16 v[96:99], a[28:31], v[120:123], v[96:99]
buffer_load_dwordx4 v8, s[12:15], 0 offen lds
v_mfma_f32_16x16x32_bf16 v[100:103], a[28:31], v[124:127], 0
s_add_u32 m0, s47, 147456
v_add_u32 v8, 0x3600, v8
v_accvgpr_read_b32 v33, a41
v_mfma_f32_16x16x32_bf16 v[100:103], a[24:27], v[116:119], v[100:103]
s_waitcnt lgkmcnt(0)
v_accvgpr_read_b32 v34, a42
v_accvgpr_read_b32 v35, a43
v_mfma_f32_16x16x32_bf16 v[48:51], a[0:3], v[128:131], v[48:51]
ds_read_b64_tr_b16 a[16:17], v106
v_accvgpr_read_b32 v36, a56
v_mfma_f32_16x16x32_bf16 v[48:51], a[4:7], v[136:139], v[48:51]
ds_read_b64_tr_b16 a[18:19], v106 offset:4096
v_accvgpr_read_b32 v37, a57
v_mfma_f32_16x16x32_bf16 v[52:55], a[4:7], v[140:143], v[52:55]
ds_read_b64_tr_b16 a[20:21], v106 offset:8192
v_accvgpr_read_b32 v38, a58
v_mfma_f32_16x16x32_bf16 v[52:55], a[0:3], v[132:135], v[52:55]
ds_read_b64_tr_b16 a[22:23], v106 offset:12288
v_accvgpr_read_b32 v39, a59
v_mfma_f32_16x16x32_bf16 v[56:59], a[0:3], a[128:131], v[56:59]
ds_read_b64_tr_b16 a[24:25], v107
buffer_load_dwordx4 v8, s[12:15], 0 offen lds
v_mfma_f32_16x16x32_bf16 v[56:59], a[4:7], a[136:139], v[56:59]
s_add_u32 m0, s47, 151552
ds_read_b64_tr_b16 a[26:27], v107 offset:4096
v_add_u32 v8, 0x17a00, v8
v_mfma_f32_16x16x32_bf16 v[60:63], a[4:7], a[140:143], v[60:63]
ds_read_b64_tr_b16 a[28:29], v107 offset:8192
v_max_f32 v32, 0, v32
v_mfma_f32_16x16x32_bf16 v[60:63], a[0:3], a[132:135], v[60:63]
ds_read_b64_tr_b16 a[30:31], v107 offset:12288
v_max_f32 v33, 0, v33
v_mfma_f32_16x16x32_bf16 v[64:67], a[8:11], v[128:131], v[64:67]
v_max_f32 v34, 0, v34
v_max_f32 v35, 0, v35
v_mfma_f32_16x16x32_bf16 v[64:67], a[12:15], v[136:139], v[64:67]
v_mul_f32 v32, v32, v36
v_mul_f32 v33, v33, v37
v_mfma_f32_16x16x32_bf16 v[68:71], a[12:15], v[140:143], v[68:71]
v_mul_f32 v34, v34, v38
v_mul_f32 v35, v35, v39
v_mfma_f32_16x16x32_bf16 v[68:71], a[8:11], v[132:135], v[68:71]
buffer_load_dwordx4 v8, s[12:15], 0 offen lds
v_mfma_f32_16x16x32_bf16 v[72:75], a[8:11], a[128:131], v[72:75]
s_add_u32 m0, s47, 155648
v_add_u32 v8, 0x3600, v8
v_cvt_pk_bf16_f32 v36, v32, v33
v_mfma_f32_16x16x32_bf16 v[72:75], a[12:15], a[136:139], v[72:75]
v_cvt_pk_bf16_f32 v37, v34, v35
v_accvgpr_write_b32 a104, v36
v_mfma_f32_16x16x32_bf16 v[76:79], a[12:15], a[140:143], v[76:79]
L_pad3:
s_cbranch_execz L_pad7
v_accvgpr_write_b32 a105, v37
v_accvgpr_read_b32 v32, a44
v_mfma_f32_16x16x32_bf16 v[76:79], a[8:11], a[132:135], v[76:79]
s_waitcnt vmcnt(10) lgkmcnt(0)
v_accvgpr_read_b32 v33, a45
v_accvgpr_read_b32 v34, a46
v_mfma_f32_16x16x32_bf16 v[80:83], a[16:19], v[128:131], v[80:83]
s_barrier
ds_read_b64_tr_b16 a[0:1], v104 offset:20480
v_accvgpr_read_b32 v35, a47
v_mfma_f32_16x16x32_bf16 v[80:83], a[20:23], v[136:139], v[80:83]
ds_read_b64_tr_b16 a[2:3], v104 offset:24576
v_accvgpr_read_b32 v36, a60
v_mfma_f32_16x16x32_bf16 v[84:87], a[20:23], v[140:143], v[84:87]
ds_read_b64_tr_b16 a[4:5], v104 offset:28672
buffer_load_dwordx4 v8, s[12:15], 0 offen lds
v_mfma_f32_16x16x32_bf16 v[84:87], a[16:19], v[132:135], v[84:87]
s_add_u32 m0, s47, 159744
ds_read_b64_tr_b16 a[6:7], v104 offset:32768
v_add_u32 v8, 0x17a00, v8
v_mfma_f32_16x16x32_bf16 v[88:91], a[16:19], a[128:131], v[88:91]
ds_read_b64_tr_b16 a[8:9], v105 offset:20480
v_accvgpr_read_b32 v37, a61
v_mfma_f32_16x16x32_bf16 v[88:91], a[20:23], a[136:139], v[88:91]
ds_read_b64_tr_b16 a[10:11], v105 offset:24576
v_accvgpr_read_b32 v38, a62
v_mfma_f32_16x16x32_bf16 v[92:95], a[20:23], a[140:143], v[92:95]
ds_read_b64_tr_b16 a[12:13], v105 offset:28672
v_accvgpr_read_b32 v39, a63
v_mfma_f32_16x16x32_bf16 v[92:95], a[16:19], a[132:135], v[92:95]
ds_read_b64_tr_b16 a[14:15], v105 offset:32768
v_max_f32 v32, 0, v32
v_mfma_f32_16x16x32_bf16 v[96:99], a[24:27], v[128:131], v[96:99]
ds_read_b64 v[14:15], v26 offset:16384
v_max_f32 v33, 0, v33
v_mfma_f32_16x16x32_bf16 v[96:99], a[28:31], v[136:139], v[96:99]
buffer_load_dwordx4 v8, s[12:15], 0 offen lds
v_mfma_f32_16x16x32_bf16 v[100:103], a[28:31], v[140:143], v[100:103]
s_add_u32 m0, s47, 0
v_add_u32 v8, 0x3600, v8
v_max_f32 v34, 0, v34
v_mfma_f32_16x16x32_bf16 v[100:103], a[24:27], v[132:135], v[100:103]
s_waitcnt lgkmcnt(1)
v_max_f32 v35, 0, v35
v_mul_f32 v32, v32, v36
v_mfma_f32_16x16x32_bf16 v[48:51], a[0:3], v[144:147], v[48:51]
ds_read_b64_tr_b16 a[16:17], v106 offset:20480
v_mul_f32 v33, v33, v37
v_mfma_f32_16x16x32_bf16 v[48:51], a[4:7], v[152:155], v[48:51]
ds_read_b64_tr_b16 a[18:19], v106 offset:24576
v_mul_f32 v34, v34, v38
v_mfma_f32_16x16x32_bf16 v[52:55], a[4:7], v[156:159], v[52:55]
s_waitcnt lgkmcnt(2)
ds_read_b64_tr_b16 a[20:21], v106 offset:28672
v_mul_f32 v35, v35, v39
v_mfma_f32_16x16x32_bf16 v[52:55], a[0:3], v[148:151], v[52:55]
ds_read_b64_tr_b16 a[22:23], v106 offset:32768
v_cvt_pk_bf16_f32 v36, v32, v33
v_mfma_f32_16x16x32_bf16 v[56:59], a[0:3], a[144:147], v[56:59]
ds_read_b64_tr_b16 a[24:25], v107 offset:20480
buffer_load_dwordx4 v8, s[12:15], 0 offen lds
v_mfma_f32_16x16x32_bf16 v[56:59], a[4:7], a[152:155], v[56:59]
s_add_u32 m0, s47, 4096
ds_read_b64_tr_b16 a[26:27], v107 offset:24576
v_add_u32 v8, 0x17a00, v8
v_mfma_f32_16x16x32_bf16 v[60:63], a[4:7], a[156:159], v[60:63]
ds_read_b64_tr_b16 a[28:29], v107 offset:28672
v_cvt_pk_bf16_f32 v37, v34, v35
v_mfma_f32_16x16x32_bf16 v[60:63], a[0:3], a[148:151], v[60:63]
ds_read_b64_tr_b16 a[30:31], v107 offset:32768
v_accvgpr_write_b32 a108, v36
v_mfma_f32_16x16x32_bf16 v[64:67], a[8:11], v[144:147], v[64:67]
v_accvgpr_write_b32 a109, v37
v_accvgpr_read_b32 v32, a64
v_mfma_f32_16x16x32_bf16 v[64:67], a[12:15], v[152:155], v[64:67]
v_accvgpr_read_b32 v33, a65
v_accvgpr_read_b32 v34, a66
v_mfma_f32_16x16x32_bf16 v[68:71], a[12:15], v[156:159], v[68:71]
v_accvgpr_read_b32 v35, a67
v_accvgpr_read_b32 v36, a80
v_mfma_f32_16x16x32_bf16 v[68:71], a[8:11], v[148:151], v[68:71]
buffer_load_dwordx4 v8, s[12:15], 0 offen lds
v_mfma_f32_16x16x32_bf16 v[72:75], a[8:11], a[144:147], v[72:75]
s_add_u32 m0, s47, 8192
v_add_u32 v8, 0x3600, v8
v_accvgpr_read_b32 v37, a81
v_mfma_f32_16x16x32_bf16 v[72:75], a[12:15], a[152:155], v[72:75]
v_accvgpr_read_b32 v38, a82
v_accvgpr_read_b32 v39, a83
v_mfma_f32_16x16x32_bf16 v[76:79], a[12:15], a[156:159], v[76:79]
v_max_f32 v32, 0, v32
v_max_f32 v33, 0, v33
v_mfma_f32_16x16x32_bf16 v[76:79], a[8:11], a[148:151], v[76:79]
s_waitcnt lgkmcnt(0)
v_max_f32 v34, 0, v34
v_max_f32 v35, 0, v35
v_mfma_f32_16x16x32_bf16 v[80:83], a[16:19], v[144:147], v[80:83]
ds_read_b64_tr_b16 a[0:1], v104 offset:36864
v_mul_f32 v32, v32, v36
v_mfma_f32_16x16x32_bf16 v[80:83], a[20:23], v[152:155], v[80:83]
ds_read_b64_tr_b16 a[2:3], v104 offset:40960
v_mul_f32 v33, v33, v37
v_mfma_f32_16x16x32_bf16 v[84:87], a[20:23], v[156:159], v[84:87]
ds_read_b64_tr_b16 a[4:5], v104 offset:45056
buffer_load_dwordx4 v8, s[12:15], 0 offen lds
v_mfma_f32_16x16x32_bf16 v[84:87], a[16:19], v[148:151], v[84:87]
s_add_u32 m0, s47, 12288
ds_read_b64_tr_b16 a[6:7], v104 offset:49152
v_add_u32 v8, 0x17a00, v8
v_mfma_f32_16x16x32_bf16 v[88:91], a[16:19], a[144:147], v[88:91]
ds_read_b64_tr_b16 a[8:9], v105 offset:36864
v_mul_f32 v34, v34, v38
v_mfma_f32_16x16x32_bf16 v[88:91], a[20:23], a[152:155], v[88:91]
ds_read_b64_tr_b16 a[10:11], v105 offset:40960
v_mul_f32 v35, v35, v39
v_mfma_f32_16x16x32_bf16 v[92:95], a[20:23], a[156:159], v[92:95]
ds_read_b64_tr_b16 a[12:13], v105 offset:45056
v_cvt_pk_bf16_f32 v36, v32, v33
v_mfma_f32_16x16x32_bf16 v[92:95], a[16:19], a[148:151], v[92:95]
ds_read_b64_tr_b16 a[14:15], v105 offset:49152
v_cvt_pk_bf16_f32 v37, v34, v35
v_mfma_f32_16x16x32_bf16 v[96:99], a[24:27], v[144:147], v[96:99]
v_accvgpr_write_b32 a98, v36
v_accvgpr_write_b32 a99, v37
v_mfma_f32_16x16x32_bf16 v[96:99], a[28:31], v[152:155], v[96:99]
buffer_load_dwordx4 v8, s[12:15], 0 offen lds
v_mfma_f32_16x16x32_bf16 v[100:103], a[28:31], v[156:159], v[100:103]
s_add_u32 m0, s47, 16384
v_add_u32 v8, 0x3600, v8
v_accvgpr_read_b32 v32, a68
v_mfma_f32_16x16x32_bf16 v[100:103], a[24:27], v[148:151], v[100:103]
s_waitcnt lgkmcnt(0)
v_accvgpr_read_b32 v33, a69
v_accvgpr_read_b32 v34, a70
v_mfma_f32_16x16x32_bf16 v[48:51], a[0:3], v[160:163], v[48:51]
ds_read_b64_tr_b16 a[16:17], v106 offset:36864
v_accvgpr_read_b32 v35, a71
v_mfma_f32_16x16x32_bf16 v[48:51], a[4:7], v[168:171], v[48:51]
ds_read_b64_tr_b16 a[18:19], v106 offset:40960
v_accvgpr_read_b32 v36, a84
v_mfma_f32_16x16x32_bf16 v[52:55], a[4:7], v[172:175], v[52:55]
ds_read_b64_tr_b16 a[20:21], v106 offset:45056
v_accvgpr_read_b32 v37, a85
v_mfma_f32_16x16x32_bf16 v[52:55], a[0:3], v[164:167], v[52:55]
ds_read_b64_tr_b16 a[22:23], v106 offset:49152
v_accvgpr_read_b32 v38, a86
v_mfma_f32_16x16x32_bf16 v[56:59], a[0:3], a[160:163], v[56:59]
ds_read_b64_tr_b16 a[24:25], v107 offset:36864
buffer_load_dwordx4 v8, s[12:15], 0 offen lds
v_mfma_f32_16x16x32_bf16 v[56:59], a[4:7], a[168:171], v[56:59]
s_add_u32 m0, s47, 20480
ds_read_b64_tr_b16 a[26:27], v107 offset:40960
v_add_u32 v8, 0x17a00, v8
v_mfma_f32_16x16x32_bf16 v[60:63], a[4:7], a[172:175], v[60:63]
ds_read_b64_tr_b16 a[28:29], v107 offset:45056
v_accvgpr_read_b32 v39, a87
v_mfma_f32_16x16x32_bf16 v[60:63], a[0:3], a[164:167], v[60:63]
ds_read_b64_tr_b16 a[30:31], v107 offset:49152
v_max_f32 v32, 0, v32
v_mfma_f32_16x16x32_bf16 v[64:67], a[8:11], v[160:163], v[64:67]
v_max_f32 v33, 0, v33
v_max_f32 v34, 0, v34
v_mfma_f32_16x16x32_bf16 v[64:67], a[12:15], v[168:171], v[64:67]
v_max_f32 v35, 0, v35
v_mul_f32 v32, v32, v36
v_mfma_f32_16x16x32_bf16 v[68:71], a[12:15], v[172:175], v[68:71]
v_mul_f32 v33, v33, v37
v_mul_f32 v34, v34, v38
v_mfma_f32_16x16x32_bf16 v[68:71], a[8:11], v[164:167], v[68:71]
buffer_load_dwordx4 v8, s[12:15], 0 offen lds
v_mfma_f32_16x16x32_bf16 v[72:75], a[8:11], a[160:163], v[72:75]
s_add_u32 m0, s47, 24576
v_add_u32 v8, 0x3600, v8
v_mul_f32 v35, v35, v39
v_mfma_f32_16x16x32_bf16 v[72:75], a[12:15], a[168:171], v[72:75]
v_cvt_pk_bf16_f32 v36, v32, v33
v_cvt_pk_bf16_f32 v37, v34, v35
v_mfma_f32_16x16x32_bf16 v[76:79], a[12:15], a[172:175], v[76:79]
v_accvgpr_write_b32 a102, v36
v_accvgpr_write_b32 a103, v37
v_mfma_f32_16x16x32_bf16 v[76:79], a[8:11], a[164:167], v[76:79]
s_waitcnt vmcnt(9) lgkmcnt(0)
v_accvgpr_read_b32 v32, a72
v_accvgpr_read_b32 v33, a73
v_mfma_f32_16x16x32_bf16 v[80:83], a[16:19], v[160:163], v[80:83]
s_barrier
ds_read_b64_tr_b16 a[0:1], v104 offset:53248
v_accvgpr_read_b32 v34, a74
v_mfma_f32_16x16x32_bf16 v[80:83], a[20:23], v[168:171], v[80:83]
ds_read_b64_tr_b16 a[2:3], v104 offset:57344
v_accvgpr_read_b32 v35, a75
v_mfma_f32_16x16x32_bf16 v[84:87], a[20:23], v[172:175], v[84:87]
ds_read_b64_tr_b16 a[4:5], v104 offset:61440
v_add_u32 v104, 0x10000, v104
v_mfma_f32_16x16x32_bf16 v[84:87], a[16:19], v[164:167], v[84:87]
ds_read_b64_tr_b16 a[6:7], v104
buffer_load_dwordx4 v8, s[12:15], 0 offen lds
v_mfma_f32_16x16x32_bf16 v[88:91], a[16:19], a[160:163], v[88:91]
s_add_u32 m0, s47, 28672
ds_read_b64_tr_b16 a[8:9], v105 offset:53248
v_add_u32 v8, 0x17a00, v8
v_mfma_f32_16x16x32_bf16 v[88:91], a[20:23], a[168:171], v[88:91]
ds_read_b64_tr_b16 a[10:11], v105 offset:57344
v_accvgpr_read_b32 v36, a88
v_mfma_f32_16x16x32_bf16 v[92:95], a[20:23], a[172:175], v[92:95]
ds_read_b64_tr_b16 a[12:13], v105 offset:61440
v_add_u32 v105, 0x10000, v105
v_mfma_f32_16x16x32_bf16 v[92:95], a[16:19], a[164:167], v[92:95]
ds_read_b64_tr_b16 a[14:15], v105
v_accvgpr_read_b32 v37, a89
v_mfma_f32_16x16x32_bf16 v[96:99], a[24:27], v[160:163], v[96:99]
v_accvgpr_read_b32 v38, a90
v_accvgpr_read_b32 v39, a91
v_mfma_f32_16x16x32_bf16 v[96:99], a[28:31], v[168:171], v[96:99]
buffer_load_dwordx4 v8, s[12:15], 0 offen lds
v_mfma_f32_16x16x32_bf16 v[100:103], a[28:31], v[172:175], v[100:103]
s_add_u32 m0, s47, 32768
v_add_u32 v8, 0x3600, v8
v_max_f32 v32, 0, v32
v_mfma_f32_16x16x32_bf16 v[100:103], a[24:27], v[164:167], v[100:103]
s_waitcnt lgkmcnt(0)
v_max_f32 v33, 0, v33
v_max_f32 v34, 0, v34
v_mfma_f32_16x16x32_bf16 v[48:51], a[0:3], v[176:179], v[48:51]
ds_read_b64_tr_b16 a[16:17], v106 offset:53248
v_max_f32 v35, 0, v35
v_mfma_f32_16x16x32_bf16 v[48:51], a[4:7], v[184:187], v[48:51]
ds_read_b64_tr_b16 a[18:19], v106 offset:57344
v_mul_f32 v32, v32, v36
v_mfma_f32_16x16x32_bf16 v[52:55], a[4:7], v[188:191], v[52:55]
ds_read_b64_tr_b16 a[20:21], v106 offset:61440
v_add_u32 v106, 0x10000, v106
v_mfma_f32_16x16x32_bf16 v[52:55], a[0:3], v[180:183], v[52:55]
ds_read_b64_tr_b16 a[22:23], v106
v_mul_f32 v33, v33, v37
v_mfma_f32_16x16x32_bf16 v[56:59], a[0:3], a[176:179], v[56:59]
ds_read_b64_tr_b16 a[24:25], v107 offset:53248
buffer_load_dwordx4 v8, s[12:15], 0 offen lds
v_mfma_f32_16x16x32_bf16 v[56:59], a[4:7], a[184:187], v[56:59]
s_add_u32 s1, s5, 128
s_and_b32 s1, s1, 384
ds_read_b64_tr_b16 a[26:27], v107 offset:57344
v_mfma_f32_16x16x32_bf16 v[60:63], a[4:7], a[188:191], v[60:63]
s_min_u32 s1, s1, 1
ds_read_b64_tr_b16 a[28:29], v107 offset:61440
v_add_u32 v107, 0x10000, v107
v_mfma_f32_16x16x32_bf16 v[60:63], a[0:3], a[180:183], v[60:63]
s_mul_i32 s1, s1, 512
s_add_u32 s1, s1, 0xffb37e80
ds_read_b64_tr_b16 a[30:31], v107
v_mfma_f32_16x16x32_bf16 v[64:67], a[8:11], v[176:179], v[64:67]
s_add_u32 m0, s47, 36864
v_add_u32 v6, s1, v6
v_mul_f32 v34, v34, v38
v_mfma_f32_16x16x32_bf16 v[64:67], a[12:15], v[184:187], v[64:67]
v_mul_f32 v35, v35, v39
v_cvt_pk_bf16_f32 v36, v32, v33
v_mfma_f32_16x16x32_bf16 v[68:71], a[12:15], v[188:191], v[68:71]
v_cvt_pk_bf16_f32 v37, v34, v35
v_accvgpr_write_b32 a106, v36
v_mfma_f32_16x16x32_bf16 v[68:71], a[8:11], v[180:183], v[68:71]
buffer_load_dwordx4 v6, s[16:19], 0 offen lds
v_mfma_f32_16x16x32_bf16 v[72:75], a[8:11], a[176:179], v[72:75]
s_add_u32 m0, s47, 40960
v_accvgpr_write_b32 a107, v37
v_accvgpr_read_b32 v32, a76
v_mfma_f32_16x16x32_bf16 v[72:75], a[12:15], a[184:187], v[72:75]
v_accvgpr_read_b32 v33, a77
v_accvgpr_read_b32 v34, a78
v_mfma_f32_16x16x32_bf16 v[76:79], a[12:15], a[188:191], v[76:79]
v_accvgpr_read_b32 v35, a79
v_accvgpr_read_b32 v36, a92
v_mfma_f32_16x16x32_bf16 v[76:79], a[8:11], a[180:183], v[76:79]
s_waitcnt lgkmcnt(0)
v_accvgpr_read_b32 v37, a93
v_accvgpr_read_b32 v38, a94
v_mfma_f32_16x16x32_bf16 v[80:83], a[16:19], v[176:179], v[80:83]
ds_read_b64_tr_b16 a[0:1], v104 offset:4096
v_accvgpr_read_b32 v39, a95
v_mfma_f32_16x16x32_bf16 v[80:83], a[20:23], v[184:187], v[80:83]
ds_read_b64_tr_b16 a[2:3], v104 offset:8192
buffer_load_dwordx4 v6, s[20:23], 0 offen lds
v_mfma_f32_16x16x32_bf16 v[84:87], a[20:23], v[188:191], v[84:87]
s_add_u32 m0, s47, 45056
ds_read_b64_tr_b16 a[4:5], v104 offset:12288
v_add_u32 v6, 0x48000, v6
v_mfma_f32_16x16x32_bf16 v[84:87], a[16:19], v[180:183], v[84:87]
ds_read_b64_tr_b16 a[6:7], v104 offset:16384
v_max_f32 v32, 0, v32
v_mfma_f32_16x16x32_bf16 v[88:91], a[16:19], a[176:179], v[88:91]
ds_read_b64_tr_b16 a[8:9], v105 offset:4096
v_max_f32 v33, 0, v33
v_mfma_f32_16x16x32_bf16 v[88:91], a[20:23], a[184:187], v[88:91]
ds_read_b64_tr_b16 a[10:11], v105 offset:8192
v_max_f32 v34, 0, v34
v_mfma_f32_16x16x32_bf16 v[92:95], a[20:23], a[188:191], v[92:95]
ds_read_b64_tr_b16 a[12:13], v105 offset:12288
v_max_f32 v35, 0, v35
v_mfma_f32_16x16x32_bf16 v[92:95], a[16:19], a[180:183], v[92:95]
ds_read_b64_tr_b16 a[14:15], v105 offset:16384
buffer_load_dwordx4 v6, s[16:19], 0 offen lds
v_mfma_f32_16x16x32_bf16 v[96:99], a[24:27], v[176:179], v[96:99]
s_add_u32 m0, s47, 49152
v_mul_f32 v32, v32, v36
v_mul_f32 v33, v33, v37
v_mfma_f32_16x16x32_bf16 v[96:99], a[28:31], v[184:187], v[96:99]
v_mul_f32 v34, v34, v38
v_mul_f32 v35, v35, v39
v_mfma_f32_16x16x32_bf16 v[100:103], a[28:31], v[188:191], v[100:103]
v_cvt_pk_bf16_f32 v36, v32, v33
v_cvt_pk_bf16_f32 v37, v34, v35
v_mfma_f32_16x16x32_bf16 v[100:103], a[24:27], v[180:183], v[100:103]
s_waitcnt lgkmcnt(0)
v_accvgpr_write_b32 a110, v36
v_accvgpr_write_b32 a111, v37
v_mfma_f32_16x16x32_bf16 v[48:51], a[0:3], v[192:195], v[48:51]
ds_read_b64_tr_b16 a[16:17], v106 offset:4096
v_lshrrev_b32 v40, 4, v1
v_mfma_f32_16x16x32_bf16 v[48:51], a[4:7], v[200:203], v[48:51]
ds_read_b64_tr_b16 a[18:19], v106 offset:8192
buffer_load_dwordx4 v6, s[20:23], 0 offen lds
v_mfma_f32_16x16x32_bf16 v[52:55], a[4:7], v[204:207], v[52:55]
s_add_u32 m0, s47, 53248
ds_read_b64_tr_b16 a[20:21], v106 offset:12288
v_add_u32 v6, 0x48000, v6
v_mfma_f32_16x16x32_bf16 v[52:55], a[0:3], v[196:199], v[52:55]
ds_read_b64_tr_b16 a[22:23], v106 offset:16384
v_lshl_add_u32 v40, v40, 1, s50
v_mfma_f32_16x16x32_bf16 v[56:59], a[0:3], a[192:195], v[56:59]
ds_read_b64_tr_b16 a[24:25], v107 offset:4096
v_cmp_gt_u32 vcc, 32, v40
v_mfma_f32_16x16x32_bf16 v[56:59], a[4:7], a[200:203], v[56:59]
ds_read_b64_tr_b16 a[26:27], v107 offset:8192
v_mov_b32 v41, 1051597459
v_mfma_f32_16x16x32_bf16 v[60:63], a[4:7], a[204:207], v[60:63]
ds_read_b64_tr_b16 a[28:29], v107 offset:12288
v_lshrrev_b32 v42, 5, v1
v_mfma_f32_16x16x32_bf16 v[60:63], a[0:3], a[196:199], v[60:63]
ds_read_b64_tr_b16 a[30:31], v107 offset:16384
buffer_load_dwordx4 v6, s[16:19], 0 offen lds
v_mfma_f32_16x16x32_bf16 v[64:67], a[8:11], v[192:195], v[64:67]
s_add_u32 m0, s47, 57344
v_cndmask_b32 v20, 1.0, v41, vcc
v_lshl_add_u32 v43, v42, 2, s50
v_mfma_f32_16x16x32_bf16 v[64:67], a[12:15], v[200:203], v[64:67]
v_and_b32 v44, 31, v1
v_lshlrev_b32 v44, 2, v44
v_mfma_f32_16x16x32_bf16 v[68:71], a[12:15], v[204:207], v[68:71]
v_mul_u32_u24 v45, 622592, v42
v_add_u32 v44, v44, v45
v_mfma_f32_16x16x32_bf16 v[68:71], a[8:11], v[196:199], v[68:71]
v_mov_b32 v46, 2147483648
v_cmp_gt_u32 vcc, 64, v43
v_mfma_f32_16x16x32_bf16 v[72:75], a[8:11], a[192:195], v[72:75]
v_lshl_add_u32 v43, v42, 6, v43
v_add_u32 v45, 311296, v44
v_mfma_f32_16x16x32_bf16 v[72:75], a[12:15], a[200:203], v[72:75]
buffer_load_dwordx4 v6, s[20:23], 0 offen lds
v_mfma_f32_16x16x32_bf16 v[76:79], a[12:15], a[204:207], v[76:79]
s_add_u32 m0, s47, 61440
v_add_u32 v6, 0x48000, v6
v_cndmask_b32 v21, v46, v44, vcc
v_mfma_f32_16x16x32_bf16 v[76:79], a[8:11], a[196:199], v[76:79]
s_waitcnt vmcnt(10) lgkmcnt(0)
v_cmp_gt_u32 vcc, 62, v43
v_bfe_u32 v40, v1, 1, 3
v_mfma_f32_16x16x32_bf16 v[80:83], a[16:19], v[192:195], v[80:83]
s_barrier
ds_read_b64_tr_b16 a[0:1], v104 offset:20480
v_and_b32 v41, 1, v1
v_mfma_f32_16x16x32_bf16 v[80:83], a[20:23], v[200:203], v[80:83]
ds_read_b64_tr_b16 a[2:3], v104 offset:24576
v_cndmask_b32 v22, v46, v45, vcc
v_mfma_f32_16x16x32_bf16 v[84:87], a[20:23], v[204:207], v[84:87]
ds_read_b64_tr_b16 a[4:5], v104 offset:28672
v_add_u32 v104, 0xfffe0000, v104
v_mfma_f32_16x16x32_bf16 v[84:87], a[16:19], v[196:199], v[84:87]
ds_read_b64_tr_b16 a[6:7], v104
buffer_load_dwordx4 v6, s[16:19], 0 offen lds
v_mfma_f32_16x16x32_bf16 v[88:91], a[16:19], a[192:195], v[88:91]
s_add_u32 m0, s47, 65536
ds_read_b64_tr_b16 a[8:9], v105 offset:20480
v_lshrrev_b32 v42, 4, v1
v_mfma_f32_16x16x32_bf16 v[88:91], a[20:23], a[200:203], v[88:91]
ds_read_b64_tr_b16 a[10:11], v105 offset:24576
v_lshl_add_u32 v41, v41, 2, v42
v_mfma_f32_16x16x32_bf16 v[92:95], a[20:23], a[204:207], v[92:95]
ds_read_b64_tr_b16 a[12:13], v105 offset:28672
v_add_u32 v105, 0xfffe0000, v105
v_mfma_f32_16x16x32_bf16 v[92:95], a[16:19], a[196:199], v[92:95]
ds_read_b64_tr_b16 a[14:15], v105
v_mul_u32_u24 v43, 155648, v40
v_mfma_f32_16x16x32_bf16 v[96:99], a[24:27], v[192:195], v[96:99]
v_lshl_add_u32 v43, v41, 4, v43
v_cmp_gt_u32 vcc, 6, v40
v_mfma_f32_16x16x32_bf16 v[96:99], a[28:31], v[200:203], v[96:99]
buffer_load_dwordx4 v6, s[20:23], 0 offen lds
v_mfma_f32_16x16x32_bf16 v[100:103], a[28:31], v[204:207], v[100:103]
s_add_u32 m0, s47, 69632
v_add_u32 v6, 0x48000, v6
v_add_u32 v40, s50, v40
v_mfma_f32_16x16x32_bf16 v[100:103], a[24:27], v[196:199], v[100:103]
s_waitcnt lgkmcnt(0)
v_cndmask_b32 v43, v46, v43, vcc
v_cmp_le_u32 vcc, 64, v40
v_mfma_f32_16x16x32_bf16 v[48:51], a[0:3], v[208:211], v[48:51]
ds_read_b64_tr_b16 a[16:17], v106 offset:20480
v_lshrrev_b32 v40, 3, v1
v_mfma_f32_16x16x32_bf16 v[48:51], a[4:7], v[216:219], v[48:51]
ds_read_b64_tr_b16 a[18:19], v106 offset:24576
v_and_b32 v41, 3, v1
v_mfma_f32_16x16x32_bf16 v[52:55], a[4:7], v[220:223], v[52:55]
ds_read_b64_tr_b16 a[20:21], v106 offset:28672
v_add_u32 v106, 0xfffe0000, v106
v_mfma_f32_16x16x32_bf16 v[52:55], a[0:3], v[212:215], v[52:55]
ds_read_b64_tr_b16 a[22:23], v106
buffer_load_dwordx4 v6, s[16:19], 0 offen lds
v_mfma_f32_16x16x32_bf16 v[56:59], a[0:3], a[208:211], v[56:59]
s_add_u32 m0, s47, 73728
ds_read_b64_tr_b16 a[24:25], v107 offset:20480
v_cndmask_b32 v23, v46, v43, vcc
v_mfma_f32_16x16x32_bf16 v[56:59], a[4:7], a[216:219], v[56:59]
ds_read_b64_tr_b16 a[26:27], v107 offset:24576
v_cmp_eq_u32 s[62:63], 0, v41
v_mfma_f32_16x16x32_bf16 v[60:63], a[4:7], a[220:223], v[60:63]
ds_read_b64_tr_b16 a[28:29], v107 offset:28672
v_add_u32 v107, 0xfffe0000, v107
v_mfma_f32_16x16x32_bf16 v[60:63], a[0:3], a[212:215], v[60:63]
ds_read_b64_tr_b16 a[30:31], v107
v_mul_u32_u24 v43, 155520, v40
v_mfma_f32_16x16x32_bf16 v[64:67], a[8:11], v[208:211], v[64:67]
v_cmp_gt_u32 vcc, 6, v40
v_add_u32 v43, v43, v10
v_mfma_f32_16x16x32_bf16 v[64:67], a[12:15], v[216:219], v[64:67]
buffer_load_dwordx4 v6, s[20:23], 0 offen lds
v_mfma_f32_16x16x32_bf16 v[68:71], a[12:15], v[220:223], v[68:71]
s_add_u32 m0, s47, 77824
v_add_u32 v6, 0x48000, v6
v_add_u32 v40, s50, v40
v_mfma_f32_16x16x32_bf16 v[68:71], a[8:11], v[212:215], v[68:71]
v_cndmask_b32 v43, v46, v43, vcc
v_cmp_le_u32 vcc, 64, v40
v_mfma_f32_16x16x32_bf16 v[72:75], a[8:11], a[208:211], v[72:75]
s_nop 0
v_cndmask_b32 v24, v46, v43, vcc
v_mfma_f32_16x16x32_bf16 v[72:75], a[12:15], a[216:219], v[72:75]
s_min_u32 s57, s46, 1
s_lshl_b32 s57, s57, 30
s_lshl_b32 s54, s45, 9
v_mfma_f32_16x16x32_bf16 v[76:79], a[12:15], a[220:223], v[76:79]
s_add_u32 s57, s57, s54
s_lshl_b32 s54, s44, 7
s_add_u32 s57, s57, s54
v_mfma_f32_16x16x32_bf16 v[76:79], a[8:11], a[212:215], v[76:79]
s_waitcnt lgkmcnt(0)
s_add_u32 s54, s57, 56885248
buffer_load_dwordx4 v6, s[16:19], 0 offen lds
v_mfma_f32_16x16x32_bf16 v[80:83], a[16:19], v[208:211], v[80:83]
s_add_u32 m0, s47, 81920
ds_read_b64_tr_b16 a[0:1], v104 offset:4096
v_cmp_gt_u32 vcc, 16, v1
v_mfma_f32_16x16x32_bf16 v[80:83], a[20:23], v[216:219], v[80:83]
ds_read_b64_tr_b16 a[2:3], v104 offset:8192
v_lshrrev_b32 v25, 5, v1
v_mfma_f32_16x16x32_bf16 v[84:87], a[20:23], v[220:223], v[84:87]
ds_read_b64_tr_b16 a[4:5], v104 offset:12288
v_lshlrev_b32 v25, 29, v25
v_mfma_f32_16x16x32_bf16 v[84:87], a[16:19], v[212:215], v[84:87]
ds_read_b64_tr_b16 a[6:7], v104 offset:16384
v_cndmask_b32 v26, v13, v12, vcc
v_mfma_f32_16x16x32_bf16 v[88:91], a[16:19], a[208:211], v[88:91]
ds_read_b64_tr_b16 a[8:9], v105 offset:4096
v_add_lshl_u32 v25, v25, v1, 2
v_mfma_f32_16x16x32_bf16 v[88:91], a[20:23], a[216:219], v[88:91]
ds_read_b64_tr_b16 a[10:11], v105 offset:8192
buffer_load_dwordx4 v6, s[20:23], 0 offen lds
v_mfma_f32_16x16x32_bf16 v[92:95], a[20:23], a[220:223], v[92:95]
s_add_u32 m0, s47, 86016
ds_read_b64_tr_b16 a[12:13], v105 offset:12288
v_add_u32 v6, 0x48000, v6
v_mfma_f32_16x16x32_bf16 v[92:95], a[16:19], a[212:215], v[92:95]
ds_read_b64_tr_b16 a[14:15], v105 offset:16384
v_mfma_f32_16x16x32_bf16 v[96:99], a[24:27], v[208:211], v[96:99]
buffer_store_dword v26, v25, s[28:31], s54 offen sc1
v_mfma_f32_16x16x32_bf16 v[96:99], a[28:31], v[216:219], v[96:99]
v_mfma_f32_16x16x32_bf16 v[100:103], a[28:31], v[220:223], v[100:103]
v_mfma_f32_16x16x32_bf16 v[100:103], a[24:27], v[212:215], v[100:103]
s_waitcnt lgkmcnt(0)
buffer_load_dwordx4 v6, s[16:19], 0 offen lds
v_mfma_f32_16x16x32_bf16 v[48:51], a[0:3], v[224:227], v[48:51]
s_add_u32 m0, s47, 90112
ds_read_b64_tr_b16 a[16:17], v106 offset:4096
v_mfma_f32_16x16x32_bf16 v[48:51], a[4:7], v[232:235], v[48:51]
ds_read_b64_tr_b16 a[18:19], v106 offset:8192
v_mfma_f32_16x16x32_bf16 v[52:55], a[4:7], v[236:239], v[52:55]
ds_read_b64_tr_b16 a[20:21], v106 offset:12288
v_mfma_f32_16x16x32_bf16 v[52:55], a[0:3], v[228:231], v[52:55]
ds_read_b64_tr_b16 a[22:23], v106 offset:16384
v_mfma_f32_16x16x32_bf16 v[56:59], a[0:3], a[224:227], v[56:59]
ds_read_b64_tr_b16 a[24:25], v107 offset:4096
v_mfma_f32_16x16x32_bf16 v[56:59], a[4:7], a[232:235], v[56:59]
ds_read_b64_tr_b16 a[26:27], v107 offset:8192
buffer_load_dwordx4 v6, s[20:23], 0 offen lds
v_mfma_f32_16x16x32_bf16 v[60:63], a[4:7], a[236:239], v[60:63]
s_add_u32 m0, s47, 94208
ds_read_b64_tr_b16 a[28:29], v107 offset:12288
v_add_u32 v6, 0x48000, v6
v_mfma_f32_16x16x32_bf16 v[60:63], a[0:3], a[228:231], v[60:63]
ds_read_b64_tr_b16 a[30:31], v107 offset:16384
v_mfma_f32_16x16x32_bf16 v[64:67], a[8:11], v[224:227], v[64:67]
v_mfma_f32_16x16x32_bf16 v[64:67], a[12:15], v[232:235], v[64:67]
v_mfma_f32_16x16x32_bf16 v[68:71], a[12:15], v[236:239], v[68:71]
v_mfma_f32_16x16x32_bf16 v[68:71], a[8:11], v[228:231], v[68:71]
buffer_load_dwordx4 v6, s[16:19], 0 offen lds
v_mfma_f32_16x16x32_bf16 v[72:75], a[8:11], a[224:227], v[72:75]
s_add_u32 m0, s47, 98304
v_mfma_f32_16x16x32_bf16 v[72:75], a[12:15], a[232:235], v[72:75]
v_mfma_f32_16x16x32_bf16 v[76:79], a[12:15], a[236:239], v[76:79]
v_mfma_f32_16x16x32_bf16 v[76:79], a[8:11], a[228:231], v[76:79]
s_waitcnt vmcnt(16) lgkmcnt(0)
v_mfma_f32_16x16x32_bf16 v[80:83], a[16:19], v[224:227], v[80:83]
s_barrier
ds_read_b64_tr_b16 a[0:1], v104 offset:20480
v_mfma_f32_16x16x32_bf16 v[80:83], a[20:23], v[232:235], v[80:83]
ds_read_b64_tr_b16 a[2:3], v104 offset:24576
buffer_load_dwordx4 v6, s[20:23], 0 offen lds
v_mfma_f32_16x16x32_bf16 v[84:87], a[20:23], v[236:239], v[84:87]
s_add_u32 m0, s47, 102400
ds_read_b64_tr_b16 a[4:5], v104 offset:28672
v_add_u32 v6, 0x48000, v6
v_mfma_f32_16x16x32_bf16 v[84:87], a[16:19], v[228:231], v[84:87]
ds_read_b64_tr_b16 a[6:7], v104 offset:32768
v_mfma_f32_16x16x32_bf16 v[88:91], a[16:19], a[224:227], v[88:91]
ds_read_b64_tr_b16 a[8:9], v105 offset:20480
v_mfma_f32_16x16x32_bf16 v[88:91], a[20:23], a[232:235], v[88:91]
ds_read_b64_tr_b16 a[10:11], v105 offset:24576
v_mfma_f32_16x16x32_bf16 v[92:95], a[20:23], a[236:239], v[92:95]
ds_read_b64_tr_b16 a[12:13], v105 offset:28672
v_mfma_f32_16x16x32_bf16 v[92:95], a[16:19], a[228:231], v[92:95]
ds_read_b64_tr_b16 a[14:15], v105 offset:32768
buffer_load_dwordx4 v6, s[16:19], 0 offen lds
v_mfma_f32_16x16x32_bf16 v[96:99], a[24:27], v[224:227], v[96:99]
s_add_u32 m0, s47, 106496
v_mfma_f32_16x16x32_bf16 v[96:99], a[28:31], v[232:235], v[96:99]
v_mfma_f32_16x16x32_bf16 v[100:103], a[28:31], v[236:239], v[100:103]
v_mfma_f32_16x16x32_bf16 v[100:103], a[24:27], v[228:231], v[100:103]
s_waitcnt lgkmcnt(0)
v_mfma_f32_16x16x32_bf16 v[48:51], a[0:3], v[240:243], v[48:51]
ds_read_b64_tr_b16 a[16:17], v106 offset:20480
v_mfma_f32_16x16x32_bf16 v[48:51], a[4:7], v[248:251], v[48:51]
ds_read_b64_tr_b16 a[18:19], v106 offset:24576
buffer_load_dwordx4 v6, s[20:23], 0 offen lds
v_mfma_f32_16x16x32_bf16 v[52:55], a[4:7], v[252:255], v[52:55]
s_add_u32 m0, s47, 110592
ds_read_b64_tr_b16 a[20:21], v106 offset:28672
v_add_u32 v6, 0x48000, v6
v_mfma_f32_16x16x32_bf16 v[52:55], a[0:3], v[244:247], v[52:55]
ds_read_b64_tr_b16 a[22:23], v106 offset:32768
v_mfma_f32_16x16x32_bf16 v[56:59], a[0:3], a[240:243], v[56:59]
ds_read_b64_tr_b16 a[24:25], v107 offset:20480
v_mfma_f32_16x16x32_bf16 v[56:59], a[4:7], a[248:251], v[56:59]
L_pad4:
s_cbranch_execz L_pad8
ds_read_b64_tr_b16 a[26:27], v107 offset:24576
v_mfma_f32_16x16x32_bf16 v[60:63], a[4:7], a[252:255], v[60:63]
ds_read_b64_tr_b16 a[28:29], v107 offset:28672
v_mfma_f32_16x16x32_bf16 v[60:63], a[0:3], a[244:247], v[60:63]
ds_read_b64_tr_b16 a[30:31], v107 offset:32768
buffer_load_dwordx4 v6, s[16:19], 0 offen lds
v_mfma_f32_16x16x32_bf16 v[64:67], a[8:11], v[240:243], v[64:67]
s_add_u32 m0, s47, 114688
v_mfma_f32_16x16x32_bf16 v[64:67], a[12:15], v[248:251], v[64:67]
v_mfma_f32_16x16x32_bf16 v[68:71], a[12:15], v[252:255], v[68:71]
v_mfma_f32_16x16x32_bf16 v[68:71], a[8:11], v[244:247], v[68:71]
v_mfma_f32_16x16x32_bf16 v[72:75], a[8:11], a[240:243], v[72:75]
v_mfma_f32_16x16x32_bf16 v[72:75], a[12:15], a[248:251], v[72:75]
buffer_load_dwordx4 v6, s[20:23], 0 offen lds
v_mfma_f32_16x16x32_bf16 v[76:79], a[12:15], a[252:255], v[76:79]
s_add_u32 m0, s47, 118784
v_add_u32 v6, 0x48000, v6
v_mfma_f32_16x16x32_bf16 v[76:79], a[8:11], a[244:247], v[76:79]
s_waitcnt vmcnt(13) lgkmcnt(0)
v_mfma_f32_16x16x32_bf16 v[80:83], a[16:19], v[240:243], v[80:83]
s_barrier
ds_read_b64_tr_b16 a[0:1], v2 offset:36864
v_mfma_f32_16x16x32_bf16 v[80:83], a[20:23], v[248:251], v[80:83]
ds_read_b64_tr_b16 a[2:3], v2 offset:38912
v_mfma_f32_16x16x32_bf16 v[84:87], a[20:23], v[252:255], v[84:87]
ds_read_b64_tr_b16 a[4:5], v2 offset:45056
v_mfma_f32_16x16x32_bf16 v[84:87], a[16:19], v[244:247], v[84:87]
ds_read_b64_tr_b16 a[6:7], v2 offset:47104
buffer_load_dwordx4 v6, s[16:19], 0 offen lds
v_mfma_f32_16x16x32_bf16 v[88:91], a[16:19], a[240:243], v[88:91]
s_add_u32 m0, s47, 122880
ds_read_b64_tr_b16 a[8:9], v2 offset:53248
v_mfma_f32_16x16x32_bf16 v[88:91], a[20:23], a[248:251], v[88:91]
ds_read_b64_tr_b16 a[10:11], v2 offset:55296
v_mfma_f32_16x16x32_bf16 v[92:95], a[20:23], a[252:255], v[92:95]
ds_read_b64_tr_b16 a[12:13], v2 offset:61440
v_mfma_f32_16x16x32_bf16 v[92:95], a[16:19], a[244:247], v[92:95]
ds_read_b64_tr_b16 a[14:15], v2 offset:63488
v_mfma_f32_16x16x32_bf16 v[96:99], a[24:27], v[240:243], v[96:99]
v_mfma_f32_16x16x32_bf16 v[96:99], a[28:31], v[248:251], v[96:99]
buffer_load_dwordx4 v6, s[20:23], 0 offen lds
v_mfma_f32_16x16x32_bf16 v[100:103], a[28:31], v[252:255], v[100:103]
s_add_u32 m0, s47, 126976
v_add_u32 v6, 0x48000, v6
v_mfma_f32_16x16x32_bf16 v[100:103], a[24:27], v[244:247], v[100:103]
s_waitcnt lgkmcnt(0)
v_mfma_f32_16x16x32_bf16 a[32:35], a[0:3], v[112:115], 0
ds_read_b64_tr_b16 a[16:17], v2 offset:40960
v_mfma_f32_16x16x32_bf16 a[32:35], a[4:7], v[120:123], a[32:35]
s_add_u32 s58, s50, 0
s_lshr_b32 s51, s58, 5
s_min_u32 s51, s51, 1
ds_read_b64_tr_b16 a[18:19], v2 offset:43008
v_mfma_f32_16x16x32_bf16 a[32:35], a[8:11], v[128:131], a[32:35]
s_mul_i32 s51, s51, 0xd1e56d
s_add_u32 s51, s51, 1051597459
ds_read_b64_tr_b16 a[20:21], v2 offset:49152
v_mfma_f32_16x16x32_bf16 a[32:35], a[12:15], v[136:139], a[32:35]
ds_read_b64_tr_b16 a[22:23], v2 offset:51200
buffer_load_dwordx4 v6, s[16:19], 0 offen lds
v_mfma_f32_16x16x32_bf16 a[36:39], a[12:15], v[140:143], 0
s_add_u32 m0, s47, 131072
ds_read_b64_tr_b16 a[24:25], v2 offset:57344
v_sqrt_f32 v25, v12
v_mfma_f32_16x16x32_bf16 a[36:39], a[8:11], v[132:135], a[36:39]
ds_read_b64_tr_b16 a[26:27], v2 offset:59392
v_add_u32 v2, 0x10000, v2
v_mfma_f32_16x16x32_bf16 a[36:39], a[4:7], v[124:127], a[36:39]
ds_read_b64_tr_b16 a[28:29], v2
v_mfma_f32_16x16x32_bf16 a[36:39], a[0:3], v[116:119], a[36:39]
ds_read_b64_tr_b16 a[30:31], v2 offset:2048
v_mfma_f32_16x16x32_bf16 a[40:43], a[0:3], a[112:115], 0
v_sqrt_f32 v26, v13
v_mfma_f32_16x16x32_bf16 a[40:43], a[4:7], a[120:123], a[40:43]
buffer_load_dwordx4 v6, s[20:23], 0 offen lds
v_mfma_f32_16x16x32_bf16 a[40:43], a[8:11], a[128:131], a[40:43]
s_add_u32 m0, s47, 135168
v_add_u32 v6, 0x48000, v6
v_mul_f32 v25, s51, v25
v_mfma_f32_16x16x32_bf16 a[40:43], a[12:15], a[136:139], a[40:43]
v_mul_f32 v26, s51, v26
v_mul_f32 v48, v25, v48
v_mfma_f32_16x16x32_bf16 a[44:47], a[12:15], a[140:143], 0
v_mul_f32 v49, v25, v49
v_mul_f32 v50, v25, v50
v_mfma_f32_16x16x32_bf16 a[44:47], a[8:11], a[132:135], a[44:47]
v_mul_f32 v51, v25, v51
v_mul_f32 v52, v26, v52
v_mfma_f32_16x16x32_bf16 a[44:47], a[4:7], a[124:127], a[44:47]
v_mul_f32 v53, v26, v53
v_mul_f32 v54, v26, v54
v_mfma_f32_16x16x32_bf16 a[44:47], a[0:3], a[116:119], a[44:47]
s_waitcnt lgkmcnt(0)
buffer_load_dwordx4 v6, s[16:19], 0 offen lds
v_mfma_f32_16x16x32_bf16 a[48:51], a[16:19], v[112:115], 0
s_add_u32 m0, s47, 139264
ds_read_b64_tr_b16 a[0:1], v3 offset:36864
v_mul_f32 v55, v26, v55
v_mfma_f32_16x16x32_bf16 a[48:51], a[20:23], v[120:123], a[48:51]
ds_read_b64_tr_b16 a[2:3], v3 offset:38912
v_cvt_pk_bf16_f32 v40, v48, v49
v_mfma_f32_16x16x32_bf16 a[48:51], a[24:27], v[128:131], a[48:51]
ds_read_b64_tr_b16 a[4:5], v3 offset:45056
v_cvt_pk_bf16_f32 v41, v50, v51
v_mfma_f32_16x16x32_bf16 a[48:51], a[28:31], v[136:139], a[48:51]
ds_read_b64_tr_b16 a[6:7], v3 offset:47104
v_cvt_pk_bf16_f32 v42, v52, v53
v_mfma_f32_16x16x32_bf16 a[52:55], a[28:31], v[140:143], 0
ds_read_b64_tr_b16 a[8:9], v3 offset:53248
v_cvt_pk_bf16_f32 v43, v54, v55
v_mfma_f32_16x16x32_bf16 a[52:55], a[24:27], v[132:135], a[52:55]
ds_read_b64_tr_b16 a[10:11], v3 offset:55296
buffer_load_dwordx4 v6, s[20:23], 0 offen lds
v_mfma_f32_16x16x32_bf16 a[52:55], a[20:23], v[124:127], a[52:55]
s_add_u32 m0, s47, 143360
ds_read_b64_tr_b16 a[12:13], v3 offset:61440
v_add_u32 v6, 0x48000, v6
v_mfma_f32_16x16x32_bf16 a[52:55], a[16:19], v[116:119], a[52:55]
ds_read_b64_tr_b16 a[14:15], v3 offset:63488
v_mfma_f32_16x16x16_bf16 v[48:51], v[40:41], v[30:31], 0
v_mfma_f32_16x16x16_bf16 v[52:55], v[42:43], v[30:31], 0
v_mfma_f32_16x16x32_bf16 a[56:59], a[16:19], a[112:115], 0
v_mfma_f32_16x16x32_bf16 a[56:59], a[20:23], a[120:123], a[56:59]
buffer_load_dwordx4 v6, s[16:19], 0 offen lds
v_mfma_f32_16x16x32_bf16 a[56:59], a[24:27], a[128:131], a[56:59]
s_add_u32 m0, s47, 147456
v_mfma_f32_16x16x32_bf16 a[56:59], a[28:31], a[136:139], a[56:59]
s_lshr_b32 s54, s58, 6
s_mul_i32 s52, s54, -1
s_mov_b32 s53, s52
v_mfma_f32_16x16x32_bf16 a[60:63], a[28:31], a[140:143], 0
s_mul_i32 s61, s54, 0xffb40480
s_add_u32 s54, s61, s48
s_add_u32 s54, s54, 0
v_mfma_f32_16x16x32_bf16 a[60:63], a[24:27], a[132:135], a[60:63]
v_cvt_pk_bf16_f32 v44, v48, v49
v_cvt_pk_bf16_f32 v45, v50, v51
v_mfma_f32_16x16x32_bf16 a[60:63], a[20:23], a[124:127], a[60:63]
v_cvt_pk_bf16_f32 v46, v52, v53
v_cvt_pk_bf16_f32 v47, v54, v55
v_mfma_f32_16x16x32_bf16 a[60:63], a[16:19], a[116:119], a[60:63]
s_waitcnt lgkmcnt(0)
buffer_load_dwordx4 v6, s[20:23], 0 offen lds
v_mfma_f32_16x16x32_bf16 a[64:67], a[0:3], v[112:115], 0
s_add_u32 m0, s47, 151552
ds_read_b64_tr_b16 a[16:17], v3 offset:40960
v_add_u32 v6, 0x48000, v6
v_mfma_f32_16x16x32_bf16 a[64:67], a[4:7], v[120:123], a[64:67]
ds_read_b64_tr_b16 a[18:19], v3 offset:43008
v_cndmask_b32 v44, v40, v44, s[52:53]
v_mfma_f32_16x16x32_bf16 a[64:67], a[8:11], v[128:131], a[64:67]
ds_read_b64_tr_b16 a[20:21], v3 offset:49152
v_cndmask_b32 v45, v41, v45, s[52:53]
v_mfma_f32_16x16x32_bf16 a[64:67], a[12:15], v[136:139], a[64:67]
ds_read_b64_tr_b16 a[22:23], v3 offset:51200
v_cndmask_b32 v46, v42, v46, s[52:53]
v_mfma_f32_16x16x32_bf16 a[68:71], a[12:15], v[140:143], 0
ds_read_b64_tr_b16 a[24:25], v3 offset:57344
v_cndmask_b32 v47, v43, v47, s[52:53]
v_mfma_f32_16x16x32_bf16 a[68:71], a[8:11], v[132:135], a[68:71]
ds_read_b64_tr_b16 a[26:27], v3 offset:59392
v_add_u32 v3, 0x10000, v3
v_mfma_f32_16x16x32_bf16 a[68:71], a[4:7], v[124:127], a[68:71]
ds_read_b64_tr_b16 a[28:29], v3
buffer_load_dwordx4 v6, s[16:19], 0 offen lds
v_mfma_f32_16x16x32_bf16 a[68:71], a[0:3], v[116:119], a[68:71]
s_add_u32 m0, s47, 155648
ds_read_b64_tr_b16 a[30:31], v3 offset:2048
v_mfma_f32_16x16x32_bf16 a[72:75], a[0:3], a[112:115], 0
v_permlane16_swap_b32 v44, v46
v_mfma_f32_16x16x32_bf16 a[72:75], a[4:7], a[120:123], a[72:75]
v_permlane16_swap_b32 v45, v47
v_mfma_f32_16x16x32_bf16 a[72:75], a[8:11], a[128:131], a[72:75]
v_sqrt_f32 v25, v14
v_mfma_f32_16x16x32_bf16 a[72:75], a[12:15], a[136:139], a[72:75]
buffer_load_dwordx4 v6, s[20:23], 0 offen lds
v_mfma_f32_16x16x32_bf16 a[76:79], a[12:15], a[140:143], 0
s_add_u32 m0, s47, 159744
v_add_u32 v6, 0x48000, v6
v_mfma_f32_16x16x32_bf16 a[76:79], a[8:11], a[132:135], a[76:79]
v_sqrt_f32 v26, v15
v_mfma_f32_16x16x32_bf16 a[76:79], a[4:7], a[124:127], a[76:79]
v_mul_f32 v25, s51, v25
v_mul_f32 v26, s51, v26
v_mfma_f32_16x16x32_bf16 a[76:79], a[0:3], a[116:119], a[76:79]
s_waitcnt vmcnt(16) lgkmcnt(0)
v_mul_f32 v56, v25, v56
v_mul_f32 v57, v25, v57
v_mfma_f32_16x16x32_bf16 a[80:83], a[16:19], v[112:115], 0
s_barrier
ds_read_b64_tr_b16 a[0:1], v2 offset:4096
v_mul_f32 v58, v25, v58
v_mfma_f32_16x16x32_bf16 a[80:83], a[20:23], v[120:123], a[80:83]
ds_read_b64_tr_b16 a[2:3], v2 offset:6144
buffer_load_dwordx4 v6, s[16:19], 0 offen lds
v_mfma_f32_16x16x32_bf16 a[80:83], a[24:27], v[128:131], a[80:83]
s_add_u32 m0, s47, 0
ds_read_b64_tr_b16 a[4:5], v2 offset:12288
v_mul_f32 v59, v25, v59
v_mfma_f32_16x16x32_bf16 a[80:83], a[28:31], v[136:139], a[80:83]
ds_read_b64_tr_b16 a[6:7], v2 offset:14336
v_mul_f32 v60, v26, v60
v_mfma_f32_16x16x32_bf16 a[84:87], a[28:31], v[140:143], 0
ds_read_b64_tr_b16 a[8:9], v2 offset:20480
v_mul_f32 v61, v26, v61
v_mfma_f32_16x16x32_bf16 a[84:87], a[24:27], v[132:135], a[84:87]
ds_read_b64_tr_b16 a[10:11], v2 offset:22528
v_mul_f32 v62, v26, v62
v_mfma_f32_16x16x32_bf16 a[84:87], a[20:23], v[124:127], a[84:87]
v_mul_f32 v63, v26, v63
v_cvt_pk_bf16_f32 v40, v56, v57
v_mfma_f32_16x16x32_bf16 a[84:87], a[16:19], v[116:119], a[84:87]
buffer_load_dwordx4 v6, s[20:23], 0 offen lds
v_mfma_f32_16x16x32_bf16 a[88:91], a[16:19], a[112:115], 0
s_add_u32 m0, s47, 4096
v_add_u32 v6, 0x48000, v6
v_cvt_pk_bf16_f32 v41, v58, v59
v_mfma_f32_16x16x32_bf16 a[88:91], a[20:23], a[120:123], a[88:91]
v_cvt_pk_bf16_f32 v42, v60, v61
v_cvt_pk_bf16_f32 v43, v62, v63
v_mfma_f32_16x16x32_bf16 a[88:91], a[24:27], a[128:131], a[88:91]
v_mfma_f32_16x16x32_bf16 a[88:91], a[28:31], a[136:139], a[88:91]
v_mfma_f32_16x16x16_bf16 v[56:59], v[40:41], v[30:31], 0
v_mfma_f32_16x16x16_bf16 v[60:63], v[42:43], v[30:31], 0
buffer_store_dwordx4 v[44:47], v10, s[28:31], s54 offen sc1
v_mfma_f32_16x16x32_bf16 a[92:95], a[28:31], a[140:143], 0
v_mfma_f32_16x16x32_bf16 a[92:95], a[24:27], a[132:135], a[92:95]
buffer_load_dwordx4 v6, s[16:19], 0 offen lds
v_mfma_f32_16x16x32_bf16 a[92:95], a[20:23], a[124:127], a[92:95]
s_add_u32 m0, s47, 8192
v_mfma_f32_16x16x32_bf16 a[92:95], a[16:19], a[116:119], a[92:95]
s_waitcnt lgkmcnt(0)
s_add_u32 s54, s54, s49
v_cvt_pk_bf16_f32 v44, v56, v57
v_cvt_pk_bf16_f32 v45, v58, v59
v_mfma_f32_16x16x32_bf16 a[32:35], a[0:3], v[144:147], a[32:35]
ds_read_b64_tr_b16 a[16:17], v2 offset:8192
v_cvt_pk_bf16_f32 v46, v60, v61
v_cvt_pk_bf16_f32 v47, v62, v63
v_mfma_f32_16x16x32_bf16 a[32:35], a[4:7], v[152:155], a[32:35]
ds_read_b64_tr_b16 a[18:19], v2 offset:10240
buffer_load_dwordx4 v6, s[20:23], 0 offen lds
v_mfma_f32_16x16x32_bf16 a[32:35], a[8:11], v[160:163], a[32:35]
s_add_u32 m0, s47, 12288
ds_read_b64_tr_b16 a[20:21], v2 offset:16384
v_add_u32 v6, 0x48000, v6
v_cndmask_b32 v44, v40, v44, s[52:53]
v_mfma_f32_16x16x32_bf16 a[36:39], a[8:11], v[164:167], a[36:39]
ds_read_b64_tr_b16 a[22:23], v2 offset:18432
v_cndmask_b32 v45, v41, v45, s[52:53]
v_mfma_f32_16x16x32_bf16 a[36:39], a[4:7], v[156:159], a[36:39]
ds_read_b64_tr_b16 a[24:25], v2 offset:24576
v_cndmask_b32 v46, v42, v46, s[52:53]
v_mfma_f32_16x16x32_bf16 a[36:39], a[0:3], v[148:151], a[36:39]
ds_read_b64_tr_b16 a[26:27], v2 offset:26624
v_cndmask_b32 v47, v43, v47, s[52:53]
v_mfma_f32_16x16x32_bf16 a[40:43], a[0:3], a[144:147], a[40:43]
v_permlane16_swap_b32 v44, v46
v_mfma_f32_16x16x32_bf16 a[40:43], a[4:7], a[152:155], a[40:43]
buffer_load_dwordx4 v6, s[16:19], 0 offen lds
v_mfma_f32_16x16x32_bf16 a[40:43], a[8:11], a[160:163], a[40:43]
s_add_u32 m0, s47, 16384
v_permlane16_swap_b32 v45, v47
v_mfma_f32_16x16x32_bf16 a[44:47], a[8:11], a[164:167], a[44:47]
s_add_u32 s58, s50, 2
s_lshr_b32 s51, s58, 5
s_min_u32 s51, s51, 1
v_mfma_f32_16x16x32_bf16 a[44:47], a[4:7], a[156:159], a[44:47]
s_mul_i32 s51, s51, 0xd1e56d
s_add_u32 s51, s51, 1051597459
v_mfma_f32_16x16x32_bf16 a[44:47], a[0:3], a[148:151], a[44:47]
s_waitcnt lgkmcnt(0)
v_sqrt_f32 v25, v12
v_mfma_f32_16x16x32_bf16 a[48:51], a[16:19], v[144:147], a[48:51]
ds_read_b64_tr_b16 a[0:1], v3 offset:4096
v_mfma_f32_16x16x32_bf16 a[48:51], a[20:23], v[152:155], a[48:51]
ds_read_b64_tr_b16 a[2:3], v3 offset:6144
buffer_load_dwordx4 v6, s[20:23], 0 offen lds
v_mfma_f32_16x16x32_bf16 a[48:51], a[24:27], v[160:163], a[48:51]
s_add_u32 s1, s5, 256
s_and_b32 s1, s1, 384
ds_read_b64_tr_b16 a[4:5], v3 offset:12288
v_mfma_f32_16x16x32_bf16 a[52:55], a[24:27], v[164:167], a[52:55]
s_min_u32 s1, s1, 1
s_mul_i32 s1, s1, 512
ds_read_b64_tr_b16 a[6:7], v3 offset:14336
v_mfma_f32_16x16x32_bf16 a[52:55], a[20:23], v[156:159], a[52:55]
s_add_u32 s1, s1, 0xffb37e80
ds_read_b64_tr_b16 a[8:9], v3 offset:20480
v_add_u32 v6, s1, v6
v_mfma_f32_16x16x32_bf16 a[52:55], a[16:19], v[148:151], a[52:55]
s_add_u32 m0, s47, 20480
ds_read_b64_tr_b16 a[10:11], v3 offset:22528
v_mfma_f32_16x16x32_bf16 a[56:59], a[16:19], a[144:147], a[56:59]
v_sqrt_f32 v26, v13
v_mfma_f32_16x16x32_bf16 a[56:59], a[20:23], a[152:155], a[56:59]
buffer_load_dwordx4 v6, s[16:19], 0 offen lds
v_mfma_f32_16x16x32_bf16 a[56:59], a[24:27], a[160:163], a[56:59]
s_add_u32 m0, s47, 24576
v_mul_f32 v25, s51, v25
v_mul_f32 v26, s51, v26
v_mfma_f32_16x16x32_bf16 a[60:63], a[24:27], a[164:167], a[60:63]
v_mul_f32 v64, v25, v64
v_mul_f32 v65, v25, v65
v_mfma_f32_16x16x32_bf16 a[60:63], a[20:23], a[156:159], a[60:63]
v_mul_f32 v66, v25, v66
v_mul_f32 v67, v25, v67
v_mfma_f32_16x16x32_bf16 a[60:63], a[16:19], a[148:151], a[60:63]
s_waitcnt lgkmcnt(0)
v_mul_f32 v68, v26, v68
v_mul_f32 v69, v26, v69
v_mfma_f32_16x16x32_bf16 a[64:67], a[0:3], v[144:147], a[64:67]
ds_read_b64_tr_b16 a[16:17], v3 offset:8192
v_mul_f32 v70, v26, v70
v_mfma_f32_16x16x32_bf16 a[64:67], a[4:7], v[152:155], a[64:67]
ds_read_b64_tr_b16 a[18:19], v3 offset:10240
buffer_load_dwordx4 v6, s[20:23], 0 offen lds
v_mfma_f32_16x16x32_bf16 a[64:67], a[8:11], v[160:163], a[64:67]
s_add_u32 m0, s47, 28672
ds_read_b64_tr_b16 a[20:21], v3 offset:16384
v_add_u32 v6, 0x48000, v6
v_mfma_f32_16x16x32_bf16 a[68:71], a[8:11], v[164:167], a[68:71]
ds_read_b64_tr_b16 a[22:23], v3 offset:18432
v_mul_f32 v71, v26, v71
v_mfma_f32_16x16x32_bf16 a[68:71], a[4:7], v[156:159], a[68:71]
ds_read_b64_tr_b16 a[24:25], v3 offset:24576
v_cvt_pk_bf16_f32 v40, v64, v65
v_mfma_f32_16x16x32_bf16 a[68:71], a[0:3], v[148:151], a[68:71]
ds_read_b64_tr_b16 a[26:27], v3 offset:26624
v_cvt_pk_bf16_f32 v41, v66, v67
v_mfma_f32_16x16x32_bf16 a[72:75], a[0:3], a[144:147], a[72:75]
v_cvt_pk_bf16_f32 v42, v68, v69
v_cvt_pk_bf16_f32 v43, v70, v71
v_mfma_f32_16x16x32_bf16 a[72:75], a[4:7], a[152:155], a[72:75]
buffer_load_dwordx4 v6, s[16:19], 0 offen lds
v_mfma_f32_16x16x32_bf16 a[72:75], a[8:11], a[160:163], a[72:75]
s_add_u32 m0, s47, 32768
v_mfma_f32_16x16x16_bf16 v[64:67], v[40:41], v[30:31], 0
v_mfma_f32_16x16x16_bf16 v[68:71], v[42:43], v[30:31], 0
buffer_store_dwordx4 v[44:47], v10, s[28:31], s54 offen sc1
v_mfma_f32_16x16x32_bf16 a[76:79], a[8:11], a[164:167], a[76:79]
v_mfma_f32_16x16x32_bf16 a[76:79], a[4:7], a[156:159], a[76:79]
v_mfma_f32_16x16x32_bf16 a[76:79], a[0:3], a[148:151], a[76:79]
s_waitcnt vmcnt(19) lgkmcnt(0)
buffer_load_dwordx4 v6, s[20:23], 0 offen lds
v_mfma_f32_16x16x32_bf16 a[80:83], a[16:19], v[144:147], a[80:83]
s_barrier
s_lshr_b32 s54, s58, 6
ds_read_b64_tr_b16 a[0:1], v2 offset:28672
v_add_u32 v6, 0x48000, v6
v_mfma_f32_16x16x32_bf16 a[80:83], a[20:23], v[152:155], a[80:83]
s_add_u32 m0, s47, 36864
s_mul_i32 s52, s54, -1
s_mov_b32 s53, s52
ds_read_b64_tr_b16 a[2:3], v2 offset:30720
v_mfma_f32_16x16x32_bf16 a[80:83], a[24:27], v[160:163], a[80:83]
s_mul_i32 s61, s54, 0xffb40480
s_add_u32 s54, s61, s48
s_add_u32 s54, s54, 311296
ds_read_b64_tr_b16 a[4:5], v2 offset:36864
v_mfma_f32_16x16x32_bf16 a[84:87], a[24:27], v[164:167], a[84:87]
ds_read_b64_tr_b16 a[6:7], v2 offset:38912
v_cvt_pk_bf16_f32 v44, v64, v65
v_cvt_pk_bf16_f32 v45, v66, v67
v_mfma_f32_16x16x32_bf16 a[84:87], a[20:23], v[156:159], a[84:87]
ds_read_b64_tr_b16 a[8:9], v2 offset:45056
v_cvt_pk_bf16_f32 v46, v68, v69
v_cvt_pk_bf16_f32 v47, v70, v71
v_mfma_f32_16x16x32_bf16 a[84:87], a[16:19], v[148:151], a[84:87]
ds_read_b64_tr_b16 a[10:11], v2 offset:47104
buffer_load_dwordx4 v6, s[16:19], 0 offen lds
v_mfma_f32_16x16x32_bf16 a[88:91], a[16:19], a[144:147], a[88:91]
s_add_u32 m0, s47, 40960
ds_read_b64_tr_b16 a[12:13], v2 offset:53248
v_cndmask_b32 v44, v40, v44, s[52:53]
v_mfma_f32_16x16x32_bf16 a[88:91], a[20:23], a[152:155], a[88:91]
ds_read_b64_tr_b16 a[14:15], v2 offset:55296
v_cndmask_b32 v45, v41, v45, s[52:53]
v_mfma_f32_16x16x32_bf16 a[88:91], a[24:27], a[160:163], a[88:91]
v_cndmask_b32 v46, v42, v46, s[52:53]
v_cndmask_b32 v47, v43, v47, s[52:53]
v_mfma_f32_16x16x32_bf16 a[92:95], a[24:27], a[164:167], a[92:95]
v_permlane16_swap_b32 v44, v46
v_mfma_f32_16x16x32_bf16 a[92:95], a[20:23], a[156:159], a[92:95]
v_permlane16_swap_b32 v45, v47
v_mfma_f32_16x16x32_bf16 a[92:95], a[16:19], a[148:151], a[92:95]
s_waitcnt lgkmcnt(0)
buffer_load_dwordx4 v6, s[20:23], 0 offen lds
v_mfma_f32_16x16x32_bf16 a[32:35], a[0:3], v[168:171], a[32:35]
s_add_u32 m0, s47, 45056
ds_read_b64_tr_b16 a[16:17], v2 offset:32768
v_add_u32 v6, 0x48000, v6
v_mfma_f32_16x16x32_bf16 a[32:35], a[4:7], v[176:179], a[32:35]
ds_read_b64_tr_b16 a[18:19], v2 offset:34816
v_mfma_f32_16x16x32_bf16 a[32:35], a[8:11], v[184:187], a[32:35]
ds_read_b64_tr_b16 a[20:21], v2 offset:40960
v_mfma_f32_16x16x32_bf16 a[32:35], a[12:15], v[192:195], a[32:35]
ds_read_b64_tr_b16 a[22:23], v2 offset:43008
v_mfma_f32_16x16x32_bf16 a[36:39], a[12:15], v[196:199], a[36:39]
ds_read_b64_tr_b16 a[24:25], v2 offset:49152
v_mfma_f32_16x16x32_bf16 a[36:39], a[8:11], v[188:191], a[36:39]
ds_read_b64_tr_b16 a[26:27], v2 offset:51200
buffer_load_dwordx4 v6, s[16:19], 0 offen lds
v_mfma_f32_16x16x32_bf16 a[36:39], a[4:7], v[180:183], a[36:39]
s_add_u32 m0, s47, 49152
ds_read_b64_tr_b16 a[28:29], v2 offset:57344
v_mfma_f32_16x16x32_bf16 a[36:39], a[0:3], v[172:175], a[36:39]
ds_read_b64_tr_b16 a[30:31], v2 offset:59392
v_mfma_f32_16x16x32_bf16 a[40:43], a[0:3], a[168:171], a[40:43]
v_sqrt_f32 v25, v14
v_mfma_f32_16x16x32_bf16 a[40:43], a[4:7], a[176:179], a[40:43]
v_sqrt_f32 v26, v15
v_mfma_f32_16x16x32_bf16 a[40:43], a[8:11], a[184:187], a[40:43]
v_mul_f32 v25, s51, v25
v_mul_f32 v26, s51, v26
v_mfma_f32_16x16x32_bf16 a[40:43], a[12:15], a[192:195], a[40:43]
buffer_load_dwordx4 v6, s[20:23], 0 offen lds
v_mfma_f32_16x16x32_bf16 a[44:47], a[12:15], a[196:199], a[44:47]
s_add_u32 m0, s47, 53248
v_add_u32 v6, 0x48000, v6
v_mul_f32 v72, v25, v72
v_mfma_f32_16x16x32_bf16 a[44:47], a[8:11], a[188:191], a[44:47]
v_mul_f32 v73, v25, v73
v_mul_f32 v74, v25, v74
v_mfma_f32_16x16x32_bf16 a[44:47], a[4:7], a[180:183], a[44:47]
v_mul_f32 v75, v25, v75
v_mul_f32 v76, v26, v76
v_mfma_f32_16x16x32_bf16 a[44:47], a[0:3], a[172:175], a[44:47]
s_waitcnt lgkmcnt(0)
v_mul_f32 v77, v26, v77
v_mul_f32 v78, v26, v78
v_mfma_f32_16x16x32_bf16 a[48:51], a[16:19], v[168:171], a[48:51]
ds_read_b64_tr_b16 a[0:1], v3 offset:28672
v_mul_f32 v79, v26, v79
v_mfma_f32_16x16x32_bf16 a[48:51], a[20:23], v[176:179], a[48:51]
ds_read_b64_tr_b16 a[2:3], v3 offset:30720
buffer_load_dwordx4 v6, s[16:19], 0 offen lds
v_mfma_f32_16x16x32_bf16 a[48:51], a[24:27], v[184:187], a[48:51]
s_add_u32 m0, s47, 57344
ds_read_b64_tr_b16 a[4:5], v3 offset:36864
v_cvt_pk_bf16_f32 v40, v72, v73
v_mfma_f32_16x16x32_bf16 a[48:51], a[28:31], v[192:195], a[48:51]
ds_read_b64_tr_b16 a[6:7], v3 offset:38912
v_cvt_pk_bf16_f32 v41, v74, v75
v_mfma_f32_16x16x32_bf16 a[52:55], a[28:31], v[196:199], a[52:55]
ds_read_b64_tr_b16 a[8:9], v3 offset:45056
v_cvt_pk_bf16_f32 v42, v76, v77
v_mfma_f32_16x16x32_bf16 a[52:55], a[24:27], v[188:191], a[52:55]
ds_read_b64_tr_b16 a[10:11], v3 offset:47104
v_cvt_pk_bf16_f32 v43, v78, v79
v_mfma_f32_16x16x32_bf16 a[52:55], a[20:23], v[180:183], a[52:55]
ds_read_b64_tr_b16 a[12:13], v3 offset:53248
v_mfma_f32_16x16x32_bf16 a[52:55], a[16:19], v[172:175], a[52:55]
ds_read_b64_tr_b16 a[14:15], v3 offset:55296
buffer_load_dwordx4 v6, s[20:23], 0 offen lds
v_mfma_f32_16x16x16_bf16 v[72:75], v[40:41], v[30:31], 0
s_add_u32 m0, s47, 61440
v_add_u32 v6, 0x48000, v6
v_mfma_f32_16x16x16_bf16 v[76:79], v[42:43], v[30:31], 0
buffer_store_dwordx4 v[44:47], v10, s[28:31], s54 offen sc1
v_mfma_f32_16x16x32_bf16 a[56:59], a[16:19], a[168:171], a[56:59]
v_mfma_f32_16x16x32_bf16 a[56:59], a[20:23], a[176:179], a[56:59]
v_mfma_f32_16x16x32_bf16 a[56:59], a[24:27], a[184:187], a[56:59]
v_mfma_f32_16x16x32_bf16 a[56:59], a[28:31], a[192:195], a[56:59]
s_add_u32 s54, s54, s49
buffer_load_dwordx4 v6, s[16:19], 0 offen lds
v_mfma_f32_16x16x32_bf16 a[60:63], a[28:31], a[196:199], a[60:63]
s_add_u32 m0, s47, 65536
v_cvt_pk_bf16_f32 v44, v72, v73
v_cvt_pk_bf16_f32 v45, v74, v75
v_cvt_pk_bf16_f32 v46, v76, v77
v_mfma_f32_16x16x32_bf16 a[60:63], a[24:27], a[188:191], a[60:63]
v_cvt_pk_bf16_f32 v47, v78, v79
v_cndmask_b32 v44, v40, v44, s[52:53]
v_cndmask_b32 v45, v41, v45, s[52:53]
v_mfma_f32_16x16x32_bf16 a[60:63], a[20:23], a[180:183], a[60:63]
v_cndmask_b32 v46, v42, v46, s[52:53]
v_cndmask_b32 v47, v43, v47, s[52:53]
v_mfma_f32_16x16x32_bf16 a[60:63], a[16:19], a[172:175], a[60:63]
s_waitcnt lgkmcnt(0)
v_permlane16_swap_b32 v44, v46
v_mfma_f32_16x16x32_bf16 a[64:67], a[0:3], v[168:171], a[64:67]
ds_read_b64_tr_b16 a[16:17], v3 offset:32768
v_permlane16_swap_b32 v45, v47
v_mfma_f32_16x16x32_bf16 a[64:67], a[4:7], v[176:179], a[64:67]
s_add_u32 s58, s50, 4
ds_read_b64_tr_b16 a[18:19], v3 offset:34816
buffer_load_dwordx4 v6, s[20:23], 0 offen lds
v_mfma_f32_16x16x32_bf16 a[64:67], a[8:11], v[184:187], a[64:67]
s_add_u32 m0, s47, 69632
ds_read_b64_tr_b16 a[20:21], v3 offset:40960
v_add_u32 v6, 0x48000, v6
v_mfma_f32_16x16x32_bf16 a[64:67], a[12:15], v[192:195], a[64:67]
s_lshr_b32 s51, s58, 5
s_min_u32 s51, s51, 1
ds_read_b64_tr_b16 a[22:23], v3 offset:43008
v_mfma_f32_16x16x32_bf16 a[68:71], a[12:15], v[196:199], a[68:71]
s_mul_i32 s51, s51, 0xd1e56d
s_add_u32 s51, s51, 1051597459
ds_read_b64_tr_b16 a[24:25], v3 offset:49152
v_mfma_f32_16x16x32_bf16 a[68:71], a[8:11], v[188:191], a[68:71]
ds_read_b64_tr_b16 a[26:27], v3 offset:51200
v_mfma_f32_16x16x32_bf16 a[68:71], a[4:7], v[180:183], a[68:71]
ds_read_b64_tr_b16 a[28:29], v3 offset:57344
v_mfma_f32_16x16x32_bf16 a[68:71], a[0:3], v[172:175], a[68:71]
ds_read_b64_tr_b16 a[30:31], v3 offset:59392
buffer_load_dwordx4 v6, s[16:19], 0 offen lds
v_mfma_f32_16x16x32_bf16 a[72:75], a[0:3], a[168:171], a[72:75]
s_add_u32 m0, s47, 73728
v_sqrt_f32 v25, v12
v_mfma_f32_16x16x32_bf16 a[72:75], a[4:7], a[176:179], a[72:75]
v_sqrt_f32 v26, v13
v_mfma_f32_16x16x32_bf16 a[72:75], a[8:11], a[184:187], a[72:75]
v_mul_f32 v25, s51, v25
v_mul_f32 v26, s51, v26
v_mfma_f32_16x16x32_bf16 a[72:75], a[12:15], a[192:195], a[72:75]
v_mul_f32 v80, v25, v80
v_mul_f32 v81, v25, v81
v_mfma_f32_16x16x32_bf16 a[76:79], a[12:15], a[196:199], a[76:79]
v_mul_f32 v82, v25, v82
v_mul_f32 v83, v25, v83
v_mfma_f32_16x16x32_bf16 a[76:79], a[8:11], a[188:191], a[76:79]
buffer_load_dwordx4 v6, s[20:23], 0 offen lds
v_mfma_f32_16x16x32_bf16 a[76:79], a[4:7], a[180:183], a[76:79]
s_add_u32 m0, s47, 77824
v_add_u32 v6, 0x48000, v6
v_mul_f32 v84, v26, v84
v_mfma_f32_16x16x32_bf16 a[76:79], a[0:3], a[172:175], a[76:79]
s_waitcnt vmcnt(25) lgkmcnt(0)
v_mul_f32 v85, v26, v85
v_mul_f32 v86, v26, v86
v_mfma_f32_16x16x32_bf16 a[80:83], a[16:19], v[168:171], a[80:83]
s_barrier
ds_read_b64_tr_b16 a[0:1], v2 offset:61440
v_mul_f32 v87, v26, v87
v_mfma_f32_16x16x32_bf16 a[80:83], a[20:23], v[176:179], a[80:83]
ds_read_b64_tr_b16 a[2:3], v2 offset:63488
v_add_u32 v2, 0x10000, v2
v_mfma_f32_16x16x32_bf16 a[80:83], a[24:27], v[184:187], a[80:83]
ds_read_b64_tr_b16 a[4:5], v2 offset:4096
v_cvt_pk_bf16_f32 v40, v80, v81
v_mfma_f32_16x16x32_bf16 a[80:83], a[28:31], v[192:195], a[80:83]
ds_read_b64_tr_b16 a[6:7], v2 offset:6144
buffer_load_dwordx4 v6, s[16:19], 0 offen lds
v_mfma_f32_16x16x32_bf16 a[84:87], a[28:31], v[196:199], a[84:87]
s_add_u32 m0, s47, 81920
ds_read_b64_tr_b16 a[8:9], v2 offset:12288
v_cvt_pk_bf16_f32 v41, v82, v83
v_mfma_f32_16x16x32_bf16 a[84:87], a[24:27], v[188:191], a[84:87]
ds_read_b64_tr_b16 a[10:11], v2 offset:14336
v_cvt_pk_bf16_f32 v42, v84, v85
v_mfma_f32_16x16x32_bf16 a[84:87], a[20:23], v[180:183], a[84:87]
v_cvt_pk_bf16_f32 v43, v86, v87
v_mfma_f32_16x16x32_bf16 a[84:87], a[16:19], v[172:175], a[84:87]
v_mfma_f32_16x16x16_bf16 v[80:83], v[40:41], v[30:31], 0
v_mfma_f32_16x16x16_bf16 v[84:87], v[42:43], v[30:31], 0
buffer_store_dwordx4 v[44:47], v10, s[28:31], s54 offen sc1
v_mfma_f32_16x16x32_bf16 a[88:91], a[16:19], a[168:171], a[88:91]
v_mfma_f32_16x16x32_bf16 a[88:91], a[20:23], a[176:179], a[88:91]
buffer_load_dwordx4 v6, s[20:23], 0 offen lds
v_mfma_f32_16x16x32_bf16 a[88:91], a[24:27], a[184:187], a[88:91]
s_add_u32 m0, s47, 86016
v_add_u32 v6, 0x48000, v6
v_mfma_f32_16x16x32_bf16 a[88:91], a[28:31], a[192:195], a[88:91]
s_lshr_b32 s54, s58, 6
s_mul_i32 s52, s54, -1
L_pad5:
s_cbranch_execz L_pad9
s_mov_b32 s53, s52
v_mfma_f32_16x16x32_bf16 a[92:95], a[28:31], a[196:199], a[92:95]
s_mul_i32 s61, s54, 0xffb40480
s_add_u32 s54, s61, s48
s_add_u32 s54, s54, 622592
v_mfma_f32_16x16x32_bf16 a[92:95], a[24:27], a[188:191], a[92:95]
buffer_load_dwordx4 v6, s[16:19], 0 offen lds
v_mfma_f32_16x16x32_bf16 a[92:95], a[20:23], a[180:183], a[92:95]
s_add_u32 m0, s47, 90112
v_cvt_pk_bf16_f32 v44, v80, v81
v_cvt_pk_bf16_f32 v45, v82, v83
v_mfma_f32_16x16x32_bf16 a[92:95], a[16:19], a[172:175], a[92:95]
s_waitcnt lgkmcnt(0)
v_cvt_pk_bf16_f32 v46, v84, v85
v_cvt_pk_bf16_f32 v47, v86, v87
v_mfma_f32_16x16x32_bf16 a[32:35], a[0:3], v[200:203], a[32:35]
ds_read_b64_tr_b16 a[16:17], v2
v_cndmask_b32 v44, v40, v44, s[52:53]
v_mfma_f32_16x16x32_bf16 a[32:35], a[4:7], v[208:211], a[32:35]
ds_read_b64_tr_b16 a[18:19], v2 offset:2048
v_cndmask_b32 v45, v41, v45, s[52:53]
v_mfma_f32_16x16x32_bf16 a[32:35], a[8:11], v[216:219], a[32:35]
ds_read_b64_tr_b16 a[20:21], v2 offset:8192
v_cndmask_b32 v46, v42, v46, s[52:53]
v_mfma_f32_16x16x32_bf16 a[36:39], a[8:11], v[220:223], a[36:39]
ds_read_b64_tr_b16 a[22:23], v2 offset:10240
buffer_load_dwordx4 v6, s[20:23], 0 offen lds
v_mfma_f32_16x16x32_bf16 a[36:39], a[4:7], v[212:215], a[36:39]
s_add_u32 m0, s47, 94208
ds_read_b64_tr_b16 a[24:25], v2 offset:16384
v_add_u32 v6, 0x48000, v6
v_mfma_f32_16x16x32_bf16 a[36:39], a[0:3], v[204:207], a[36:39]
ds_read_b64_tr_b16 a[26:27], v2 offset:18432
v_cndmask_b32 v47, v43, v47, s[52:53]
v_mfma_f32_16x16x32_bf16 a[40:43], a[0:3], a[200:203], a[40:43]
v_permlane16_swap_b32 v44, v46
v_mfma_f32_16x16x32_bf16 a[40:43], a[4:7], a[208:211], a[40:43]
v_permlane16_swap_b32 v45, v47
v_mfma_f32_16x16x32_bf16 a[40:43], a[8:11], a[216:219], a[40:43]
v_sqrt_f32 v25, v14
v_mfma_f32_16x16x32_bf16 a[44:47], a[8:11], a[220:223], a[44:47]
buffer_load_dwordx4 v6, s[16:19], 0 offen lds
v_mfma_f32_16x16x32_bf16 a[44:47], a[4:7], a[212:215], a[44:47]
s_add_u32 m0, s47, 98304
v_sqrt_f32 v26, v15
v_mfma_f32_16x16x32_bf16 a[44:47], a[0:3], a[204:207], a[44:47]
s_waitcnt lgkmcnt(0)
v_mul_f32 v25, s51, v25
v_mul_f32 v26, s51, v26
v_mfma_f32_16x16x32_bf16 a[48:51], a[16:19], v[200:203], a[48:51]
ds_read_b64_tr_b16 a[0:1], v3 offset:61440
v_mul_f32 v88, v25, v88
v_mfma_f32_16x16x32_bf16 a[48:51], a[20:23], v[208:211], a[48:51]
ds_read_b64_tr_b16 a[2:3], v3 offset:63488
v_add_u32 v3, 0x10000, v3
v_mfma_f32_16x16x32_bf16 a[48:51], a[24:27], v[216:219], a[48:51]
ds_read_b64_tr_b16 a[4:5], v3 offset:4096
v_mul_f32 v89, v25, v89
v_mfma_f32_16x16x32_bf16 a[52:55], a[24:27], v[220:223], a[52:55]
ds_read_b64_tr_b16 a[6:7], v3 offset:6144
buffer_load_dwordx4 v6, s[20:23], 0 offen lds
v_mfma_f32_16x16x32_bf16 a[52:55], a[20:23], v[212:215], a[52:55]
s_add_u32 m0, s47, 102400
ds_read_b64_tr_b16 a[8:9], v3 offset:12288
v_add_u32 v6, 0x48000, v6
v_mfma_f32_16x16x32_bf16 a[52:55], a[16:19], v[204:207], a[52:55]
ds_read_b64_tr_b16 a[10:11], v3 offset:14336
v_mul_f32 v90, v25, v90
v_mfma_f32_16x16x32_bf16 a[56:59], a[16:19], a[200:203], a[56:59]
v_mul_f32 v91, v25, v91
v_mul_f32 v92, v26, v92
v_mfma_f32_16x16x32_bf16 a[56:59], a[20:23], a[208:211], a[56:59]
v_mul_f32 v93, v26, v93
v_mul_f32 v94, v26, v94
v_mfma_f32_16x16x32_bf16 a[56:59], a[24:27], a[216:219], a[56:59]
v_mul_f32 v95, v26, v95
v_cvt_pk_bf16_f32 v40, v88, v89
v_mfma_f32_16x16x32_bf16 a[60:63], a[24:27], a[220:223], a[60:63]
buffer_load_dwordx4 v6, s[16:19], 0 offen lds
v_mfma_f32_16x16x32_bf16 a[60:63], a[20:23], a[212:215], a[60:63]
s_add_u32 m0, s47, 106496
v_cvt_pk_bf16_f32 v41, v90, v91
v_cvt_pk_bf16_f32 v42, v92, v93
v_mfma_f32_16x16x32_bf16 a[60:63], a[16:19], a[204:207], a[60:63]
s_waitcnt lgkmcnt(0)
v_cvt_pk_bf16_f32 v43, v94, v95
v_mfma_f32_16x16x32_bf16 a[64:67], a[0:3], v[200:203], a[64:67]
ds_read_b64_tr_b16 a[16:17], v3
v_mfma_f32_16x16x32_bf16 a[64:67], a[4:7], v[208:211], a[64:67]
ds_read_b64_tr_b16 a[18:19], v3 offset:2048
v_mfma_f32_16x16x32_bf16 a[64:67], a[8:11], v[216:219], a[64:67]
ds_read_b64_tr_b16 a[20:21], v3 offset:8192
v_mfma_f32_16x16x32_bf16 a[68:71], a[8:11], v[220:223], a[68:71]
ds_read_b64_tr_b16 a[22:23], v3 offset:10240
buffer_load_dwordx4 v6, s[20:23], 0 offen lds
v_mfma_f32_16x16x32_bf16 a[68:71], a[4:7], v[212:215], a[68:71]
s_add_u32 m0, s47, 110592
ds_read_b64_tr_b16 a[24:25], v3 offset:16384
v_add_u32 v6, 0x48000, v6
v_mfma_f32_16x16x32_bf16 a[68:71], a[0:3], v[204:207], a[68:71]
ds_read_b64_tr_b16 a[26:27], v3 offset:18432
v_mfma_f32_16x16x16_bf16 v[88:91], v[40:41], v[30:31], 0
v_mfma_f32_16x16x16_bf16 v[92:95], v[42:43], v[30:31], 0
buffer_store_dwordx4 v[44:47], v10, s[28:31], s54 offen sc1
v_mfma_f32_16x16x32_bf16 a[72:75], a[0:3], a[200:203], a[72:75]
v_mfma_f32_16x16x32_bf16 a[72:75], a[4:7], a[208:211], a[72:75]
buffer_load_dwordx4 v6, s[16:19], 0 offen lds
v_mfma_f32_16x16x32_bf16 a[72:75], a[8:11], a[216:219], a[72:75]
s_add_u32 m0, s47, 114688
v_mfma_f32_16x16x32_bf16 a[76:79], a[8:11], a[220:223], a[76:79]
s_add_u32 s54, s54, s49
v_cvt_pk_bf16_f32 v44, v88, v89
v_cvt_pk_bf16_f32 v45, v90, v91
v_mfma_f32_16x16x32_bf16 a[76:79], a[4:7], a[212:215], a[76:79]
v_cvt_pk_bf16_f32 v46, v92, v93
v_cvt_pk_bf16_f32 v47, v94, v95
v_mfma_f32_16x16x32_bf16 a[76:79], a[0:3], a[204:207], a[76:79]
s_waitcnt vmcnt(27) lgkmcnt(0)
v_cndmask_b32 v44, v40, v44, s[52:53]
v_cndmask_b32 v45, v41, v45, s[52:53]
v_mfma_f32_16x16x32_bf16 a[80:83], a[16:19], v[200:203], a[80:83]
s_barrier
ds_read_b64_tr_b16 a[0:1], v2 offset:20480
v_cndmask_b32 v46, v42, v46, s[52:53]
v_mfma_f32_16x16x32_bf16 a[80:83], a[20:23], v[208:211], a[80:83]
s_lshr_b32 s58, s44, 1
ds_read_b64_tr_b16 a[2:3], v2 offset:22528
buffer_load_dwordx4 v6, s[20:23], 0 offen lds
v_mfma_f32_16x16x32_bf16 a[80:83], a[24:27], v[216:219], a[80:83]
s_add_u32 m0, s47, 118784
ds_read_b64_tr_b16 a[4:5], v2 offset:28672
v_add_u32 v6, 0x48000, v6
v_mfma_f32_16x16x32_bf16 a[84:87], a[24:27], v[220:223], a[84:87]
s_lshl_b32 s59, s58, 11
ds_read_b64_tr_b16 a[6:7], v2 offset:30720
v_add_u32 v2, 0xfffe0000, v2
v_mfma_f32_16x16x32_bf16 a[84:87], a[20:23], v[212:215], a[84:87]
s_lshl_b32 s60, s7, 13
ds_read_b64_tr_b16 a[8:9], v2 offset:4096
v_cndmask_b32 v47, v43, v47, s[52:53]
v_mfma_f32_16x16x32_bf16 a[84:87], a[16:19], v[204:207], a[84:87]
s_add_u32 s59, s59, s60
s_lshl_b32 s60, s7, 10
ds_read_b64_tr_b16 a[10:11], v2 offset:6144
v_mfma_f32_16x16x32_bf16 a[88:91], a[16:19], a[200:203], a[88:91]
ds_read_b64_tr_b16 a[12:13], v2 offset:12288
v_add_u32 v16, s59, v10
v_mfma_f32_16x16x32_bf16 a[88:91], a[20:23], a[208:211], a[88:91]
ds_read_b64_tr_b16 a[14:15], v2 offset:14336
v_add_u32 v2, 0x20000, v2
v_mfma_f32_16x16x32_bf16 a[88:91], a[24:27], a[216:219], a[88:91]
buffer_load_dwordx4 v6, s[16:19], 0 offen lds
v_mfma_f32_16x16x32_bf16 a[92:95], a[24:27], a[220:223], a[92:95]
s_add_u32 m0, s47, 122880
v_permlane16_swap_b32 v44, v46
v_mfma_f32_16x16x32_bf16 a[92:95], a[20:23], a[212:215], a[92:95]
v_permlane16_swap_b32 v45, v47
v_mfma_f32_16x16x32_bf16 a[92:95], a[16:19], a[204:207], a[92:95]
s_waitcnt lgkmcnt(0)
v_sqrt_f32 v25, v12
v_mfma_f32_16x16x32_bf16 a[32:35], a[0:3], v[224:227], a[32:35]
ds_read_b64_tr_b16 a[16:17], v2 offset:24576
v_xor_b32 v17, 0x2000, v16
v_mfma_f32_16x16x32_bf16 a[32:35], a[4:7], v[232:235], a[32:35]
ds_read_b64_tr_b16 a[18:19], v2 offset:26624
v_add_u32 v2, 0xfffe0000, v2
v_mfma_f32_16x16x32_bf16 a[32:35], a[8:11], v[240:243], a[32:35]
ds_read_b64_tr_b16 a[20:21], v2
buffer_load_dwordx4 v6, s[20:23], 0 offen lds
v_mfma_f32_16x16x32_bf16 a[32:35], a[12:15], v[248:251], a[32:35]
s_add_u32 m0, s47, 126976
ds_read_b64_tr_b16 a[22:23], v2 offset:2048
v_add_u32 v6, 0x48000, v6
v_mfma_f32_16x16x32_bf16 a[36:39], a[12:15], v[252:255], a[36:39]
ds_read_b64_tr_b16 a[24:25], v2 offset:8192
v_add_u32 v18, s60, v16
v_mfma_f32_16x16x32_bf16 a[36:39], a[8:11], v[244:247], a[36:39]
ds_read_b64_tr_b16 a[26:27], v2 offset:10240
v_add_u32 v19, s60, v17
v_mfma_f32_16x16x32_bf16 a[36:39], a[4:7], v[236:239], a[36:39]
ds_read_b64_tr_b16 a[28:29], v2 offset:16384
v_mfma_f32_16x16x32_bf16 a[36:39], a[0:3], v[228:231], a[36:39]
ds_read_b64_tr_b16 a[30:31], v2 offset:18432
buffer_load_dwordx4 v6, s[16:19], 0 offen lds
v_mfma_f32_16x16x32_bf16 a[40:43], a[0:3], a[224:227], a[40:43]
s_add_u32 m0, s47, 131072
v_sqrt_f32 v26, v13
v_mfma_f32_16x16x32_bf16 a[40:43], a[4:7], a[232:235], a[40:43]
v_mul_f32 v25, v20, v25
v_mul_f32 v26, v20, v26
v_mfma_f32_16x16x32_bf16 a[40:43], a[8:11], a[240:243], a[40:43]
v_mul_f32 v96, v25, v96
v_mul_f32 v97, v25, v97
v_mfma_f32_16x16x32_bf16 a[40:43], a[12:15], a[248:251], a[40:43]
v_mul_f32 v98, v25, v98
v_mul_f32 v99, v25, v99
v_mfma_f32_16x16x32_bf16 a[44:47], a[12:15], a[252:255], a[44:47]
v_mul_f32 v100, v26, v100
v_mul_f32 v101, v26, v101
v_mfma_f32_16x16x32_bf16 a[44:47], a[8:11], a[244:247], a[44:47]
buffer_load_dwordx4 v6, s[20:23], 0 offen lds
v_mfma_f32_16x16x32_bf16 a[44:47], a[4:7], a[236:239], a[44:47]
s_add_u32 m0, s47, 16384
v_add_u32 v6, 0x48000, v6
v_mul_f32 v102, v26, v102
v_mfma_f32_16x16x32_bf16 a[44:47], a[0:3], a[228:231], a[44:47]
s_waitcnt lgkmcnt(0)
v_mul_f32 v103, v26, v103
v_cvt_pk_bf16_f32 v40, v96, v97
v_mfma_f32_16x16x32_bf16 a[48:51], a[16:19], v[224:227], a[48:51]
ds_read_b64_tr_b16 a[0:1], v3 offset:20480
v_cvt_pk_bf16_f32 v41, v98, v99
v_mfma_f32_16x16x32_bf16 a[48:51], a[20:23], v[232:235], a[48:51]
ds_read_b64_tr_b16 a[2:3], v3 offset:22528
v_cvt_pk_bf16_f32 v42, v100, v101
v_mfma_f32_16x16x32_bf16 a[48:51], a[24:27], v[240:243], a[48:51]
ds_read_b64_tr_b16 a[4:5], v3 offset:28672
v_cvt_pk_bf16_f32 v43, v102, v103
v_mfma_f32_16x16x32_bf16 a[48:51], a[28:31], v[248:251], a[48:51]
ds_read_b64_tr_b16 a[6:7], v3 offset:30720
v_add_u32 v3, 0xfffe0000, v3
v_mfma_f32_16x16x32_bf16 a[52:55], a[28:31], v[252:255], a[52:55]
ds_read_b64_tr_b16 a[8:9], v3 offset:4096
v_mfma_f32_16x16x32_bf16 a[52:55], a[24:27], v[244:247], a[52:55]
ds_read_b64_tr_b16 a[10:11], v3 offset:6144
v_mfma_f32_16x16x32_bf16 a[52:55], a[20:23], v[236:239], a[52:55]
ds_read_b64_tr_b16 a[12:13], v3 offset:12288
v_accvgpr_read_b32 v32, a32
v_mfma_f32_16x16x32_bf16 a[52:55], a[16:19], v[228:231], a[52:55]
ds_read_b64_tr_b16 a[14:15], v3 offset:14336
v_add_u32 v3, 0x20000, v3
v_mfma_f32_16x16x16_bf16 v[96:99], v[40:41], v[30:31], 0
v_accvgpr_read_b32 v33, a33
v_accvgpr_read_b32 v34, a34
v_accvgpr_read_b32 v35, a35
v_mfma_f32_16x16x16_bf16 v[100:103], v[42:43], v[30:31], 0
buffer_store_dwordx4 v[44:47], v10, s[28:31], s54 offen sc1
v_mfma_f32_16x16x32_bf16 a[56:59], a[16:19], a[224:227], a[56:59]
v_accvgpr_read_b32 v36, a48
v_accvgpr_read_b32 v37, a49
v_mfma_f32_16x16x32_bf16 a[56:59], a[20:23], a[232:235], a[56:59]
v_accvgpr_read_b32 v38, a50
v_accvgpr_read_b32 v39, a51
v_mfma_f32_16x16x32_bf16 a[56:59], a[24:27], a[240:243], a[56:59]
s_add_u32 s54, s55, 155648
s_add_u32 s61, s61, s55
v_max_f32 v32, 0, v32
v_mfma_f32_16x16x32_bf16 a[56:59], a[28:31], a[248:251], a[56:59]
v_permlane16_swap_b32 v40, v42
v_mfma_f32_16x16x32_bf16 a[60:63], a[28:31], a[252:255], a[60:63]
v_permlane16_swap_b32 v41, v43
v_mfma_f32_16x16x32_bf16 a[60:63], a[24:27], a[244:247], a[60:63]
v_cvt_pk_bf16_f32 v44, v96, v97
v_max_f32 v33, 0, v33
v_mfma_f32_16x16x32_bf16 a[60:63], a[20:23], a[236:239], a[60:63]
buffer_store_dword v40, v21, s[28:31], s55 offen offset:1024 sc1
v_mfma_f32_16x16x32_bf16 a[60:63], a[16:19], a[228:231], a[60:63]
s_waitcnt lgkmcnt(0)
v_cvt_pk_bf16_f32 v45, v98, v99
v_max_f32 v34, 0, v34
v_mfma_f32_16x16x32_bf16 a[64:67], a[0:3], v[224:227], a[64:67]
ds_read_b64_tr_b16 a[16:17], v3 offset:24576
v_max_f32 v35, 0, v35
v_mfma_f32_16x16x32_bf16 a[64:67], a[4:7], v[232:235], a[64:67]
ds_read_b64_tr_b16 a[18:19], v3 offset:26624
v_add_u32 v3, 0xfffe0000, v3
v_mfma_f32_16x16x32_bf16 a[64:67], a[8:11], v[240:243], a[64:67]
ds_read_b64_tr_b16 a[20:21], v3
v_mul_f32 v32, v32, v36
v_mfma_f32_16x16x32_bf16 a[64:67], a[12:15], v[248:251], a[64:67]
ds_read_b64_tr_b16 a[22:23], v3 offset:2048
v_mul_f32 v33, v33, v37
v_mfma_f32_16x16x32_bf16 a[68:71], a[12:15], v[252:255], a[68:71]
ds_read_b64_tr_b16 a[24:25], v3 offset:8192
v_mul_f32 v34, v34, v38
v_mfma_f32_16x16x32_bf16 a[68:71], a[8:11], v[244:247], a[68:71]
ds_read_b64_tr_b16 a[26:27], v3 offset:10240
v_mul_f32 v35, v35, v39
v_mfma_f32_16x16x32_bf16 a[68:71], a[4:7], v[236:239], a[68:71]
ds_read_b64_tr_b16 a[28:29], v3 offset:16384
v_cvt_pk_bf16_f32 v36, v32, v33
v_mfma_f32_16x16x32_bf16 a[68:71], a[0:3], v[228:231], a[68:71]
ds_read_b64_tr_b16 a[30:31], v3 offset:18432
v_cvt_pk_bf16_f32 v37, v34, v35
v_mfma_f32_16x16x32_bf16 a[72:75], a[0:3], a[224:227], a[72:75]
buffer_store_dword v41, v21, s[28:31], s54 offen offset:1024 sc1
v_mfma_f32_16x16x32_bf16 a[72:75], a[4:7], a[232:235], a[72:75]
v_cvt_pk_bf16_f32 v46, v100, v101
v_accvgpr_write_b32 a32, v36
v_mfma_f32_16x16x32_bf16 a[72:75], a[8:11], a[240:243], a[72:75]
buffer_store_dword v42, v22, s[28:31], s55 offen offset:1024 sc1
v_mfma_f32_16x16x32_bf16 a[72:75], a[12:15], a[248:251], a[72:75]
v_cvt_pk_bf16_f32 v47, v102, v103
v_accvgpr_write_b32 a33, v37
v_mfma_f32_16x16x32_bf16 a[76:79], a[12:15], a[252:255], a[76:79]
buffer_store_dword v43, v22, s[28:31], s54 offen offset:1024 sc1
v_mfma_f32_16x16x32_bf16 a[76:79], a[8:11], a[244:247], a[76:79]
v_permlane16_swap_b32 v44, v46
v_mfma_f32_16x16x32_bf16 a[76:79], a[4:7], a[236:239], a[76:79]
v_permlane16_swap_b32 v45, v47
v_mfma_f32_16x16x32_bf16 a[76:79], a[0:3], a[228:231], a[76:79]
s_waitcnt vmcnt(28) lgkmcnt(0)
v_mov_b32 v41, 0x3f803f80
v_cndmask_b32 v40, 0, v41, s[62:63]
v_mfma_f32_16x16x32_bf16 a[80:83], a[16:19], v[224:227], a[80:83]
s_barrier
ds_read_b64_tr_b16 a[0:1], v2 offset:20480
v_accvgpr_read_b32 v32, a36
v_mfma_f32_16x16x32_bf16 a[80:83], a[20:23], v[232:235], a[80:83]
ds_read_b64_tr_b16 a[2:3], v2 offset:22528
v_accvgpr_read_b32 v33, a37
v_mfma_f32_16x16x32_bf16 a[80:83], a[24:27], v[240:243], a[80:83]
ds_read_b64_tr_b16 a[4:5], v2 offset:28672
buffer_load_dwordx4 v6, s[16:19], 0 offen lds
v_mfma_f32_16x16x32_bf16 a[80:83], a[28:31], v[248:251], a[80:83]
s_add_u32 m0, s47, 20480
ds_read_b64_tr_b16 a[6:7], v2 offset:30720
v_accvgpr_read_b32 v34, a38
v_mfma_f32_16x16x32_bf16 a[84:87], a[28:31], v[252:255], a[84:87]
ds_read_b64_tr_b16 a[8:9], v2 offset:36864
v_accvgpr_read_b32 v35, a39
v_mfma_f32_16x16x32_bf16 a[84:87], a[24:27], v[244:247], a[84:87]
ds_read_b64_tr_b16 a[10:11], v2 offset:38912
v_accvgpr_read_b32 v36, a52
v_mfma_f32_16x16x32_bf16 a[84:87], a[20:23], v[236:239], a[84:87]
ds_read_b64_tr_b16 a[12:13], v2 offset:45056
v_accvgpr_read_b32 v37, a53
v_mfma_f32_16x16x32_bf16 a[84:87], a[16:19], v[228:231], a[84:87]
ds_read_b64_tr_b16 a[14:15], v2 offset:47104
v_accvgpr_read_b32 v38, a54
v_mfma_f32_16x16x32_bf16 a[88:91], a[16:19], a[224:227], a[88:91]
buffer_store_dwordx4 v[44:47], v23, s[28:31], s61 offen offset:1024 sc1
v_mfma_f32_16x16x32_bf16 a[88:91], a[20:23], a[232:235], a[88:91]
v_mov_b32 v41, v40
v_mov_b32 v42, v40
v_mfma_f32_16x16x32_bf16 a[88:91], a[24:27], a[240:243], a[88:91]
v_mov_b32 v43, v40
v_accvgpr_read_b32 v39, a55
v_mfma_f32_16x16x32_bf16 a[88:91], a[28:31], a[248:251], a[88:91]
s_lshl_b32 s57, s46, 7
buffer_store_dwordx4 v[40:43], v24, s[28:31], s61 offen offset:1152 sc1
v_mfma_f32_16x16x32_bf16 a[92:95], a[28:31], a[252:255], a[92:95]
s_add_u32 s57, s57, 58728448
v_max_f32 v32, 0, v32
v_max_f32 v33, 0, v33
v_mfma_f32_16x16x32_bf16 a[92:95], a[24:27], a[244:247], a[92:95]
v_max_f32 v34, 0, v34
v_max_f32 v35, 0, v35
v_mfma_f32_16x16x32_bf16 a[92:95], a[20:23], a[236:239], a[92:95]
v_mul_f32 v32, v32, v36
v_mul_f32 v33, v33, v37
v_mfma_f32_16x16x32_bf16 a[92:95], a[16:19], a[228:231], a[92:95]
s_waitcnt lgkmcnt(0)
v_mul_f32 v34, v34, v38
v_mul_f32 v35, v35, v39
v_mfma_f32_16x16x32_bf16 v[48:51], a[0:3], v[112:115], 0
ds_read_b64_tr_b16 a[16:17], v2 offset:24576
v_cvt_pk_bf16_f32 v36, v32, v33
v_mfma_f32_16x16x32_bf16 v[48:51], a[4:7], v[120:123], v[48:51]
ds_read_b64_tr_b16 a[18:19], v2 offset:26624
v_cvt_pk_bf16_f32 v37, v34, v35
v_mfma_f32_16x16x32_bf16 v[48:51], a[8:11], v[128:131], v[48:51]
ds_read_b64_tr_b16 a[20:21], v2 offset:32768
v_accvgpr_write_b32 a36, v36
v_mfma_f32_16x16x32_bf16 v[48:51], a[12:15], v[136:139], v[48:51]
ds_read_b64_tr_b16 a[22:23], v2 offset:34816
v_accvgpr_write_b32 a37, v37
v_mfma_f32_16x16x32_bf16 v[52:55], a[12:15], v[140:143], 0
ds_read_b64_tr_b16 a[24:25], v2 offset:40960
v_accvgpr_read_b32 v32, a40
v_mfma_f32_16x16x32_bf16 v[52:55], a[8:11], v[132:135], v[52:55]
s_add_u32 s100, s5, 384
s_and_b32 s100, s100, 384
ds_read_b64_tr_b16 a[26:27], v2 offset:43008
v_mfma_f32_16x16x32_bf16 v[52:55], a[4:7], v[124:127], v[52:55]
ds_read_b64_tr_b16 a[28:29], v2 offset:49152
buffer_load_dword v0, v27, s[16:19], s100 offen
v_mfma_f32_16x16x32_bf16 v[52:55], a[0:3], v[116:119], v[52:55]
ds_read_b64_tr_b16 a[30:31], v2 offset:51200
buffer_load_dword v0, v27, s[20:23], s100 offen
v_mfma_f32_16x16x32_bf16 v[56:59], a[0:3], a[112:115], 0
v_add_u32 v27, s4, v27
v_accvgpr_read_b32 v33, a41
v_mfma_f32_16x16x32_bf16 v[56:59], a[4:7], a[120:123], v[56:59]
buffer_load_dword v0, v27, s[16:19], 0 offen
buffer_load_dword v0, v27, s[20:23], 0 offen
v_mfma_f32_16x16x32_bf16 v[56:59], a[8:11], a[128:131], v[56:59]
v_accvgpr_read_b32 v34, a42
v_accvgpr_read_b32 v35, a43
v_mfma_f32_16x16x32_bf16 v[56:59], a[12:15], a[136:139], v[56:59]
v_accvgpr_read_b32 v36, a56
v_accvgpr_read_b32 v37, a57
v_mfma_f32_16x16x32_bf16 v[60:63], a[12:15], a[140:143], 0
v_accvgpr_read_b32 v38, a58
v_accvgpr_read_b32 v39, a59
v_mfma_f32_16x16x32_bf16 v[60:63], a[8:11], a[132:135], v[60:63]
v_max_f32 v32, 0, v32
v_max_f32 v33, 0, v33
v_mfma_f32_16x16x32_bf16 v[60:63], a[4:7], a[124:127], v[60:63]
v_max_f32 v34, 0, v34
v_max_f32 v35, 0, v35
v_mfma_f32_16x16x32_bf16 v[60:63], a[0:3], a[116:119], v[60:63]
s_waitcnt lgkmcnt(0)
v_mul_f32 v32, v32, v36
v_mul_f32 v33, v33, v37
v_mfma_f32_16x16x32_bf16 v[64:67], a[16:19], v[112:115], 0
ds_read_b64_tr_b16 a[0:1], v3 offset:20480
v_mul_f32 v34, v34, v38
v_mfma_f32_16x16x32_bf16 v[64:67], a[20:23], v[120:123], v[64:67]
ds_read_b64_tr_b16 a[2:3], v3 offset:22528
v_mul_f32 v35, v35, v39
v_mfma_f32_16x16x32_bf16 v[64:67], a[24:27], v[128:131], v[64:67]
ds_read_b64_tr_b16 a[4:5], v3 offset:28672
v_cvt_pk_bf16_f32 v36, v32, v33
v_mfma_f32_16x16x32_bf16 v[64:67], a[28:31], v[136:139], v[64:67]
ds_read_b64_tr_b16 a[6:7], v3 offset:30720
v_cvt_pk_bf16_f32 v37, v34, v35
v_mfma_f32_16x16x32_bf16 v[68:71], a[28:31], v[140:143], 0
ds_read_b64_tr_b16 a[8:9], v3 offset:36864
v_accvgpr_write_b32 a40, v36
v_mfma_f32_16x16x32_bf16 v[68:71], a[24:27], v[132:135], v[68:71]
s_lshl_b32 s58, s45, 2
ds_read_b64_tr_b16 a[10:11], v3 offset:38912
v_add_u32 v16, 0x20000, v16
v_mfma_f32_16x16x32_bf16 v[68:71], a[20:23], v[124:127], v[68:71]
s_add_u32 s58, s58, s44
ds_read_b64_tr_b16 a[12:13], v3 offset:45056
v_add_u32 v17, 0x20000, v17
v_mfma_f32_16x16x32_bf16 v[68:71], a[16:19], v[116:119], v[68:71]
ds_read_b64_tr_b16 a[14:15], v3 offset:47104
v_add_u32 v18, 0x20000, v18
v_mfma_f32_16x16x32_bf16 v[72:75], a[16:19], a[112:115], 0
v_add_u32 v19, 0x20000, v19
v_accvgpr_write_b32 a41, v37
v_mfma_f32_16x16x32_bf16 v[72:75], a[20:23], a[120:123], v[72:75]
v_accvgpr_read_b32 v32, a44
v_accvgpr_read_b32 v33, a45
v_mfma_f32_16x16x32_bf16 v[72:75], a[24:27], a[128:131], v[72:75]
v_accvgpr_read_b32 v34, a46
v_accvgpr_read_b32 v35, a47
v_mfma_f32_16x16x32_bf16 v[72:75], a[28:31], a[136:139], v[72:75]
v_accvgpr_read_b32 v36, a60
v_accvgpr_read_b32 v37, a61
v_mfma_f32_16x16x32_bf16 v[76:79], a[28:31], a[140:143], 0
v_accvgpr_read_b32 v38, a62
v_accvgpr_read_b32 v39, a63
v_mfma_f32_16x16x32_bf16 v[76:79], a[24:27], a[132:135], v[76:79]
v_max_f32 v32, 0, v32
v_max_f32 v33, 0, v33
v_mfma_f32_16x16x32_bf16 v[76:79], a[20:23], a[124:127], v[76:79]
v_max_f32 v34, 0, v34
v_max_f32 v35, 0, v35
v_mfma_f32_16x16x32_bf16 v[76:79], a[16:19], a[116:119], v[76:79]
s_waitcnt lgkmcnt(0)
v_mul_f32 v32, v32, v36
v_mul_f32 v33, v33, v37
v_mfma_f32_16x16x32_bf16 v[80:83], a[0:3], v[112:115], 0
ds_read_b64_tr_b16 a[16:17], v3 offset:24576
v_mul_f32 v34, v34, v38
v_mfma_f32_16x16x32_bf16 v[80:83], a[4:7], v[120:123], v[80:83]
ds_read_b64_tr_b16 a[18:19], v3 offset:26624
v_mul_f32 v35, v35, v39
v_mfma_f32_16x16x32_bf16 v[80:83], a[8:11], v[128:131], v[80:83]
ds_read_b64_tr_b16 a[20:21], v3 offset:32768
v_cvt_pk_bf16_f32 v36, v32, v33
v_mfma_f32_16x16x32_bf16 v[80:83], a[12:15], v[136:139], v[80:83]
ds_read_b64_tr_b16 a[22:23], v3 offset:34816
v_cvt_pk_bf16_f32 v37, v34, v35
v_mfma_f32_16x16x32_bf16 v[84:87], a[12:15], v[140:143], 0
ds_read_b64_tr_b16 a[24:25], v3 offset:40960
v_accvgpr_write_b32 a44, v36
v_mfma_f32_16x16x32_bf16 v[84:87], a[8:11], v[132:135], v[84:87]
ds_read_b64_tr_b16 a[26:27], v3 offset:43008
v_accvgpr_write_b32 a45, v37
v_mfma_f32_16x16x32_bf16 v[84:87], a[4:7], v[124:127], v[84:87]
ds_read_b64_tr_b16 a[28:29], v3 offset:49152
v_accvgpr_read_b32 v32, a64
v_mfma_f32_16x16x32_bf16 v[84:87], a[0:3], v[116:119], v[84:87]
ds_read_b64_tr_b16 a[30:31], v3 offset:51200
v_accvgpr_read_b32 v33, a65
v_mfma_f32_16x16x32_bf16 v[88:91], a[0:3], a[112:115], 0
v_accvgpr_read_b32 v34, a66
v_accvgpr_read_b32 v35, a67
v_mfma_f32_16x16x32_bf16 v[88:91], a[4:7], a[120:123], v[88:91]
v_accvgpr_read_b32 v36, a80
v_accvgpr_read_b32 v37, a81
v_mfma_f32_16x16x32_bf16 v[88:91], a[8:11], a[128:131], v[88:91]
v_accvgpr_read_b32 v38, a82
v_accvgpr_read_b32 v39, a83
v_mfma_f32_16x16x32_bf16 v[88:91], a[12:15], a[136:139], v[88:91]
v_max_f32 v32, 0, v32
v_max_f32 v33, 0, v33
v_mfma_f32_16x16x32_bf16 v[92:95], a[12:15], a[140:143], 0
v_max_f32 v34, 0, v34
v_max_f32 v35, 0, v35
v_mfma_f32_16x16x32_bf16 v[92:95], a[8:11], a[132:135], v[92:95]
v_mul_f32 v32, v32, v36
v_mul_f32 v33, v33, v37
v_mfma_f32_16x16x32_bf16 v[92:95], a[4:7], a[124:127], v[92:95]
v_mul_f32 v34, v34, v38
v_mul_f32 v35, v35, v39
v_mfma_f32_16x16x32_bf16 v[92:95], a[0:3], a[116:119], v[92:95]
s_waitcnt vmcnt(28) lgkmcnt(0)
v_cvt_pk_bf16_f32 v36, v32, v33
v_cvt_pk_bf16_f32 v37, v34, v35
v_mfma_f32_16x16x32_bf16 v[96:99], a[16:19], v[112:115], 0
s_barrier
ds_read_b64_tr_b16 a[0:1], v2 offset:53248
v_accvgpr_write_b32 a34, v36
v_mfma_f32_16x16x32_bf16 v[96:99], a[20:23], v[120:123], v[96:99]
ds_read_b64_tr_b16 a[2:3], v2 offset:55296
v_accvgpr_write_b32 a35, v37
v_mfma_f32_16x16x32_bf16 v[96:99], a[24:27], v[128:131], v[96:99]
ds_read_b64_tr_b16 a[4:5], v2 offset:61440
buffer_load_dwordx4 v6, s[20:23], 0 offen lds
v_mfma_f32_16x16x32_bf16 v[96:99], a[28:31], v[136:139], v[96:99]
s_add_u32 m0, s47, 24576
ds_read_b64_tr_b16 a[6:7], v2 offset:63488
v_add_u32 v2, 0x10000, v2
v_mfma_f32_16x16x32_bf16 v[100:103], a[28:31], v[140:143], 0
ds_read_b64_tr_b16 a[8:9], v2 offset:4096
v_add_u32 v6, 0x48000, v6
v_mfma_f32_16x16x32_bf16 v[100:103], a[24:27], v[132:135], v[100:103]
ds_read_b64_tr_b16 a[10:11], v2 offset:6144
v_add_u32 v2, 0xffff0000, v2
v_mfma_f32_16x16x32_bf16 v[100:103], a[20:23], v[124:127], v[100:103]
v_accvgpr_read_b32 v32, a68
v_accvgpr_read_b32 v33, a69
v_mfma_f32_16x16x32_bf16 v[100:103], a[16:19], v[116:119], v[100:103]
v_accvgpr_read_b32 v34, a70
v_accvgpr_read_b32 v35, a71
v_mfma_f32_16x16x32_bf16 v[104:107], a[16:19], a[112:115], 0
buffer_load_dwordx4 v6, s[16:19], 0 offen lds
buffer_load_dword v0, off, s[40:43], 0 sc1
v_mfma_f32_16x16x32_bf16 v[104:107], a[20:23], a[120:123], v[104:107]
s_add_u32 m0, s47, 28672
v_accvgpr_read_b32 v36, a84
v_accvgpr_read_b32 v37, a85
v_mfma_f32_16x16x32_bf16 v[104:107], a[24:27], a[128:131], v[104:107]
v_accvgpr_read_b32 v38, a86
v_accvgpr_read_b32 v39, a87
v_mfma_f32_16x16x32_bf16 v[104:107], a[28:31], a[136:139], v[104:107]
v_max_f32 v32, 0, v32
v_max_f32 v33, 0, v33
v_mfma_f32_16x16x32_bf16 v[108:111], a[28:31], a[140:143], 0
v_max_f32 v34, 0, v34
v_max_f32 v35, 0, v35
v_mfma_f32_16x16x32_bf16 v[108:111], a[24:27], a[132:135], v[108:111]
v_mul_f32 v32, v32, v36
v_mul_f32 v33, v33, v37
v_mfma_f32_16x16x32_bf16 v[108:111], a[20:23], a[124:127], v[108:111]
buffer_load_dwordx4 v6, s[20:23], 0 offen lds
v_mfma_f32_16x16x32_bf16 v[108:111], a[16:19], a[116:119], v[108:111]
s_waitcnt lgkmcnt(0)
v_add_u32 v6, 0x48000, v6
v_mul_f32 v34, v34, v38
v_mfma_f32_16x16x32_bf16 v[48:51], a[0:3], v[144:147], v[48:51]
s_add_u32 m0, s47, 32768
ds_read_b64_tr_b16 a[16:17], v2 offset:57344
v_mul_f32 v35, v35, v39
v_mfma_f32_16x16x32_bf16 v[48:51], a[4:7], v[152:155], v[48:51]
ds_read_b64_tr_b16 a[18:19], v2 offset:59392
v_add_u32 v2, 0x10000, v2
v_mfma_f32_16x16x32_bf16 v[48:51], a[8:11], v[160:163], v[48:51]
ds_read_b64_tr_b16 a[20:21], v2
v_cvt_pk_bf16_f32 v36, v32, v33
v_mfma_f32_16x16x32_bf16 v[52:55], a[8:11], v[164:167], v[52:55]
ds_read_b64_tr_b16 a[22:23], v2 offset:2048
v_cvt_pk_bf16_f32 v37, v34, v35
L_pad6:
s_cbranch_execz L_pad10
v_mfma_f32_16x16x32_bf16 v[52:55], a[4:7], v[156:159], v[52:55]
ds_read_b64_tr_b16 a[24:25], v2 offset:8192
buffer_load_dwordx4 v6, s[16:19], 0 offen lds
v_mfma_f32_16x16x32_bf16 v[52:55], a[0:3], v[148:151], v[52:55]
s_add_u32 m0, s47, 36864
ds_read_b64_tr_b16 a[26:27], v2 offset:10240
v_accvgpr_write_b32 a38, v36
v_mfma_f32_16x16x32_bf16 v[56:59], a[0:3], a[144:147], v[56:59]
v_accvgpr_write_b32 a39, v37
v_accvgpr_read_b32 v32, a72
v_mfma_f32_16x16x32_bf16 v[56:59], a[4:7], a[152:155], v[56:59]
v_accvgpr_read_b32 v33, a73
v_accvgpr_read_b32 v34, a74
v_mfma_f32_16x16x32_bf16 v[56:59], a[8:11], a[160:163], v[56:59]
v_accvgpr_read_b32 v35, a75
v_accvgpr_read_b32 v36, a88
v_mfma_f32_16x16x32_bf16 v[60:63], a[8:11], a[164:167], v[60:63]
v_accvgpr_read_b32 v37, a89
v_accvgpr_read_b32 v38, a90
v_mfma_f32_16x16x32_bf16 v[60:63], a[4:7], a[156:159], v[60:63]
buffer_load_dwordx4 v6, s[20:23], 0 offen lds
v_mfma_f32_16x16x32_bf16 v[60:63], a[0:3], a[148:151], v[60:63]
s_waitcnt lgkmcnt(0)
v_add_u32 v6, 0x48000, v6
v_accvgpr_read_b32 v39, a91
v_mfma_f32_16x16x32_bf16 v[64:67], a[16:19], v[144:147], v[64:67]
s_add_u32 m0, s47, 40960
ds_read_b64_tr_b16 a[0:1], v3 offset:53248
v_max_f32 v32, 0, v32
v_mfma_f32_16x16x32_bf16 v[64:67], a[20:23], v[152:155], v[64:67]
ds_read_b64_tr_b16 a[2:3], v3 offset:55296
v_max_f32 v33, 0, v33
v_mfma_f32_16x16x32_bf16 v[64:67], a[24:27], v[160:163], v[64:67]
ds_read_b64_tr_b16 a[4:5], v3 offset:61440
v_max_f32 v34, 0, v34
v_mfma_f32_16x16x32_bf16 v[68:71], a[24:27], v[164:167], v[68:71]
ds_read_b64_tr_b16 a[6:7], v3 offset:63488
v_add_u32 v3, 0x10000, v3
v_mfma_f32_16x16x32_bf16 v[68:71], a[20:23], v[156:159], v[68:71]
ds_read_b64_tr_b16 a[8:9], v3 offset:4096
buffer_load_dwordx4 v6, s[16:19], 0 offen lds
v_mfma_f32_16x16x32_bf16 v[68:71], a[16:19], v[148:151], v[68:71]
s_add_u32 m0, s47, 45056
ds_read_b64_tr_b16 a[10:11], v3 offset:6144
v_add_u32 v3, 0xffff0000, v3
v_mfma_f32_16x16x32_bf16 v[72:75], a[16:19], a[144:147], v[72:75]
v_max_f32 v35, 0, v35
v_mul_f32 v32, v32, v36
v_mfma_f32_16x16x32_bf16 v[72:75], a[20:23], a[152:155], v[72:75]
v_mul_f32 v33, v33, v37
v_mul_f32 v34, v34, v38
v_mfma_f32_16x16x32_bf16 v[72:75], a[24:27], a[160:163], v[72:75]
v_mul_f32 v35, v35, v39
v_cvt_pk_bf16_f32 v36, v32, v33
v_mfma_f32_16x16x32_bf16 v[76:79], a[24:27], a[164:167], v[76:79]
v_cvt_pk_bf16_f32 v37, v34, v35
v_accvgpr_write_b32 a42, v36
v_mfma_f32_16x16x32_bf16 v[76:79], a[20:23], a[156:159], v[76:79]
buffer_load_dwordx4 v6, s[20:23], 0 offen lds
v_mfma_f32_16x16x32_bf16 v[76:79], a[16:19], a[148:151], v[76:79]
s_waitcnt lgkmcnt(0)
s_add_u32 s1, s5, 384
s_and_b32 s1, s1, 384
v_mfma_f32_16x16x32_bf16 v[80:83], a[0:3], v[144:147], v[80:83]
s_min_u32 s1, s1, 1
s_mul_i32 s1, s1, 512
ds_read_b64_tr_b16 a[16:17], v3 offset:57344
v_mfma_f32_16x16x32_bf16 v[80:83], a[4:7], v[152:155], v[80:83]
s_add_u32 s1, s1, 0xffb37e80
ds_read_b64_tr_b16 a[18:19], v3 offset:59392
v_add_u32 v3, 0x10000, v3
v_mfma_f32_16x16x32_bf16 v[80:83], a[8:11], v[160:163], v[80:83]
s_add_u32 m0, s47, 49152
ds_read_b64_tr_b16 a[20:21], v3
v_add_u32 v6, s1, v6
v_mfma_f32_16x16x32_bf16 v[84:87], a[8:11], v[164:167], v[84:87]
ds_read_b64_tr_b16 a[22:23], v3 offset:2048
v_accvgpr_write_b32 a43, v37
v_mfma_f32_16x16x32_bf16 v[84:87], a[4:7], v[156:159], v[84:87]
ds_read_b64_tr_b16 a[24:25], v3 offset:8192
buffer_load_dwordx4 v6, s[16:19], 0 offen lds
v_mfma_f32_16x16x32_bf16 v[84:87], a[0:3], v[148:151], v[84:87]
s_add_u32 m0, s47, 53248
ds_read_b64_tr_b16 a[26:27], v3 offset:10240
v_accvgpr_read_b32 v32, a76
v_mfma_f32_16x16x32_bf16 v[88:91], a[0:3], a[144:147], v[88:91]
v_accvgpr_read_b32 v33, a77
v_accvgpr_read_b32 v34, a78
v_mfma_f32_16x16x32_bf16 v[88:91], a[4:7], a[152:155], v[88:91]
v_accvgpr_read_b32 v35, a79
v_accvgpr_read_b32 v36, a92
v_mfma_f32_16x16x32_bf16 v[88:91], a[8:11], a[160:163], v[88:91]
v_accvgpr_read_b32 v37, a93
v_accvgpr_read_b32 v38, a94
v_mfma_f32_16x16x32_bf16 v[92:95], a[8:11], a[164:167], v[92:95]
v_accvgpr_read_b32 v39, a95
v_max_f32 v32, 0, v32
v_mfma_f32_16x16x32_bf16 v[92:95], a[4:7], a[156:159], v[92:95]
v_max_f32 v33, 0, v33
v_max_f32 v34, 0, v34
v_mfma_f32_16x16x32_bf16 v[92:95], a[0:3], a[148:151], v[92:95]
s_waitcnt vmcnt(6) lgkmcnt(0)
v_max_f32 v35, 0, v35
v_mul_f32 v32, v32, v36
v_mfma_f32_16x16x32_bf16 v[96:99], a[16:19], v[144:147], v[96:99]
s_barrier
ds_read_b64_tr_b16 a[0:1], v2 offset:12288
v_mul_f32 v33, v33, v37
v_mfma_f32_16x16x32_bf16 v[96:99], a[20:23], v[152:155], v[96:99]
ds_read_b64_tr_b16 a[2:3], v2 offset:14336
v_mul_f32 v34, v34, v38
v_mfma_f32_16x16x32_bf16 v[96:99], a[24:27], v[160:163], v[96:99]
ds_read_b64_tr_b16 a[4:5], v2 offset:20480
buffer_load_dwordx4 v6, s[20:23], 0 offen lds
v_mfma_f32_16x16x32_bf16 v[100:103], a[24:27], v[164:167], v[100:103]
s_add_u32 m0, s47, 57344
ds_read_b64_tr_b16 a[6:7], v2 offset:22528
v_add_u32 v6, 0x48000, v6
v_mfma_f32_16x16x32_bf16 v[100:103], a[20:23], v[156:159], v[100:103]
ds_read_b64_tr_b16 a[8:9], v2 offset:28672
v_mul_f32 v35, v35, v39
v_mfma_f32_16x16x32_bf16 v[100:103], a[16:19], v[148:151], v[100:103]
ds_read_b64_tr_b16 a[10:11], v2 offset:30720
v_cvt_pk_bf16_f32 v36, v32, v33
v_mfma_f32_16x16x32_bf16 v[104:107], a[16:19], a[144:147], v[104:107]
ds_read_b64_tr_b16 a[12:13], v2 offset:36864
v_cvt_pk_bf16_f32 v37, v34, v35
v_mfma_f32_16x16x32_bf16 v[104:107], a[20:23], a[152:155], v[104:107]
ds_read_b64_tr_b16 a[14:15], v2 offset:38912
v_accvgpr_write_b32 a46, v36
v_mfma_f32_16x16x32_bf16 v[104:107], a[24:27], a[160:163], v[104:107]
buffer_load_dwordx4 v6, s[16:19], 0 offen lds
v_mfma_f32_16x16x32_bf16 v[108:111], a[24:27], a[164:167], v[108:111]
s_add_u32 m0, s47, 61440
v_accvgpr_write_b32 a47, v37
v_mov_b32 v44, 2147483648
v_mfma_f32_16x16x32_bf16 v[108:111], a[20:23], a[156:159], v[108:111]
s_mul_i32 s59, s46, 331776
s_mul_i32 s60, s58, 81
s_lshr_b32 s60, s60, 1
v_mfma_f32_16x16x32_bf16 v[108:111], a[16:19], a[148:151], v[108:111]
s_waitcnt lgkmcnt(0)
s_lshl_b32 s60, s60, 7
s_add_u32 s59, s59, s60
v_mfma_f32_16x16x32_bf16 v[48:51], a[0:3], v[168:171], v[48:51]
ds_read_b64_tr_b16 a[16:17], v2 offset:16384
v_cmp_gt_u32 vcc, 41, v1
v_mfma_f32_16x16x32_bf16 v[48:51], a[4:7], v[176:179], v[48:51]
ds_read_b64_tr_b16 a[18:19], v2 offset:18432
v_lshlrev_b32 v45, 7, v1
v_mfma_f32_16x16x32_bf16 v[48:51], a[8:11], v[184:187], v[48:51]
s_lshl_b32 s60, s2, 2
ds_read_b64_tr_b16 a[20:21], v2 offset:24576
buffer_load_dwordx4 v6, s[20:23], 0 offen lds
v_mfma_f32_16x16x32_bf16 v[48:51], a[12:15], v[192:195], v[48:51]
s_add_u32 m0, s47, 65536
ds_read_b64_tr_b16 a[22:23], v2 offset:26624
v_add_u32 v6, 0x48000, v6
v_mfma_f32_16x16x32_bf16 v[52:55], a[12:15], v[196:199], v[52:55]
ds_read_b64_tr_b16 a[24:25], v2 offset:32768
v_cndmask_b32 v45, v44, v45, vcc
v_mfma_f32_16x16x32_bf16 v[52:55], a[8:11], v[188:191], v[52:55]
ds_read_b64_tr_b16 a[26:27], v2 offset:34816
v_add_u32 v46, s59, v45
v_mfma_f32_16x16x32_bf16 v[52:55], a[4:7], v[180:183], v[52:55]
s_add_u32 s60, s60, s44
s_mul_i32 s60, s60, 81
ds_read_b64_tr_b16 a[28:29], v2 offset:40960
v_mfma_f32_16x16x32_bf16 v[52:55], a[0:3], v[172:175], v[52:55]
s_lshr_b32 s60, s60, 4
s_lshl_b32 s60, s60, 7
ds_read_b64_tr_b16 a[30:31], v2 offset:43008
v_mfma_f32_16x16x32_bf16 v[56:59], a[0:3], a[168:171], v[56:59]
buffer_load_dwordx4 v6, s[16:19], 0 offen lds
v_mfma_f32_16x16x32_bf16 v[56:59], a[4:7], a[176:179], v[56:59]
s_add_u32 m0, s47, 69632
v_lshrrev_b32 v45, 3, v1
v_min_u32 v45, 5, v45
v_mfma_f32_16x16x32_bf16 v[56:59], a[8:11], a[184:187], v[56:59]
v_lshl_add_u32 v47, v45, 7, s60
v_readfirstlane_b32 s3, v0
v_mfma_f32_16x16x32_bf16 v[56:59], a[12:15], a[192:195], v[56:59]
v_mfma_f32_16x16x32_bf16 v[60:63], a[12:15], a[196:199], v[60:63]
s_cmp_lt_u32 s3, 1
s_cbranch_scc1 L_spin0
L_back0:
v_mfma_f32_16x16x32_bf16 v[60:63], a[8:11], a[188:191], v[60:63]
buffer_atomic_add v29, v28, s[28:31], s57 offen sc1
v_mfma_f32_16x16x32_bf16 v[60:63], a[4:7], a[180:183], v[60:63]
s_add_u32 s40, s5, 0
s_and_b32 s40, s40, 384
buffer_load_dwordx4 v6, s[20:23], 0 offen lds
v_mfma_f32_16x16x32_bf16 v[60:63], a[0:3], a[172:175], v[60:63]
s_waitcnt lgkmcnt(0)
s_min_u32 s40, s40, 1
v_add_u32 v6, 0x48000, v6
v_mfma_f32_16x16x32_bf16 v[64:67], a[16:19], v[168:171], v[64:67]
s_add_u32 m0, s47, 73728
s_mul_i32 s40, s40, 294912
ds_read_b64_tr_b16 a[0:1], v3 offset:12288
v_mfma_f32_16x16x32_bf16 v[64:67], a[20:23], v[176:179], v[64:67]
s_add_u32 s40, s40, 0xfffc1080
s_add_u32 s41, s5, 128
ds_read_b64_tr_b16 a[2:3], v3 offset:14336
v_mfma_f32_16x16x32_bf16 v[64:67], a[24:27], v[184:187], v[64:67]
s_and_b32 s41, s41, 384
s_min_u32 s41, s41, 1
ds_read_b64_tr_b16 a[4:5], v3 offset:20480
v_mfma_f32_16x16x32_bf16 v[64:67], a[28:31], v[192:195], v[64:67]
s_mul_i32 s41, s41, 294912
s_add_u32 s41, s41, 0xfffc1000
ds_read_b64_tr_b16 a[6:7], v3 offset:22528
v_mfma_f32_16x16x32_bf16 v[68:71], a[28:31], v[196:199], v[68:71]
s_add_u32 s42, s5, 256
ds_read_b64_tr_b16 a[8:9], v3 offset:28672
buffer_load_dwordx4 v6, s[16:19], 0 offen lds
v_mfma_f32_16x16x32_bf16 v[68:71], a[24:27], v[188:191], v[68:71]
s_add_u32 m0, s47, 77824
s_and_b32 s42, s42, 384
ds_read_b64_tr_b16 a[10:11], v3 offset:30720
v_mfma_f32_16x16x32_bf16 v[68:71], a[20:23], v[180:183], v[68:71]
s_min_u32 s42, s42, 1
s_mul_i32 s42, s42, 294912
ds_read_b64_tr_b16 a[12:13], v3 offset:36864
v_mfma_f32_16x16x32_bf16 v[68:71], a[16:19], v[172:175], v[68:71]
s_add_u32 s42, s42, 0xfffc1000
s_add_u32 s43, s5, 384
ds_read_b64_tr_b16 a[14:15], v3 offset:38912
v_mfma_f32_16x16x32_bf16 v[72:75], a[16:19], a[168:171], v[72:75]
s_and_b32 s43, s43, 384
s_min_u32 s43, s43, 1
s_mul_i32 s43, s43, 294912
v_mfma_f32_16x16x32_bf16 v[72:75], a[20:23], a[176:179], v[72:75]
s_add_u32 s43, s43, 0xfffc1000
v_mfma_f32_16x16x32_bf16 v[72:75], a[24:27], a[184:187], v[72:75]
v_mfma_f32_16x16x32_bf16 v[72:75], a[28:31], a[192:195], v[72:75]
v_mfma_f32_16x16x32_bf16 v[76:79], a[28:31], a[196:199], v[76:79]
v_mfma_f32_16x16x32_bf16 v[76:79], a[24:27], a[188:191], v[76:79]
v_mfma_f32_16x16x32_bf16 v[76:79], a[20:23], a[180:183], v[76:79]
v_mfma_f32_16x16x32_bf16 v[76:79], a[16:19], a[172:175], v[76:79]
s_waitcnt lgkmcnt(0)
v_mfma_f32_16x16x32_bf16 v[80:83], a[0:3], v[168:171], v[80:83]
ds_read_b64_tr_b16 a[16:17], v3 offset:16384
v_mfma_f32_16x16x32_bf16 v[80:83], a[4:7], v[176:179], v[80:83]
ds_read_b64_tr_b16 a[18:19], v3 offset:18432
v_mfma_f32_16x16x32_bf16 v[80:83], a[8:11], v[184:187], v[80:83]
ds_read_b64_tr_b16 a[20:21], v3 offset:24576
v_mfma_f32_16x16x32_bf16 v[80:83], a[12:15], v[192:195], v[80:83]
ds_read_b64_tr_b16 a[22:23], v3 offset:26624
v_mfma_f32_16x16x32_bf16 v[84:87], a[12:15], v[196:199], v[84:87]
ds_read_b64_tr_b16 a[24:25], v3 offset:32768
v_mfma_f32_16x16x32_bf16 v[84:87], a[8:11], v[188:191], v[84:87]
ds_read_b64_tr_b16 a[26:27], v3 offset:34816
v_mfma_f32_16x16x32_bf16 v[84:87], a[4:7], v[180:183], v[84:87]
ds_read_b64_tr_b16 a[28:29], v3 offset:40960
v_mfma_f32_16x16x32_bf16 v[84:87], a[0:3], v[172:175], v[84:87]
ds_read_b64_tr_b16 a[30:31], v3 offset:43008
v_mfma_f32_16x16x32_bf16 v[88:91], a[0:3], a[168:171], v[88:91]
v_mfma_f32_16x16x32_bf16 v[88:91], a[4:7], a[176:179], v[88:91]
v_mfma_f32_16x16x32_bf16 v[88:91], a[8:11], a[184:187], v[88:91]
v_mfma_f32_16x16x32_bf16 v[88:91], a[12:15], a[192:195], v[88:91]
ds_write_b128 v18, a[96:99] offset:4096
v_mfma_f32_16x16x32_bf16 v[92:95], a[12:15], a[196:199], v[92:95]
v_mfma_f32_16x16x32_bf16 v[92:95], a[8:11], a[188:191], v[92:95]
ds_write_b128 v18, a[100:103] offset:8192
v_mfma_f32_16x16x32_bf16 v[92:95], a[4:7], a[180:183], v[92:95]
v_add_u32 v18, 0xfffe0000, v18
v_mfma_f32_16x16x32_bf16 v[92:95], a[0:3], a[172:175], v[92:95]
s_waitcnt lgkmcnt(2)
v_mfma_f32_16x16x32_bf16 v[96:99], a[16:19], v[168:171], v[96:99]
s_barrier
ds_read_b64_tr_b16 a[0:1], v2 offset:45056
v_mfma_f32_16x16x32_bf16 v[96:99], a[20:23], v[176:179], v[96:99]
ds_read_b64_tr_b16 a[2:3], v2 offset:47104
v_mfma_f32_16x16x32_bf16 v[96:99], a[24:27], v[184:187], v[96:99]
ds_read_b64_tr_b16 a[4:5], v2 offset:53248
v_mfma_f32_16x16x32_bf16 v[96:99], a[28:31], v[192:195], v[96:99]
ds_read_b64_tr_b16 a[6:7], v2 offset:55296
v_mfma_f32_16x16x32_bf16 v[100:103], a[28:31], v[196:199], v[100:103]
ds_read_b64_tr_b16 a[8:9], v2 offset:61440
v_mfma_f32_16x16x32_bf16 v[100:103], a[24:27], v[188:191], v[100:103]
ds_read_b64_tr_b16 a[10:11], v2 offset:63488
v_mfma_f32_16x16x32_bf16 v[100:103], a[20:23], v[180:183], v[100:103]
ds_write_b128 v19, a[104:107] offset:4096
v_mfma_f32_16x16x32_bf16 v[100:103], a[16:19], v[172:175], v[100:103]
v_mfma_f32_16x16x32_bf16 v[104:107], a[16:19], a[168:171], v[104:107]
ds_write_b128 v19, a[108:111] offset:8192
v_mfma_f32_16x16x32_bf16 v[104:107], a[20:23], a[176:179], v[104:107]
v_add_u32 v19, 0xfffe0000, v19
v_mfma_f32_16x16x32_bf16 v[104:107], a[24:27], a[184:187], v[104:107]
ds_write_b128 v18, a[32:35]
v_mfma_f32_16x16x32_bf16 v[104:107], a[28:31], a[192:195], v[104:107]
v_mfma_f32_16x16x32_bf16 v[108:111], a[28:31], a[196:199], v[108:111]
ds_write_b128 v18, a[36:39] offset:4096
v_mfma_f32_16x16x32_bf16 v[108:111], a[24:27], a[188:191], v[108:111]
v_add_u32 v18, 0x10000, v18
v_mfma_f32_16x16x32_bf16 v[108:111], a[20:23], a[180:183], v[108:111]
v_mfma_f32_16x16x32_bf16 v[108:111], a[16:19], a[172:175], v[108:111]
s_waitcnt lgkmcnt(4)
v_mfma_f32_16x16x32_bf16 v[48:51], a[0:3], v[200:203], v[48:51]
ds_read_b64_tr_b16 a[16:17], v2 offset:49152
v_mfma_f32_16x16x32_bf16 v[48:51], a[4:7], v[208:211], v[48:51]
ds_read_b64_tr_b16 a[18:19], v2 offset:51200
v_mfma_f32_16x16x32_bf16 v[48:51], a[8:11], v[216:219], v[48:51]
ds_read_b64_tr_b16 a[20:21], v2 offset:57344
v_mfma_f32_16x16x32_bf16 v[52:55], a[8:11], v[220:223], v[52:55]
ds_read_b64_tr_b16 a[22:23], v2 offset:59392
v_add_u32 v2, 0x10000, v2
v_mfma_f32_16x16x32_bf16 v[52:55], a[4:7], v[212:215], v[52:55]
ds_read_b64_tr_b16 a[24:25], v2
v_mfma_f32_16x16x32_bf16 v[52:55], a[0:3], v[204:207], v[52:55]
ds_read_b64_tr_b16 a[26:27], v2 offset:2048
v_add_u32 v2, 0xfffe0000, v2
v_mfma_f32_16x16x32_bf16 v[56:59], a[0:3], a[200:203], v[56:59]
ds_write_b128 v19, a[40:43]
v_mfma_f32_16x16x32_bf16 v[56:59], a[4:7], a[208:211], v[56:59]
v_mfma_f32_16x16x32_bf16 v[56:59], a[8:11], a[216:219], v[56:59]
ds_write_b128 v19, a[44:47] offset:4096
v_mfma_f32_16x16x32_bf16 v[60:63], a[8:11], a[220:223], v[60:63]
v_add_u32 v19, 0x10000, v19
v_mfma_f32_16x16x32_bf16 v[60:63], a[4:7], a[212:215], v[60:63]
buffer_load_dwordx4 v6, s[20:23], 0 offen lds
v_mfma_f32_16x16x32_bf16 v[60:63], a[0:3], a[204:207], v[60:63]
s_waitcnt lgkmcnt(2)
v_add_u32 v6, 0x48000, v6
v_mfma_f32_16x16x32_bf16 v[64:67], a[16:19], v[200:203], v[64:67]
s_add_u32 m0, s47, 81920
ds_read_b64_tr_b16 a[0:1], v3 offset:45056
v_mfma_f32_16x16x32_bf16 v[64:67], a[20:23], v[208:211], v[64:67]
ds_read_b64_tr_b16 a[2:3], v3 offset:47104
v_mfma_f32_16x16x32_bf16 v[64:67], a[24:27], v[216:219], v[64:67]
ds_read_b64_tr_b16 a[4:5], v3 offset:53248
buffer_load_dwordx4 v6, s[16:19], 0 offen lds
v_mfma_f32_16x16x32_bf16 v[68:71], a[24:27], v[220:223], v[68:71]
s_add_u32 m0, s47, 86016
ds_read_b64_tr_b16 a[6:7], v3 offset:55296
v_mfma_f32_16x16x32_bf16 v[68:71], a[20:23], v[212:215], v[68:71]
ds_read_b64_tr_b16 a[8:9], v3 offset:61440
v_mfma_f32_16x16x32_bf16 v[68:71], a[16:19], v[204:207], v[68:71]
ds_read_b64_tr_b16 a[10:11], v3 offset:63488
v_mfma_f32_16x16x32_bf16 v[72:75], a[16:19], a[200:203], v[72:75]
buffer_load_dwordx4 v6, s[20:23], 0 offen lds
v_mfma_f32_16x16x32_bf16 v[72:75], a[20:23], a[208:211], v[72:75]
s_add_u32 m0, s47, 90112
v_add_u32 v6, 0x48000, v6
v_mfma_f32_16x16x32_bf16 v[72:75], a[24:27], a[216:219], v[72:75]
v_mfma_f32_16x16x32_bf16 v[76:79], a[24:27], a[220:223], v[76:79]
v_mfma_f32_16x16x32_bf16 v[76:79], a[20:23], a[212:215], v[76:79]
buffer_load_dwordx4 v6, s[16:19], 0 offen lds
v_mfma_f32_16x16x32_bf16 v[76:79], a[16:19], a[204:207], v[76:79]
s_waitcnt lgkmcnt(0)
v_mfma_f32_16x16x32_bf16 v[80:83], a[0:3], v[200:203], v[80:83]
s_add_u32 m0, s47, 94208
ds_read_b64_tr_b16 a[16:17], v3 offset:49152
v_mfma_f32_16x16x32_bf16 v[80:83], a[4:7], v[208:211], v[80:83]
ds_read_b64_tr_b16 a[18:19], v3 offset:51200
v_mfma_f32_16x16x32_bf16 v[80:83], a[8:11], v[216:219], v[80:83]
ds_read_b64_tr_b16 a[20:21], v3 offset:57344
buffer_load_dwordx4 v6, s[20:23], 0 offen lds
v_mfma_f32_16x16x32_bf16 v[84:87], a[8:11], v[220:223], v[84:87]
s_add_u32 m0, s47, 98304
ds_read_b64_tr_b16 a[22:23], v3 offset:59392
v_add_u32 v3, 0x10000, v3
v_mfma_f32_16x16x32_bf16 v[84:87], a[4:7], v[212:215], v[84:87]
ds_read_b64_tr_b16 a[24:25], v3
v_add_u32 v6, 0x48000, v6
v_mfma_f32_16x16x32_bf16 v[84:87], a[0:3], v[204:207], v[84:87]
ds_read_b64_tr_b16 a[26:27], v3 offset:2048
v_add_u32 v3, 0xfffe0000, v3
v_mfma_f32_16x16x32_bf16 v[88:91], a[0:3], a[200:203], v[88:91]
buffer_load_dwordx4 v6, s[16:19], 0 offen lds
v_mfma_f32_16x16x32_bf16 v[88:91], a[4:7], a[208:211], v[88:91]
s_add_u32 m0, s47, 102400
v_mfma_f32_16x16x32_bf16 v[88:91], a[8:11], a[216:219], v[88:91]
v_mfma_f32_16x16x32_bf16 v[92:95], a[8:11], a[220:223], v[92:95]
v_mfma_f32_16x16x32_bf16 v[92:95], a[4:7], a[212:215], v[92:95]
buffer_load_dwordx4 v6, s[20:23], 0 offen lds
v_mfma_f32_16x16x32_bf16 v[92:95], a[0:3], a[204:207], v[92:95]
s_waitcnt vmcnt(15) lgkmcnt(0)
v_add_u32 v6, 0x48000, v6
v_mfma_f32_16x16x32_bf16 v[96:99], a[16:19], v[200:203], v[96:99]
s_barrier
ds_read_b64_tr_b16 a[0:1], v2 offset:16384
v_mfma_f32_16x16x32_bf16 v[96:99], a[20:23], v[208:211], v[96:99]
s_add_u32 m0, s47, 106496
ds_read_b64_tr_b16 a[2:3], v2 offset:18432
v_mfma_f32_16x16x32_bf16 v[96:99], a[24:27], v[216:219], v[96:99]
ds_read_b64_tr_b16 a[4:5], v2 offset:24576
v_mfma_f32_16x16x32_bf16 v[100:103], a[24:27], v[220:223], v[100:103]
ds_read_b64_tr_b16 a[6:7], v2 offset:26624
buffer_load_dwordx4 v6, s[16:19], 0 offen lds
v_mfma_f32_16x16x32_bf16 v[100:103], a[20:23], v[212:215], v[100:103]
s_add_u32 m0, s47, 110592
ds_read_b64_tr_b16 a[8:9], v2 offset:32768
v_mfma_f32_16x16x32_bf16 v[100:103], a[16:19], v[204:207], v[100:103]
ds_read_b64_tr_b16 a[10:11], v2 offset:34816
v_mfma_f32_16x16x32_bf16 v[104:107], a[16:19], a[200:203], v[104:107]
ds_read_b64_tr_b16 a[12:13], v2 offset:40960
v_mfma_f32_16x16x32_bf16 v[104:107], a[20:23], a[208:211], v[104:107]
ds_read_b64_tr_b16 a[14:15], v2 offset:43008
v_mfma_f32_16x16x32_bf16 v[104:107], a[24:27], a[216:219], v[104:107]
v_mfma_f32_16x16x32_bf16 v[108:111], a[24:27], a[220:223], v[108:111]
buffer_load_dwordx4 v6, s[20:23], 0 offen lds
v_mfma_f32_16x16x32_bf16 v[108:111], a[20:23], a[212:215], v[108:111]
s_add_u32 m0, s47, 114688
v_add_u32 v6, 0x48000, v6
v_mfma_f32_16x16x32_bf16 v[108:111], a[16:19], a[204:207], v[108:111]
s_waitcnt lgkmcnt(0)
v_mfma_f32_16x16x32_bf16 v[48:51], a[0:3], v[224:227], v[48:51]
ds_read_b64_tr_b16 a[16:17], v2 offset:20480
v_mfma_f32_16x16x32_bf16 v[48:51], a[4:7], v[232:235], v[48:51]
ds_read_b64_tr_b16 a[18:19], v2 offset:22528
v_mfma_f32_16x16x32_bf16 v[48:51], a[8:11], v[240:243], v[48:51]
ds_read_b64_tr_b16 a[20:21], v2 offset:28672
v_mfma_f32_16x16x32_bf16 v[48:51], a[12:15], v[248:251], v[48:51]
ds_read_b64_tr_b16 a[22:23], v2 offset:30720
buffer_load_dwordx4 v6, s[16:19], 0 offen lds
v_mfma_f32_16x16x32_bf16 v[52:55], a[12:15], v[252:255], v[52:55]
s_add_u32 m0, s47, 118784
ds_read_b64_tr_b16 a[24:25], v2 offset:36864
v_mfma_f32_16x16x32_bf16 v[52:55], a[8:11], v[244:247], v[52:55]
ds_read_b64_tr_b16 a[26:27], v2 offset:38912
v_mfma_f32_16x16x32_bf16 v[52:55], a[4:7], v[236:239], v[52:55]
ds_read_b64_tr_b16 a[28:29], v2 offset:45056
buffer_load_dword v0, v46, s[24:27], 0 offen
v_mfma_f32_16x16x32_bf16 v[52:55], a[0:3], v[228:231], v[52:55]
ds_read_b64_tr_b16 a[30:31], v2 offset:47104
buffer_load_dword v0, v47, s[32:35], 0 offen
v_mfma_f32_16x16x32_bf16 v[56:59], a[0:3], a[224:227], v[56:59]
s_and_b32 s48, s71, 3
ds_read_b128 a[32:35], v16 offset:4096
v_max_f32 v48, 0, v48
v_mfma_f32_16x16x32_bf16 v[56:59], a[4:7], a[232:235], v[56:59]
s_lshl_b32 s58, s70, 2
ds_read_b128 a[48:51], v16 offset:5120
v_max_f32 v49, 0, v49
v_mfma_f32_16x16x32_bf16 v[56:59], a[8:11], a[240:243], v[56:59]
s_add_u32 s48, s48, s58
ds_read_b128 a[36:39], v16 offset:8192
v_max_f32 v50, 0, v50
v_mfma_f32_16x16x32_bf16 v[56:59], a[12:15], a[248:251], v[56:59]
s_and_b32 s49, s71, 28
ds_read_b128 a[52:55], v16 offset:9216
v_add_u32 v16, 0xfffe0000, v16
v_mfma_f32_16x16x32_bf16 v[60:63], a[12:15], a[252:255], v[60:63]
s_add_u32 s49, s49, s44
ds_read_b128 a[40:43], v17 offset:4096
v_max_f32 v51, 0, v51
v_mfma_f32_16x16x32_bf16 v[60:63], a[8:11], a[244:247], v[60:63]
s_mul_i32 s50, s48, 155648
ds_read_b128 a[56:59], v17 offset:5120
v_max_f32 v52, 0, v52
v_mfma_f32_16x16x32_bf16 v[60:63], a[4:7], a[236:239], v[60:63]
s_mul_i32 s51, s49, 4864
ds_read_b128 a[44:47], v17 offset:8192
v_max_f32 v53, 0, v53
v_mfma_f32_16x16x32_bf16 v[60:63], a[0:3], a[228:231], v[60:63]
s_waitcnt lgkmcnt(7)
ds_read_b128 a[60:63], v17 offset:9216
v_add_u32 v17, 0xfffe0000, v17
v_mfma_f32_16x16x32_bf16 v[64:67], a[16:19], v[224:227], v[64:67]
s_add_u32 s51, s51, s50
ds_read_b64_tr_b16 a[0:1], v3 offset:16384
v_max_f32 v54, 0, v54
v_mfma_f32_16x16x32_bf16 v[64:67], a[20:23], v[232:235], v[64:67]
s_add_u32 s50, s50, 4980736
ds_read_b64_tr_b16 a[2:3], v3 offset:18432
v_max_f32 v55, 0, v55
v_mfma_f32_16x16x32_bf16 v[64:67], a[24:27], v[240:243], v[64:67]
s_add_u32 s58, s50, s47
ds_read_b64_tr_b16 a[4:5], v3 offset:24576
v_max_f32 v56, 0, v56
v_mfma_f32_16x16x32_bf16 v[64:67], a[28:31], v[248:251], v[64:67]
s_mov_b32 s52, 0
ds_read_b64_tr_b16 a[6:7], v3 offset:26624
v_max_f32 v57, 0, v57
v_mfma_f32_16x16x32_bf16 v[68:71], a[28:31], v[252:255], v[68:71]
ds_read_b64_tr_b16 a[8:9], v3 offset:32768
v_max_f32 v58, 0, v58
v_mfma_f32_16x16x32_bf16 v[68:71], a[24:27], v[244:247], v[68:71]
ds_read_b64_tr_b16 a[10:11], v3 offset:34816
v_max_f32 v59, 0, v59
v_mfma_f32_16x16x32_bf16 v[68:71], a[20:23], v[236:239], v[68:71]
ds_read_b64_tr_b16 a[12:13], v3 offset:40960
v_max_f32 v60, 0, v60
v_mfma_f32_16x16x32_bf16 v[68:71], a[16:19], v[228:231], v[68:71]
ds_read_b64_tr_b16 a[14:15], v3 offset:43008
v_max_f32 v61, 0, v61
v_mfma_f32_16x16x32_bf16 v[72:75], a[16:19], a[224:227], v[72:75]
ds_read_b128 a[64:67], v16
v_max_f32 v62, 0, v62
v_mfma_f32_16x16x32_bf16 v[72:75], a[20:23], a[232:235], v[72:75]
ds_read_b128 a[80:83], v16 offset:1024
v_max_f32 v63, 0, v63
v_mfma_f32_16x16x32_bf16 v[72:75], a[24:27], a[240:243], v[72:75]
ds_read_b128 a[68:71], v16 offset:4096
v_mul_f32 v48, v48, v64
v_mfma_f32_16x16x32_bf16 v[72:75], a[28:31], a[248:251], v[72:75]
ds_read_b128 a[84:87], v16 offset:5120
v_add_u32 v16, 0x10000, v16
v_mfma_f32_16x16x32_bf16 v[76:79], a[28:31], a[252:255], v[76:79]
ds_read_b128 a[72:75], v17
v_mul_f32 v49, v49, v65
v_mfma_f32_16x16x32_bf16 v[76:79], a[24:27], a[244:247], v[76:79]
ds_read_b128 a[88:91], v17 offset:1024
v_mul_f32 v50, v50, v66
v_mfma_f32_16x16x32_bf16 v[76:79], a[20:23], a[236:239], v[76:79]
ds_read_b128 a[76:79], v17 offset:4096
v_mul_f32 v51, v51, v67
v_mfma_f32_16x16x32_bf16 v[76:79], a[16:19], a[228:231], v[76:79]
s_waitcnt lgkmcnt(7)
ds_read_b128 a[92:95], v17 offset:5120
v_add_u32 v17, 0x10000, v17
v_mfma_f32_16x16x32_bf16 v[80:83], a[0:3], v[224:227], v[80:83]
ds_read_b64_tr_b16 a[16:17], v3 offset:20480
v_cvt_pk_bf16_f32 v32, v48, v49
v_mfma_f32_16x16x32_bf16 v[80:83], a[4:7], v[232:235], v[80:83]
ds_read_b64_tr_b16 a[18:19], v3 offset:22528
v_cvt_pk_bf16_f32 v33, v50, v51
v_mfma_f32_16x16x32_bf16 v[80:83], a[8:11], v[240:243], v[80:83]
ds_read_b64_tr_b16 a[20:21], v3 offset:28672
v_accvgpr_write_b32 a96, v32
v_mfma_f32_16x16x32_bf16 v[80:83], a[12:15], v[248:251], v[80:83]
ds_read_b64_tr_b16 a[22:23], v3 offset:30720
v_accvgpr_write_b32 a97, v33
v_mfma_f32_16x16x32_bf16 v[84:87], a[12:15], v[252:255], v[84:87]
ds_read_b64_tr_b16 a[24:25], v3 offset:36864
v_mul_f32 v52, v52, v68
v_mfma_f32_16x16x32_bf16 v[84:87], a[8:11], v[244:247], v[84:87]
ds_read_b64_tr_b16 a[26:27], v3 offset:38912
v_mul_f32 v53, v53, v69
v_mfma_f32_16x16x32_bf16 v[84:87], a[4:7], v[236:239], v[84:87]
ds_read_b64_tr_b16 a[28:29], v3 offset:45056
buffer_load_dwordx4 v6, s[20:23], 0 offen lds
v_mfma_f32_16x16x32_bf16 v[84:87], a[0:3], v[228:231], v[84:87]
s_add_u32 m0, s47, 122880
ds_read_b64_tr_b16 a[30:31], v3 offset:47104
v_add_u32 v6, 0x48000, v6
v_mfma_f32_16x16x32_bf16 v[88:91], a[0:3], a[224:227], v[88:91]
v_mul_f32 v54, v54, v70
v_mul_f32 v55, v55, v71
v_mfma_f32_16x16x32_bf16 v[88:91], a[4:7], a[232:235], v[88:91]
v_cvt_pk_bf16_f32 v34, v52, v53
v_cvt_pk_bf16_f32 v35, v54, v55
v_mfma_f32_16x16x32_bf16 v[88:91], a[8:11], a[240:243], v[88:91]
v_accvgpr_write_b32 a100, v34
v_accvgpr_write_b32 a101, v35
v_mfma_f32_16x16x32_bf16 v[88:91], a[12:15], a[248:251], v[88:91]
v_mul_f32 v56, v56, v72
v_mul_f32 v57, v57, v73
v_mfma_f32_16x16x32_bf16 v[92:95], a[12:15], a[252:255], v[92:95]
buffer_load_dwordx4 v6, s[16:19], 0 offen lds
v_mfma_f32_16x16x32_bf16 v[92:95], a[8:11], a[244:247], v[92:95]
s_add_u32 m0, s47, 126976
v_mul_f32 v58, v58, v74
v_mul_f32 v59, v59, v75
v_mfma_f32_16x16x32_bf16 v[92:95], a[4:7], a[236:239], v[92:95]
v_cvt_pk_bf16_f32 v36, v56, v57
v_cvt_pk_bf16_f32 v37, v58, v59
L_pad7:
s_cbranch_execz L_pad11
v_mfma_f32_16x16x32_bf16 v[92:95], a[0:3], a[228:231], v[92:95]
s_waitcnt vmcnt(13) lgkmcnt(0)
v_accvgpr_write_b32 a104, v36
v_accvgpr_write_b32 a105, v37
v_mfma_f32_16x16x32_bf16 v[96:99], a[16:19], v[224:227], v[96:99]
s_barrier
ds_read_b64_tr_b16 a[0:1], v2 offset:49152
v_mul_f32 v60, v60, v76
v_mfma_f32_16x16x32_bf16 v[96:99], a[20:23], v[232:235], v[96:99]
ds_read_b64_tr_b16 a[2:3], v2 offset:51200
v_mul_f32 v61, v61, v77
v_mfma_f32_16x16x32_bf16 v[96:99], a[24:27], v[240:243], v[96:99]
ds_read_b64_tr_b16 a[4:5], v2 offset:57344
buffer_load_dwordx4 v6, s[20:23], 0 offen lds
v_mfma_f32_16x16x32_bf16 v[96:99], a[28:31], v[248:251], v[96:99]
s_add_u32 m0, s47, 131072
ds_read_b64_tr_b16 a[6:7], v2 offset:59392
v_add_u32 v2, 0x10000, v2
v_mfma_f32_16x16x32_bf16 v[100:103], a[28:31], v[252:255], v[100:103]
ds_read_b64_tr_b16 a[8:9], v2
v_add_u32 v6, 0x48000, v6
v_mfma_f32_16x16x32_bf16 v[100:103], a[24:27], v[244:247], v[100:103]
ds_read_b64_tr_b16 a[10:11], v2 offset:2048
v_mul_f32 v62, v62, v78
v_mfma_f32_16x16x32_bf16 v[100:103], a[20:23], v[236:239], v[100:103]
ds_read_b64_tr_b16 a[12:13], v2 offset:8192
v_mul_f32 v63, v63, v79
v_mfma_f32_16x16x32_bf16 v[100:103], a[16:19], v[228:231], v[100:103]
ds_read_b64_tr_b16 a[14:15], v2 offset:10240
v_add_u32 v2, 0xffff0000, v2
v_mfma_f32_16x16x32_bf16 v[104:107], a[16:19], a[224:227], v[104:107]
buffer_load_dwordx4 v6, s[16:19], 0 offen lds
v_mfma_f32_16x16x32_bf16 v[104:107], a[20:23], a[232:235], v[104:107]
s_add_u32 m0, s47, 135168
v_cvt_pk_bf16_f32 v38, v60, v61
v_cvt_pk_bf16_f32 v39, v62, v63
v_mfma_f32_16x16x32_bf16 v[104:107], a[24:27], a[240:243], v[104:107]
v_accvgpr_write_b32 a108, v38
v_accvgpr_write_b32 a109, v39
v_mfma_f32_16x16x32_bf16 v[104:107], a[28:31], a[248:251], v[104:107]
v_max_f32 v80, 0, v80
v_max_f32 v81, 0, v81
v_mfma_f32_16x16x32_bf16 v[108:111], a[28:31], a[252:255], v[108:111]
v_max_f32 v82, 0, v82
v_max_f32 v83, 0, v83
v_mfma_f32_16x16x32_bf16 v[108:111], a[24:27], a[244:247], v[108:111]
v_max_f32 v84, 0, v84
v_max_f32 v85, 0, v85
v_mfma_f32_16x16x32_bf16 v[108:111], a[20:23], a[236:239], v[108:111]
buffer_load_dwordx4 v6, s[20:23], 0 offen lds
v_mfma_f32_16x16x32_bf16 v[108:111], a[16:19], a[228:231], v[108:111]
s_waitcnt lgkmcnt(0)
v_add_u32 v6, 0x48000, v6
v_max_f32 v86, 0, v86
v_mfma_f32_16x16x32_bf16 v[48:51], a[0:3], v[112:115], 0
s_add_u32 m0, s47, 139264
ds_read_b64_tr_b16 a[16:17], v2 offset:53248
v_max_f32 v87, 0, v87
v_mfma_f32_16x16x32_bf16 v[48:51], a[4:7], v[120:123], v[48:51]
ds_read_b64_tr_b16 a[18:19], v2 offset:55296
v_max_f32 v88, 0, v88
v_mfma_f32_16x16x32_bf16 v[48:51], a[8:11], v[128:131], v[48:51]
ds_read_b64_tr_b16 a[20:21], v2 offset:61440
v_max_f32 v89, 0, v89
v_mfma_f32_16x16x32_bf16 v[48:51], a[12:15], v[136:139], v[48:51]
ds_read_b64_tr_b16 a[22:23], v2 offset:63488
v_add_u32 v2, 0x10000, v2
v_mfma_f32_16x16x32_bf16 v[52:55], a[12:15], v[140:143], 0
ds_read_b64_tr_b16 a[24:25], v2 offset:4096
buffer_load_dwordx4 v6, s[16:19], 0 offen lds
v_mfma_f32_16x16x32_bf16 v[52:55], a[8:11], v[132:135], v[52:55]
s_add_u32 m0, s47, 143360
ds_read_b64_tr_b16 a[26:27], v2 offset:6144
v_max_f32 v90, 0, v90
v_mfma_f32_16x16x32_bf16 v[52:55], a[4:7], v[124:127], v[52:55]
ds_read_b64_tr_b16 a[28:29], v2 offset:12288
v_max_f32 v91, 0, v91
v_mfma_f32_16x16x32_bf16 v[52:55], a[0:3], v[116:119], v[52:55]
ds_read_b64_tr_b16 a[30:31], v2 offset:14336
v_max_f32 v92, 0, v92
v_mfma_f32_16x16x32_bf16 v[56:59], a[0:3], a[112:115], 0
v_max_f32 v93, 0, v93
v_max_f32 v94, 0, v94
v_mfma_f32_16x16x32_bf16 v[56:59], a[4:7], a[120:123], v[56:59]
v_max_f32 v95, 0, v95
v_mul_f32 v80, v80, v96
v_mfma_f32_16x16x32_bf16 v[56:59], a[8:11], a[128:131], v[56:59]
buffer_load_dwordx4 v6, s[20:23], 0 offen lds
v_mfma_f32_16x16x32_bf16 v[56:59], a[12:15], a[136:139], v[56:59]
s_add_u32 m0, s47, 147456
v_add_u32 v6, 0x48000, v6
v_mul_f32 v81, v81, v97
v_mfma_f32_16x16x32_bf16 v[60:63], a[12:15], a[140:143], 0
v_mul_f32 v82, v82, v98
v_mul_f32 v83, v83, v99
v_mfma_f32_16x16x32_bf16 v[60:63], a[8:11], a[132:135], v[60:63]
v_cvt_pk_bf16_f32 v32, v80, v81
v_cvt_pk_bf16_f32 v33, v82, v83
v_mfma_f32_16x16x32_bf16 v[60:63], a[4:7], a[124:127], v[60:63]
v_accvgpr_write_b32 a98, v32
v_accvgpr_write_b32 a99, v33
v_mfma_f32_16x16x32_bf16 v[60:63], a[0:3], a[116:119], v[60:63]
s_waitcnt lgkmcnt(0)
v_mul_f32 v84, v84, v100
v_mul_f32 v85, v85, v101
v_mfma_f32_16x16x32_bf16 v[64:67], a[16:19], v[112:115], 0
ds_read_b64_tr_b16 a[0:1], v3 offset:49152
buffer_load_dwordx4 v6, s[16:19], 0 offen lds
v_mfma_f32_16x16x32_bf16 v[64:67], a[20:23], v[120:123], v[64:67]
s_add_u32 m0, s47, 151552
ds_read_b64_tr_b16 a[2:3], v3 offset:51200
v_mul_f32 v86, v86, v102
v_mfma_f32_16x16x32_bf16 v[64:67], a[24:27], v[128:131], v[64:67]
ds_read_b64_tr_b16 a[4:5], v3 offset:57344
v_mul_f32 v87, v87, v103
v_mfma_f32_16x16x32_bf16 v[64:67], a[28:31], v[136:139], v[64:67]
ds_read_b64_tr_b16 a[6:7], v3 offset:59392
v_add_u32 v3, 0x10000, v3
v_mfma_f32_16x16x32_bf16 v[68:71], a[28:31], v[140:143], 0
ds_read_b64_tr_b16 a[8:9], v3
v_cvt_pk_bf16_f32 v34, v84, v85
v_mfma_f32_16x16x32_bf16 v[68:71], a[24:27], v[132:135], v[68:71]
ds_read_b64_tr_b16 a[10:11], v3 offset:2048
v_cvt_pk_bf16_f32 v35, v86, v87
v_mfma_f32_16x16x32_bf16 v[68:71], a[20:23], v[124:127], v[68:71]
ds_read_b64_tr_b16 a[12:13], v3 offset:8192
buffer_load_dwordx4 v6, s[20:23], 0 offen lds
v_mfma_f32_16x16x32_bf16 v[68:71], a[16:19], v[116:119], v[68:71]
s_add_u32 m0, s47, 155648
ds_read_b64_tr_b16 a[14:15], v3 offset:10240
v_add_u32 v3, 0xffff0000, v3
v_mfma_f32_16x16x32_bf16 v[72:75], a[16:19], a[112:115], 0
v_add_u32 v6, 0x48000, v6
v_accvgpr_write_b32 a102, v34
v_mfma_f32_16x16x32_bf16 v[72:75], a[20:23], a[120:123], v[72:75]
v_accvgpr_write_b32 a103, v35
v_mul_f32 v88, v88, v104
v_mfma_f32_16x16x32_bf16 v[72:75], a[24:27], a[128:131], v[72:75]
v_mul_f32 v89, v89, v105
v_mul_f32 v90, v90, v106
v_mfma_f32_16x16x32_bf16 v[72:75], a[28:31], a[136:139], v[72:75]
v_mul_f32 v91, v91, v107
v_cvt_pk_bf16_f32 v36, v88, v89
v_mfma_f32_16x16x32_bf16 v[76:79], a[28:31], a[140:143], 0
buffer_load_dwordx4 v6, s[16:19], 0 offen lds
v_mfma_f32_16x16x32_bf16 v[76:79], a[24:27], a[132:135], v[76:79]
s_add_u32 m0, s47, 159744
v_cvt_pk_bf16_f32 v37, v90, v91
v_accvgpr_write_b32 a106, v36
v_mfma_f32_16x16x32_bf16 v[76:79], a[20:23], a[124:127], v[76:79]
v_accvgpr_write_b32 a107, v37
v_mul_f32 v92, v92, v108
v_mfma_f32_16x16x32_bf16 v[76:79], a[16:19], a[116:119], v[76:79]
s_waitcnt lgkmcnt(0)
v_mul_f32 v93, v93, v109
v_mul_f32 v94, v94, v110
v_mfma_f32_16x16x32_bf16 v[80:83], a[0:3], v[112:115], 0
ds_read_b64_tr_b16 a[16:17], v3 offset:53248
v_mul_f32 v95, v95, v111
v_mfma_f32_16x16x32_bf16 v[80:83], a[4:7], v[120:123], v[80:83]
ds_read_b64_tr_b16 a[18:19], v3 offset:55296
v_cvt_pk_bf16_f32 v38, v92, v93
v_mfma_f32_16x16x32_bf16 v[80:83], a[8:11], v[128:131], v[80:83]
ds_read_b64_tr_b16 a[20:21], v3 offset:61440
buffer_load_dwordx4 v6, s[20:23], 0 offen lds
v_mfma_f32_16x16x32_bf16 v[80:83], a[12:15], v[136:139], v[80:83]
s_add_u32 m0, s47, 0
ds_read_b64_tr_b16 a[22:23], v3 offset:63488
v_add_u32 v3, 0x10000, v3
v_mfma_f32_16x16x32_bf16 v[84:87], a[12:15], v[140:143], 0
ds_read_b64_tr_b16 a[24:25], v3 offset:4096
v_add_u32 v6, 0x48000, v6
v_mfma_f32_16x16x32_bf16 v[84:87], a[8:11], v[132:135], v[84:87]
ds_read_b64_tr_b16 a[26:27], v3 offset:6144
v_cvt_pk_bf16_f32 v39, v94, v95
v_mfma_f32_16x16x32_bf16 v[84:87], a[4:7], v[124:127], v[84:87]
ds_read_b64_tr_b16 a[28:29], v3 offset:12288
v_accvgpr_write_b32 a110, v38
v_mfma_f32_16x16x32_bf16 v[84:87], a[0:3], v[116:119], v[84:87]
ds_read_b64_tr_b16 a[30:31], v3 offset:14336
v_accvgpr_write_b32 a111, v39
v_mfma_f32_16x16x32_bf16 v[88:91], a[0:3], a[112:115], 0
v_add_u32 v8, s58, v10
v_mov_b32 v26, 0xdddddddd
v_mfma_f32_16x16x32_bf16 v[88:91], a[4:7], a[120:123], v[88:91]
v_mov_b32 v22, v10
v_and_b32 v40, 31, v1
v_mfma_f32_16x16x32_bf16 v[88:91], a[8:11], a[128:131], v[88:91]
v_lshrrev_b32 v41, 5, v1
v_mul_u32_u24 v42, 2432, v41
v_mfma_f32_16x16x32_bf16 v[88:91], a[12:15], a[136:139], v[88:91]
v_lshl_add_u32 v42, v40, 2, v42
v_add_u32 v23, 1024, v42
v_mfma_f32_16x16x32_bf16 v[92:95], a[12:15], a[140:143], 0
v_bfe_u32 v42, v40, 2, 1
v_lshl_add_u32 v42, v42, 1, v41
v_mfma_f32_16x16x32_bf16 v[92:95], a[8:11], a[132:135], v[92:95]
v_lshlrev_b32 v42, 5, v42
v_add_u32 v42, 2176, v42
v_mfma_f32_16x16x32_bf16 v[92:95], a[4:7], a[124:127], v[92:95]
v_add_u32 v43, 16, v42
v_and_b32 v44, 27, v40
v_mfma_f32_16x16x32_bf16 v[92:95], a[0:3], a[116:119], v[92:95]
s_waitcnt vmcnt(16) lgkmcnt(0)
v_cmp_eq_u32 vcc, 17, v44
v_mov_b32 v45, 2304
v_mfma_f32_16x16x32_bf16 v[96:99], a[16:19], v[112:115], 0
s_barrier
ds_read_b64_tr_b16 a[0:1], v2 offset:16384
v_mov_b32 v46, 2320
v_mfma_f32_16x16x32_bf16 v[96:99], a[20:23], v[120:123], v[96:99]
ds_read_b64_tr_b16 a[2:3], v2 offset:18432
v_cndmask_b32 v45, v46, v45, vcc
v_mfma_f32_16x16x32_bf16 v[96:99], a[24:27], v[128:131], v[96:99]
ds_read_b64_tr_b16 a[4:5], v2 offset:24576
buffer_load_dwordx4 v6, s[16:19], 0 offen lds
v_mfma_f32_16x16x32_bf16 v[96:99], a[28:31], v[136:139], v[96:99]
s_add_u32 m0, s47, 4096
ds_read_b64_tr_b16 a[6:7], v2 offset:26624
v_add_u32 v46, 12, v40
v_mfma_f32_16x16x32_bf16 v[100:103], a[28:31], v[140:143], 0
ds_read_b64_tr_b16 a[8:9], v2 offset:32768
v_and_b32 v46, 8, v46
v_mfma_f32_16x16x32_bf16 v[100:103], a[24:27], v[132:135], v[100:103]
ds_read_b64_tr_b16 a[10:11], v2 offset:34816
v_lshl_add_u32 v45, v46, 3, v45
v_mfma_f32_16x16x32_bf16 v[100:103], a[20:23], v[124:127], v[100:103]
v_cmp_eq_u32 vcc, 16, v44
v_add_u32 v46, 1152, v10
v_mfma_f32_16x16x32_bf16 v[100:103], a[16:19], v[116:119], v[100:103]
v_add_u32 v47, 1408, v10
v_cndmask_b32 v42, v45, v42, vcc
v_mfma_f32_16x16x32_bf16 v[104:107], a[16:19], a[112:115], 0
buffer_load_dwordx4 v6, s[20:23], 0 offen lds
v_mfma_f32_16x16x32_bf16 v[104:107], a[20:23], a[120:123], v[104:107]
s_add_u32 m0, s47, 8192
v_add_u32 v6, 0x48000, v6
v_cndmask_b32 v43, v45, v43, vcc
v_mfma_f32_16x16x32_bf16 v[104:107], a[24:27], a[128:131], v[104:107]
v_cmp_gt_u32 vcc, 16, v40
v_mfma_f32_16x16x32_bf16 v[104:107], a[28:31], a[136:139], v[104:107]
s_lshl_b32 s63, s45, 7
s_add_u32 s63, s63, 58720256
v_cndmask_b32 v24, v42, v46, vcc
v_mfma_f32_16x16x32_bf16 v[108:111], a[28:31], a[140:143], 0
v_cndmask_b32 v25, v43, v47, vcc
v_mfma_f32_16x16x32_bf16 v[108:111], a[24:27], a[132:135], v[108:111]
s_lshl_b32 s64, s49, 7
s_add_u32 s64, s64, 58724352
s_lshl_b32 s65, s49, 16
v_mfma_f32_16x16x32_bf16 v[108:111], a[20:23], a[124:127], v[108:111]
s_lshr_b32 s58, s48, 1
s_lshl_b32 s58, s58, 10
buffer_load_dwordx4 v6, s[16:19], 0 offen lds
v_mfma_f32_16x16x32_bf16 v[108:111], a[16:19], a[116:119], v[108:111]
s_waitcnt lgkmcnt(0)
s_add_u32 s65, s65, s58
s_and_b32 s58, s48, 1
v_mfma_f32_16x16x32_bf16 v[48:51], a[0:3], v[144:147], v[48:51]
s_add_u32 m0, s47, 12288
s_lshl_b32 s58, s58, 9
ds_read_b64_tr_b16 a[16:17], v2 offset:20480
v_mfma_f32_16x16x32_bf16 v[48:51], a[4:7], v[152:155], v[48:51]
s_add_u32 s65, s65, s58
s_add_u32 s65, s65, 54525952
ds_read_b64_tr_b16 a[18:19], v2 offset:22528
v_mfma_f32_16x16x32_bf16 v[48:51], a[8:11], v[160:163], v[48:51]
s_lshl_b32 s66, s49, 13
s_lshl_b32 s58, s48, 7
ds_read_b64_tr_b16 a[20:21], v2 offset:28672
v_mfma_f32_16x16x32_bf16 v[52:55], a[8:11], v[164:167], v[52:55]
s_add_u32 s66, s66, s58
s_add_u32 s66, s66, 56623104
ds_read_b64_tr_b16 a[22:23], v2 offset:30720
v_mfma_f32_16x16x32_bf16 v[52:55], a[4:7], v[156:159], v[52:55]
ds_read_b64_tr_b16 a[24:25], v2 offset:36864
buffer_load_dwordx4 v6, s[20:23], 0 offen lds
v_mfma_f32_16x16x32_bf16 v[52:55], a[0:3], v[148:151], v[52:55]
s_add_u32 m0, s47, 16384
ds_read_b64_tr_b16 a[26:27], v2 offset:38912
v_add_u32 v6, 0x48000, v6
v_mfma_f32_16x16x32_bf16 v[56:59], a[0:3], a[144:147], v[56:59]
v_lshl_add_u32 v40, v1, 5, s48
v_mul_u32_u24 v40, 171, v40
v_mfma_f32_16x16x32_bf16 v[56:59], a[4:7], a[152:155], v[56:59]
v_lshrrev_b32 v40, 10, v40
v_lshlrev_b32 v40, 7, v40
v_mfma_f32_16x16x32_bf16 v[56:59], a[8:11], a[160:163], v[56:59]
v_add_u32 v40, 58728448, v40
v_mfma_f32_16x16x32_bf16 v[60:63], a[8:11], a[164:167], v[60:63]
s_min_u32 s1, s44, 1
s_sub_u32 s1, s1, 1
s_and_b32 s58, s1, 3
v_mfma_f32_16x16x32_bf16 v[60:63], a[4:7], a[156:159], v[60:63]
buffer_load_dwordx4 v6, s[16:19], 0 offen lds
v_mfma_f32_16x16x32_bf16 v[60:63], a[0:3], a[148:151], v[60:63]
s_waitcnt lgkmcnt(0)
v_cmp_gt_u32 vcc, s58, v1
v_mov_b32 v41, 2147483648
v_mfma_f32_16x16x32_bf16 v[64:67], a[16:19], v[144:147], v[64:67]
s_add_u32 m0, s47, 20480
s_and_b32 s1, s1, 7
ds_read_b64_tr_b16 a[0:1], v3 offset:16384
v_mfma_f32_16x16x32_bf16 v[64:67], a[20:23], v[152:155], v[64:67]
ds_read_b64_tr_b16 a[2:3], v3 offset:18432
v_cndmask_b32 v20, v41, v40, vcc
v_mfma_f32_16x16x32_bf16 v[64:67], a[24:27], v[160:163], v[64:67]
s_mul_i32 s61, s49, 4864
ds_read_b64_tr_b16 a[4:5], v3 offset:24576
v_mov_b32 v46, 0
v_mfma_f32_16x16x32_bf16 v[68:71], a[24:27], v[164:167], v[68:71]
s_add_u32 s61, s61, s50
ds_read_b64_tr_b16 a[6:7], v3 offset:26624
v_min_u32 v21, 37, v1
v_mfma_f32_16x16x32_bf16 v[68:71], a[20:23], v[156:159], v[68:71]
ds_read_b64_tr_b16 a[8:9], v3 offset:32768
buffer_load_dwordx4 v6, s[20:23], 0 offen lds
v_mfma_f32_16x16x32_bf16 v[68:71], a[16:19], v[148:151], v[68:71]
s_add_u32 m0, s47, 24576
ds_read_b64_tr_b16 a[10:11], v3 offset:34816
v_add_u32 v6, 0x48000, v6
v_mfma_f32_16x16x32_bf16 v[72:75], a[16:19], a[144:147], v[72:75]
v_lshl_add_u32 v21, v21, 7, s61
v_mfma_f32_16x16x32_bf16 v[72:75], a[20:23], a[152:155], v[72:75]
v_mfma_f32_16x16x32_bf16 v[72:75], a[24:27], a[160:163], v[72:75]
v_mfma_f32_16x16x32_bf16 v[76:79], a[24:27], a[164:167], v[76:79]
v_mfma_f32_16x16x32_bf16 v[76:79], a[20:23], a[156:159], v[76:79]
buffer_load_dwordx4 v6, s[16:19], 0 offen lds
v_mfma_f32_16x16x32_bf16 v[76:79], a[16:19], a[148:151], v[76:79]
s_waitcnt lgkmcnt(0)
v_mfma_f32_16x16x32_bf16 v[80:83], a[0:3], v[144:147], v[80:83]
s_add_u32 m0, s47, 28672
ds_read_b64_tr_b16 a[16:17], v3 offset:20480
v_mfma_f32_16x16x32_bf16 v[80:83], a[4:7], v[152:155], v[80:83]
ds_read_b64_tr_b16 a[18:19], v3 offset:22528
v_mfma_f32_16x16x32_bf16 v[80:83], a[8:11], v[160:163], v[80:83]
ds_read_b64_tr_b16 a[20:21], v3 offset:28672
v_mfma_f32_16x16x32_bf16 v[84:87], a[8:11], v[164:167], v[84:87]
ds_read_b64_tr_b16 a[22:23], v3 offset:30720
v_mfma_f32_16x16x32_bf16 v[84:87], a[4:7], v[156:159], v[84:87]
ds_read_b64_tr_b16 a[24:25], v3 offset:36864
buffer_load_dwordx4 v6, s[20:23], 0 offen lds
v_mfma_f32_16x16x32_bf16 v[84:87], a[0:3], v[148:151], v[84:87]
s_add_u32 m0, s47, 32768
ds_read_b64_tr_b16 a[26:27], v3 offset:38912
v_mfma_f32_16x16x32_bf16 v[88:91], a[0:3], a[144:147], v[88:91]
v_mfma_f32_16x16x32_bf16 v[88:91], a[4:7], a[152:155], v[88:91]
v_mfma_f32_16x16x32_bf16 v[88:91], a[8:11], a[160:163], v[88:91]
v_mfma_f32_16x16x32_bf16 v[92:95], a[8:11], a[164:167], v[92:95]
v_mfma_f32_16x16x32_bf16 v[92:95], a[4:7], a[156:159], v[92:95]
buffer_load_dwordx4 v9, s[16:19], 0 offen lds
v_mfma_f32_16x16x32_bf16 v[92:95], a[0:3], a[148:151], v[92:95]
s_waitcnt vmcnt(15) lgkmcnt(0)
v_mfma_f32_16x16x32_bf16 v[96:99], a[16:19], v[144:147], v[96:99]
s_barrier
ds_read_b64_tr_b16 a[0:1], v2 offset:40960
v_mfma_f32_16x16x32_bf16 v[96:99], a[20:23], v[152:155], v[96:99]
s_add_u32 m0, s47, 36864
ds_read_b64_tr_b16 a[2:3], v2 offset:43008
v_mfma_f32_16x16x32_bf16 v[96:99], a[24:27], v[160:163], v[96:99]
ds_read_b64_tr_b16 a[4:5], v2 offset:49152
v_mfma_f32_16x16x32_bf16 v[100:103], a[24:27], v[164:167], v[100:103]
ds_read_b64_tr_b16 a[6:7], v2 offset:51200
v_mfma_f32_16x16x32_bf16 v[100:103], a[20:23], v[156:159], v[100:103]
ds_read_b64_tr_b16 a[8:9], v2 offset:57344
v_mfma_f32_16x16x32_bf16 v[100:103], a[16:19], v[148:151], v[100:103]
ds_read_b64_tr_b16 a[10:11], v2 offset:59392
v_add_u32 v2, 0x10000, v2
v_mfma_f32_16x16x32_bf16 v[104:107], a[16:19], a[144:147], v[104:107]
ds_read_b64_tr_b16 a[12:13], v2
v_mfma_f32_16x16x32_bf16 v[104:107], a[20:23], a[152:155], v[104:107]
ds_read_b64_tr_b16 a[14:15], v2 offset:2048
v_add_u32 v2, 0xffff0000, v2
v_mfma_f32_16x16x32_bf16 v[104:107], a[24:27], a[160:163], v[104:107]
buffer_load_dwordx4 v9, s[20:23], 0 offen lds
v_mfma_f32_16x16x32_bf16 v[108:111], a[24:27], a[164:167], v[108:111]
s_add_u32 m0, s47, 40960
v_add_u32 v9, 0x90000, v9
v_mfma_f32_16x16x32_bf16 v[108:111], a[20:23], a[156:159], v[108:111]
v_mfma_f32_16x16x32_bf16 v[108:111], a[16:19], a[148:151], v[108:111]
s_waitcnt lgkmcnt(0)
v_mfma_f32_16x16x32_bf16 v[48:51], a[0:3], v[168:171], v[48:51]
ds_read_b64_tr_b16 a[16:17], v2 offset:45056
v_mfma_f32_16x16x32_bf16 v[48:51], a[4:7], v[176:179], v[48:51]
ds_read_b64_tr_b16 a[18:19], v2 offset:47104
v_mfma_f32_16x16x32_bf16 v[48:51], a[8:11], v[184:187], v[48:51]
ds_read_b64_tr_b16 a[20:21], v2 offset:53248
v_mfma_f32_16x16x32_bf16 v[48:51], a[12:15], v[192:195], v[48:51]
ds_read_b64_tr_b16 a[22:23], v2 offset:55296
v_mfma_f32_16x16x32_bf16 v[52:55], a[12:15], v[196:199], v[52:55]
ds_read_b64_tr_b16 a[24:25], v2 offset:61440
v_mfma_f32_16x16x32_bf16 v[52:55], a[8:11], v[188:191], v[52:55]
ds_read_b64_tr_b16 a[26:27], v2 offset:63488
v_add_u32 v2, 0x10000, v2
v_mfma_f32_16x16x32_bf16 v[52:55], a[4:7], v[180:183], v[52:55]
ds_read_b64_tr_b16 a[28:29], v2 offset:4096
buffer_load_dwordx4 v9, s[16:19], 0 offen lds
v_mfma_f32_16x16x32_bf16 v[52:55], a[0:3], v[172:175], v[52:55]
s_add_u32 m0, s47, 45056
ds_read_b64_tr_b16 a[30:31], v2 offset:6144
v_mfma_f32_16x16x32_bf16 v[56:59], a[0:3], a[168:171], v[56:59]
v_mfma_f32_16x16x32_bf16 v[56:59], a[4:7], a[176:179], v[56:59]
v_mfma_f32_16x16x32_bf16 v[56:59], a[8:11], a[184:187], v[56:59]
v_mfma_f32_16x16x32_bf16 v[56:59], a[12:15], a[192:195], v[56:59]
v_mfma_f32_16x16x32_bf16 v[60:63], a[12:15], a[196:199], v[60:63]
v_mfma_f32_16x16x32_bf16 v[60:63], a[8:11], a[188:191], v[60:63]
v_mfma_f32_16x16x32_bf16 v[60:63], a[4:7], a[180:183], v[60:63]
v_mfma_f32_16x16x32_bf16 v[60:63], a[0:3], a[172:175], v[60:63]
s_waitcnt lgkmcnt(0)
v_mfma_f32_16x16x32_bf16 v[64:67], a[16:19], v[168:171], v[64:67]
ds_read_b64_tr_b16 a[0:1], v3 offset:40960
buffer_load_dwordx4 v9, s[20:23], 0 offen lds
v_mfma_f32_16x16x32_bf16 v[64:67], a[20:23], v[176:179], v[64:67]
s_add_u32 m0, s47, 49152
ds_read_b64_tr_b16 a[2:3], v3 offset:43008
v_add_u32 v9, 0x90000, v9
v_mfma_f32_16x16x32_bf16 v[64:67], a[24:27], v[184:187], v[64:67]
ds_read_b64_tr_b16 a[4:5], v3 offset:49152
v_mfma_f32_16x16x32_bf16 v[64:67], a[28:31], v[192:195], v[64:67]
ds_read_b64_tr_b16 a[6:7], v3 offset:51200
v_mfma_f32_16x16x32_bf16 v[68:71], a[28:31], v[196:199], v[68:71]
ds_read_b64_tr_b16 a[8:9], v3 offset:57344
v_mfma_f32_16x16x32_bf16 v[68:71], a[24:27], v[188:191], v[68:71]
ds_read_b64_tr_b16 a[10:11], v3 offset:59392
v_add_u32 v3, 0x10000, v3
v_mfma_f32_16x16x32_bf16 v[68:71], a[20:23], v[180:183], v[68:71]
ds_read_b64_tr_b16 a[12:13], v3
v_mfma_f32_16x16x32_bf16 v[68:71], a[16:19], v[172:175], v[68:71]
ds_read_b64_tr_b16 a[14:15], v3 offset:2048
v_add_u32 v3, 0xffff0000, v3
v_mfma_f32_16x16x32_bf16 v[72:75], a[16:19], a[168:171], v[72:75]
ds_write_b128 v18, a[96:99] offset:16384
v_mfma_f32_16x16x32_bf16 v[72:75], a[20:23], a[176:179], v[72:75]
v_mfma_f32_16x16x32_bf16 v[72:75], a[24:27], a[184:187], v[72:75]
v_mfma_f32_16x16x32_bf16 v[72:75], a[28:31], a[192:195], v[72:75]
ds_write_b128 v18, a[100:103] offset:20480
v_mfma_f32_16x16x32_bf16 v[76:79], a[28:31], a[196:199], v[76:79]
v_mfma_f32_16x16x32_bf16 v[76:79], a[24:27], a[188:191], v[76:79]
buffer_load_dwordx4 v9, s[16:19], 0 offen lds
v_mfma_f32_16x16x32_bf16 v[76:79], a[20:23], a[180:183], v[76:79]
s_add_u32 m0, s47, 53248
v_mfma_f32_16x16x32_bf16 v[76:79], a[16:19], a[172:175], v[76:79]
s_waitcnt lgkmcnt(2)
v_mfma_f32_16x16x32_bf16 v[80:83], a[0:3], v[168:171], v[80:83]
ds_read_b64_tr_b16 a[16:17], v3 offset:45056
v_mfma_f32_16x16x32_bf16 v[80:83], a[4:7], v[176:179], v[80:83]
ds_read_b64_tr_b16 a[18:19], v3 offset:47104
v_mfma_f32_16x16x32_bf16 v[80:83], a[8:11], v[184:187], v[80:83]
ds_read_b64_tr_b16 a[20:21], v3 offset:53248
v_mfma_f32_16x16x32_bf16 v[80:83], a[12:15], v[192:195], v[80:83]
ds_read_b64_tr_b16 a[22:23], v3 offset:55296
v_mfma_f32_16x16x32_bf16 v[84:87], a[12:15], v[196:199], v[84:87]
ds_read_b64_tr_b16 a[24:25], v3 offset:61440
buffer_load_dwordx4 v9, s[20:23], 0 offen lds
v_mfma_f32_16x16x32_bf16 v[84:87], a[8:11], v[188:191], v[84:87]
s_add_u32 m0, s47, 57344
ds_read_b64_tr_b16 a[26:27], v3 offset:63488
v_add_u32 v3, 0x10000, v3
v_mfma_f32_16x16x32_bf16 v[84:87], a[4:7], v[180:183], v[84:87]
ds_read_b64_tr_b16 a[28:29], v3 offset:4096
v_add_u32 v9, 0x90000, v9
v_mfma_f32_16x16x32_bf16 v[84:87], a[0:3], v[172:175], v[84:87]
ds_read_b64_tr_b16 a[30:31], v3 offset:6144
v_mfma_f32_16x16x32_bf16 v[88:91], a[0:3], a[168:171], v[88:91]
ds_write_b128 v19, a[104:107] offset:16384
v_mfma_f32_16x16x32_bf16 v[88:91], a[4:7], a[176:179], v[88:91]
buffer_atomic_umax v46, v20, s[28:31], 0 offen sc0 sc1
v_mfma_f32_16x16x32_bf16 v[88:91], a[8:11], a[184:187], v[88:91]
v_mfma_f32_16x16x32_bf16 v[88:91], a[12:15], a[192:195], v[88:91]
ds_write_b128 v19, a[108:111] offset:20480
v_mfma_f32_16x16x32_bf16 v[92:95], a[12:15], a[196:199], v[92:95]
v_mfma_f32_16x16x32_bf16 v[92:95], a[8:11], a[188:191], v[92:95]
v_mfma_f32_16x16x32_bf16 v[92:95], a[4:7], a[180:183], v[92:95]
buffer_load_dwordx4 v9, s[16:19], 0 offen lds
v_mfma_f32_16x16x32_bf16 v[92:95], a[0:3], a[172:175], v[92:95]
s_waitcnt vmcnt(16) lgkmcnt(2)
v_mfma_f32_16x16x32_bf16 v[96:99], a[16:19], v[168:171], v[96:99]
s_barrier
ds_read_b64_tr_b16 a[0:1], v2 offset:8192
v_mfma_f32_16x16x32_bf16 v[96:99], a[20:23], v[176:179], v[96:99]
s_add_u32 m0, s47, 61440
ds_read_b64_tr_b16 a[2:3], v2 offset:10240
v_mfma_f32_16x16x32_bf16 v[96:99], a[24:27], v[184:187], v[96:99]
ds_read_b64_tr_b16 a[4:5], v2 offset:16384
v_mfma_f32_16x16x32_bf16 v[96:99], a[28:31], v[192:195], v[96:99]
ds_read_b64_tr_b16 a[6:7], v2 offset:18432
v_mfma_f32_16x16x32_bf16 v[100:103], a[28:31], v[196:199], v[100:103]
ds_read_b64_tr_b16 a[8:9], v2 offset:24576
v_mfma_f32_16x16x32_bf16 v[100:103], a[24:27], v[188:191], v[100:103]
ds_read_b64_tr_b16 a[10:11], v2 offset:26624
v_mfma_f32_16x16x32_bf16 v[100:103], a[20:23], v[180:183], v[100:103]
v_mfma_f32_16x16x32_bf16 v[100:103], a[16:19], v[172:175], v[100:103]
v_mfma_f32_16x16x32_bf16 v[104:107], a[16:19], a[168:171], v[104:107]
buffer_load_dwordx4 v9, s[20:23], 0 offen lds
v_mfma_f32_16x16x32_bf16 v[104:107], a[20:23], a[176:179], v[104:107]
s_add_u32 m0, s47, 65536
v_add_u32 v9, 0x90000, v9
v_mfma_f32_16x16x32_bf16 v[104:107], a[24:27], a[184:187], v[104:107]
v_mfma_f32_16x16x32_bf16 v[104:107], a[28:31], a[192:195], v[104:107]
v_mfma_f32_16x16x32_bf16 v[108:111], a[28:31], a[196:199], v[108:111]
v_mfma_f32_16x16x32_bf16 v[108:111], a[24:27], a[188:191], v[108:111]
v_mfma_f32_16x16x32_bf16 v[108:111], a[20:23], a[180:183], v[108:111]
v_mfma_f32_16x16x32_bf16 v[108:111], a[16:19], a[172:175], v[108:111]
s_waitcnt lgkmcnt(0)
v_mfma_f32_16x16x32_bf16 v[48:51], a[0:3], v[200:203], v[48:51]
ds_read_b64_tr_b16 a[16:17], v2 offset:12288
v_mfma_f32_16x16x32_bf16 v[48:51], a[4:7], v[208:211], v[48:51]
ds_read_b64_tr_b16 a[18:19], v2 offset:14336
v_mfma_f32_16x16x32_bf16 v[48:51], a[8:11], v[216:219], v[48:51]
ds_read_b64_tr_b16 a[20:21], v2 offset:20480
buffer_load_dwordx4 v9, s[16:19], 0 offen lds
v_mfma_f32_16x16x32_bf16 v[52:55], a[8:11], v[220:223], v[52:55]
s_add_u32 m0, s47, 69632
ds_read_b64_tr_b16 a[22:23], v2 offset:22528
v_mfma_f32_16x16x32_bf16 v[52:55], a[4:7], v[212:215], v[52:55]
ds_read_b64_tr_b16 a[24:25], v2 offset:28672
v_mfma_f32_16x16x32_bf16 v[52:55], a[0:3], v[204:207], v[52:55]
ds_read_b64_tr_b16 a[26:27], v2 offset:30720
v_add_u32 v2, 0xfffe0000, v2
v_mfma_f32_16x16x32_bf16 v[56:59], a[0:3], a[200:203], v[56:59]
v_mfma_f32_16x16x32_bf16 v[56:59], a[4:7], a[208:211], v[56:59]
v_mfma_f32_16x16x32_bf16 v[56:59], a[8:11], a[216:219], v[56:59]
v_mfma_f32_16x16x32_bf16 v[60:63], a[8:11], a[220:223], v[60:63]
v_mfma_f32_16x16x32_bf16 v[60:63], a[4:7], a[212:215], v[60:63]
v_mfma_f32_16x16x32_bf16 v[60:63], a[0:3], a[204:207], v[60:63]
s_waitcnt lgkmcnt(0)
v_mfma_f32_16x16x32_bf16 v[64:67], a[16:19], v[200:203], v[64:67]
ds_read_b64_tr_b16 a[0:1], v3 offset:8192
buffer_load_dwordx4 v9, s[20:23], 0 offen lds
v_mfma_f32_16x16x32_bf16 v[64:67], a[20:23], v[208:211], v[64:67]
s_add_u32 m0, s47, 73728
ds_read_b64_tr_b16 a[2:3], v3 offset:10240
v_add_u32 v9, 0x90000, v9
v_mfma_f32_16x16x32_bf16 v[64:67], a[24:27], v[216:219], v[64:67]
ds_read_b64_tr_b16 a[4:5], v3 offset:16384
v_mfma_f32_16x16x32_bf16 v[68:71], a[24:27], v[220:223], v[68:71]
ds_read_b64_tr_b16 a[6:7], v3 offset:18432
v_mfma_f32_16x16x32_bf16 v[68:71], a[20:23], v[212:215], v[68:71]
ds_read_b64_tr_b16 a[8:9], v3 offset:24576
v_mfma_f32_16x16x32_bf16 v[68:71], a[16:19], v[204:207], v[68:71]
ds_read_b64_tr_b16 a[10:11], v3 offset:26624
v_mfma_f32_16x16x32_bf16 v[72:75], a[16:19], a[200:203], v[72:75]
v_mfma_f32_16x16x32_bf16 v[72:75], a[20:23], a[208:211], v[72:75]
v_mfma_f32_16x16x32_bf16 v[72:75], a[24:27], a[216:219], v[72:75]
v_mfma_f32_16x16x32_bf16 v[76:79], a[24:27], a[220:223], v[76:79]
v_mfma_f32_16x16x32_bf16 v[76:79], a[20:23], a[212:215], v[76:79]
buffer_load_dwordx4 v9, s[16:19], 0 offen lds
v_mfma_f32_16x16x32_bf16 v[76:79], a[16:19], a[204:207], v[76:79]
s_waitcnt lgkmcnt(0)
v_mfma_f32_16x16x32_bf16 v[80:83], a[0:3], v[200:203], v[80:83]
s_add_u32 m0, s47, 77824
ds_read_b64_tr_b16 a[16:17], v3 offset:12288
v_mfma_f32_16x16x32_bf16 v[80:83], a[4:7], v[208:211], v[80:83]
ds_read_b64_tr_b16 a[18:19], v3 offset:14336
v_mfma_f32_16x16x32_bf16 v[80:83], a[8:11], v[216:219], v[80:83]
ds_read_b64_tr_b16 a[20:21], v3 offset:20480
v_mfma_f32_16x16x32_bf16 v[84:87], a[8:11], v[220:223], v[84:87]
ds_read_b64_tr_b16 a[22:23], v3 offset:22528
v_mfma_f32_16x16x32_bf16 v[84:87], a[4:7], v[212:215], v[84:87]
ds_read_b64_tr_b16 a[24:25], v3 offset:28672
L_pad8:
s_cbranch_execz L_pad12
v_mfma_f32_16x16x32_bf16 v[84:87], a[0:3], v[204:207], v[84:87]
ds_read_b64_tr_b16 a[26:27], v3 offset:30720
v_add_u32 v3, 0xfffe0000, v3
v_mfma_f32_16x16x32_bf16 v[88:91], a[0:3], a[200:203], v[88:91]
s_waitcnt vmcnt(5)
v_cmp_gt_u32 vcc, 16, v46
v_mfma_f32_16x16x32_bf16 v[88:91], a[4:7], a[208:211], v[88:91]
v_mfma_f32_16x16x32_bf16 v[88:91], a[8:11], a[216:219], v[88:91]
buffer_load_dwordx4 v9, s[20:23], 0 offen lds
v_mfma_f32_16x16x32_bf16 v[92:95], a[8:11], a[220:223], v[92:95]
s_add_u32 m0, s47, 98304
v_add_u32 v9, 0x90000, v9
v_mfma_f32_16x16x32_bf16 v[92:95], a[4:7], a[212:215], v[92:95]
s_and_b32 s3, vcc_lo, s1
s_cbranch_scc1 L_spin1
L_back1:
v_mfma_f32_16x16x32_bf16 v[92:95], a[0:3], a[204:207], v[92:95]
s_waitcnt lgkmcnt(0)
v_mfma_f32_16x16x32_bf16 v[96:99], a[16:19], v[200:203], v[96:99]
s_barrier
ds_read_b64_tr_b16 a[0:1], v2
v_mfma_f32_16x16x32_bf16 v[96:99], a[20:23], v[208:211], v[96:99]
ds_read_b64_tr_b16 a[2:3], v2 offset:2048
buffer_load_dword v0, v21, s[28:31], 0 offen sc1
v_mfma_f32_16x16x32_bf16 v[96:99], a[24:27], v[216:219], v[96:99]
s_getpc_b64 s[58:59]
L_pc2:
s_lshl_b32 s60, s71, 2
ds_read_b64_tr_b16 a[4:5], v2 offset:8192
v_mfma_f32_16x16x32_bf16 v[100:103], a[24:27], v[220:223], v[100:103]
s_add_u32 s60, s60, s44
s_lshl_b32 s60, s60, 8
ds_read_b64_tr_b16 a[6:7], v2 offset:10240
v_mfma_f32_16x16x32_bf16 v[100:103], a[20:23], v[212:215], v[100:103]
ds_read_b64_tr_b16 a[8:9], v2 offset:16384
v_lshrrev_b32 v44, 5, v1
v_mfma_f32_16x16x32_bf16 v[100:103], a[16:19], v[204:207], v[100:103]
ds_read_b64_tr_b16 a[10:11], v2 offset:18432
v_lshl_add_u32 v44, v44, 7, s60
v_mfma_f32_16x16x32_bf16 v[104:107], a[16:19], a[200:203], v[104:107]
ds_read_b64_tr_b16 a[12:13], v2 offset:24576
v_sub_u32 v44, L_end-L_pc2, v44
v_mfma_f32_16x16x32_bf16 v[104:107], a[20:23], a[208:211], v[104:107]
ds_read_b64_tr_b16 a[14:15], v2 offset:26624
v_mov_b32 v45, s59
v_mfma_f32_16x16x32_bf16 v[104:107], a[24:27], a[216:219], v[104:107]
v_add_co_u32 v44, vcc, s58, v44
s_nop 1
v_addc_co_u32 v45, vcc, 0, v45, vcc
v_mfma_f32_16x16x32_bf16 v[108:111], a[24:27], a[220:223], v[108:111]
global_load_dword v0, v[44:45], off
v_mfma_f32_16x16x32_bf16 v[108:111], a[20:23], a[212:215], v[108:111]
v_mfma_f32_16x16x32_bf16 v[108:111], a[16:19], a[204:207], v[108:111]
s_waitcnt lgkmcnt(0)
v_mfma_f32_16x16x32_bf16 v[48:51], a[0:3], v[224:227], v[48:51]
ds_read_b64_tr_b16 a[16:17], v2 offset:4096
v_mfma_f32_16x16x32_bf16 v[48:51], a[4:7], v[232:235], v[48:51]
ds_read_b64_tr_b16 a[18:19], v2 offset:6144
v_mfma_f32_16x16x32_bf16 v[48:51], a[8:11], v[240:243], v[48:51]
ds_read_b64_tr_b16 a[20:21], v2 offset:12288
v_mfma_f32_16x16x32_bf16 v[48:51], a[12:15], v[248:251], v[48:51]
ds_read_b64_tr_b16 a[22:23], v2 offset:14336
v_mfma_f32_16x16x32_bf16 v[52:55], a[12:15], v[252:255], v[52:55]
s_lshl_b32 s59, s44, 11
s_lshl_b32 s60, s7, 3
ds_read_b64_tr_b16 a[24:25], v2 offset:20480
v_mfma_f32_16x16x32_bf16 v[52:55], a[8:11], v[244:247], v[52:55]
ds_read_b64_tr_b16 a[26:27], v2 offset:22528
v_add_u32 v40, s59, v10
v_mfma_f32_16x16x32_bf16 v[52:55], a[4:7], v[236:239], v[52:55]
ds_read_b64_tr_b16 a[28:29], v2 offset:28672
v_xor_b32 v41, 0x800, v40
v_mfma_f32_16x16x32_bf16 v[52:55], a[0:3], v[228:231], v[52:55]
ds_read_b64_tr_b16 a[30:31], v2 offset:30720
v_add_u32 v2, 0x20000, v2
v_mfma_f32_16x16x32_bf16 v[56:59], a[0:3], a[224:227], v[56:59]
v_add_u32 v42, s60, v40
v_add_u32 v43, s60, v41
v_mfma_f32_16x16x32_bf16 v[56:59], a[4:7], a[232:235], v[56:59]
v_max_f32 v48, 0, v48
v_max_f32 v49, 0, v49
v_mfma_f32_16x16x32_bf16 v[56:59], a[8:11], a[240:243], v[56:59]
v_max_f32 v50, 0, v50
v_max_f32 v51, 0, v51
v_mfma_f32_16x16x32_bf16 v[56:59], a[12:15], a[248:251], v[56:59]
v_max_f32 v52, 0, v52
v_max_f32 v53, 0, v53
v_mfma_f32_16x16x32_bf16 v[60:63], a[12:15], a[252:255], v[60:63]
v_max_f32 v54, 0, v54
v_max_f32 v55, 0, v55
v_mfma_f32_16x16x32_bf16 v[60:63], a[8:11], a[244:247], v[60:63]
v_mfma_f32_16x16x32_bf16 v[60:63], a[4:7], a[236:239], v[60:63]
v_mfma_f32_16x16x32_bf16 v[60:63], a[0:3], a[228:231], v[60:63]
s_waitcnt lgkmcnt(0)
v_max_f32 v56, 0, v56
v_max_f32 v57, 0, v57
v_mfma_f32_16x16x32_bf16 v[64:67], a[16:19], v[224:227], v[64:67]
ds_read_b64_tr_b16 a[0:1], v3
v_max_f32 v58, 0, v58
v_mfma_f32_16x16x32_bf16 v[64:67], a[20:23], v[232:235], v[64:67]
ds_read_b64_tr_b16 a[2:3], v3 offset:2048
v_max_f32 v59, 0, v59
v_mfma_f32_16x16x32_bf16 v[64:67], a[24:27], v[240:243], v[64:67]
ds_read_b64_tr_b16 a[4:5], v3 offset:8192
v_mfma_f32_16x16x32_bf16 v[64:67], a[28:31], v[248:251], v[64:67]
ds_read_b64_tr_b16 a[6:7], v3 offset:10240
v_max_f32 v60, 0, v60
v_mfma_f32_16x16x32_bf16 v[68:71], a[28:31], v[252:255], v[68:71]
ds_read_b64_tr_b16 a[8:9], v3 offset:16384
v_max_f32 v61, 0, v61
v_mfma_f32_16x16x32_bf16 v[68:71], a[24:27], v[244:247], v[68:71]
ds_read_b64_tr_b16 a[10:11], v3 offset:18432
buffer_load_dwordx4 v9, s[16:19], 0 offen lds
v_mfma_f32_16x16x32_bf16 v[68:71], a[20:23], v[236:239], v[68:71]
s_add_u32 m0, s47, 102400
ds_read_b64_tr_b16 a[12:13], v3 offset:24576
v_max_f32 v62, 0, v62
v_mfma_f32_16x16x32_bf16 v[68:71], a[16:19], v[228:231], v[68:71]
ds_read_b64_tr_b16 a[14:15], v3 offset:26624
v_max_f32 v63, 0, v63
v_mfma_f32_16x16x32_bf16 v[72:75], a[16:19], a[224:227], v[72:75]
v_mul_f32 v48, v48, v64
v_mul_f32 v49, v49, v65
v_mfma_f32_16x16x32_bf16 v[72:75], a[20:23], a[232:235], v[72:75]
v_mul_f32 v50, v50, v66
v_mul_f32 v51, v51, v67
v_mfma_f32_16x16x32_bf16 v[72:75], a[24:27], a[240:243], v[72:75]
v_cvt_pk_bf16_f32 v32, v48, v49
v_cvt_pk_bf16_f32 v33, v50, v51
v_mfma_f32_16x16x32_bf16 v[72:75], a[28:31], a[248:251], v[72:75]
v_accvgpr_write_b32 a96, v32
v_accvgpr_write_b32 a97, v33
v_mfma_f32_16x16x32_bf16 v[76:79], a[28:31], a[252:255], v[76:79]
v_mul_f32 v52, v52, v68
v_mul_f32 v53, v53, v69
v_mfma_f32_16x16x32_bf16 v[76:79], a[24:27], a[244:247], v[76:79]
v_mul_f32 v54, v54, v70
v_mul_f32 v55, v55, v71
v_mfma_f32_16x16x32_bf16 v[76:79], a[20:23], a[236:239], v[76:79]
v_cvt_pk_bf16_f32 v34, v52, v53
v_cvt_pk_bf16_f32 v35, v54, v55
v_mfma_f32_16x16x32_bf16 v[76:79], a[16:19], a[228:231], v[76:79]
s_waitcnt lgkmcnt(0)
buffer_load_dwordx4 v9, s[20:23], 0 offen lds
v_mfma_f32_16x16x32_bf16 v[80:83], a[0:3], v[224:227], v[80:83]
s_add_u32 m0, s47, 106496
ds_read_b64_tr_b16 a[16:17], v3 offset:4096
v_add_u32 v9, 0x90000, v9
v_mfma_f32_16x16x32_bf16 v[80:83], a[4:7], v[232:235], v[80:83]
ds_read_b64_tr_b16 a[18:19], v3 offset:6144
v_accvgpr_write_b32 a100, v34
v_mfma_f32_16x16x32_bf16 v[80:83], a[8:11], v[240:243], v[80:83]
ds_read_b64_tr_b16 a[20:21], v3 offset:12288
v_accvgpr_write_b32 a101, v35
v_mfma_f32_16x16x32_bf16 v[80:83], a[12:15], v[248:251], v[80:83]
ds_read_b64_tr_b16 a[22:23], v3 offset:14336
v_mul_f32 v56, v56, v72
v_mfma_f32_16x16x32_bf16 v[84:87], a[12:15], v[252:255], v[84:87]
ds_read_b64_tr_b16 a[24:25], v3 offset:20480
v_mul_f32 v57, v57, v73
v_mfma_f32_16x16x32_bf16 v[84:87], a[8:11], v[244:247], v[84:87]
ds_read_b64_tr_b16 a[26:27], v3 offset:22528
v_mul_f32 v58, v58, v74
v_mfma_f32_16x16x32_bf16 v[84:87], a[4:7], v[236:239], v[84:87]
ds_read_b64_tr_b16 a[28:29], v3 offset:28672
v_mul_f32 v59, v59, v75
v_mfma_f32_16x16x32_bf16 v[84:87], a[0:3], v[228:231], v[84:87]
ds_read_b64_tr_b16 a[30:31], v3 offset:30720
v_add_u32 v3, 0x20000, v3
v_mfma_f32_16x16x32_bf16 v[88:91], a[0:3], a[224:227], v[88:91]
v_cvt_pk_bf16_f32 v36, v56, v57
v_cvt_pk_bf16_f32 v37, v58, v59
v_mfma_f32_16x16x32_bf16 v[88:91], a[4:7], a[232:235], v[88:91]
buffer_load_dwordx4 v9, s[16:19], 0 offen lds
v_mfma_f32_16x16x32_bf16 v[88:91], a[8:11], a[240:243], v[88:91]
s_add_u32 m0, s47, 110592
v_accvgpr_write_b32 a104, v36
v_accvgpr_write_b32 a105, v37
v_mfma_f32_16x16x32_bf16 v[88:91], a[12:15], a[248:251], v[88:91]
v_mul_f32 v60, v60, v76
v_mul_f32 v61, v61, v77
v_mfma_f32_16x16x32_bf16 v[92:95], a[12:15], a[252:255], v[92:95]
v_mul_f32 v62, v62, v78
v_mul_f32 v63, v63, v79
v_mfma_f32_16x16x32_bf16 v[92:95], a[8:11], a[244:247], v[92:95]
v_cvt_pk_bf16_f32 v38, v60, v61
v_cvt_pk_bf16_f32 v39, v62, v63
v_mfma_f32_16x16x32_bf16 v[92:95], a[4:7], a[236:239], v[92:95]
v_accvgpr_write_b32 a108, v38
v_accvgpr_write_b32 a109, v39
v_mfma_f32_16x16x32_bf16 v[92:95], a[0:3], a[228:231], v[92:95]
s_waitcnt lgkmcnt(0)
v_max_f32 v80, 0, v80
v_max_f32 v81, 0, v81
v_mfma_f32_16x16x32_bf16 v[96:99], a[16:19], v[224:227], v[96:99]
s_barrier
ds_read_b64_tr_b16 a[0:1], v4 offset:32768
v_max_f32 v82, 0, v82
v_mfma_f32_16x16x32_bf16 v[96:99], a[20:23], v[232:235], v[96:99]
ds_read_b64_tr_b16 a[2:3], v4 offset:34816
v_max_f32 v83, 0, v83
v_mfma_f32_16x16x32_bf16 v[96:99], a[24:27], v[240:243], v[96:99]
ds_read_b64_tr_b16 a[4:5], v5 offset:32768
v_max_f32 v84, 0, v84
v_mfma_f32_16x16x32_bf16 v[96:99], a[28:31], v[248:251], v[96:99]
ds_read_b64_tr_b16 a[6:7], v5 offset:34816
buffer_load_dwordx4 v9, s[20:23], 0 offen lds
v_mfma_f32_16x16x32_bf16 v[100:103], a[28:31], v[252:255], v[100:103]
s_add_u32 m0, s47, 131072
ds_read_b64_tr_b16 a[8:9], v4 offset:40960
v_add_u32 v9, 0x90000, v9
v_mfma_f32_16x16x32_bf16 v[100:103], a[24:27], v[244:247], v[100:103]
ds_read_b64_tr_b16 a[10:11], v4 offset:43008
v_max_f32 v85, 0, v85
v_mfma_f32_16x16x32_bf16 v[100:103], a[20:23], v[236:239], v[100:103]
v_max_f32 v86, 0, v86
v_max_f32 v87, 0, v87
v_mfma_f32_16x16x32_bf16 v[100:103], a[16:19], v[228:231], v[100:103]
v_max_f32 v88, 0, v88
v_max_f32 v89, 0, v89
v_mfma_f32_16x16x32_bf16 v[104:107], a[16:19], a[224:227], v[104:107]
v_max_f32 v90, 0, v90
v_max_f32 v91, 0, v91
v_mfma_f32_16x16x32_bf16 v[104:107], a[20:23], a[232:235], v[104:107]
v_max_f32 v92, 0, v92
v_max_f32 v93, 0, v93
v_mfma_f32_16x16x32_bf16 v[104:107], a[24:27], a[240:243], v[104:107]
v_max_f32 v94, 0, v94
v_max_f32 v95, 0, v95
v_mfma_f32_16x16x32_bf16 v[104:107], a[28:31], a[248:251], v[104:107]
v_mul_f32 v80, v80, v96
v_mul_f32 v81, v81, v97
v_mfma_f32_16x16x32_bf16 v[108:111], a[28:31], a[252:255], v[108:111]
v_mul_f32 v82, v82, v98
v_mul_f32 v83, v83, v99
v_mfma_f32_16x16x32_bf16 v[108:111], a[24:27], a[244:247], v[108:111]
buffer_load_dwordx4 v9, s[16:19], 0 offen lds
v_mfma_f32_16x16x32_bf16 v[108:111], a[20:23], a[236:239], v[108:111]
s_add_u32 m0, s47, 135168
v_cvt_pk_bf16_f32 v32, v80, v81
v_cvt_pk_bf16_f32 v33, v82, v83
v_mfma_f32_16x16x32_bf16 v[108:111], a[16:19], a[228:231], v[108:111]
s_waitcnt lgkmcnt(0)
v_accvgpr_write_b32 a98, v32
v_accvgpr_write_b32 a99, v33
v_mfma_f32_16x16x32_bf16 v[48:51], a[0:3], v[112:115], 0
ds_read_b64_tr_b16 a[16:17], v4 offset:36864
v_mul_f32 v84, v84, v100
v_mfma_f32_16x16x32_bf16 v[48:51], a[4:7], v[120:123], v[48:51]
ds_read_b64_tr_b16 a[18:19], v4 offset:38912
v_mul_f32 v85, v85, v101
v_mfma_f32_16x16x32_bf16 v[48:51], a[8:11], v[128:131], v[48:51]
ds_read_b64_tr_b16 a[20:21], v5 offset:36864
v_mul_f32 v86, v86, v102
v_mfma_f32_16x16x32_bf16 v[52:55], a[8:11], v[132:135], 0
ds_read_b64_tr_b16 a[22:23], v5 offset:38912
v_mul_f32 v87, v87, v103
v_mfma_f32_16x16x32_bf16 v[52:55], a[4:7], v[124:127], v[52:55]
ds_read_b64_tr_b16 a[24:25], v4 offset:45056
v_cvt_pk_bf16_f32 v34, v84, v85
v_mfma_f32_16x16x32_bf16 v[52:55], a[0:3], v[116:119], v[52:55]
ds_read_b64_tr_b16 a[26:27], v4 offset:47104
v_cvt_pk_bf16_f32 v35, v86, v87
v_mfma_f32_16x16x32_bf16 v[56:59], a[0:3], a[112:115], 0
v_accvgpr_write_b32 a102, v34
v_accvgpr_write_b32 a103, v35
v_mfma_f32_16x16x32_bf16 v[56:59], a[4:7], a[120:123], v[56:59]
buffer_load_dwordx4 v9, s[20:23], 0 offen lds
v_mfma_f32_16x16x32_bf16 v[56:59], a[8:11], a[128:131], v[56:59]
s_add_u32 m0, s47, 138240
v_mul_f32 v88, v88, v104
v_mul_f32 v89, v89, v105
v_mfma_f32_16x16x32_bf16 v[60:63], a[8:11], a[132:135], 0
v_mul_f32 v90, v90, v106
v_mul_f32 v91, v91, v107
v_mfma_f32_16x16x32_bf16 v[60:63], a[4:7], a[124:127], v[60:63]
v_cvt_pk_bf16_f32 v36, v88, v89
v_cvt_pk_bf16_f32 v37, v90, v91
v_mfma_f32_16x16x32_bf16 v[60:63], a[0:3], a[116:119], v[60:63]
s_waitcnt lgkmcnt(0)
v_accvgpr_write_b32 a106, v36
v_accvgpr_write_b32 a107, v37
v_mfma_f32_16x16x32_bf16 v[64:67], a[16:19], v[112:115], 0
ds_read_b64_tr_b16 a[0:1], v5 offset:40960
v_mul_f32 v92, v92, v108
v_mfma_f32_16x16x32_bf16 v[64:67], a[20:23], v[120:123], v[64:67]
ds_read_b64_tr_b16 a[2:3], v5 offset:43008
v_mul_f32 v93, v93, v109
v_mfma_f32_16x16x32_bf16 v[64:67], a[24:27], v[128:131], v[64:67]
ds_read_b64_tr_b16 a[4:5], v4 offset:49152
v_mul_f32 v94, v94, v110
v_mfma_f32_16x16x32_bf16 v[68:71], a[24:27], v[132:135], 0
ds_read_b64_tr_b16 a[6:7], v4 offset:51200
v_mul_f32 v95, v95, v111
v_mfma_f32_16x16x32_bf16 v[68:71], a[20:23], v[124:127], v[68:71]
ds_read_b64_tr_b16 a[8:9], v5 offset:49152
v_cvt_pk_bf16_f32 v38, v92, v93
v_mfma_f32_16x16x32_bf16 v[68:71], a[16:19], v[116:119], v[68:71]
ds_read_b64_tr_b16 a[10:11], v5 offset:51200
buffer_load_dwordx4 v7, s[24:27], 0 offen offset:1024 lds
v_mfma_f32_16x16x32_bf16 v[72:75], a[16:19], a[112:115], 0
s_add_u32 m0, s47, 143360
v_add_u32 v7, 0x9400, v7
v_cvt_pk_bf16_f32 v39, v94, v95
v_mfma_f32_16x16x32_bf16 v[72:75], a[20:23], a[120:123], v[72:75]
v_accvgpr_write_b32 a110, v38
v_accvgpr_write_b32 a111, v39
v_mfma_f32_16x16x32_bf16 v[72:75], a[24:27], a[128:131], v[72:75]
v_mfma_f32_16x16x32_bf16 v[76:79], a[24:27], a[132:135], 0
v_mfma_f32_16x16x32_bf16 v[76:79], a[20:23], a[124:127], v[76:79]
v_mfma_f32_16x16x32_bf16 v[76:79], a[16:19], a[116:119], v[76:79]
s_waitcnt lgkmcnt(0)
buffer_load_dwordx4 v7, s[24:27], 0 offen lds
v_mfma_f32_16x16x32_bf16 v[48:51], a[0:3], v[136:139], v[48:51]
s_add_u32 m0, s47, 147456
ds_read_b64_tr_b16 a[16:17], v5 offset:45056
v_add_u32 v7, s41, v7
v_mfma_f32_16x16x32_bf16 v[48:51], a[4:7], v[144:147], v[48:51]
ds_read_b64_tr_b16 a[18:19], v5 offset:47104
v_mfma_f32_16x16x32_bf16 v[48:51], a[8:11], v[152:155], v[48:51]
ds_read_b64_tr_b16 a[20:21], v4 offset:53248
v_mfma_f32_16x16x32_bf16 v[52:55], a[8:11], v[156:159], v[52:55]
ds_read_b64_tr_b16 a[22:23], v4 offset:55296
v_mfma_f32_16x16x32_bf16 v[52:55], a[4:7], v[148:151], v[52:55]
ds_read_b64_tr_b16 a[24:25], v5 offset:53248
v_mfma_f32_16x16x32_bf16 v[52:55], a[0:3], v[140:143], v[52:55]
ds_read_b64_tr_b16 a[26:27], v5 offset:55296
buffer_load_dwordx4 v7, s[24:27], 0 offen lds
v_mfma_f32_16x16x32_bf16 v[56:59], a[0:3], a[136:139], v[56:59]
s_add_u32 m0, s47, 151552
v_add_u32 v7, 0x9000, v7
v_mfma_f32_16x16x32_bf16 v[56:59], a[4:7], a[144:147], v[56:59]
v_mfma_f32_16x16x32_bf16 v[56:59], a[8:11], a[152:155], v[56:59]
v_mfma_f32_16x16x32_bf16 v[60:63], a[8:11], a[156:159], v[60:63]
v_mfma_f32_16x16x32_bf16 v[60:63], a[4:7], a[148:151], v[60:63]
v_mfma_f32_16x16x32_bf16 v[60:63], a[0:3], a[140:143], v[60:63]
s_waitcnt vmcnt(11) lgkmcnt(0)
buffer_load_dwordx4 v7, s[24:27], 0 offen lds
v_mfma_f32_16x16x32_bf16 v[64:67], a[16:19], v[136:139], v[64:67]
s_barrier
ds_read_b64_tr_b16 a[0:1], v4 offset:57344
v_add_u32 v7, s42, v7
v_mfma_f32_16x16x32_bf16 v[64:67], a[20:23], v[144:147], v[64:67]
s_add_u32 m0, s47, 155648
ds_read_b64_tr_b16 a[2:3], v4 offset:59392
v_add_u32 v4, 0x10000, v4
v_mfma_f32_16x16x32_bf16 v[64:67], a[24:27], v[152:155], v[64:67]
ds_read_b64_tr_b16 a[4:5], v5 offset:57344
v_mfma_f32_16x16x32_bf16 v[68:71], a[24:27], v[156:159], v[68:71]
ds_read_b64_tr_b16 a[6:7], v5 offset:59392
v_mfma_f32_16x16x32_bf16 v[68:71], a[20:23], v[148:151], v[68:71]
ds_read_b64_tr_b16 a[8:9], v4
v_mfma_f32_16x16x32_bf16 v[68:71], a[16:19], v[140:143], v[68:71]
ds_read_b64_tr_b16 a[10:11], v4 offset:2048
v_add_u32 v4, 0xffff0000, v4
v_mfma_f32_16x16x32_bf16 v[72:75], a[16:19], a[136:139], v[72:75]
buffer_load_dwordx4 v7, s[24:27], 0 offen lds
v_mfma_f32_16x16x32_bf16 v[72:75], a[20:23], a[144:147], v[72:75]
s_add_u32 m0, s47, 159744
v_add_u32 v7, 0x9000, v7
v_mfma_f32_16x16x32_bf16 v[72:75], a[24:27], a[152:155], v[72:75]
v_mfma_f32_16x16x32_bf16 v[76:79], a[24:27], a[156:159], v[76:79]
v_mfma_f32_16x16x32_bf16 v[76:79], a[20:23], a[148:151], v[76:79]
v_mfma_f32_16x16x32_bf16 v[76:79], a[16:19], a[140:143], v[76:79]
s_waitcnt lgkmcnt(0)
v_mfma_f32_16x16x32_bf16 v[48:51], a[0:3], v[160:163], v[48:51]
ds_read_b64_tr_b16 a[16:17], v4 offset:61440
v_mfma_f32_16x16x32_bf16 v[48:51], a[4:7], v[168:171], v[48:51]
ds_read_b64_tr_b16 a[18:19], v4 offset:63488
v_add_u32 v4, 0x10000, v4
v_mfma_f32_16x16x32_bf16 v[48:51], a[8:11], v[176:179], v[48:51]
ds_read_b64_tr_b16 a[20:21], v5 offset:61440
v_mfma_f32_16x16x32_bf16 v[52:55], a[8:11], v[180:183], v[52:55]
ds_read_b64_tr_b16 a[22:23], v5 offset:63488
v_add_u32 v5, 0x10000, v5
v_mfma_f32_16x16x32_bf16 v[52:55], a[4:7], v[172:175], v[52:55]
ds_read_b64_tr_b16 a[24:25], v4 offset:4096
v_mfma_f32_16x16x32_bf16 v[52:55], a[0:3], v[164:167], v[52:55]
ds_read_b64_tr_b16 a[26:27], v4 offset:6144
v_mfma_f32_16x16x32_bf16 v[56:59], a[0:3], a[160:163], v[56:59]
ds_write_b128 v18, a[96:99] offset:49152
v_mfma_f32_16x16x32_bf16 v[56:59], a[4:7], a[168:171], v[56:59]
v_mfma_f32_16x16x32_bf16 v[56:59], a[8:11], a[176:179], v[56:59]
ds_write_b128 v18, a[100:103] offset:53248
v_mfma_f32_16x16x32_bf16 v[60:63], a[8:11], a[180:183], v[60:63]
v_mfma_f32_16x16x32_bf16 v[60:63], a[4:7], a[172:175], v[60:63]
v_mfma_f32_16x16x32_bf16 v[60:63], a[0:3], a[164:167], v[60:63]
s_waitcnt lgkmcnt(2)
v_mfma_f32_16x16x32_bf16 v[64:67], a[16:19], v[160:163], v[64:67]
ds_read_b64_tr_b16 a[0:1], v5
v_mfma_f32_16x16x32_bf16 v[64:67], a[20:23], v[168:171], v[64:67]
ds_read_b64_tr_b16 a[2:3], v5 offset:2048
v_mfma_f32_16x16x32_bf16 v[64:67], a[24:27], v[176:179], v[64:67]
ds_read_b64_tr_b16 a[4:5], v4 offset:8192
v_mfma_f32_16x16x32_bf16 v[68:71], a[24:27], v[180:183], v[68:71]
ds_read_b64_tr_b16 a[6:7], v4 offset:10240
v_mfma_f32_16x16x32_bf16 v[68:71], a[20:23], v[172:175], v[68:71]
ds_read_b64_tr_b16 a[8:9], v5 offset:8192
v_mfma_f32_16x16x32_bf16 v[68:71], a[16:19], v[164:167], v[68:71]
ds_read_b64_tr_b16 a[10:11], v5 offset:10240
v_mfma_f32_16x16x32_bf16 v[72:75], a[16:19], a[160:163], v[72:75]
ds_write_b128 v19, a[104:107] offset:49152
v_mfma_f32_16x16x32_bf16 v[72:75], a[20:23], a[168:171], v[72:75]
v_mfma_f32_16x16x32_bf16 v[72:75], a[24:27], a[176:179], v[72:75]
ds_write_b128 v19, a[108:111] offset:53248
v_mfma_f32_16x16x32_bf16 v[76:79], a[24:27], a[180:183], v[76:79]
v_mfma_f32_16x16x32_bf16 v[76:79], a[20:23], a[172:175], v[76:79]
buffer_load_dwordx4 v7, s[24:27], 0 offen lds
v_mfma_f32_16x16x32_bf16 v[76:79], a[16:19], a[164:167], v[76:79]
s_waitcnt lgkmcnt(2)
v_add_u32 v7, s43, v7
v_mfma_f32_16x16x32_bf16 v[48:51], a[0:3], v[184:187], v[48:51]
s_add_u32 m0, s47, 0
ds_read_b64_tr_b16 a[16:17], v5 offset:4096
v_mfma_f32_16x16x32_bf16 v[48:51], a[4:7], v[192:195], v[48:51]
ds_read_b64_tr_b16 a[18:19], v5 offset:6144
v_mfma_f32_16x16x32_bf16 v[48:51], a[8:11], v[200:203], v[48:51]
ds_read_b64_tr_b16 a[20:21], v4 offset:12288
buffer_load_dwordx4 v7, s[24:27], 0 offen lds
v_mfma_f32_16x16x32_bf16 v[52:55], a[8:11], v[204:207], v[52:55]
s_add_u32 m0, s47, 4096
ds_read_b64_tr_b16 a[22:23], v4 offset:14336
v_add_u32 v7, 0x9000, v7
v_mfma_f32_16x16x32_bf16 v[52:55], a[4:7], v[196:199], v[52:55]
ds_read_b64_tr_b16 a[24:25], v5 offset:12288
v_mfma_f32_16x16x32_bf16 v[52:55], a[0:3], v[188:191], v[52:55]
ds_read_b64_tr_b16 a[26:27], v5 offset:14336
v_mfma_f32_16x16x32_bf16 v[56:59], a[0:3], a[184:187], v[56:59]
buffer_load_dwordx4 v7, s[24:27], 0 offen lds
v_mfma_f32_16x16x32_bf16 v[56:59], a[4:7], a[192:195], v[56:59]
s_add_u32 m0, s47, 7168
v_mfma_f32_16x16x32_bf16 v[56:59], a[8:11], a[200:203], v[56:59]
v_mfma_f32_16x16x32_bf16 v[60:63], a[8:11], a[204:207], v[60:63]
v_mfma_f32_16x16x32_bf16 v[60:63], a[4:7], a[196:199], v[60:63]
buffer_load_dwordx4 v11, s[24:27], 0 offen offset:1024 lds
v_mfma_f32_16x16x32_bf16 v[60:63], a[0:3], a[188:191], v[60:63]
s_waitcnt vmcnt(9) lgkmcnt(0)
v_add_u32 v7, s40, v7
v_add_u32 v7, 0xfffffb80, v7
v_mfma_f32_16x16x32_bf16 v[64:67], a[16:19], v[184:187], v[64:67]
s_barrier
ds_read_b64_tr_b16 a[0:1], v4 offset:32768
v_mfma_f32_16x16x32_bf16 v[64:67], a[20:23], v[192:195], v[64:67]
s_add_u32 m0, s47, 20480
ds_read_b64_tr_b16 a[2:3], v4 offset:34816
v_mfma_f32_16x16x32_bf16 v[64:67], a[24:27], v[200:203], v[64:67]
ds_read_b64_tr_b16 a[4:5], v5 offset:32768
buffer_load_dwordx4 v7, s[24:27], 0 offen lds
v_mfma_f32_16x16x32_bf16 v[68:71], a[24:27], v[204:207], v[68:71]
s_add_u32 m0, s47, 24576
ds_read_b64_tr_b16 a[6:7], v5 offset:34816
v_add_u32 v7, 0x9000, v7
v_mfma_f32_16x16x32_bf16 v[68:71], a[20:23], v[196:199], v[68:71]
ds_read_b64_tr_b16 a[8:9], v4 offset:40960
v_mfma_f32_16x16x32_bf16 v[68:71], a[16:19], v[188:191], v[68:71]
ds_read_b64_tr_b16 a[10:11], v4 offset:43008
v_mfma_f32_16x16x32_bf16 v[72:75], a[16:19], a[184:187], v[72:75]
buffer_load_dwordx4 v7, s[24:27], 0 offen lds
v_mfma_f32_16x16x32_bf16 v[72:75], a[20:23], a[192:195], v[72:75]
s_add_u32 m0, s47, 28672
v_add_u32 v7, s41, v7
v_mfma_f32_16x16x32_bf16 v[72:75], a[24:27], a[200:203], v[72:75]
v_mfma_f32_16x16x32_bf16 v[76:79], a[24:27], a[204:207], v[76:79]
v_mfma_f32_16x16x32_bf16 v[76:79], a[20:23], a[196:199], v[76:79]
buffer_load_dwordx4 v7, s[24:27], 0 offen lds
v_mfma_f32_16x16x32_bf16 v[76:79], a[16:19], a[188:191], v[76:79]
s_waitcnt lgkmcnt(0)
v_add_u32 v7, 0x9000, v7
v_mfma_f32_16x16x32_bf16 v[48:51], a[0:3], v[208:211], v[48:51]
s_add_u32 m0, s47, 32768
ds_read_b64_tr_b16 a[16:17], v4 offset:36864
v_mfma_f32_16x16x32_bf16 v[48:51], a[4:7], v[216:219], v[48:51]
ds_read_b64_tr_b16 a[18:19], v4 offset:38912
v_mfma_f32_16x16x32_bf16 v[48:51], a[8:11], v[224:227], v[48:51]
ds_read_b64_tr_b16 a[20:21], v5 offset:36864
v_mfma_f32_16x16x32_bf16 v[52:55], a[8:11], v[228:231], v[52:55]
ds_read_b64_tr_b16 a[22:23], v5 offset:38912
buffer_load_dwordx4 v7, s[24:27], 0 offen lds
v_mfma_f32_16x16x32_bf16 v[52:55], a[4:7], v[220:223], v[52:55]
s_add_u32 m0, s47, 36864
ds_read_b64_tr_b16 a[24:25], v4 offset:45056
v_add_u32 v7, s42, v7
v_mfma_f32_16x16x32_bf16 v[52:55], a[0:3], v[212:215], v[52:55]
ds_read_b64_tr_b16 a[26:27], v4 offset:47104
v_add_u32 v4, 0x10000, v4
v_mfma_f32_16x16x32_bf16 v[56:59], a[0:3], a[208:211], v[56:59]
ds_read_b128 a[112:115], v16 offset:16384
v_mfma_f32_16x16x32_bf16 v[56:59], a[4:7], a[216:219], v[56:59]
ds_read_b128 a[128:131], v16 offset:17408
v_mfma_f32_16x16x32_bf16 v[56:59], a[8:11], a[224:227], v[56:59]
ds_read_b128 a[116:119], v16 offset:20480
v_mfma_f32_16x16x32_bf16 v[60:63], a[8:11], a[228:231], v[60:63]
ds_read_b128 a[132:135], v16 offset:21504
buffer_load_dwordx4 v7, s[24:27], 0 offen lds
v_mfma_f32_16x16x32_bf16 v[60:63], a[4:7], a[220:223], v[60:63]
s_add_u32 m0, s47, 40960
ds_read_b128 a[120:123], v17 offset:16384
v_add_u32 v7, 0x9000, v7
v_mfma_f32_16x16x32_bf16 v[60:63], a[0:3], a[212:215], v[60:63]
s_waitcnt lgkmcnt(5)
ds_read_b128 a[136:139], v17 offset:17408
v_mfma_f32_16x16x32_bf16 v[64:67], a[16:19], v[208:211], v[64:67]
ds_read_b64_tr_b16 a[0:1], v5 offset:40960
v_mfma_f32_16x16x32_bf16 v[64:67], a[20:23], v[216:219], v[64:67]
ds_read_b64_tr_b16 a[2:3], v5 offset:43008
v_add_u32 v5, 0x10000, v5
v_mfma_f32_16x16x32_bf16 v[64:67], a[24:27], v[224:227], v[64:67]
ds_read_b64_tr_b16 a[4:5], v4
v_mfma_f32_16x16x32_bf16 v[68:71], a[24:27], v[228:231], v[68:71]
ds_read_b64_tr_b16 a[6:7], v4 offset:2048
buffer_load_dwordx4 v7, s[24:27], 0 offen lds
v_mfma_f32_16x16x32_bf16 v[68:71], a[20:23], v[220:223], v[68:71]
s_add_u32 m0, s47, 45056
ds_read_b64_tr_b16 a[8:9], v5
v_add_u32 v7, s43, v7
v_mfma_f32_16x16x32_bf16 v[68:71], a[16:19], v[212:215], v[68:71]
ds_read_b64_tr_b16 a[10:11], v5 offset:2048
v_add_u32 v5, 0xffff0000, v5
v_mfma_f32_16x16x32_bf16 v[72:75], a[16:19], a[208:211], v[72:75]
ds_read_b128 a[124:127], v17 offset:20480
v_mfma_f32_16x16x32_bf16 v[72:75], a[20:23], a[216:219], v[72:75]
ds_read_b128 a[140:143], v17 offset:21504
v_mfma_f32_16x16x32_bf16 v[72:75], a[24:27], a[224:227], v[72:75]
ds_read_b128 a[144:147], v16 offset:49152
v_mfma_f32_16x16x32_bf16 v[76:79], a[24:27], a[228:231], v[76:79]
ds_read_b128 a[160:163], v16 offset:50176
buffer_load_dwordx4 v7, s[24:27], 0 offen lds
v_mfma_f32_16x16x32_bf16 v[76:79], a[20:23], a[220:223], v[76:79]
s_add_u32 m0, s47, 49152
ds_read_b128 a[148:151], v16 offset:53248
v_add_u32 v7, 0x9000, v7
v_mfma_f32_16x16x32_bf16 v[76:79], a[16:19], a[212:215], v[76:79]
s_waitcnt lgkmcnt(5)
ds_read_b128 a[164:167], v16 offset:54272
v_mfma_f32_16x16x32_bf16 v[48:51], a[0:3], v[232:235], v[48:51]
ds_read_b64_tr_b16 a[16:17], v5 offset:45056
v_mfma_f32_16x16x32_bf16 v[48:51], a[4:7], v[240:243], v[48:51]
ds_read_b64_tr_b16 a[18:19], v5 offset:47104
v_add_u32 v5, 0x10000, v5
v_mfma_f32_16x16x32_bf16 v[48:51], a[8:11], v[248:251], v[48:51]
ds_read_b64_tr_b16 a[20:21], v4 offset:4096
v_mfma_f32_16x16x32_bf16 v[52:55], a[8:11], v[252:255], v[52:55]
ds_read_b64_tr_b16 a[22:23], v4 offset:6144
buffer_load_dwordx4 v7, s[24:27], 0 offen lds
v_mfma_f32_16x16x32_bf16 v[52:55], a[4:7], v[244:247], v[52:55]
s_add_u32 m0, s47, 53248
ds_read_b64_tr_b16 a[24:25], v5 offset:4096
v_mfma_f32_16x16x32_bf16 v[52:55], a[0:3], v[236:239], v[52:55]
ds_read_b64_tr_b16 a[26:27], v5 offset:6144
v_mfma_f32_16x16x32_bf16 v[56:59], a[0:3], a[232:235], v[56:59]
ds_read_b128 a[152:155], v17 offset:49152
v_max_f32 v48, 0, v48
v_mfma_f32_16x16x32_bf16 v[56:59], a[4:7], a[240:243], v[56:59]
ds_read_b128 a[168:171], v17 offset:50176
v_max_f32 v49, 0, v49
v_mfma_f32_16x16x32_bf16 v[56:59], a[8:11], a[248:251], v[56:59]
ds_read_b128 a[156:159], v17 offset:53248
v_max_f32 v50, 0, v50
v_mfma_f32_16x16x32_bf16 v[60:63], a[8:11], a[252:255], v[60:63]
ds_read_b128 a[172:175], v17 offset:54272
buffer_load_dwordx4 v11, s[24:27], 0 offen lds
v_mfma_f32_16x16x32_bf16 v[60:63], a[4:7], a[244:247], v[60:63]
s_add_u32 m0, s47, 57344
v_add_u32 v7, s40, v7
v_max_f32 v51, 0, v51
v_mfma_f32_16x16x32_bf16 v[60:63], a[0:3], a[236:239], v[60:63]
s_waitcnt vmcnt(9) lgkmcnt(4)
v_max_f32 v52, 0, v52
v_max_f32 v53, 0, v53
v_mfma_f32_16x16x32_bf16 v[64:67], a[16:19], v[232:235], v[64:67]
s_barrier
ds_read_b64_tr_b16 a[0:1], v2 offset:8192
v_max_f32 v54, 0, v54
L_pad9:
s_cbranch_execz L_pad13
v_mfma_f32_16x16x32_bf16 v[64:67], a[20:23], v[240:243], v[64:67]
ds_read_b64_tr_b16 a[2:3], v2 offset:10240
v_max_f32 v55, 0, v55
v_mfma_f32_16x16x32_bf16 v[64:67], a[24:27], v[248:251], v[64:67]
ds_read_b64_tr_b16 a[4:5], v2 offset:12288
v_max_f32 v56, 0, v56
v_mfma_f32_16x16x32_bf16 v[68:71], a[24:27], v[252:255], v[68:71]
ds_read_b64_tr_b16 a[6:7], v2 offset:14336
buffer_load_dwordx4 v7, s[24:27], 0 offen lds
v_mfma_f32_16x16x32_bf16 v[68:71], a[20:23], v[244:247], v[68:71]
s_add_u32 m0, s47, 61440
ds_read_b64_tr_b16 a[8:9], v2 offset:16384
v_add_u32 v7, 0x9000, v7
v_mfma_f32_16x16x32_bf16 v[68:71], a[16:19], v[236:239], v[68:71]
ds_read_b64_tr_b16 a[10:11], v2 offset:18432
v_max_f32 v57, 0, v57
v_mfma_f32_16x16x32_bf16 v[72:75], a[16:19], a[232:235], v[72:75]
ds_read_b64_tr_b16 a[12:13], v2 offset:20480
v_max_f32 v58, 0, v58
v_mfma_f32_16x16x32_bf16 v[72:75], a[20:23], a[240:243], v[72:75]
ds_read_b64_tr_b16 a[14:15], v2 offset:22528
v_max_f32 v59, 0, v59
v_mfma_f32_16x16x32_bf16 v[72:75], a[24:27], a[248:251], v[72:75]
v_max_f32 v60, 0, v60
v_max_f32 v61, 0, v61
v_mfma_f32_16x16x32_bf16 v[76:79], a[24:27], a[252:255], v[76:79]
buffer_load_dwordx4 v7, s[24:27], 0 offen lds
v_mfma_f32_16x16x32_bf16 v[76:79], a[20:23], a[244:247], v[76:79]
s_add_u32 m0, s47, 65536
v_add_u32 v7, s41, v7
v_max_f32 v62, 0, v62
v_mfma_f32_16x16x32_bf16 v[76:79], a[16:19], a[236:239], v[76:79]
s_waitcnt lgkmcnt(0)
v_max_f32 v63, 0, v63
v_mul_f32 v48, v48, v64
v_mfma_f32_16x16x32_bf16 v[144:147], a[0:3], a[32:35], 0
ds_read_b64_tr_b16 a[16:17], v2 offset:24576
v_mul_f32 v49, v49, v65
v_mfma_f32_16x16x32_bf16 v[144:147], a[4:7], a[48:51], v[144:147]
ds_read_b64_tr_b16 a[18:19], v2 offset:26624
v_mul_f32 v50, v50, v66
v_mfma_f32_16x16x32_bf16 v[144:147], a[8:11], a[64:67], v[144:147]
s_lshl_b32 s4, s7, 15
ds_read_b64_tr_b16 a[20:21], v2 offset:28672
v_mul_f32 v51, v51, v67
v_mfma_f32_16x16x32_bf16 v[144:147], a[12:15], a[80:83], v[144:147]
s_add_u32 s5, s4, s56
ds_read_b64_tr_b16 a[22:23], v2 offset:30720
v_add_u32 v2, 0xfffe0000, v2
v_mfma_f32_16x16x32_bf16 v[148:151], a[12:15], a[84:87], 0
s_add_u32 s16, s28, s5
s_addc_u32 s17, s29, 0
ds_read_b64_tr_b16 a[24:25], v2
buffer_load_dwordx4 v7, s[24:27], 0 offen lds
v_mfma_f32_16x16x32_bf16 v[148:151], a[8:11], a[68:71], v[148:151]
s_add_u32 m0, s47, 69632
ds_read_b64_tr_b16 a[26:27], v2 offset:2048
v_add_u32 v7, 0x9000, v7
v_mfma_f32_16x16x32_bf16 v[148:151], a[4:7], a[52:55], v[148:151]
s_mul_i32 s58, s7, 0xffee0000
ds_read_b64_tr_b16 a[28:29], v2 offset:4096
v_cvt_pk_bf16_f32 v32, v48, v49
v_mfma_f32_16x16x32_bf16 v[148:151], a[0:3], a[36:39], v[148:151]
s_add_u32 s5, s5, s58
ds_read_b64_tr_b16 a[30:31], v2 offset:6144
v_cvt_pk_bf16_f32 v33, v50, v51
v_mfma_f32_16x16x32_bf16 v[152:155], a[0:3], a[40:43], 0
s_add_u32 s5, s5, 589824
v_mul_f32 v52, v52, v68
v_mul_f32 v53, v53, v69
v_mfma_f32_16x16x32_bf16 v[152:155], a[4:7], a[56:59], v[152:155]
s_add_u32 s20, s28, s5
s_addc_u32 s21, s29, 0
s_sub_u32 s5, 311296, s4
buffer_load_dwordx4 v7, s[24:27], 0 offen lds
v_mfma_f32_16x16x32_bf16 v[152:155], a[8:11], a[72:75], v[152:155]
s_add_u32 m0, s47, 73728
v_add_u32 v7, s42, v7
v_mul_f32 v54, v54, v70
v_mfma_f32_16x16x32_bf16 v[152:155], a[12:15], a[88:91], v[152:155]
s_sub_u32 s4, 49152, s4
v_mul_f32 v55, v55, v71
v_cvt_pk_bf16_f32 v34, v52, v53
v_mfma_f32_16x16x32_bf16 v[156:159], a[12:15], a[92:95], 0
s_mov_b32 s18, 1024
v_cvt_pk_bf16_f32 v35, v54, v55
v_mul_f32 v56, v56, v72
v_mfma_f32_16x16x32_bf16 v[156:159], a[8:11], a[76:79], v[156:159]
s_mov_b32 s22, 1024
v_mul_f32 v57, v57, v73
v_mul_f32 v58, v58, v74
v_mfma_f32_16x16x32_bf16 v[156:159], a[4:7], a[60:63], v[156:159]
s_mov_b64 s[12:13], s[28:29]
v_mul_f32 v59, v59, v75
v_cvt_pk_bf16_f32 v36, v56, v57
v_mfma_f32_16x16x32_bf16 v[156:159], a[0:3], a[44:47], v[156:159]
s_waitcnt lgkmcnt(0)
v_cvt_pk_bf16_f32 v37, v58, v59
v_mul_f32 v60, v60, v76
v_mfma_f32_16x16x32_bf16 v[144:147], a[16:19], a[112:115], v[144:147]
s_mov_b32 s14, 67108864
ds_read_b64_tr_b16 a[0:1], v3 offset:8192
v_mul_f32 v61, v61, v77
v_mfma_f32_16x16x32_bf16 v[144:147], a[20:23], a[128:131], v[144:147]
ds_read_b64_tr_b16 a[2:3], v3 offset:10240
v_mul_f32 v62, v62, v78
v_mfma_f32_16x16x32_bf16 v[144:147], a[24:27], a[144:147], v[144:147]
ds_read_b64_tr_b16 a[4:5], v3 offset:12288
v_mul_f32 v63, v63, v79
v_mfma_f32_16x16x32_bf16 v[144:147], a[28:31], a[160:163], v[144:147]
ds_read_b64_tr_b16 a[6:7], v3 offset:14336
v_cvt_pk_bf16_f32 v38, v60, v61
v_mfma_f32_16x16x32_bf16 v[148:151], a[28:31], a[164:167], v[148:151]
ds_read_b64_tr_b16 a[8:9], v3 offset:16384
v_cvt_pk_bf16_f32 v39, v62, v63
v_mfma_f32_16x16x32_bf16 v[148:151], a[24:27], a[148:151], v[148:151]
ds_read_b64_tr_b16 a[10:11], v3 offset:18432
v_mfma_f32_16x16x32_bf16 v[148:151], a[20:23], a[132:135], v[148:151]
ds_read_b64_tr_b16 a[12:13], v3 offset:20480
v_mfma_f32_16x16x32_bf16 v[148:151], a[16:19], a[116:119], v[148:151]
ds_read_b64_tr_b16 a[14:15], v3 offset:22528
v_mfma_f32_16x16x32_bf16 v[152:155], a[16:19], a[120:123], v[152:155]
ds_write_b64 v42, v[32:33] offset:12288
v_mfma_f32_16x16x32_bf16 v[152:155], a[20:23], a[136:139], v[152:155]
v_mfma_f32_16x16x32_bf16 v[152:155], a[24:27], a[152:155], v[152:155]
ds_write_b64 v42, v[34:35] offset:13312
v_mfma_f32_16x16x32_bf16 v[152:155], a[28:31], a[168:171], v[152:155]
v_mfma_f32_16x16x32_bf16 v[156:159], a[28:31], a[172:175], v[156:159]
ds_write_b64 v43, v[36:37] offset:12288
v_mfma_f32_16x16x32_bf16 v[156:159], a[24:27], a[156:159], v[156:159]
v_mfma_f32_16x16x32_bf16 v[156:159], a[20:23], a[140:143], v[156:159]
ds_write_b64 v43, v[38:39] offset:13312
v_mfma_f32_16x16x32_bf16 v[156:159], a[16:19], a[124:127], v[156:159]
s_waitcnt lgkmcnt(4)
buffer_load_dwordx4 v7, s[24:27], 0 offen lds
v_mfma_f32_16x16x32_bf16 v[160:163], a[0:3], a[32:35], 0
s_add_u32 m0, s47, 77824
ds_read_b64_tr_b16 a[16:17], v3 offset:24576
v_add_u32 v7, 0x9000, v7
v_mfma_f32_16x16x32_bf16 v[160:163], a[4:7], a[48:51], v[160:163]
ds_read_b64_tr_b16 a[18:19], v3 offset:26624
v_mfma_f32_16x16x32_bf16 v[160:163], a[8:11], a[64:67], v[160:163]
ds_read_b64_tr_b16 a[20:21], v3 offset:28672
v_mfma_f32_16x16x32_bf16 v[160:163], a[12:15], a[80:83], v[160:163]
ds_read_b64_tr_b16 a[22:23], v3 offset:30720
v_add_u32 v3, 0xfffe0000, v3
v_mfma_f32_16x16x32_bf16 v[164:167], a[12:15], a[84:87], 0
ds_read_b64_tr_b16 a[24:25], v3
buffer_load_dwordx4 v7, s[24:27], 0 offen lds
v_mfma_f32_16x16x32_bf16 v[164:167], a[8:11], a[68:71], v[164:167]
s_add_u32 m0, s47, 81920
ds_read_b64_tr_b16 a[26:27], v3 offset:2048
v_add_u32 v7, s43, v7
v_mfma_f32_16x16x32_bf16 v[164:167], a[4:7], a[52:55], v[164:167]
ds_read_b64_tr_b16 a[28:29], v3 offset:4096
v_mfma_f32_16x16x32_bf16 v[164:167], a[0:3], a[36:39], v[164:167]
ds_read_b64_tr_b16 a[30:31], v3 offset:6144
v_mfma_f32_16x16x32_bf16 v[168:171], a[0:3], a[40:43], 0
v_mfma_f32_16x16x32_bf16 v[168:171], a[4:7], a[56:59], v[168:171]
v_mfma_f32_16x16x32_bf16 v[168:171], a[8:11], a[72:75], v[168:171]
v_mfma_f32_16x16x32_bf16 v[168:171], a[12:15], a[88:91], v[168:171]
v_mfma_f32_16x16x32_bf16 v[172:175], a[12:15], a[92:95], 0
v_mfma_f32_16x16x32_bf16 v[172:175], a[8:11], a[76:79], v[172:175]
v_mfma_f32_16x16x32_bf16 v[172:175], a[4:7], a[60:63], v[172:175]
v_mfma_f32_16x16x32_bf16 v[172:175], a[0:3], a[44:47], v[172:175]
s_waitcnt vmcnt(6) lgkmcnt(0)
v_mfma_f32_16x16x32_bf16 v[160:163], a[16:19], a[112:115], v[160:163]
s_barrier
ds_read_b64_tr_b16 a[176:177], v2 offset:8192
ds_read_b128 a[96:99], v40 offset:12288
v_mfma_f32_16x16x32_bf16 v[160:163], a[20:23], a[128:131], v[160:163]
ds_read_b64_tr_b16 a[178:179], v2 offset:10240
ds_read_b128 a[100:103], v40 offset:13312
v_mfma_f32_16x16x32_bf16 v[160:163], a[24:27], a[144:147], v[160:163]
ds_read_b64_tr_b16 a[180:181], v3 offset:8192
ds_read_b128 a[104:107], v41 offset:12288
v_mfma_f32_16x16x32_bf16 v[160:163], a[28:31], a[160:163], v[160:163]
ds_read_b64_tr_b16 a[182:183], v3 offset:10240
ds_read_b128 a[108:111], v41 offset:13312
v_mfma_f32_16x16x32_bf16 v[164:167], a[28:31], a[164:167], v[164:167]
s_lshl_b32 s58, s70, 2
ds_read_b64_tr_b16 a[0:1], v2 offset:20480
buffer_load_dwordx4 v7, s[24:27], 0 offen lds
v_mfma_f32_16x16x32_bf16 v[164:167], a[24:27], a[148:151], v[164:167]
s_add_u32 m0, s47, 86016
ds_read_b64_tr_b16 a[2:3], v2 offset:22528
v_add_u32 v7, 0x9000, v7
v_mfma_f32_16x16x32_bf16 v[164:167], a[20:23], a[132:135], v[164:167]
s_lshr_b32 s59, s71, 3
s_add_u32 s58, s58, s59
ds_read_b64_tr_b16 a[4:5], v2 offset:24576
v_mfma_f32_16x16x32_bf16 v[164:167], a[16:19], a[116:119], v[164:167]
s_lshl_b32 s62, s58, 7
s_add_u32 s62, s62, 58724352
ds_read_b64_tr_b16 a[6:7], v2 offset:26624
v_mfma_f32_16x16x32_bf16 v[168:171], a[16:19], a[120:123], v[168:171]
s_lshr_b32 s53, s58, 1
ds_read_b64_tr_b16 a[8:9], v2 offset:28672
buffer_load_dwordx4 v7, s[24:27], 0 offen lds
v_mfma_f32_16x16x32_bf16 v[168:171], a[20:23], a[136:139], v[168:171]
s_add_u32 m0, s47, 89984
s_lshl_b32 s53, s53, 7
ds_read_b64_tr_b16 a[10:11], v2 offset:30720
v_mfma_f32_16x16x32_bf16 v[168:171], a[24:27], a[152:155], v[168:171]
s_add_u32 s53, s53, 58720256
s_add_u32 s54, s53, 2048
ds_read_b64_tr_b16 a[12:13], v2 offset:32768
v_mfma_f32_16x16x32_bf16 v[168:171], a[28:31], a[168:171], v[168:171]
s_lshl_b32 s58, s58, 2
s_add_u32 s55, s58, s44
ds_read_b64_tr_b16 a[14:15], v2 offset:34816
v_mfma_f32_16x16x32_bf16 v[172:175], a[28:31], a[172:175], v[172:175]
s_bfe_u32 s61, s71, 0x20001
s_and_b32 s100, s71, 1
s_and_b32 s101, s55, 1
v_mfma_f32_16x16x32_bf16 v[172:175], a[24:27], a[156:159], v[172:175]
s_and_b32 s56, s71, 7
s_lshl_b32 s56, s56, 7
s_lshl_b32 s57, s61, 5
v_mfma_f32_16x16x32_bf16 v[172:175], a[20:23], a[140:143], v[172:175]
s_add_u32 s57, s57, 1024
s_lshl_b32 s59, s100, 31
buffer_load_dwordx4 v11, s[24:27], 0 offen offset:128 lds
v_mfma_f32_16x16x32_bf16 v[172:175], a[16:19], a[124:127], v[172:175]
s_waitcnt lgkmcnt(8)
s_or_b32 s57, s57, s59
v_add_u32 v7, s40, v7
v_mfma_f32_16x16x32_bf16 v[144:147], a[176:179], a[96:99], v[144:147]
s_add_u32 m0, s47, 94208
s_lshl_b32 s67, s55, 14
s_add_u32 s67, s67, 54525952
v_mfma_f32_16x16x32_bf16 v[148:151], a[176:179], a[100:103], v[148:151]
s_lshr_b32 s68, s55, 1
s_mul_i32 s58, s68, 589824
s_add_u32 s58, s58, 12582912
v_mfma_f32_16x16x32_bf16 v[152:155], a[176:179], a[104:107], v[152:155]
v_add_u32 v6, s58, v10
v_mfma_f32_16x16x32_bf16 v[156:159], a[176:179], a[108:111], v[156:159]
s_lshl_b32 s68, s68, 12
s_lshl_b32 s58, s101, 6
s_add_u32 s68, s68, s58
v_mfma_f32_16x16x32_bf16 v[160:163], a[180:183], a[96:99], v[160:163]
s_add_u32 s68, s68, 56623104
s_mul_i32 s69, s55, 18432
buffer_load_dwordx4 v7, s[24:27], 0 offen lds
v_mfma_f32_16x16x32_bf16 v[164:167], a[180:183], a[100:103], v[164:167]
s_add_u32 m0, s47, 98304
s_lshl_b32 s58, s55, 6
v_add_u32 v7, 0x9000, v7
v_mfma_f32_16x16x32_bf16 v[168:171], a[180:183], a[104:107], v[168:171]
s_add_u32 s58, s58, 56885248
v_and_b32 v4, 15, v1
v_lshl_add_u32 v4, v4, 2, s58
v_mfma_f32_16x16x32_bf16 v[172:175], a[180:183], a[108:111], v[172:175]
s_waitcnt lgkmcnt(0)
s_lshl_b32 s60, s61, 14
s_or_b32 s60, s60, s59
v_mfma_f32_16x16x32_bf16 v[112:115], a[0:3], a[32:35], 0
s_lshl_b32 s59, s101, 9
ds_read_b64_tr_b16 a[176:177], v2 offset:36864
v_cvt_pk_bf16_f32 v176, v144, v145
v_mfma_f32_16x16x32_bf16 v[112:115], a[4:7], a[48:51], v[112:115]
s_add_u32 s60, s60, s59
ds_read_b64_tr_b16 a[178:179], v2 offset:38912
v_cvt_pk_bf16_f32 v177, v146, v147
v_mfma_f32_16x16x32_bf16 v[112:115], a[8:11], a[64:67], v[112:115]
ds_read_b64_tr_b16 a[180:181], v2 offset:40960
buffer_load_dwordx4 v7, s[24:27], 0 offen lds
v_mfma_f32_16x16x32_bf16 v[112:115], a[12:15], a[80:83], v[112:115]
s_add_u32 m0, s47, 102400
ds_read_b64_tr_b16 a[182:183], v2 offset:43008
v_add_u32 v7, s41, v7
v_mfma_f32_16x16x32_bf16 v[116:119], a[12:15], a[84:87], 0
ds_read_b64_tr_b16 a[184:185], v2 offset:45056
v_cvt_pk_bf16_f32 v178, v148, v149
v_mfma_f32_16x16x32_bf16 v[116:119], a[8:11], a[68:71], v[116:119]
ds_read_b64_tr_b16 a[186:187], v2 offset:47104
v_cvt_pk_bf16_f32 v179, v150, v151
v_mfma_f32_16x16x32_bf16 v[116:119], a[4:7], a[52:55], v[116:119]
ds_read_b64_tr_b16 a[188:189], v2 offset:49152
v_lshrrev_b32 v37, 5, v1
v_mfma_f32_16x16x32_bf16 v[116:119], a[0:3], a[36:39], v[116:119]
ds_read_b64_tr_b16 a[190:191], v2 offset:51200
v_mul_u32_u24 v37, 504, v37
v_mfma_f32_16x16x32_bf16 v[120:123], a[0:3], a[40:43], 0
ds_read_b64_tr_b16 a[192:193], v2 offset:53248
buffer_load_dwordx4 v7, s[24:27], 0 offen lds
v_mfma_f32_16x16x32_bf16 v[120:123], a[4:7], a[56:59], v[120:123]
s_add_u32 m0, s47, 106496
ds_read_b64_tr_b16 a[194:195], v2 offset:55296
v_add_u32 v7, 0x9000, v7
v_mfma_f32_16x16x32_bf16 v[120:123], a[8:11], a[72:75], v[120:123]
v_permlane32_swap_b32 v176, v178
v_mfma_f32_16x16x32_bf16 v[120:123], a[12:15], a[88:91], v[120:123]
v_permlane32_swap_b32 v177, v179
v_mfma_f32_16x16x32_bf16 v[124:127], a[12:15], a[92:95], 0
v_cvt_pk_bf16_f32 v184, v152, v153
v_cvt_pk_bf16_f32 v185, v154, v155
v_mfma_f32_16x16x32_bf16 v[124:127], a[8:11], a[76:79], v[124:127]
v_cvt_pk_bf16_f32 v186, v156, v157
v_cvt_pk_bf16_f32 v187, v158, v159
v_mfma_f32_16x16x32_bf16 v[124:127], a[4:7], a[60:63], v[124:127]
buffer_load_dwordx4 v7, s[24:27], 0 offen lds
v_mfma_f32_16x16x32_bf16 v[124:127], a[0:3], a[44:47], v[124:127]
s_waitcnt lgkmcnt(0)
v_add_u32 v7, s42, v7
v_sub_u32 v37, v6, v37
v_mfma_f32_16x16x32_bf16 v[112:115], a[176:179], a[112:115], v[112:115]
s_add_u32 m0, s47, 110592
ds_read_b64_tr_b16 a[0:1], v3 offset:20480
v_add_u32 v37, s60, v37
v_mfma_f32_16x16x32_bf16 v[112:115], a[180:183], a[128:131], v[112:115]
s_lshr_b32 s58, s56, 6
s_add_u32 s58, s58, s101
ds_read_b64_tr_b16 a[2:3], v3 offset:22528
v_mfma_f32_16x16x32_bf16 v[112:115], a[184:187], a[144:147], v[112:115]
s_add_u32 s58, s58, 4
s_lshl_b32 s58, s58, 14
ds_read_b64_tr_b16 a[4:5], v3 offset:24576
v_mfma_f32_16x16x32_bf16 v[112:115], a[188:191], a[160:163], v[112:115]
ds_read_b64_tr_b16 a[6:7], v3 offset:26624
v_add_u32 v36, s58, v6
v_mfma_f32_16x16x32_bf16 v[112:115], a[192:195], a[96:99], v[112:115]
ds_read_b64_tr_b16 a[8:9], v3 offset:28672
buffer_load_dwordx4 v7, s[24:27], 0 offen lds
v_mfma_f32_16x16x32_bf16 v[116:119], a[192:195], a[100:103], v[116:119]
s_add_u32 m0, s47, 114688
ds_read_b64_tr_b16 a[10:11], v3 offset:30720
v_add_u32 v7, 0x9000, v7
v_mfma_f32_16x16x32_bf16 v[116:119], a[188:191], a[164:167], v[116:119]
ds_read_b64_tr_b16 a[12:13], v3 offset:32768
v_add_u32 v38, 0x40000, v36
v_mfma_f32_16x16x32_bf16 v[116:119], a[184:187], a[148:151], v[116:119]
ds_read_b64_tr_b16 a[14:15], v3 offset:34816
v_lshrrev_b32 v44, 3, v1
v_mfma_f32_16x16x32_bf16 v[116:119], a[180:183], a[132:135], v[116:119]
v_permlane32_swap_b32 v184, v186
v_mfma_f32_16x16x32_bf16 v[116:119], a[176:179], a[116:119], v[116:119]
v_permlane32_swap_b32 v185, v187
v_mfma_f32_16x16x32_bf16 v[120:123], a[176:179], a[120:123], v[120:123]
buffer_load_dwordx4 v7, s[24:27], 0 offen lds
v_mfma_f32_16x16x32_bf16 v[120:123], a[180:183], a[136:139], v[120:123]
s_add_u32 m0, s47, 118784
v_add_u32 v7, s43, v7
v_cvt_pk_bf16_f32 v180, v160, v161
v_mfma_f32_16x16x32_bf16 v[120:123], a[184:187], a[152:155], v[120:123]
v_cvt_pk_bf16_f32 v181, v162, v163
v_cvt_pk_bf16_f32 v182, v164, v165
v_mfma_f32_16x16x32_bf16 v[120:123], a[188:191], a[168:171], v[120:123]
v_cvt_pk_bf16_f32 v183, v166, v167
v_and_b32 v45, 7, v1
v_mfma_f32_16x16x32_bf16 v[120:123], a[192:195], a[104:107], v[120:123]
v_permlane32_swap_b32 v180, v182
v_mfma_f32_16x16x32_bf16 v[124:127], a[192:195], a[108:111], v[124:127]
v_permlane32_swap_b32 v181, v183
v_mfma_f32_16x16x32_bf16 v[124:127], a[188:191], a[172:175], v[124:127]
buffer_load_dwordx4 v7, s[24:27], 0 offen lds
v_mfma_f32_16x16x32_bf16 v[124:127], a[184:187], a[156:159], v[124:127]
s_add_u32 m0, s47, 122880
v_add_u32 v7, 0x9000, v7
v_cvt_pk_bf16_f32 v188, v168, v169
v_mfma_f32_16x16x32_bf16 v[124:127], a[180:183], a[140:143], v[124:127]
v_cvt_pk_bf16_f32 v189, v170, v171
v_cvt_pk_bf16_f32 v190, v172, v173
v_mfma_f32_16x16x32_bf16 v[124:127], a[176:179], a[124:127], v[124:127]
s_waitcnt lgkmcnt(0)
v_cvt_pk_bf16_f32 v191, v174, v175
v_and_b32 v46, 6, v44
v_mfma_f32_16x16x32_bf16 v[128:131], a[0:3], a[32:35], 0
ds_read_b64_tr_b16 a[176:177], v3 offset:36864
v_xor_b32 v45, v45, v46
v_mfma_f32_16x16x32_bf16 v[128:131], a[4:7], a[48:51], v[128:131]
s_and_b32 s58, s44, 1
s_lshr_b32 s60, s44, 1
ds_read_b64_tr_b16 a[178:179], v3 offset:38912
v_mfma_f32_16x16x32_bf16 v[128:131], a[8:11], a[64:67], v[128:131]
s_mul_i32 s59, s58, 20
ds_read_b64_tr_b16 a[180:181], v3 offset:40960
buffer_load_dwordx4 v7, s[24:27], 0 offen lds
v_mfma_f32_16x16x32_bf16 v[128:131], a[12:15], a[80:83], v[128:131]
s_add_u32 m0, s47, 126720
s_lshl_b32 s61, s60, 3
ds_read_b64_tr_b16 a[182:183], v3 offset:43008
v_mfma_f32_16x16x32_bf16 v[132:135], a[12:15], a[84:87], 0
s_add_u32 s59, s59, s61
ds_read_b64_tr_b16 a[184:185], v3 offset:45056
v_add_u32 v46, s59, v44
v_mfma_f32_16x16x32_bf16 v[132:135], a[8:11], a[68:71], v[132:135]
ds_read_b64_tr_b16 a[186:187], v3 offset:47104
v_mul_u32_u24 v46, 1152, v46
v_mfma_f32_16x16x32_bf16 v[132:135], a[4:7], a[52:55], v[132:135]
s_mul_i32 s59, s58, 144
s_mul_i32 s61, s60, 36
ds_read_b64_tr_b16 a[188:189], v3 offset:49152
v_mfma_f32_16x16x32_bf16 v[132:135], a[0:3], a[36:39], v[132:135]
s_add_u32 s59, s59, s61
s_add_u32 s59, s59, 16
ds_read_b64_tr_b16 a[190:191], v3 offset:51200
v_mfma_f32_16x16x32_bf16 v[136:139], a[0:3], a[40:43], 0
ds_read_b64_tr_b16 a[192:193], v3 offset:53248
buffer_load_dwordx4 v11, s[24:27], 0 offen offset:256 lds
v_mfma_f32_16x16x32_bf16 v[136:139], a[4:7], a[56:59], v[136:139]
s_add_u32 m0, s47, 131072
ds_read_b64_tr_b16 a[194:195], v3 offset:55296
v_add_u32 v7, s40, v7
v_mfma_f32_16x16x32_bf16 v[136:139], a[8:11], a[72:75], v[136:139]
v_permlane32_swap_b32 v188, v190
v_mfma_f32_16x16x32_bf16 v[136:139], a[12:15], a[88:91], v[136:139]
v_permlane32_swap_b32 v189, v191
v_mfma_f32_16x16x32_bf16 v[140:143], a[12:15], a[92:95], 0
buffer_store_dwordx4 v[176:179], v10, s[16:19], 0 offen sc1
v_mfma_f32_16x16x32_bf16 v[140:143], a[8:11], a[76:79], v[140:143]
v_cvt_pk_bf16_f32 v192, v112, v113
v_cvt_pk_bf16_f32 v193, v114, v115
v_mfma_f32_16x16x32_bf16 v[140:143], a[4:7], a[60:63], v[140:143]
buffer_load_dwordx4 v7, s[24:27], 0 offen lds
v_mfma_f32_16x16x32_bf16 v[140:143], a[0:3], a[44:47], v[140:143]
s_waitcnt vmcnt(11) lgkmcnt(0)
v_add_u32 v7, 0x9000, v7
v_cvt_pk_bf16_f32 v196, v116, v117
v_mfma_f32_16x16x32_bf16 v[128:131], a[176:179], a[112:115], v[128:131]
s_barrier
ds_read_b64_tr_b16 a[0:1], v2 offset:57344
v_cvt_pk_bf16_f32 v197, v118, v119
v_mfma_f32_16x16x32_bf16 v[128:131], a[180:183], a[128:131], v[128:131]
s_add_u32 m0, s47, 135168
ds_read_b64_tr_b16 a[2:3], v2 offset:59392
v_cvt_pk_bf16_f32 v80, v120, v121
v_mfma_f32_16x16x32_bf16 v[128:131], a[184:187], a[144:147], v[128:131]
ds_read_b64_tr_b16 a[4:5], v2 offset:61440
v_cvt_pk_bf16_f32 v81, v122, v123
v_mfma_f32_16x16x32_bf16 v[128:131], a[188:191], a[160:163], v[128:131]
ds_read_b64_tr_b16 a[6:7], v2 offset:63488
v_add_u32 v2, 0x10000, v2
v_mfma_f32_16x16x32_bf16 v[128:131], a[192:195], a[96:99], v[128:131]
ds_read_b64_tr_b16 a[8:9], v2
buffer_load_dwordx4 v7, s[24:27], 0 offen lds
v_mfma_f32_16x16x32_bf16 v[132:135], a[192:195], a[100:103], v[132:135]
s_add_u32 m0, s47, 139264
ds_read_b64_tr_b16 a[10:11], v2 offset:2048
v_add_u32 v7, s41, v7
v_mfma_f32_16x16x32_bf16 v[132:135], a[188:191], a[164:167], v[132:135]
ds_read_b64_tr_b16 a[12:13], v2 offset:4096
v_cvt_pk_bf16_f32 v84, v124, v125
v_mfma_f32_16x16x32_bf16 v[132:135], a[184:187], a[148:151], v[132:135]
ds_read_b64_tr_b16 a[14:15], v2 offset:6144
v_cvt_pk_bf16_f32 v85, v126, v127
v_mfma_f32_16x16x32_bf16 v[132:135], a[180:183], a[132:135], v[132:135]
v_lshrrev_b32 v47, 2, v44
v_mul_u32_u24 v47, 68, v47
v_mfma_f32_16x16x32_bf16 v[132:135], a[176:179], a[116:119], v[132:135]
v_add3_u32 v47, v47, v44, s59
v_mul_u32_u24 v47, 1152, v47
v_mfma_f32_16x16x32_bf16 v[136:139], a[176:179], a[120:123], v[136:139]
buffer_load_dwordx4 v7, s[24:27], 0 offen lds
v_mfma_f32_16x16x32_bf16 v[136:139], a[180:183], a[136:139], v[136:139]
s_add_u32 m0, s47, 143360
v_add_u32 v7, 0x9000, v7
v_lshl_add_u32 v6, v45, 4, s56
v_mfma_f32_16x16x32_bf16 v[136:139], a[184:187], a[152:155], v[136:139]
v_cvt_pk_bf16_f32 v194, v128, v129
v_cvt_pk_bf16_f32 v195, v130, v131
v_mfma_f32_16x16x32_bf16 v[136:139], a[188:191], a[168:171], v[136:139]
v_add_u32 v32, v6, v46
v_add_u32 v33, v6, v47
v_mfma_f32_16x16x32_bf16 v[136:139], a[192:195], a[104:107], v[136:139]
v_and_b32 v6, 1, v45
v_lshl_add_u32 v6, v6, 4, s57
v_mfma_f32_16x16x32_bf16 v[140:143], a[192:195], a[108:111], v[140:143]
v_lshrrev_b32 v44, 1, v45
v_mul_u32_u24 v44, 41472, v44
v_mfma_f32_16x16x32_bf16 v[140:143], a[188:191], a[172:175], v[140:143]
buffer_load_dwordx4 v7, s[24:27], 0 offen lds
v_mfma_f32_16x16x32_bf16 v[140:143], a[184:187], a[156:159], v[140:143]
s_add_u32 m0, s47, 147456
v_add_u32 v7, s42, v7
v_cvt_pk_bf16_f32 v198, v132, v133
v_mfma_f32_16x16x32_bf16 v[140:143], a[180:183], a[140:143], v[140:143]
v_cvt_pk_bf16_f32 v199, v134, v135
v_add3_u32 v34, v6, v46, v44
v_mfma_f32_16x16x32_bf16 v[140:143], a[176:179], a[124:127], v[140:143]
s_waitcnt lgkmcnt(0)
v_lshlrev_b32 v44, 3, v44
v_add3_u32 v35, v6, v47, v44
v_mfma_f32_16x16x32_bf16 v[112:115], a[0:3], a[32:35], 0
ds_read_b64_tr_b16 a[176:177], v2 offset:8192
v_and_b32 v44, 15, v1
v_mfma_f32_16x16x32_bf16 v[112:115], a[4:7], a[48:51], v[112:115]
ds_read_b64_tr_b16 a[178:179], v2 offset:10240
v_lshrrev_b32 v45, 4, v1
v_mfma_f32_16x16x32_bf16 v[112:115], a[8:11], a[64:67], v[112:115]
ds_read_b64_tr_b16 a[180:181], v2 offset:12288
buffer_load_dwordx4 v7, s[24:27], 0 offen lds
v_mfma_f32_16x16x32_bf16 v[112:115], a[12:15], a[80:83], v[112:115]
s_add_u32 m0, s47, 151552
ds_read_b64_tr_b16 a[182:183], v2 offset:14336
v_add_u32 v7, 0x9000, v7
v_mfma_f32_16x16x32_bf16 v[116:119], a[12:15], a[84:87], 0
ds_read_b64_tr_b16 a[184:185], v2 offset:16384
v_cvt_pk_bf16_f32 v82, v136, v137
v_mfma_f32_16x16x32_bf16 v[116:119], a[8:11], a[68:71], v[116:119]
ds_read_b64_tr_b16 a[186:187], v2 offset:18432
v_cvt_pk_bf16_f32 v83, v138, v139
v_mfma_f32_16x16x32_bf16 v[116:119], a[4:7], a[52:55], v[116:119]
ds_read_b64_tr_b16 a[188:189], v2 offset:20480
v_lshlrev_b32 v46, 2, v44
v_mfma_f32_16x16x32_bf16 v[116:119], a[0:3], a[36:39], v[116:119]
ds_read_b64_tr_b16 a[190:191], v2 offset:22528
v_cvt_pk_bf16_f32 v86, v140, v141
v_mfma_f32_16x16x32_bf16 v[120:123], a[0:3], a[40:43], 0
ds_read_b64_tr_b16 a[192:193], v2 offset:24576
buffer_load_dwordx4 v7, s[24:27], 0 offen lds
v_mfma_f32_16x16x32_bf16 v[120:123], a[4:7], a[56:59], v[120:123]
s_add_u32 m0, s47, 155648
ds_read_b64_tr_b16 a[194:195], v2 offset:26624
v_add_u32 v7, s43, v7
v_mfma_f32_16x16x32_bf16 v[120:123], a[8:11], a[72:75], v[120:123]
v_cvt_pk_bf16_f32 v87, v142, v143
v_lshl_add_u32 v39, v45, 9, v46
v_mfma_f32_16x16x32_bf16 v[120:123], a[12:15], a[88:91], v[120:123]
v_mul_u32_u24 v46, 1152, v44
v_lshl_add_u32 v46, v45, 3, v46
v_mfma_f32_16x16x32_bf16 v[124:127], a[12:15], a[92:95], 0
s_lshl_b32 s60, s60, 6
s_add_u32 s58, s56, s60
buffer_load_dwordx4 v[12:15], v10, s[28:31], s51 offen sc1
v_mfma_f32_16x16x32_bf16 v[124:127], a[8:11], a[76:79], v[124:127]
v_add_u32 v40, s58, v46
v_mfma_f32_16x16x32_bf16 v[124:127], a[4:7], a[60:63], v[124:127]
s_xor_b32 s58, s58, 64
buffer_load_dwordx4 v7, s[24:27], 0 offen lds
v_mfma_f32_16x16x32_bf16 v[124:127], a[0:3], a[44:47], v[124:127]
s_waitcnt lgkmcnt(0)
v_add_u32 v7, 0x9000, v7
v_add_u32 v5, s58, v46
v_mfma_f32_16x16x32_bf16 v[112:115], a[176:179], a[112:115], v[112:115]
s_add_u32 m0, s47, 159744
ds_read_b64_tr_b16 a[0:1], v3 offset:57344
v_add_u32 v41, s57, v46
v_mfma_f32_16x16x32_bf16 v[112:115], a[180:183], a[128:131], v[112:115]
ds_read_b64_tr_b16 a[2:3], v3 offset:59392
v_lshlrev_b32 v44, 4, v44
v_mfma_f32_16x16x32_bf16 v[112:115], a[184:187], a[144:147], v[112:115]
ds_read_b64_tr_b16 a[4:5], v3 offset:61440
v_and_b32 v45, 1, v45
v_mfma_f32_16x16x32_bf16 v[112:115], a[188:191], a[160:163], v[112:115]
ds_read_b64_tr_b16 a[6:7], v3 offset:63488
v_add_u32 v3, 0x10000, v3
v_mfma_f32_16x16x32_bf16 v[112:115], a[192:195], a[96:99], v[112:115]
ds_read_b64_tr_b16 a[8:9], v3
buffer_load_dwordx4 v7, s[24:27], 0 offen lds
v_mfma_f32_16x16x32_bf16 v[116:119], a[192:195], a[100:103], v[116:119]
s_add_u32 m0, s47, 0
ds_read_b64_tr_b16 a[10:11], v3 offset:2048
v_add_u32 v11, 0x180, v11
v_mfma_f32_16x16x32_bf16 v[116:119], a[188:191], a[164:167], v[116:119]
s_add_u32 s16, s16, 16384
s_addc_u32 s17, s17, 0
ds_read_b64_tr_b16 a[12:13], v3 offset:4096
v_lshl_add_u32 v44, v45, 14, v44
v_mfma_f32_16x16x32_bf16 v[116:119], a[184:187], a[148:151], v[116:119]
ds_read_b64_tr_b16 a[14:15], v3 offset:6144
v_lshrrev_b32 v45, 5, v1
v_mfma_f32_16x16x32_bf16 v[116:119], a[180:183], a[132:135], v[116:119]
buffer_load_dwordx4 v[16:19], v10, s[28:31], s51 offen offset:2432 sc1
v_mfma_f32_16x16x32_bf16 v[116:119], a[176:179], a[116:119], v[116:119]
v_lshl_add_u32 v42, v45, 8, v44
v_and_b32 v46, 31, v1
v_mfma_f32_16x16x32_bf16 v[120:123], a[176:179], a[120:123], v[120:123]
buffer_load_dwordx4 v11, s[24:27], 0 offen lds
v_mfma_f32_16x16x32_bf16 v[120:123], a[180:183], a[136:139], v[120:123]
s_add_u32 m0, s47, 4096
v_add_u32 v7, s40, v7
v_lshlrev_b32 v46, 2, v46
v_mfma_f32_16x16x32_bf16 v[120:123], a[184:187], a[152:155], v[120:123]
buffer_store_dwordx4 v[180:183], v10, s[16:19], 0 offen sc1
v_mfma_f32_16x16x32_bf16 v[120:123], a[188:191], a[168:171], v[120:123]
v_cvt_pk_bf16_f32 v200, v112, v113
v_cvt_pk_bf16_f32 v201, v114, v115
v_mfma_f32_16x16x32_bf16 v[120:123], a[192:195], a[104:107], v[120:123]
L_pad10:
s_cbranch_execz L_pad14
v_lshl_add_u32 v43, v45, 12, v46
v_cmp_eq_u32 vcc, 0, v1
v_mfma_f32_16x16x32_bf16 v[124:127], a[192:195], a[108:111], v[124:127]
v_mov_b32 v44, 2147483648
v_mov_b32 v45, 0
v_mfma_f32_16x16x32_bf16 v[124:127], a[188:191], a[172:175], v[124:127]
buffer_load_dwordx4 v7, s[24:27], 0 offen lds
v_mfma_f32_16x16x32_bf16 v[124:127], a[184:187], a[156:159], v[124:127]
s_add_u32 m0, s47, 8192
v_add_u32 v7, 0x9000, v7
v_cvt_pk_bf16_f32 v204, v116, v117
v_mfma_f32_16x16x32_bf16 v[124:127], a[180:183], a[140:143], v[124:127]
v_cvt_pk_bf16_f32 v205, v118, v119
v_cndmask_b32 v9, v44, v45, vcc
v_mfma_f32_16x16x32_bf16 v[124:127], a[176:179], a[124:127], v[124:127]
s_waitcnt lgkmcnt(0)
v_mfma_f32_16x16x32_bf16 v[128:131], a[0:3], a[32:35], 0
ds_read_b64_tr_b16 a[176:177], v3 offset:8192
buffer_load_dword v20, v23, s[28:31], s51 offen sc1
v_mfma_f32_16x16x32_bf16 v[128:131], a[4:7], a[48:51], v[128:131]
ds_read_b64_tr_b16 a[178:179], v3 offset:10240
v_mfma_f32_16x16x32_bf16 v[128:131], a[8:11], a[64:67], v[128:131]
ds_read_b64_tr_b16 a[180:181], v3 offset:12288
buffer_load_dwordx4 v7, s[24:27], 0 offen lds
v_mfma_f32_16x16x32_bf16 v[128:131], a[12:15], a[80:83], v[128:131]
s_add_u32 m0, s47, 12288
ds_read_b64_tr_b16 a[182:183], v3 offset:14336
v_add_u32 v7, s41, v7
v_mfma_f32_16x16x32_bf16 v[132:135], a[12:15], a[84:87], 0
ds_read_b64_tr_b16 a[184:185], v3 offset:16384
v_cvt_pk_bf16_f32 v88, v120, v121
v_mfma_f32_16x16x32_bf16 v[132:135], a[8:11], a[68:71], v[132:135]
ds_read_b64_tr_b16 a[186:187], v3 offset:18432
v_cvt_pk_bf16_f32 v89, v122, v123
v_mfma_f32_16x16x32_bf16 v[132:135], a[4:7], a[52:55], v[132:135]
ds_read_b64_tr_b16 a[188:189], v3 offset:20480
v_mfma_f32_16x16x32_bf16 v[132:135], a[0:3], a[36:39], v[132:135]
ds_read_b64_tr_b16 a[190:191], v3 offset:22528
v_cvt_pk_bf16_f32 v92, v124, v125
v_mfma_f32_16x16x32_bf16 v[136:139], a[0:3], a[40:43], 0
ds_read_b64_tr_b16 a[192:193], v3 offset:24576
buffer_load_dwordx4 v7, s[24:27], 0 offen lds
v_mfma_f32_16x16x32_bf16 v[136:139], a[4:7], a[56:59], v[136:139]
s_add_u32 m0, s47, 16384
ds_read_b64_tr_b16 a[194:195], v3 offset:26624
v_add_u32 v7, 0x9000, v7
v_mfma_f32_16x16x32_bf16 v[136:139], a[8:11], a[72:75], v[136:139]
v_cvt_pk_bf16_f32 v93, v126, v127
v_mfma_f32_16x16x32_bf16 v[136:139], a[12:15], a[88:91], v[136:139]
v_mfma_f32_16x16x32_bf16 v[140:143], a[12:15], a[92:95], 0
v_mfma_f32_16x16x32_bf16 v[140:143], a[8:11], a[76:79], v[140:143]
v_mfma_f32_16x16x32_bf16 v[140:143], a[4:7], a[60:63], v[140:143]
buffer_load_dwordx4 v7, s[24:27], 0 offen lds
v_mfma_f32_16x16x32_bf16 v[140:143], a[0:3], a[44:47], v[140:143]
s_waitcnt vmcnt(18) lgkmcnt(0)
v_add_u32 v7, s42, v7
v_mfma_f32_16x16x32_bf16 v[128:131], a[176:179], a[112:115], v[128:131]
s_barrier
ds_read_b64_tr_b16 a[0:1], v2 offset:28672
v_mfma_f32_16x16x32_bf16 v[128:131], a[180:183], a[128:131], v[128:131]
s_add_u32 m0, s47, 20480
ds_read_b64_tr_b16 a[2:3], v2 offset:30720
v_mfma_f32_16x16x32_bf16 v[128:131], a[184:187], a[144:147], v[128:131]
ds_read_b64_tr_b16 a[4:5], v2 offset:32768
v_mfma_f32_16x16x32_bf16 v[128:131], a[188:191], a[160:163], v[128:131]
ds_read_b64_tr_b16 a[6:7], v2 offset:34816
v_mfma_f32_16x16x32_bf16 v[128:131], a[192:195], a[96:99], v[128:131]
ds_read_b64_tr_b16 a[8:9], v2 offset:36864
buffer_load_dwordx4 v7, s[24:27], 0 offen lds
v_mfma_f32_16x16x32_bf16 v[132:135], a[192:195], a[100:103], v[132:135]
s_add_u32 m0, s47, 24576
ds_read_b64_tr_b16 a[10:11], v2 offset:38912
v_add_u32 v7, 0x9000, v7
v_mfma_f32_16x16x32_bf16 v[132:135], a[188:191], a[164:167], v[132:135]
ds_read_b64_tr_b16 a[12:13], v2 offset:40960
v_mfma_f32_16x16x32_bf16 v[132:135], a[184:187], a[148:151], v[132:135]
ds_read_b64_tr_b16 a[14:15], v2 offset:43008
v_mfma_f32_16x16x32_bf16 v[132:135], a[180:183], a[132:135], v[132:135]
v_mfma_f32_16x16x32_bf16 v[132:135], a[176:179], a[116:119], v[132:135]
v_mfma_f32_16x16x32_bf16 v[136:139], a[176:179], a[120:123], v[136:139]
buffer_load_dwordx4 v7, s[24:27], 0 offen lds
v_mfma_f32_16x16x32_bf16 v[136:139], a[180:183], a[136:139], v[136:139]
s_add_u32 m0, s47, 28672
v_add_u32 v7, s43, v7
v_mfma_f32_16x16x32_bf16 v[136:139], a[184:187], a[152:155], v[136:139]
v_cvt_pk_bf16_f32 v202, v128, v129
v_cvt_pk_bf16_f32 v203, v130, v131
v_mfma_f32_16x16x32_bf16 v[136:139], a[188:191], a[168:171], v[136:139]
v_mfma_f32_16x16x32_bf16 v[136:139], a[192:195], a[104:107], v[136:139]
v_mfma_f32_16x16x32_bf16 v[140:143], a[192:195], a[108:111], v[140:143]
v_mfma_f32_16x16x32_bf16 v[140:143], a[188:191], a[172:175], v[140:143]
buffer_load_dwordx4 v7, s[24:27], 0 offen lds
v_mfma_f32_16x16x32_bf16 v[140:143], a[184:187], a[156:159], v[140:143]
s_add_u32 m0, s47, 32768
v_add_u32 v7, 0x9000, v7
v_cvt_pk_bf16_f32 v206, v132, v133
v_mfma_f32_16x16x32_bf16 v[140:143], a[180:183], a[140:143], v[140:143]
v_cvt_pk_bf16_f32 v207, v134, v135
v_mfma_f32_16x16x32_bf16 v[140:143], a[176:179], a[124:127], v[140:143]
s_waitcnt lgkmcnt(0)
v_mfma_f32_16x16x32_bf16 v[112:115], a[0:3], a[32:35], 0
ds_read_b64_tr_b16 a[176:177], v2 offset:45056
v_mfma_f32_16x16x32_bf16 v[112:115], a[4:7], a[48:51], v[112:115]
ds_read_b64_tr_b16 a[178:179], v2 offset:47104
v_mfma_f32_16x16x32_bf16 v[112:115], a[8:11], a[64:67], v[112:115]
ds_read_b64_tr_b16 a[180:181], v2 offset:49152
buffer_load_dwordx4 v7, s[24:27], 0 offen lds
v_mfma_f32_16x16x32_bf16 v[112:115], a[12:15], a[80:83], v[112:115]
s_add_u32 m0, s47, 36736
ds_read_b64_tr_b16 a[182:183], v2 offset:51200
v_cvt_pk_bf16_f32 v90, v136, v137
v_mfma_f32_16x16x32_bf16 v[116:119], a[12:15], a[84:87], 0
ds_read_b64_tr_b16 a[184:185], v2 offset:53248
v_cvt_pk_bf16_f32 v91, v138, v139
v_mfma_f32_16x16x32_bf16 v[116:119], a[8:11], a[68:71], v[116:119]
ds_read_b64_tr_b16 a[186:187], v2 offset:55296
v_mfma_f32_16x16x32_bf16 v[116:119], a[4:7], a[52:55], v[116:119]
ds_read_b64_tr_b16 a[188:189], v2 offset:57344
v_mfma_f32_16x16x32_bf16 v[116:119], a[0:3], a[36:39], v[116:119]
ds_read_b64_tr_b16 a[190:191], v2 offset:59392
v_cvt_pk_bf16_f32 v94, v140, v141
v_mfma_f32_16x16x32_bf16 v[120:123], a[0:3], a[40:43], 0
ds_read_b64_tr_b16 a[192:193], v2 offset:61440
buffer_load_dwordx4 v11, s[24:27], 0 offen offset:128 lds
v_mfma_f32_16x16x32_bf16 v[120:123], a[4:7], a[56:59], v[120:123]
s_add_u32 m0, s47, 40960
ds_read_b64_tr_b16 a[194:195], v2 offset:63488
v_add_u32 v2, 0x10000, v2
v_mfma_f32_16x16x32_bf16 v[120:123], a[8:11], a[72:75], v[120:123]
v_add_u32 v7, s40, v7
v_cvt_pk_bf16_f32 v95, v142, v143
v_mfma_f32_16x16x32_bf16 v[120:123], a[12:15], a[88:91], v[120:123]
buffer_store_dwordx4 v[184:187], v10, s[20:23], 0 offen sc1
v_mfma_f32_16x16x32_bf16 v[124:127], a[12:15], a[92:95], 0
v_mfma_f32_16x16x32_bf16 v[124:127], a[8:11], a[76:79], v[124:127]
v_mfma_f32_16x16x32_bf16 v[124:127], a[4:7], a[60:63], v[124:127]
buffer_load_dwordx4 v7, s[24:27], 0 offen lds
v_mfma_f32_16x16x32_bf16 v[124:127], a[0:3], a[44:47], v[124:127]
s_waitcnt lgkmcnt(0)
v_add_u32 v7, 0x9000, v7
v_mfma_f32_16x16x32_bf16 v[112:115], a[176:179], a[112:115], v[112:115]
s_add_u32 m0, s47, 45056
ds_read_b64_tr_b16 a[0:1], v3 offset:28672
v_mfma_f32_16x16x32_bf16 v[112:115], a[180:183], a[128:131], v[112:115]
ds_read_b64_tr_b16 a[2:3], v3 offset:30720
v_mfma_f32_16x16x32_bf16 v[112:115], a[184:187], a[144:147], v[112:115]
ds_read_b64_tr_b16 a[4:5], v3 offset:32768
v_mfma_f32_16x16x32_bf16 v[112:115], a[188:191], a[160:163], v[112:115]
ds_read_b64_tr_b16 a[6:7], v3 offset:34816
v_mfma_f32_16x16x32_bf16 v[112:115], a[192:195], a[96:99], v[112:115]
ds_read_b64_tr_b16 a[8:9], v3 offset:36864
buffer_load_dwordx4 v7, s[24:27], 0 offen lds
v_mfma_f32_16x16x32_bf16 v[116:119], a[192:195], a[100:103], v[116:119]
s_add_u32 m0, s47, 49152
ds_read_b64_tr_b16 a[10:11], v3 offset:38912
v_add_u32 v7, s41, v7
v_mfma_f32_16x16x32_bf16 v[116:119], a[188:191], a[164:167], v[116:119]
ds_read_b64_tr_b16 a[12:13], v3 offset:40960
v_mfma_f32_16x16x32_bf16 v[116:119], a[184:187], a[148:151], v[116:119]
ds_read_b64_tr_b16 a[14:15], v3 offset:43008
v_mfma_f32_16x16x32_bf16 v[116:119], a[180:183], a[132:135], v[116:119]
v_mfma_f32_16x16x32_bf16 v[116:119], a[176:179], a[116:119], v[116:119]
v_mfma_f32_16x16x32_bf16 v[120:123], a[176:179], a[120:123], v[120:123]
buffer_load_dwordx4 v7, s[24:27], 0 offen lds
v_mfma_f32_16x16x32_bf16 v[120:123], a[180:183], a[136:139], v[120:123]
s_add_u32 m0, s47, 53248
v_add_u32 v7, 0x9000, v7
v_mfma_f32_16x16x32_bf16 v[120:123], a[184:187], a[152:155], v[120:123]
v_cvt_pk_bf16_f32 v208, v112, v113
v_cvt_pk_bf16_f32 v209, v114, v115
v_mfma_f32_16x16x32_bf16 v[120:123], a[188:191], a[168:171], v[120:123]
v_mfma_f32_16x16x32_bf16 v[120:123], a[192:195], a[104:107], v[120:123]
v_mfma_f32_16x16x32_bf16 v[124:127], a[192:195], a[108:111], v[124:127]
v_mfma_f32_16x16x32_bf16 v[124:127], a[188:191], a[172:175], v[124:127]
buffer_load_dwordx4 v7, s[24:27], 0 offen lds
v_mfma_f32_16x16x32_bf16 v[124:127], a[184:187], a[156:159], v[124:127]
s_add_u32 m0, s47, 57344
v_add_u32 v7, s42, v7
v_cvt_pk_bf16_f32 v212, v116, v117
v_mfma_f32_16x16x32_bf16 v[124:127], a[180:183], a[140:143], v[124:127]
v_cvt_pk_bf16_f32 v213, v118, v119
v_mfma_f32_16x16x32_bf16 v[124:127], a[176:179], a[124:127], v[124:127]
s_waitcnt lgkmcnt(0)
v_mfma_f32_16x16x32_bf16 v[128:131], a[0:3], a[32:35], 0
ds_read_b64_tr_b16 a[176:177], v3 offset:45056
v_mfma_f32_16x16x32_bf16 v[128:131], a[4:7], a[48:51], v[128:131]
ds_read_b64_tr_b16 a[178:179], v3 offset:47104
v_mfma_f32_16x16x32_bf16 v[128:131], a[8:11], a[64:67], v[128:131]
ds_read_b64_tr_b16 a[180:181], v3 offset:49152
buffer_load_dwordx4 v7, s[24:27], 0 offen lds
v_mfma_f32_16x16x32_bf16 v[128:131], a[12:15], a[80:83], v[128:131]
s_add_u32 m0, s47, 61440
ds_read_b64_tr_b16 a[182:183], v3 offset:51200
v_add_u32 v7, 0x9000, v7
v_mfma_f32_16x16x32_bf16 v[132:135], a[12:15], a[84:87], 0
ds_read_b64_tr_b16 a[184:185], v3 offset:53248
v_cvt_pk_bf16_f32 v96, v120, v121
v_mfma_f32_16x16x32_bf16 v[132:135], a[8:11], a[68:71], v[132:135]
ds_read_b64_tr_b16 a[186:187], v3 offset:55296
v_cvt_pk_bf16_f32 v97, v122, v123
v_mfma_f32_16x16x32_bf16 v[132:135], a[4:7], a[52:55], v[132:135]
ds_read_b64_tr_b16 a[188:189], v3 offset:57344
v_mfma_f32_16x16x32_bf16 v[132:135], a[0:3], a[36:39], v[132:135]
ds_read_b64_tr_b16 a[190:191], v3 offset:59392
v_cvt_pk_bf16_f32 v100, v124, v125
v_mfma_f32_16x16x32_bf16 v[136:139], a[0:3], a[40:43], 0
ds_read_b64_tr_b16 a[192:193], v3 offset:61440
buffer_load_dwordx4 v7, s[24:27], 0 offen lds
v_mfma_f32_16x16x32_bf16 v[136:139], a[4:7], a[56:59], v[136:139]
s_add_u32 m0, s47, 65536
ds_read_b64_tr_b16 a[194:195], v3 offset:63488
v_add_u32 v3, 0x10000, v3
v_mfma_f32_16x16x32_bf16 v[136:139], a[8:11], a[72:75], v[136:139]
v_add_u32 v7, s43, v7
v_cvt_pk_bf16_f32 v101, v126, v127
v_mfma_f32_16x16x32_bf16 v[136:139], a[12:15], a[88:91], v[136:139]
v_mfma_f32_16x16x32_bf16 v[140:143], a[12:15], a[92:95], 0
v_mfma_f32_16x16x32_bf16 v[140:143], a[8:11], a[76:79], v[140:143]
v_mfma_f32_16x16x32_bf16 v[140:143], a[4:7], a[60:63], v[140:143]
buffer_load_dwordx4 v7, s[24:27], 0 offen lds
v_mfma_f32_16x16x32_bf16 v[140:143], a[0:3], a[44:47], v[140:143]
s_waitcnt vmcnt(19) lgkmcnt(0)
v_add_u32 v7, 0x9000, v7
v_mfma_f32_16x16x32_bf16 v[128:131], a[176:179], a[112:115], v[128:131]
s_barrier
ds_read_b64_tr_b16 a[0:1], v2
v_mfma_f32_16x16x32_bf16 v[128:131], a[180:183], a[128:131], v[128:131]
s_add_u32 m0, s47, 69632
ds_read_b64_tr_b16 a[2:3], v2 offset:2048
v_mfma_f32_16x16x32_bf16 v[128:131], a[184:187], a[144:147], v[128:131]
ds_read_b64_tr_b16 a[4:5], v2 offset:4096
v_mfma_f32_16x16x32_bf16 v[128:131], a[188:191], a[160:163], v[128:131]
ds_read_b64_tr_b16 a[6:7], v2 offset:6144
v_mfma_f32_16x16x32_bf16 v[128:131], a[192:195], a[96:99], v[128:131]
ds_read_b64_tr_b16 a[8:9], v2 offset:8192
buffer_load_dwordx4 v7, s[24:27], 0 offen lds
v_mfma_f32_16x16x32_bf16 v[132:135], a[192:195], a[100:103], v[132:135]
s_add_u32 m0, s47, 73472
s_add_u32 s20, s20, 16384
s_addc_u32 s21, s21, 0
ds_read_b64_tr_b16 a[10:11], v2 offset:10240
v_mfma_f32_16x16x32_bf16 v[132:135], a[188:191], a[164:167], v[132:135]
ds_read_b64_tr_b16 a[12:13], v2 offset:12288
v_mfma_f32_16x16x32_bf16 v[132:135], a[184:187], a[148:151], v[132:135]
ds_read_b64_tr_b16 a[14:15], v2 offset:14336
v_mfma_f32_16x16x32_bf16 v[132:135], a[180:183], a[132:135], v[132:135]
buffer_store_dwordx4 v[188:191], v10, s[20:23], 0 offen sc1
v_mfma_f32_16x16x32_bf16 v[132:135], a[176:179], a[116:119], v[132:135]
v_mfma_f32_16x16x32_bf16 v[136:139], a[176:179], a[120:123], v[136:139]
buffer_load_dwordx4 v11, s[24:27], 0 offen offset:256 lds
v_mfma_f32_16x16x32_bf16 v[136:139], a[180:183], a[136:139], v[136:139]
s_add_u32 m0, s47, 77824
v_add_u32 v7, s40, v7
v_mfma_f32_16x16x32_bf16 v[136:139], a[184:187], a[152:155], v[136:139]
v_cvt_pk_bf16_f32 v210, v128, v129
v_cvt_pk_bf16_f32 v211, v130, v131
v_mfma_f32_16x16x32_bf16 v[136:139], a[188:191], a[168:171], v[136:139]
v_mfma_f32_16x16x32_bf16 v[136:139], a[192:195], a[104:107], v[136:139]
v_mfma_f32_16x16x32_bf16 v[140:143], a[192:195], a[108:111], v[140:143]
v_mfma_f32_16x16x32_bf16 v[140:143], a[188:191], a[172:175], v[140:143]
buffer_load_dwordx4 v7, s[24:27], 0 offen lds
v_mfma_f32_16x16x32_bf16 v[140:143], a[184:187], a[156:159], v[140:143]
s_add_u32 m0, s47, 81920
v_add_u32 v7, 0x9000, v7
v_cvt_pk_bf16_f32 v214, v132, v133
v_mfma_f32_16x16x32_bf16 v[140:143], a[180:183], a[140:143], v[140:143]
v_cvt_pk_bf16_f32 v215, v134, v135
v_mfma_f32_16x16x32_bf16 v[140:143], a[176:179], a[124:127], v[140:143]
s_waitcnt lgkmcnt(0)
v_mfma_f32_16x16x32_bf16 v[112:115], a[0:3], a[32:35], 0
ds_read_b64_tr_b16 a[176:177], v2 offset:16384
v_mfma_f32_16x16x32_bf16 v[112:115], a[4:7], a[48:51], v[112:115]
ds_read_b64_tr_b16 a[178:179], v2 offset:18432
v_mfma_f32_16x16x32_bf16 v[112:115], a[8:11], a[64:67], v[112:115]
ds_read_b64_tr_b16 a[180:181], v2 offset:20480
buffer_load_dwordx4 v7, s[24:27], 0 offen lds
v_mfma_f32_16x16x32_bf16 v[112:115], a[12:15], a[80:83], v[112:115]
s_add_u32 m0, s47, 86016
ds_read_b64_tr_b16 a[182:183], v2 offset:22528
v_add_u32 v7, s41, v7
v_mfma_f32_16x16x32_bf16 v[116:119], a[12:15], a[84:87], 0
ds_read_b64_tr_b16 a[184:185], v2 offset:24576
v_cvt_pk_bf16_f32 v98, v136, v137
v_mfma_f32_16x16x32_bf16 v[116:119], a[8:11], a[68:71], v[116:119]
ds_read_b64_tr_b16 a[186:187], v2 offset:26624
v_cvt_pk_bf16_f32 v99, v138, v139
v_mfma_f32_16x16x32_bf16 v[116:119], a[4:7], a[52:55], v[116:119]
ds_read_b64_tr_b16 a[188:189], v2 offset:28672
v_mfma_f32_16x16x32_bf16 v[116:119], a[0:3], a[36:39], v[116:119]
ds_read_b64_tr_b16 a[190:191], v2 offset:30720
v_add_u32 v2, 0xfffe0000, v2
v_mfma_f32_16x16x32_bf16 v[120:123], a[0:3], a[40:43], 0
ds_read_b64_tr_b16 a[192:193], v2
buffer_load_dwordx4 v7, s[24:27], 0 offen lds
v_mfma_f32_16x16x32_bf16 v[120:123], a[4:7], a[56:59], v[120:123]
s_add_u32 m0, s47, 90112
ds_read_b64_tr_b16 a[194:195], v2 offset:2048
v_add_u32 v7, 0x9000, v7
v_mfma_f32_16x16x32_bf16 v[120:123], a[8:11], a[72:75], v[120:123]
v_cvt_pk_bf16_f32 v102, v140, v141
v_cvt_pk_bf16_f32 v103, v142, v143
v_mfma_f32_16x16x32_bf16 v[120:123], a[12:15], a[88:91], v[120:123]
v_mfma_f32_16x16x32_bf16 v[124:127], a[12:15], a[92:95], 0
v_mfma_f32_16x16x32_bf16 v[124:127], a[8:11], a[76:79], v[124:127]
v_mfma_f32_16x16x32_bf16 v[124:127], a[4:7], a[60:63], v[124:127]
buffer_load_dwordx4 v7, s[24:27], 0 offen lds
v_mfma_f32_16x16x32_bf16 v[124:127], a[0:3], a[44:47], v[124:127]
s_waitcnt lgkmcnt(0)
v_add_u32 v7, s42, v7
v_mfma_f32_16x16x32_bf16 v[112:115], a[176:179], a[112:115], v[112:115]
s_add_u32 m0, s47, 94208
ds_read_b64_tr_b16 a[0:1], v3
v_mfma_f32_16x16x32_bf16 v[112:115], a[180:183], a[128:131], v[112:115]
ds_read_b64_tr_b16 a[2:3], v3 offset:2048
v_mfma_f32_16x16x32_bf16 v[112:115], a[184:187], a[144:147], v[112:115]
ds_read_b64_tr_b16 a[4:5], v3 offset:4096
v_mfma_f32_16x16x32_bf16 v[112:115], a[188:191], a[160:163], v[112:115]
ds_read_b64_tr_b16 a[6:7], v3 offset:6144
v_mfma_f32_16x16x32_bf16 v[112:115], a[192:195], a[96:99], v[112:115]
ds_read_b64_tr_b16 a[8:9], v3 offset:8192
buffer_load_dwordx4 v7, s[24:27], 0 offen lds
v_mfma_f32_16x16x32_bf16 v[116:119], a[192:195], a[100:103], v[116:119]
s_add_u32 m0, s47, 98304
ds_read_b64_tr_b16 a[10:11], v3 offset:10240
v_add_u32 v7, 0x9000, v7
v_mfma_f32_16x16x32_bf16 v[116:119], a[188:191], a[164:167], v[116:119]
ds_read_b64_tr_b16 a[12:13], v3 offset:12288
v_mfma_f32_16x16x32_bf16 v[116:119], a[184:187], a[148:151], v[116:119]
ds_read_b64_tr_b16 a[14:15], v3 offset:14336
v_mfma_f32_16x16x32_bf16 v[116:119], a[180:183], a[132:135], v[116:119]
v_mfma_f32_16x16x32_bf16 v[116:119], a[176:179], a[116:119], v[116:119]
v_mfma_f32_16x16x32_bf16 v[120:123], a[176:179], a[120:123], v[120:123]
buffer_load_dwordx4 v7, s[24:27], 0 offen lds
v_mfma_f32_16x16x32_bf16 v[120:123], a[180:183], a[136:139], v[120:123]
s_add_u32 m0, s47, 102400
v_add_u32 v7, s43, v7
v_mfma_f32_16x16x32_bf16 v[120:123], a[184:187], a[152:155], v[120:123]
v_cvt_pk_bf16_f32 v216, v112, v113
v_cvt_pk_bf16_f32 v217, v114, v115
v_mfma_f32_16x16x32_bf16 v[120:123], a[188:191], a[168:171], v[120:123]
v_mfma_f32_16x16x32_bf16 v[120:123], a[192:195], a[104:107], v[120:123]
v_mfma_f32_16x16x32_bf16 v[124:127], a[192:195], a[108:111], v[124:127]
v_mfma_f32_16x16x32_bf16 v[124:127], a[188:191], a[172:175], v[124:127]
buffer_load_dwordx4 v7, s[24:27], 0 offen lds
v_mfma_f32_16x16x32_bf16 v[124:127], a[184:187], a[156:159], v[124:127]
s_add_u32 m0, s47, 106496
v_add_u32 v7, 0x9000, v7
v_cvt_pk_bf16_f32 v220, v116, v117
v_mfma_f32_16x16x32_bf16 v[124:127], a[180:183], a[140:143], v[124:127]
s_add_u32 s16, s16, s4
s_addc_u32 s17, s17, 0
v_cvt_pk_bf16_f32 v221, v118, v119
v_mfma_f32_16x16x32_bf16 v[124:127], a[176:179], a[124:127], v[124:127]
s_waitcnt lgkmcnt(0)
v_mfma_f32_16x16x32_bf16 v[128:131], a[0:3], a[32:35], 0
ds_read_b64_tr_b16 a[176:177], v3 offset:16384
v_mfma_f32_16x16x32_bf16 v[128:131], a[4:7], a[48:51], v[128:131]
ds_read_b64_tr_b16 a[178:179], v3 offset:18432
v_mfma_f32_16x16x32_bf16 v[128:131], a[8:11], a[64:67], v[128:131]
ds_read_b64_tr_b16 a[180:181], v3 offset:20480
buffer_load_dwordx4 v7, s[24:27], 0 offen lds
v_mfma_f32_16x16x32_bf16 v[128:131], a[12:15], a[80:83], v[128:131]
s_add_u32 m0, s47, 110208
ds_read_b64_tr_b16 a[182:183], v3 offset:22528
v_cvt_pk_bf16_f32 v104, v120, v121
v_mfma_f32_16x16x32_bf16 v[132:135], a[12:15], a[84:87], 0
ds_read_b64_tr_b16 a[184:185], v3 offset:24576
v_cvt_pk_bf16_f32 v105, v122, v123
v_mfma_f32_16x16x32_bf16 v[132:135], a[8:11], a[68:71], v[132:135]
ds_read_b64_tr_b16 a[186:187], v3 offset:26624
v_mfma_f32_16x16x32_bf16 v[132:135], a[4:7], a[52:55], v[132:135]
ds_read_b64_tr_b16 a[188:189], v3 offset:28672
v_mfma_f32_16x16x32_bf16 v[132:135], a[0:3], a[36:39], v[132:135]
ds_read_b64_tr_b16 a[190:191], v3 offset:30720
v_add_u32 v3, 0xfffe0000, v3
v_mfma_f32_16x16x32_bf16 v[136:139], a[0:3], a[40:43], 0
ds_read_b64_tr_b16 a[192:193], v3
buffer_load_dwordx4 v11, s[24:27], 0 offen offset:384 lds
v_mfma_f32_16x16x32_bf16 v[136:139], a[4:7], a[56:59], v[136:139]
s_add_u32 m0, s47, 114688
ds_read_b64_tr_b16 a[194:195], v3 offset:2048
v_add_u32 v7, s40, v7
v_mfma_f32_16x16x32_bf16 v[136:139], a[8:11], a[72:75], v[136:139]
buffer_store_dwordx4 v[192:195], v10, s[16:19], 0 offen sc1
v_mfma_f32_16x16x32_bf16 v[136:139], a[12:15], a[88:91], v[136:139]
v_cvt_pk_bf16_f32 v108, v124, v125
v_cvt_pk_bf16_f32 v109, v126, v127
v_mfma_f32_16x16x32_bf16 v[140:143], a[12:15], a[92:95], 0
v_mfma_f32_16x16x32_bf16 v[140:143], a[8:11], a[76:79], v[140:143]
v_mfma_f32_16x16x32_bf16 v[140:143], a[4:7], a[60:63], v[140:143]
buffer_load_dwordx4 v7, s[24:27], 0 offen lds
v_mfma_f32_16x16x32_bf16 v[140:143], a[0:3], a[44:47], v[140:143]
s_waitcnt vmcnt(22) lgkmcnt(0)
v_add_u32 v7, 0x9000, v7
v_mfma_f32_16x16x32_bf16 v[128:131], a[176:179], a[112:115], v[128:131]
s_barrier
ds_read_b64_tr_b16 a[0:1], v2 offset:4096
v_mfma_f32_16x16x32_bf16 v[128:131], a[180:183], a[128:131], v[128:131]
s_add_u32 m0, s47, 118784
ds_read_b64_tr_b16 a[2:3], v2 offset:6144
v_mfma_f32_16x16x32_bf16 v[128:131], a[184:187], a[144:147], v[128:131]
ds_read_b64_tr_b16 a[4:5], v2 offset:8192
v_mfma_f32_16x16x32_bf16 v[128:131], a[188:191], a[160:163], v[128:131]
ds_read_b64_tr_b16 a[6:7], v2 offset:10240
v_mfma_f32_16x16x32_bf16 v[128:131], a[192:195], a[96:99], v[128:131]
ds_read_b64_tr_b16 a[8:9], v2 offset:12288
buffer_load_dwordx4 v7, s[24:27], 0 offen lds
v_mfma_f32_16x16x32_bf16 v[132:135], a[192:195], a[100:103], v[132:135]
s_add_u32 m0, s47, 122880
ds_read_b64_tr_b16 a[10:11], v2 offset:14336
v_add_u32 v7, s41, v7
v_mfma_f32_16x16x32_bf16 v[132:135], a[188:191], a[164:167], v[132:135]
ds_read_b64_tr_b16 a[12:13], v2 offset:16384
v_mfma_f32_16x16x32_bf16 v[132:135], a[184:187], a[148:151], v[132:135]
ds_read_b64_tr_b16 a[14:15], v2 offset:18432
v_mfma_f32_16x16x32_bf16 v[132:135], a[180:183], a[132:135], v[132:135]
v_mfma_f32_16x16x32_bf16 v[132:135], a[176:179], a[116:119], v[132:135]
v_mfma_f32_16x16x32_bf16 v[136:139], a[176:179], a[120:123], v[136:139]
buffer_load_dwordx4 v7, s[24:27], 0 offen lds
v_mfma_f32_16x16x32_bf16 v[136:139], a[180:183], a[136:139], v[136:139]
s_add_u32 m0, s47, 126976
v_add_u32 v7, 0x9000, v7
v_mfma_f32_16x16x32_bf16 v[136:139], a[184:187], a[152:155], v[136:139]
v_cvt_pk_bf16_f32 v218, v128, v129
v_cvt_pk_bf16_f32 v219, v130, v131
v_mfma_f32_16x16x32_bf16 v[136:139], a[188:191], a[168:171], v[136:139]
v_mfma_f32_16x16x32_bf16 v[136:139], a[192:195], a[104:107], v[136:139]
v_mfma_f32_16x16x32_bf16 v[140:143], a[192:195], a[108:111], v[140:143]
v_mfma_f32_16x16x32_bf16 v[140:143], a[188:191], a[172:175], v[140:143]
buffer_load_dwordx4 v7, s[24:27], 0 offen lds
v_mfma_f32_16x16x32_bf16 v[140:143], a[184:187], a[156:159], v[140:143]
s_add_u32 m0, s47, 131072
v_add_u32 v7, s42, v7
v_cvt_pk_bf16_f32 v222, v132, v133
v_mfma_f32_16x16x32_bf16 v[140:143], a[180:183], a[140:143], v[140:143]
v_cvt_pk_bf16_f32 v223, v134, v135
v_mfma_f32_16x16x32_bf16 v[140:143], a[176:179], a[124:127], v[140:143]
s_waitcnt lgkmcnt(0)
v_mfma_f32_16x16x32_bf16 v[112:115], a[0:3], a[32:35], 0
ds_read_b64_tr_b16 a[176:177], v2 offset:20480
v_mfma_f32_16x16x32_bf16 v[112:115], a[4:7], a[48:51], v[112:115]
ds_read_b64_tr_b16 a[178:179], v2 offset:22528
v_mfma_f32_16x16x32_bf16 v[112:115], a[8:11], a[64:67], v[112:115]
ds_read_b64_tr_b16 a[180:181], v2 offset:24576
buffer_load_dwordx4 v7, s[24:27], 0 offen lds
v_mfma_f32_16x16x32_bf16 v[112:115], a[12:15], a[80:83], v[112:115]
s_add_u32 m0, s47, 135168
ds_read_b64_tr_b16 a[182:183], v2 offset:26624
v_add_u32 v7, 0x9000, v7
v_mfma_f32_16x16x32_bf16 v[116:119], a[12:15], a[84:87], 0
ds_read_b64_tr_b16 a[184:185], v2 offset:28672
v_cvt_pk_bf16_f32 v106, v136, v137
v_mfma_f32_16x16x32_bf16 v[116:119], a[8:11], a[68:71], v[116:119]
ds_read_b64_tr_b16 a[186:187], v2 offset:30720
v_cvt_pk_bf16_f32 v107, v138, v139
v_mfma_f32_16x16x32_bf16 v[116:119], a[4:7], a[52:55], v[116:119]
ds_read_b64_tr_b16 a[188:189], v2 offset:32768
v_mfma_f32_16x16x32_bf16 v[116:119], a[0:3], a[36:39], v[116:119]
ds_read_b64_tr_b16 a[190:191], v2 offset:34816
v_cvt_pk_bf16_f32 v110, v140, v141
v_mfma_f32_16x16x32_bf16 v[120:123], a[0:3], a[40:43], 0
ds_read_b64_tr_b16 a[192:193], v2 offset:36864
buffer_load_dwordx4 v7, s[24:27], 0 offen lds
v_mfma_f32_16x16x32_bf16 v[120:123], a[4:7], a[56:59], v[120:123]
s_add_u32 m0, s47, 139264
ds_read_b64_tr_b16 a[194:195], v2 offset:38912
v_add_u32 v7, s43, v7
v_mfma_f32_16x16x32_bf16 v[120:123], a[8:11], a[72:75], v[120:123]
v_cvt_pk_bf16_f32 v111, v142, v143
v_mfma_f32_16x16x32_bf16 v[120:123], a[12:15], a[88:91], v[120:123]
v_mfma_f32_16x16x32_bf16 v[124:127], a[12:15], a[92:95], 0
v_mfma_f32_16x16x32_bf16 v[124:127], a[8:11], a[76:79], v[124:127]
v_mfma_f32_16x16x32_bf16 v[124:127], a[4:7], a[60:63], v[124:127]
buffer_load_dwordx4 v7, s[24:27], 0 offen lds
v_mfma_f32_16x16x32_bf16 v[124:127], a[0:3], a[44:47], v[124:127]
s_waitcnt lgkmcnt(0)
v_add_u32 v7, 0x9000, v7
v_mfma_f32_16x16x32_bf16 v[112:115], a[176:179], a[112:115], v[112:115]
s_add_u32 m0, s47, 143360
ds_read_b64_tr_b16 a[0:1], v3 offset:4096
v_mfma_f32_16x16x32_bf16 v[112:115], a[180:183], a[128:131], v[112:115]
ds_read_b64_tr_b16 a[2:3], v3 offset:6144
v_mfma_f32_16x16x32_bf16 v[112:115], a[184:187], a[144:147], v[112:115]
ds_read_b64_tr_b16 a[4:5], v3 offset:8192
v_mfma_f32_16x16x32_bf16 v[112:115], a[188:191], a[160:163], v[112:115]
ds_read_b64_tr_b16 a[6:7], v3 offset:10240
v_mfma_f32_16x16x32_bf16 v[112:115], a[192:195], a[96:99], v[112:115]
s_add_u32 s16, s16, 16384
s_addc_u32 s17, s17, 0
ds_read_b64_tr_b16 a[8:9], v3 offset:12288
buffer_load_dwordx4 v7, s[24:27], 0 offen lds
v_mfma_f32_16x16x32_bf16 v[116:119], a[192:195], a[100:103], v[116:119]
s_add_u32 m0, s47, 146944
ds_read_b64_tr_b16 a[10:11], v3 offset:14336
v_mfma_f32_16x16x32_bf16 v[116:119], a[188:191], a[164:167], v[116:119]
ds_read_b64_tr_b16 a[12:13], v3 offset:16384
v_mfma_f32_16x16x32_bf16 v[116:119], a[184:187], a[148:151], v[116:119]
ds_read_b64_tr_b16 a[14:15], v3 offset:18432
v_mfma_f32_16x16x32_bf16 v[116:119], a[180:183], a[132:135], v[116:119]
buffer_store_dwordx4 v[196:199], v10, s[16:19], 0 offen sc1
v_mfma_f32_16x16x32_bf16 v[116:119], a[176:179], a[116:119], v[116:119]
v_mfma_f32_16x16x32_bf16 v[120:123], a[176:179], a[120:123], v[120:123]
buffer_load_dwordx4 v11, s[24:27], 0 offen offset:512 lds
v_mfma_f32_16x16x32_bf16 v[120:123], a[180:183], a[136:139], v[120:123]
s_add_u32 m0, s47, 0
v_mfma_f32_16x16x32_bf16 v[120:123], a[184:187], a[152:155], v[120:123]
v_cvt_pk_bf16_f32 v224, v112, v113
v_cvt_pk_bf16_f32 v225, v114, v115
v_mfma_f32_16x16x32_bf16 v[120:123], a[188:191], a[168:171], v[120:123]
v_mfma_f32_16x16x32_bf16 v[120:123], a[192:195], a[104:107], v[120:123]
v_mfma_f32_16x16x32_bf16 v[124:127], a[192:195], a[108:111], v[124:127]
v_mfma_f32_16x16x32_bf16 v[124:127], a[188:191], a[172:175], v[124:127]
buffer_load_dwordx4 v8, s[28:31], 0 offen sc1 lds
v_mfma_f32_16x16x32_bf16 v[124:127], a[184:187], a[156:159], v[124:127]
s_add_u32 m0, s47, 151552
v_add_u32 v8, 0x25000, v8
v_cvt_pk_bf16_f32 v228, v116, v117
v_mfma_f32_16x16x32_bf16 v[124:127], a[180:183], a[140:143], v[124:127]
v_cvt_pk_bf16_f32 v229, v118, v119
v_mfma_f32_16x16x32_bf16 v[124:127], a[176:179], a[124:127], v[124:127]
s_waitcnt lgkmcnt(0)
v_mfma_f32_16x16x32_bf16 v[128:131], a[0:3], a[32:35], 0
ds_read_b64_tr_b16 a[176:177], v3 offset:20480
v_mfma_f32_16x16x32_bf16 v[128:131], a[4:7], a[48:51], v[128:131]
ds_read_b64_tr_b16 a[178:179], v3 offset:22528
v_mfma_f32_16x16x32_bf16 v[128:131], a[8:11], a[64:67], v[128:131]
ds_read_b64_tr_b16 a[180:181], v3 offset:24576
buffer_load_dwordx4 v8, s[28:31], 0 offen sc1 lds
v_mfma_f32_16x16x32_bf16 v[128:131], a[12:15], a[80:83], v[128:131]
s_add_u32 m0, s47, 4096
ds_read_b64_tr_b16 a[182:183], v3 offset:26624
L_pad11:
s_cbranch_execz L_hret0
v_add_u32 v8, 0xfffdc000, v8
v_mfma_f32_16x16x32_bf16 v[132:135], a[12:15], a[84:87], 0
ds_read_b64_tr_b16 a[184:185], v3 offset:28672
v_cvt_pk_bf16_f32 v48, v120, v121
v_mfma_f32_16x16x32_bf16 v[132:135], a[8:11], a[68:71], v[132:135]
ds_read_b64_tr_b16 a[186:187], v3 offset:30720
v_cvt_pk_bf16_f32 v49, v122, v123
v_mfma_f32_16x16x32_bf16 v[132:135], a[4:7], a[52:55], v[132:135]
ds_read_b64_tr_b16 a[188:189], v3 offset:32768
v_mfma_f32_16x16x32_bf16 v[132:135], a[0:3], a[36:39], v[132:135]
ds_read_b64_tr_b16 a[190:191], v3 offset:34816
v_cvt_pk_bf16_f32 v52, v124, v125
v_mfma_f32_16x16x32_bf16 v[136:139], a[0:3], a[40:43], 0
ds_read_b64_tr_b16 a[192:193], v3 offset:36864
v_cvt_pk_bf16_f32 v53, v126, v127
v_mfma_f32_16x16x32_bf16 v[136:139], a[4:7], a[56:59], v[136:139]
ds_read_b64_tr_b16 a[194:195], v3 offset:38912
v_mfma_f32_16x16x32_bf16 v[136:139], a[8:11], a[72:75], v[136:139]
v_mfma_f32_16x16x32_bf16 v[136:139], a[12:15], a[88:91], v[136:139]
v_mfma_f32_16x16x32_bf16 v[140:143], a[12:15], a[92:95], 0
v_mfma_f32_16x16x32_bf16 v[140:143], a[8:11], a[76:79], v[140:143]
v_mfma_f32_16x16x32_bf16 v[140:143], a[4:7], a[60:63], v[140:143]
v_mfma_f32_16x16x32_bf16 v[140:143], a[0:3], a[44:47], v[140:143]
s_waitcnt vmcnt(22) lgkmcnt(0)
v_mfma_f32_16x16x32_bf16 v[128:131], a[176:179], a[112:115], v[128:131]
s_barrier
ds_read_b64_tr_b16 a[0:1], v2 offset:40960
v_mfma_f32_16x16x32_bf16 v[128:131], a[180:183], a[128:131], v[128:131]
ds_read_b64_tr_b16 a[2:3], v2 offset:43008
v_mfma_f32_16x16x32_bf16 v[128:131], a[184:187], a[144:147], v[128:131]
ds_read_b64_tr_b16 a[4:5], v2 offset:45056
buffer_load_dwordx4 v8, s[28:31], 0 offen sc1 lds
v_mfma_f32_16x16x32_bf16 v[128:131], a[188:191], a[160:163], v[128:131]
s_add_u32 m0, s47, 8192
ds_read_b64_tr_b16 a[6:7], v2 offset:47104
v_add_u32 v8, 0x1000, v8
v_mfma_f32_16x16x32_bf16 v[128:131], a[192:195], a[96:99], v[128:131]
ds_read_b64_tr_b16 a[8:9], v2 offset:49152
v_mfma_f32_16x16x32_bf16 v[132:135], a[192:195], a[100:103], v[132:135]
ds_read_b64_tr_b16 a[10:11], v2 offset:51200
v_mfma_f32_16x16x32_bf16 v[132:135], a[188:191], a[164:167], v[132:135]
ds_read_b64_tr_b16 a[12:13], v2 offset:53248
v_mfma_f32_16x16x32_bf16 v[132:135], a[184:187], a[148:151], v[132:135]
ds_read_b64_tr_b16 a[14:15], v2 offset:55296
v_mfma_f32_16x16x32_bf16 v[132:135], a[180:183], a[132:135], v[132:135]
buffer_load_dwordx4 v8, s[28:31], 0 offen sc1 lds
v_mfma_f32_16x16x32_bf16 v[132:135], a[176:179], a[116:119], v[132:135]
s_add_u32 m0, s47, 12288
v_add_u32 v8, 0x1000, v8
v_mfma_f32_16x16x32_bf16 v[136:139], a[176:179], a[120:123], v[136:139]
v_mfma_f32_16x16x32_bf16 v[136:139], a[180:183], a[136:139], v[136:139]
v_mfma_f32_16x16x32_bf16 v[136:139], a[184:187], a[152:155], v[136:139]
v_cvt_pk_bf16_f32 v226, v128, v129
v_cvt_pk_bf16_f32 v227, v130, v131
v_mfma_f32_16x16x32_bf16 v[136:139], a[188:191], a[168:171], v[136:139]
v_mfma_f32_16x16x32_bf16 v[136:139], a[192:195], a[104:107], v[136:139]
buffer_load_dwordx4 v8, s[28:31], 0 offen sc1 lds
v_mfma_f32_16x16x32_bf16 v[140:143], a[192:195], a[108:111], v[140:143]
s_add_u32 m0, s47, 16384
v_add_u32 v8, 0x1000, v8
v_mfma_f32_16x16x32_bf16 v[140:143], a[188:191], a[172:175], v[140:143]
v_mfma_f32_16x16x32_bf16 v[140:143], a[184:187], a[156:159], v[140:143]
v_cvt_pk_bf16_f32 v230, v132, v133
v_cvt_pk_bf16_f32 v231, v134, v135
v_mfma_f32_16x16x32_bf16 v[140:143], a[180:183], a[140:143], v[140:143]
s_add_u32 s16, s16, 16384
s_addc_u32 s17, s17, 0
v_mfma_f32_16x16x32_bf16 v[140:143], a[176:179], a[124:127], v[140:143]
s_waitcnt lgkmcnt(0)
v_mfma_f32_16x16x32_bf16 v[112:115], a[0:3], a[32:35], 0
ds_read_b64_tr_b16 a[176:177], v2 offset:57344
buffer_load_dwordx4 v8, s[28:31], 0 offen sc1 lds
v_mfma_f32_16x16x32_bf16 v[112:115], a[4:7], a[48:51], v[112:115]
s_add_u32 m0, s47, 20480
ds_read_b64_tr_b16 a[178:179], v2 offset:59392
v_add_u32 v8, 0x1000, v8
v_mfma_f32_16x16x32_bf16 v[112:115], a[8:11], a[64:67], v[112:115]
ds_read_b64_tr_b16 a[180:181], v2 offset:61440
v_cvt_pk_bf16_f32 v50, v136, v137
v_mfma_f32_16x16x32_bf16 v[112:115], a[12:15], a[80:83], v[112:115]
ds_read_b64_tr_b16 a[182:183], v2 offset:63488
v_add_u32 v2, 0x10000, v2
v_mfma_f32_16x16x32_bf16 v[116:119], a[12:15], a[84:87], 0
ds_read_b64_tr_b16 a[184:185], v2
v_cvt_pk_bf16_f32 v51, v138, v139
v_mfma_f32_16x16x32_bf16 v[116:119], a[8:11], a[68:71], v[116:119]
ds_read_b64_tr_b16 a[186:187], v2 offset:2048
v_mfma_f32_16x16x32_bf16 v[116:119], a[4:7], a[52:55], v[116:119]
ds_read_b64_tr_b16 a[188:189], v2 offset:4096
buffer_load_dwordx4 v8, s[28:31], 0 offen sc1 lds
v_mfma_f32_16x16x32_bf16 v[116:119], a[0:3], a[36:39], v[116:119]
s_add_u32 m0, s47, 24576
ds_read_b64_tr_b16 a[190:191], v2 offset:6144
v_add_u32 v8, 0x1000, v8
v_mfma_f32_16x16x32_bf16 v[120:123], a[0:3], a[40:43], 0
ds_read_b64_tr_b16 a[192:193], v2 offset:8192
v_cvt_pk_bf16_f32 v54, v140, v141
v_mfma_f32_16x16x32_bf16 v[120:123], a[4:7], a[56:59], v[120:123]
ds_read_b64_tr_b16 a[194:195], v2 offset:10240
v_cvt_pk_bf16_f32 v55, v142, v143
v_mfma_f32_16x16x32_bf16 v[120:123], a[8:11], a[72:75], v[120:123]
buffer_store_dwordx4 v[200:203], v10, s[16:19], 0 offen sc1
v_mfma_f32_16x16x32_bf16 v[120:123], a[12:15], a[88:91], v[120:123]
v_mfma_f32_16x16x32_bf16 v[124:127], a[12:15], a[92:95], 0
buffer_load_dwordx4 v8, s[28:31], 0 offen sc1 lds
v_mfma_f32_16x16x32_bf16 v[124:127], a[8:11], a[76:79], v[124:127]
s_add_u32 m0, s47, 28672
v_add_u32 v8, 0x1000, v8
v_mfma_f32_16x16x32_bf16 v[124:127], a[4:7], a[60:63], v[124:127]
v_mfma_f32_16x16x32_bf16 v[124:127], a[0:3], a[44:47], v[124:127]
s_waitcnt lgkmcnt(0)
v_mfma_f32_16x16x32_bf16 v[112:115], a[176:179], a[112:115], v[112:115]
ds_read_b64_tr_b16 a[0:1], v3 offset:40960
v_mfma_f32_16x16x32_bf16 v[112:115], a[180:183], a[128:131], v[112:115]
ds_read_b64_tr_b16 a[2:3], v3 offset:43008
v_mfma_f32_16x16x32_bf16 v[112:115], a[184:187], a[144:147], v[112:115]
ds_read_b64_tr_b16 a[4:5], v3 offset:45056
buffer_load_dwordx4 v8, s[28:31], 0 offen sc1 lds
v_mfma_f32_16x16x32_bf16 v[112:115], a[188:191], a[160:163], v[112:115]
s_add_u32 m0, s47, 32768
ds_read_b64_tr_b16 a[6:7], v3 offset:47104
v_add_u32 v8, 0x1000, v8
v_mfma_f32_16x16x32_bf16 v[112:115], a[192:195], a[96:99], v[112:115]
ds_read_b64_tr_b16 a[8:9], v3 offset:49152
v_mfma_f32_16x16x32_bf16 v[116:119], a[192:195], a[100:103], v[116:119]
ds_read_b64_tr_b16 a[10:11], v3 offset:51200
v_mfma_f32_16x16x32_bf16 v[116:119], a[188:191], a[164:167], v[116:119]
ds_read_b64_tr_b16 a[12:13], v3 offset:53248
v_mfma_f32_16x16x32_bf16 v[116:119], a[184:187], a[148:151], v[116:119]
ds_read_b64_tr_b16 a[14:15], v3 offset:55296
v_mfma_f32_16x16x32_bf16 v[116:119], a[180:183], a[132:135], v[116:119]
buffer_load_dwordx4 v8, s[28:31], 0 offen sc1 lds
v_mfma_f32_16x16x32_bf16 v[116:119], a[176:179], a[116:119], v[116:119]
s_add_u32 m0, s47, 36864
v_add_u32 v8, 0x1000, v8
v_mfma_f32_16x16x32_bf16 v[120:123], a[176:179], a[120:123], v[120:123]
v_mfma_f32_16x16x32_bf16 v[120:123], a[180:183], a[136:139], v[120:123]
v_mfma_f32_16x16x32_bf16 v[120:123], a[184:187], a[152:155], v[120:123]
v_cvt_pk_bf16_f32 v232, v112, v113
v_cvt_pk_bf16_f32 v233, v114, v115
v_mfma_f32_16x16x32_bf16 v[120:123], a[188:191], a[168:171], v[120:123]
v_mfma_f32_16x16x32_bf16 v[120:123], a[192:195], a[104:107], v[120:123]
buffer_load_dwordx4 v8, s[28:31], 0 offen sc1 lds
v_mfma_f32_16x16x32_bf16 v[124:127], a[192:195], a[108:111], v[124:127]
s_add_u32 m0, s47, 40960
v_add_u32 v8, 0x1000, v8
v_mfma_f32_16x16x32_bf16 v[124:127], a[188:191], a[172:175], v[124:127]
v_mfma_f32_16x16x32_bf16 v[124:127], a[184:187], a[156:159], v[124:127]
v_cvt_pk_bf16_f32 v236, v116, v117
v_cvt_pk_bf16_f32 v237, v118, v119
v_mfma_f32_16x16x32_bf16 v[124:127], a[180:183], a[140:143], v[124:127]
v_mfma_f32_16x16x32_bf16 v[124:127], a[176:179], a[124:127], v[124:127]
s_waitcnt lgkmcnt(0)
v_mfma_f32_16x16x32_bf16 v[128:131], a[0:3], a[32:35], 0
ds_read_b64_tr_b16 a[176:177], v3 offset:57344
v_mfma_f32_16x16x32_bf16 v[128:131], a[4:7], a[48:51], v[128:131]
ds_read_b64_tr_b16 a[178:179], v3 offset:59392
v_mfma_f32_16x16x32_bf16 v[128:131], a[8:11], a[64:67], v[128:131]
ds_read_b64_tr_b16 a[180:181], v3 offset:61440
v_cvt_pk_bf16_f32 v56, v120, v121
v_mfma_f32_16x16x32_bf16 v[128:131], a[12:15], a[80:83], v[128:131]
ds_read_b64_tr_b16 a[182:183], v3 offset:63488
v_add_u32 v3, 0x10000, v3
v_mfma_f32_16x16x32_bf16 v[132:135], a[12:15], a[84:87], 0
ds_read_b64_tr_b16 a[184:185], v3
v_cvt_pk_bf16_f32 v57, v122, v123
v_mfma_f32_16x16x32_bf16 v[132:135], a[8:11], a[68:71], v[132:135]
ds_read_b64_tr_b16 a[186:187], v3 offset:2048
v_mfma_f32_16x16x32_bf16 v[132:135], a[4:7], a[52:55], v[132:135]
ds_read_b64_tr_b16 a[188:189], v3 offset:4096
v_mfma_f32_16x16x32_bf16 v[132:135], a[0:3], a[36:39], v[132:135]
ds_read_b64_tr_b16 a[190:191], v3 offset:6144
v_cvt_pk_bf16_f32 v60, v124, v125
v_mfma_f32_16x16x32_bf16 v[136:139], a[0:3], a[40:43], 0
ds_read_b64_tr_b16 a[192:193], v3 offset:8192
v_cvt_pk_bf16_f32 v61, v126, v127
v_mfma_f32_16x16x32_bf16 v[136:139], a[4:7], a[56:59], v[136:139]
ds_read_b64_tr_b16 a[194:195], v3 offset:10240
v_mfma_f32_16x16x32_bf16 v[136:139], a[8:11], a[72:75], v[136:139]
v_mfma_f32_16x16x32_bf16 v[136:139], a[12:15], a[88:91], v[136:139]
v_mfma_f32_16x16x32_bf16 v[140:143], a[12:15], a[92:95], 0
v_mfma_f32_16x16x32_bf16 v[140:143], a[8:11], a[76:79], v[140:143]
v_mfma_f32_16x16x32_bf16 v[140:143], a[4:7], a[60:63], v[140:143]
v_mfma_f32_16x16x32_bf16 v[140:143], a[0:3], a[44:47], v[140:143]
s_waitcnt vmcnt(23) lgkmcnt(0)
v_mfma_f32_16x16x32_bf16 v[128:131], a[176:179], a[112:115], v[128:131]
s_barrier
ds_read_b64_tr_b16 a[0:1], v2 offset:12288
v_mfma_f32_16x16x32_bf16 v[128:131], a[180:183], a[128:131], v[128:131]
ds_read_b64_tr_b16 a[2:3], v2 offset:14336
v_mfma_f32_16x16x32_bf16 v[128:131], a[184:187], a[144:147], v[128:131]
ds_read_b64_tr_b16 a[4:5], v2 offset:16384
buffer_load_dwordx4 v8, s[28:31], 0 offen sc1 lds
v_mfma_f32_16x16x32_bf16 v[128:131], a[188:191], a[160:163], v[128:131]
s_add_u32 m0, s47, 45056
ds_read_b64_tr_b16 a[6:7], v2 offset:18432
v_add_u32 v8, 0x1000, v8
v_mfma_f32_16x16x32_bf16 v[128:131], a[192:195], a[96:99], v[128:131]
s_add_u32 s16, s16, 16384
s_addc_u32 s17, s17, 0
ds_read_b64_tr_b16 a[8:9], v2 offset:20480
v_mfma_f32_16x16x32_bf16 v[132:135], a[192:195], a[100:103], v[132:135]
ds_read_b64_tr_b16 a[10:11], v2 offset:22528
v_mfma_f32_16x16x32_bf16 v[132:135], a[188:191], a[164:167], v[132:135]
ds_read_b64_tr_b16 a[12:13], v2 offset:24576
v_mfma_f32_16x16x32_bf16 v[132:135], a[184:187], a[148:151], v[132:135]
ds_read_b64_tr_b16 a[14:15], v2 offset:26624
v_mfma_f32_16x16x32_bf16 v[132:135], a[180:183], a[132:135], v[132:135]
buffer_load_dwordx4 v8, s[28:31], 0 offen sc1 lds
v_mfma_f32_16x16x32_bf16 v[132:135], a[176:179], a[116:119], v[132:135]
s_add_u32 m0, s47, 49152
v_add_u32 v8, 0x1000, v8
v_mfma_f32_16x16x32_bf16 v[136:139], a[176:179], a[120:123], v[136:139]
buffer_store_dwordx4 v[204:207], v10, s[16:19], 0 offen sc1
v_mfma_f32_16x16x32_bf16 v[136:139], a[180:183], a[136:139], v[136:139]
v_mfma_f32_16x16x32_bf16 v[136:139], a[184:187], a[152:155], v[136:139]
v_cvt_pk_bf16_f32 v234, v128, v129
v_cvt_pk_bf16_f32 v235, v130, v131
v_mfma_f32_16x16x32_bf16 v[136:139], a[188:191], a[168:171], v[136:139]
v_mfma_f32_16x16x32_bf16 v[136:139], a[192:195], a[104:107], v[136:139]
buffer_load_dwordx4 v8, s[28:31], 0 offen sc1 lds
v_mfma_f32_16x16x32_bf16 v[140:143], a[192:195], a[108:111], v[140:143]
s_add_u32 m0, s47, 53248
v_add_u32 v8, 0x1000, v8
v_mfma_f32_16x16x32_bf16 v[140:143], a[188:191], a[172:175], v[140:143]
v_mfma_f32_16x16x32_bf16 v[140:143], a[184:187], a[156:159], v[140:143]
v_cvt_pk_bf16_f32 v238, v132, v133
v_cvt_pk_bf16_f32 v239, v134, v135
v_mfma_f32_16x16x32_bf16 v[140:143], a[180:183], a[140:143], v[140:143]
v_mfma_f32_16x16x32_bf16 v[140:143], a[176:179], a[124:127], v[140:143]
s_waitcnt lgkmcnt(0)
v_mfma_f32_16x16x32_bf16 v[112:115], a[0:3], a[32:35], 0
ds_read_b64_tr_b16 a[176:177], v2 offset:28672
buffer_load_dwordx4 v8, s[28:31], 0 offen sc1 lds
v_mfma_f32_16x16x32_bf16 v[112:115], a[4:7], a[48:51], v[112:115]
s_add_u32 m0, s47, 57344
ds_read_b64_tr_b16 a[178:179], v2 offset:30720
v_add_u32 v8, 0x1000, v8
v_mfma_f32_16x16x32_bf16 v[112:115], a[8:11], a[64:67], v[112:115]
ds_read_b64_tr_b16 a[180:181], v2 offset:32768
v_cvt_pk_bf16_f32 v58, v136, v137
v_mfma_f32_16x16x32_bf16 v[112:115], a[12:15], a[80:83], v[112:115]
ds_read_b64_tr_b16 a[182:183], v2 offset:34816
v_cvt_pk_bf16_f32 v59, v138, v139
v_mfma_f32_16x16x32_bf16 v[116:119], a[12:15], a[84:87], 0
ds_read_b64_tr_b16 a[184:185], v2 offset:36864
v_mfma_f32_16x16x32_bf16 v[116:119], a[8:11], a[68:71], v[116:119]
ds_read_b64_tr_b16 a[186:187], v2 offset:38912
v_mfma_f32_16x16x32_bf16 v[116:119], a[4:7], a[52:55], v[116:119]
ds_read_b64_tr_b16 a[188:189], v2 offset:40960
buffer_load_dwordx4 v8, s[28:31], 0 offen sc1 lds
v_mfma_f32_16x16x32_bf16 v[116:119], a[0:3], a[36:39], v[116:119]
s_add_u32 m0, s47, 61440
ds_read_b64_tr_b16 a[190:191], v2 offset:43008
v_add_u32 v8, 0x1000, v8
v_mfma_f32_16x16x32_bf16 v[120:123], a[0:3], a[40:43], 0
ds_read_b64_tr_b16 a[192:193], v2 offset:45056
v_cvt_pk_bf16_f32 v62, v140, v141
v_mfma_f32_16x16x32_bf16 v[120:123], a[4:7], a[56:59], v[120:123]
ds_read_b64_tr_b16 a[194:195], v2 offset:47104
v_cvt_pk_bf16_f32 v63, v142, v143
v_mfma_f32_16x16x32_bf16 v[120:123], a[8:11], a[72:75], v[120:123]
v_mfma_f32_16x16x32_bf16 v[120:123], a[12:15], a[88:91], v[120:123]
v_mfma_f32_16x16x32_bf16 v[124:127], a[12:15], a[92:95], 0
buffer_load_dwordx4 v8, s[28:31], 0 offen sc1 lds
v_mfma_f32_16x16x32_bf16 v[124:127], a[8:11], a[76:79], v[124:127]
s_add_u32 m0, s47, 65536
v_add_u32 v8, 0x1000, v8
v_mfma_f32_16x16x32_bf16 v[124:127], a[4:7], a[60:63], v[124:127]
v_mfma_f32_16x16x32_bf16 v[124:127], a[0:3], a[44:47], v[124:127]
s_waitcnt lgkmcnt(0)
v_mfma_f32_16x16x32_bf16 v[112:115], a[176:179], a[112:115], v[112:115]
ds_read_b64_tr_b16 a[0:1], v3 offset:12288
v_mfma_f32_16x16x32_bf16 v[112:115], a[180:183], a[128:131], v[112:115]
ds_read_b64_tr_b16 a[2:3], v3 offset:14336
v_mfma_f32_16x16x32_bf16 v[112:115], a[184:187], a[144:147], v[112:115]
ds_read_b64_tr_b16 a[4:5], v3 offset:16384
buffer_load_dwordx4 v8, s[28:31], 0 offen sc1 lds
v_mfma_f32_16x16x32_bf16 v[112:115], a[188:191], a[160:163], v[112:115]
s_add_u32 m0, s47, 69632
ds_read_b64_tr_b16 a[6:7], v3 offset:18432
v_add_u32 v8, 0x1000, v8
v_mfma_f32_16x16x32_bf16 v[112:115], a[192:195], a[96:99], v[112:115]
ds_read_b64_tr_b16 a[8:9], v3 offset:20480
v_mfma_f32_16x16x32_bf16 v[116:119], a[192:195], a[100:103], v[116:119]
ds_read_b64_tr_b16 a[10:11], v3 offset:22528
v_mfma_f32_16x16x32_bf16 v[116:119], a[188:191], a[164:167], v[116:119]
ds_read_b64_tr_b16 a[12:13], v3 offset:24576
v_mfma_f32_16x16x32_bf16 v[116:119], a[184:187], a[148:151], v[116:119]
ds_read_b64_tr_b16 a[14:15], v3 offset:26624
v_mfma_f32_16x16x32_bf16 v[116:119], a[180:183], a[132:135], v[116:119]
buffer_load_dwordx4 v8, s[28:31], 0 offen sc1 lds
v_mfma_f32_16x16x32_bf16 v[116:119], a[176:179], a[116:119], v[116:119]
s_add_u32 m0, s47, 73728
v_add_u32 v8, 0x1000, v8
v_mfma_f32_16x16x32_bf16 v[120:123], a[176:179], a[120:123], v[120:123]
v_mfma_f32_16x16x32_bf16 v[120:123], a[180:183], a[136:139], v[120:123]
v_mfma_f32_16x16x32_bf16 v[120:123], a[184:187], a[152:155], v[120:123]
v_cvt_pk_bf16_f32 v240, v112, v113
v_cvt_pk_bf16_f32 v241, v114, v115
v_mfma_f32_16x16x32_bf16 v[120:123], a[188:191], a[168:171], v[120:123]
v_mfma_f32_16x16x32_bf16 v[120:123], a[192:195], a[104:107], v[120:123]
buffer_load_dwordx4 v8, s[28:31], 0 offen sc1 lds
v_mfma_f32_16x16x32_bf16 v[124:127], a[192:195], a[108:111], v[124:127]
s_add_u32 m0, s47, 77824
v_add_u32 v8, 0x1000, v8
v_mfma_f32_16x16x32_bf16 v[124:127], a[188:191], a[172:175], v[124:127]
v_mfma_f32_16x16x32_bf16 v[124:127], a[184:187], a[156:159], v[124:127]
v_cvt_pk_bf16_f32 v244, v116, v117
v_cvt_pk_bf16_f32 v245, v118, v119
v_mfma_f32_16x16x32_bf16 v[124:127], a[180:183], a[140:143], v[124:127]
v_mfma_f32_16x16x32_bf16 v[124:127], a[176:179], a[124:127], v[124:127]
s_waitcnt lgkmcnt(0)
v_mfma_f32_16x16x32_bf16 v[128:131], a[0:3], a[32:35], 0
s_add_u32 s16, s16, 16384
s_addc_u32 s17, s17, 0
ds_read_b64_tr_b16 a[176:177], v3 offset:28672
v_mfma_f32_16x16x32_bf16 v[128:131], a[4:7], a[48:51], v[128:131]
ds_read_b64_tr_b16 a[178:179], v3 offset:30720
v_mfma_f32_16x16x32_bf16 v[128:131], a[8:11], a[64:67], v[128:131]
ds_read_b64_tr_b16 a[180:181], v3 offset:32768
v_cvt_pk_bf16_f32 v64, v120, v121
v_mfma_f32_16x16x32_bf16 v[128:131], a[12:15], a[80:83], v[128:131]
ds_read_b64_tr_b16 a[182:183], v3 offset:34816
v_cvt_pk_bf16_f32 v65, v122, v123
v_mfma_f32_16x16x32_bf16 v[132:135], a[12:15], a[84:87], 0
ds_read_b64_tr_b16 a[184:185], v3 offset:36864
v_mfma_f32_16x16x32_bf16 v[132:135], a[8:11], a[68:71], v[132:135]
ds_read_b64_tr_b16 a[186:187], v3 offset:38912
v_mfma_f32_16x16x32_bf16 v[132:135], a[4:7], a[52:55], v[132:135]
ds_read_b64_tr_b16 a[188:189], v3 offset:40960
v_mfma_f32_16x16x32_bf16 v[132:135], a[0:3], a[36:39], v[132:135]
ds_read_b64_tr_b16 a[190:191], v3 offset:43008
v_cvt_pk_bf16_f32 v68, v124, v125
v_mfma_f32_16x16x32_bf16 v[136:139], a[0:3], a[40:43], 0
ds_read_b64_tr_b16 a[192:193], v3 offset:45056
v_cvt_pk_bf16_f32 v69, v126, v127
v_mfma_f32_16x16x32_bf16 v[136:139], a[4:7], a[56:59], v[136:139]
ds_read_b64_tr_b16 a[194:195], v3 offset:47104
v_mfma_f32_16x16x32_bf16 v[136:139], a[8:11], a[72:75], v[136:139]
buffer_store_dwordx4 v[208:211], v10, s[16:19], 0 offen sc1
v_mfma_f32_16x16x32_bf16 v[136:139], a[12:15], a[88:91], v[136:139]
v_mfma_f32_16x16x32_bf16 v[140:143], a[12:15], a[92:95], 0
v_mfma_f32_16x16x32_bf16 v[140:143], a[8:11], a[76:79], v[140:143]
v_mfma_f32_16x16x32_bf16 v[140:143], a[4:7], a[60:63], v[140:143]
v_mfma_f32_16x16x32_bf16 v[140:143], a[0:3], a[44:47], v[140:143]
s_waitcnt vmcnt(4) lgkmcnt(0)
v_mfma_f32_16x16x32_bf16 v[128:131], a[176:179], a[112:115], v[128:131]
s_barrier
ds_read_b64_tr_b16 a[0:1], v2 offset:49152
v_mov_b32 v21, 0
v_mfma_f32_16x16x32_bf16 v[128:131], a[180:183], a[128:131], v[128:131]
ds_read_b64_tr_b16 a[2:3], v2 offset:51200
ds_read_b32 a24, v23
v_mfma_f32_16x16x32_bf16 v[128:131], a[184:187], a[144:147], v[128:131]
ds_read_b64_tr_b16 a[4:5], v2 offset:53248
buffer_load_dwordx4 v8, s[28:31], 0 offen sc1 lds
v_mfma_f32_16x16x32_bf16 v[128:131], a[188:191], a[160:163], v[128:131]
s_add_u32 m0, s47, 81920
ds_read_b64_tr_b16 a[6:7], v2 offset:55296
v_add_u32 v8, 0x1000, v8
v_mfma_f32_16x16x32_bf16 v[128:131], a[192:195], a[96:99], v[128:131]
ds_read_b64_tr_b16 a[8:9], v2 offset:57344
ds_read_b128 a[20:23], v22 offset:2432
v_mfma_f32_16x16x32_bf16 v[132:135], a[192:195], a[100:103], v[132:135]
ds_read_b64_tr_b16 a[10:11], v2 offset:59392
ds_read_b128 a[16:19], v22
v_mfma_f32_16x16x32_bf16 v[132:135], a[188:191], a[164:167], v[132:135]
ds_read_b64_tr_b16 a[12:13], v2 offset:61440
v_mov_b32 v46, 0x3f803f80
v_mfma_f32_16x16x32_bf16 v[132:135], a[184:187], a[148:151], v[132:135]
ds_read_b64_tr_b16 a[14:15], v2 offset:63488
v_add_u32 v2, 0x10000, v2
v_mfma_f32_16x16x32_bf16 v[132:135], a[180:183], a[132:135], v[132:135]
buffer_load_dwordx4 v8, s[28:31], 0 offen sc1 lds
v_mfma_f32_16x16x32_bf16 v[132:135], a[176:179], a[116:119], v[132:135]
s_add_u32 m0, s47, 86016
v_add_u32 v8, 0x1000, v8
v_accvgpr_write_b32 a25, v46
v_mfma_f32_16x16x32_bf16 v[136:139], a[176:179], a[120:123], v[136:139]
v_accvgpr_write_b32 a27, v46
v_mov_b32 v46, 0
v_mfma_f32_16x16x32_bf16 v[136:139], a[180:183], a[136:139], v[136:139]
v_mfma_f32_16x16x32_bf16 v[136:139], a[184:187], a[152:155], v[136:139]
v_cvt_pk_bf16_f32 v242, v128, v129
v_cvt_pk_bf16_f32 v243, v130, v131
v_mfma_f32_16x16x32_bf16 v[136:139], a[188:191], a[168:171], v[136:139]
v_mfma_f32_16x16x32_bf16 v[136:139], a[192:195], a[104:107], v[136:139]
s_add_u32 s16, s16, 16384
s_addc_u32 s17, s17, 0
buffer_load_dwordx4 v8, s[28:31], 0 offen sc1 lds
v_mfma_f32_16x16x32_bf16 v[140:143], a[192:195], a[108:111], v[140:143]
s_add_u32 m0, s47, 90112
v_add_u32 v8, 0x1000, v8
v_mfma_f32_16x16x32_bf16 v[140:143], a[188:191], a[172:175], v[140:143]
v_mfma_f32_16x16x32_bf16 v[140:143], a[184:187], a[156:159], v[140:143]
v_cvt_pk_bf16_f32 v246, v132, v133
v_cvt_pk_bf16_f32 v247, v134, v135
v_mfma_f32_16x16x32_bf16 v[140:143], a[180:183], a[140:143], v[140:143]
v_mfma_f32_16x16x32_bf16 v[140:143], a[176:179], a[124:127], v[140:143]
s_waitcnt lgkmcnt(2)
v_mfma_f32_32x32x4_2b_bf16 v[144:175], a[24:25], v[20:21], 0 cbsz:1 abid:1
s_waitcnt lgkmcnt(0)
buffer_store_dwordx4 v[212:215], v10, s[16:19], 0 offen sc1
v_mov_b32 v176, 0
v_mov_b32 v177, 0
v_mov_b32 v178, 0
v_mov_b32 v179, 0
v_mov_b32 v180, 0
v_mov_b32 v181, 0
v_mov_b32 v182, 0
v_mov_b32 v183, 0
v_mov_b32 v184, 0
v_mov_b32 v185, 0
v_mfma_f32_16x16x32_bf16 v[112:115], a[0:3], a[32:35], 0
ds_read_b64_tr_b16 a[176:177], v2
buffer_load_dwordx4 v8, s[28:31], 0 offen sc1 lds
v_mfma_f32_16x16x32_bf16 v[112:115], a[4:7], a[48:51], v[112:115]
s_add_u32 m0, s47, 94208
ds_read_b64_tr_b16 a[178:179], v2 offset:2048
v_add_u32 v8, 0x1000, v8
v_mfma_f32_16x16x32_bf16 v[112:115], a[8:11], a[64:67], v[112:115]
ds_read_b64_tr_b16 a[180:181], v2 offset:4096
v_cvt_pk_bf16_f32 v66, v136, v137
v_mfma_f32_16x16x32_bf16 v[112:115], a[12:15], a[80:83], v[112:115]
ds_read_b64_tr_b16 a[182:183], v2 offset:6144
v_cvt_pk_bf16_f32 v67, v138, v139
v_mfma_f32_32x32x16_bf16 v[144:159], a[20:23], v[12:15], v[144:159]
ds_read_b64_tr_b16 a[184:185], v2 offset:8192
buffer_load_dwordx4 v8, s[28:31], 0 offen sc1 lds
v_mfma_f32_32x32x16_bf16 v[160:175], a[20:23], v[16:19], v[160:175]
s_add_u32 m0, s47, 98304
ds_read_b64_tr_b16 a[186:187], v2 offset:10240
v_add_u32 v8, 0x1000, v8
v_mfma_f32_16x16x32_bf16 v[116:119], a[12:15], a[84:87], 0
ds_read_b64_tr_b16 a[188:189], v2 offset:12288
v_cvt_pk_bf16_f32 v70, v140, v141
v_mfma_f32_16x16x32_bf16 v[116:119], a[8:11], a[68:71], v[116:119]
ds_read_b64_tr_b16 a[190:191], v2 offset:14336
v_cvt_pk_bf16_f32 v71, v142, v143
v_mfma_f32_16x16x32_bf16 v[116:119], a[4:7], a[52:55], v[116:119]
ds_read_b64_tr_b16 a[192:193], v2 offset:16384
buffer_load_dwordx4 v8, s[28:31], 0 offen sc1 lds
v_mfma_f32_16x16x32_bf16 v[116:119], a[0:3], a[36:39], v[116:119]
s_add_u32 m0, s47, 102400
ds_read_b64_tr_b16 a[194:195], v2 offset:18432
v_add_u32 v8, 0x1000, v8
v_mfma_f32_16x16x32_bf16 v[120:123], a[0:3], a[40:43], 0
v_max_f32 v44, v144, v145
v_max3_f32 v44, v146, v147, v44
v_mfma_f32_16x16x32_bf16 v[120:123], a[4:7], a[56:59], v[120:123]
v_max3_f32 v44, v148, v149, v44
v_max3_f32 v44, v150, v151, v44
v_mfma_f32_16x16x32_bf16 v[120:123], a[8:11], a[72:75], v[120:123]
v_max3_f32 v44, v152, v153, v44
v_max3_f32 v44, v154, v155, v44
v_mfma_f32_16x16x32_bf16 v[120:123], a[12:15], a[88:91], v[120:123]
buffer_load_dwordx4 v8, s[28:31], 0 offen sc1 lds
v_mfma_f32_16x16x32_bf16 v[124:127], a[12:15], a[92:95], 0
s_add_u32 m0, s47, 106496
v_add_u32 v8, 0x1000, v8
v_max3_f32 v44, v156, v157, v44
v_mfma_f32_16x16x32_bf16 v[124:127], a[8:11], a[76:79], v[124:127]
v_max3_f32 v44, v158, v159, v44
v_max_f32 v45, v160, v161
v_mfma_f32_16x16x32_bf16 v[124:127], a[4:7], a[60:63], v[124:127]
v_max3_f32 v45, v162, v163, v45
v_max3_f32 v45, v164, v165, v45
v_mfma_f32_16x16x32_bf16 v[124:127], a[0:3], a[44:47], v[124:127]
s_waitcnt lgkmcnt(0)
v_max3_f32 v45, v166, v167, v45
v_max3_f32 v45, v168, v169, v45
v_mfma_f32_16x16x32_bf16 v[112:115], a[176:179], a[112:115], v[112:115]
ds_read_b64_tr_b16 a[0:1], v3 offset:49152
v_max3_f32 v45, v170, v171, v45
v_mfma_f32_16x16x32_bf16 v[112:115], a[180:183], a[128:131], v[112:115]
ds_read_b64_tr_b16 a[2:3], v3 offset:51200
buffer_load_dwordx4 v8, s[28:31], 0 offen sc1 lds
v_mfma_f32_16x16x32_bf16 v[112:115], a[184:187], a[144:147], v[112:115]
s_add_u32 m0, s47, 110592
ds_read_b64_tr_b16 a[4:5], v3 offset:53248
v_add_u32 v8, 0x1000, v8
v_mfma_f32_16x16x32_bf16 v[112:115], a[188:191], a[160:163], v[112:115]
ds_read_b64_tr_b16 a[6:7], v3 offset:55296
v_max3_f32 v45, v172, v173, v45
v_mfma_f32_16x16x32_bf16 v[112:115], a[192:195], a[96:99], v[112:115]
s_add_u32 s16, s16, 16384
s_addc_u32 s17, s17, 0
ds_read_b64_tr_b16 a[8:9], v3 offset:57344
v_max3_f32 v45, v174, v175, v45
v_mfma_f32_16x16x32_bf16 v[116:119], a[192:195], a[100:103], v[116:119]
ds_read_b64_tr_b16 a[10:11], v3 offset:59392
v_mfma_f32_16x16x32_bf16 v[116:119], a[188:191], a[164:167], v[116:119]
ds_read_b64_tr_b16 a[12:13], v3 offset:61440
v_mfma_f32_16x16x32_bf16 v[116:119], a[184:187], a[148:151], v[116:119]
ds_read_b64_tr_b16 a[14:15], v3 offset:63488
v_add_u32 v3, 0x10000, v3
v_mfma_f32_16x16x32_bf16 v[116:119], a[180:183], a[132:135], v[116:119]
v_mfma_f32_16x16x32_bf16 v[116:119], a[176:179], a[116:119], v[116:119]
v_mfma_f32_32x32x4_2b_bf16 v[144:175], a[24:25], v[20:21], 0 cbsz:1 abid:0
buffer_store_dwordx4 v[216:219], v10, s[16:19], 0 offen sc1
v_mov_b32 v192, 0
v_mov_b32 v193, 0
v_mov_b32 v194, 0
v_mov_b32 v195, 0
v_mov_b32 v196, 0
v_mov_b32 v197, 0
v_mov_b32 v198, 0
v_mov_b32 v199, 0
v_mov_b32 v200, 0
v_mov_b32 v201, 0
v_mfma_f32_16x16x32_bf16 v[120:123], a[176:179], a[120:123], v[120:123]
buffer_load_dwordx4 v8, s[28:31], 0 offen sc1 lds
v_mfma_f32_16x16x32_bf16 v[120:123], a[180:183], a[136:139], v[120:123]
v_cvt_pk_bf16_f32 v248, v112, v113
v_cvt_pk_bf16_f32 v249, v114, v115
v_mfma_f32_16x16x32_bf16 v[120:123], a[184:187], a[152:155], v[120:123]
v_mfma_f32_16x16x32_bf16 v[120:123], a[188:191], a[168:171], v[120:123]
v_mfma_f32_16x16x32_bf16 v[120:123], a[192:195], a[104:107], v[120:123]
v_mfma_f32_16x16x32_bf16 v[124:127], a[192:195], a[108:111], v[124:127]
v_mfma_f32_16x16x32_bf16 v[124:127], a[188:191], a[172:175], v[124:127]
v_cvt_pk_bf16_f32 v252, v116, v117
v_cvt_pk_bf16_f32 v253, v118, v119
v_mfma_f32_16x16x32_bf16 v[124:127], a[184:187], a[156:159], v[124:127]
v_mfma_f32_16x16x32_bf16 v[124:127], a[180:183], a[140:143], v[124:127]
v_mfma_f32_16x16x32_bf16 v[124:127], a[176:179], a[124:127], v[124:127]
v_mfma_f32_32x32x16_bf16 v[144:159], a[16:19], v[12:15], v[144:159]
v_mfma_f32_32x32x16_bf16 v[160:175], a[16:19], v[16:19], v[160:175]
s_waitcnt lgkmcnt(0)
v_mfma_f32_16x16x32_bf16 v[128:131], a[0:3], a[32:35], 0
ds_read_b64_tr_b16 a[176:177], v3
v_cvt_pk_bf16_f32 v72, v120, v121
v_mfma_f32_16x16x32_bf16 v[128:131], a[4:7], a[48:51], v[128:131]
ds_read_b64_tr_b16 a[178:179], v3 offset:2048
L_pad12:
s_cbranch_execz L_hret0
v_cvt_pk_bf16_f32 v73, v122, v123
v_mfma_f32_16x16x32_bf16 v[128:131], a[8:11], a[64:67], v[128:131]
ds_read_b64_tr_b16 a[180:181], v3 offset:4096
v_mfma_f32_16x16x32_bf16 v[128:131], a[12:15], a[80:83], v[128:131]
ds_read_b64_tr_b16 a[182:183], v3 offset:6144
v_mfma_f32_16x16x32_bf16 v[132:135], a[12:15], a[84:87], 0
ds_read_b64_tr_b16 a[184:185], v3 offset:8192
v_max3_f32 v44, v144, v145, v44
v_mfma_f32_16x16x32_bf16 v[132:135], a[8:11], a[68:71], v[132:135]
ds_read_b64_tr_b16 a[186:187], v3 offset:10240
v_cvt_pk_bf16_f32 v76, v124, v125
v_mfma_f32_16x16x32_bf16 v[132:135], a[4:7], a[52:55], v[132:135]
ds_read_b64_tr_b16 a[188:189], v3 offset:12288
v_cvt_pk_bf16_f32 v77, v126, v127
v_mfma_f32_16x16x32_bf16 v[132:135], a[0:3], a[36:39], v[132:135]
ds_read_b64_tr_b16 a[190:191], v3 offset:14336
v_max3_f32 v44, v146, v147, v44
v_mfma_f32_16x16x32_bf16 v[136:139], a[0:3], a[40:43], 0
ds_read_b64_tr_b16 a[192:193], v3 offset:16384
v_max3_f32 v44, v148, v149, v44
v_mfma_f32_16x16x32_bf16 v[136:139], a[4:7], a[56:59], v[136:139]
ds_read_b64_tr_b16 a[194:195], v3 offset:18432
v_max3_f32 v44, v150, v151, v44
v_mfma_f32_16x16x32_bf16 v[136:139], a[8:11], a[72:75], v[136:139]
v_max3_f32 v44, v152, v153, v44
v_max3_f32 v44, v154, v155, v44
v_mfma_f32_16x16x32_bf16 v[136:139], a[12:15], a[88:91], v[136:139]
v_max3_f32 v44, v156, v157, v44
v_max3_f32 v44, v158, v159, v44
v_mfma_f32_16x16x32_bf16 v[140:143], a[12:15], a[92:95], 0
v_max3_f32 v45, v160, v161, v45
v_max3_f32 v45, v162, v163, v45
v_mfma_f32_16x16x32_bf16 v[140:143], a[8:11], a[76:79], v[140:143]
v_max3_f32 v45, v164, v165, v45
v_max3_f32 v45, v166, v167, v45
v_mfma_f32_16x16x32_bf16 v[140:143], a[4:7], a[60:63], v[140:143]
v_max3_f32 v45, v168, v169, v45
v_max3_f32 v45, v170, v171, v45
v_mfma_f32_16x16x32_bf16 v[140:143], a[0:3], a[44:47], v[140:143]
s_waitcnt lgkmcnt(0)
v_max3_f32 v45, v172, v173, v45
v_max3_f32 v45, v174, v175, v45
v_mfma_f32_16x16x32_bf16 v[128:131], a[176:179], a[112:115], v[128:131]
s_nop 0
v_permlane32_swap_b32 v44, v45
v_mfma_f32_16x16x32_bf16 v[128:131], a[180:183], a[128:131], v[128:131]
v_max_f32 v44, v44, v45
v_sub_f32 v44, 3266576384, v44
v_mfma_f32_16x16x32_bf16 v[128:131], a[184:187], a[144:147], v[128:131]
v_cvt_pk_bf16_f32 v45, v44, v44
v_and_b32 v45, 0xffff0000, v45
v_mfma_f32_16x16x32_bf16 v[128:131], a[188:191], a[160:163], v[128:131]
v_sub_f32 v44, v44, v45
v_cvt_pk_bf16_f32 v47, v45, v44
v_mfma_f32_16x16x32_bf16 v[128:131], a[192:195], a[96:99], v[128:131]
s_add_u32 s16, s16, 16384
s_addc_u32 s17, s17, 0
v_mov_b32 v21, v47
v_mfma_f32_16x16x32_bf16 v[132:135], a[192:195], a[100:103], v[132:135]
v_mfma_f32_16x16x32_bf16 v[132:135], a[188:191], a[164:167], v[132:135]
v_mfma_f32_16x16x32_bf16 v[132:135], a[184:187], a[148:151], v[132:135]
v_mfma_f32_16x16x32_bf16 v[132:135], a[180:183], a[132:135], v[132:135]
v_mfma_f32_16x16x32_bf16 v[132:135], a[176:179], a[116:119], v[132:135]
v_mfma_f32_32x32x4_2b_bf16 v[144:175], a[24:25], v[46:47], v[144:175] cbsz:1 abid:0
buffer_store_dwordx4 v[220:223], v10, s[16:19], 0 offen sc1
v_mfma_f32_16x16x32_bf16 v[136:139], a[176:179], a[120:123], v[136:139]
v_mfma_f32_16x16x32_bf16 v[136:139], a[180:183], a[136:139], v[136:139]
v_cvt_pk_bf16_f32 v250, v128, v129
v_cvt_pk_bf16_f32 v251, v130, v131
v_mfma_f32_16x16x32_bf16 v[136:139], a[184:187], a[152:155], v[136:139]
v_mfma_f32_16x16x32_bf16 v[136:139], a[188:191], a[168:171], v[136:139]
v_mfma_f32_16x16x32_bf16 v[136:139], a[192:195], a[104:107], v[136:139]
v_mfma_f32_16x16x32_bf16 v[140:143], a[192:195], a[108:111], v[140:143]
v_mfma_f32_16x16x32_bf16 v[140:143], a[188:191], a[172:175], v[140:143]
v_cvt_pk_bf16_f32 v254, v132, v133
v_cvt_pk_bf16_f32 v255, v134, v135
v_mfma_f32_16x16x32_bf16 v[140:143], a[184:187], a[156:159], v[140:143]
v_mfma_f32_16x16x32_bf16 v[140:143], a[180:183], a[140:143], v[140:143]
v_mfma_f32_16x16x32_bf16 v[140:143], a[176:179], a[124:127], v[140:143]
ds_read_b128 a[32:35], v24
ds_read_b128 a[36:39], v25
v_cvt_pk_bf16_f32 v74, v136, v137
v_cvt_pk_bf16_f32 v75, v138, v139
s_nop 3
v_cvt_pk_bf16_f32 v78, v140, v141
v_cvt_pk_bf16_f32 v79, v142, v143
v_exp_f32 v144, v144
v_exp_f32 v145, v145
v_exp_f32 v146, v146
v_exp_f32 v147, v147
v_exp_f32 v148, v148
v_mfma_f32_32x32x4_2b_bf16 v[112:143], a[24:25], v[20:21], 0 cbsz:1 abid:1
v_exp_f32 v149, v149
v_exp_f32 v150, v150
v_exp_f32 v151, v151
v_exp_f32 v152, v152
v_exp_f32 v153, v153
v_exp_f32 v154, v154
v_exp_f32 v155, v155
v_exp_f32 v156, v156
s_waitcnt lgkmcnt(1)
v_smfmac_f32_32x32x32_bf16 v[176:191], a[32:35], v[144:151], v26
s_add_u32 s16, s16, 16384
s_addc_u32 s17, s17, 0
ds_read_b128 a[40:43], v24 offset:2432
ds_read_b128 a[44:47], v25 offset:2432
ds_read_b128 a[16:19], v22 offset:4864
ds_read_b32 a26, v23 offset:4864
v_exp_f32 v157, v157
v_exp_f32 v158, v158
v_exp_f32 v159, v159
v_exp_f32 v160, v160
v_exp_f32 v161, v161
s_waitcnt lgkmcnt(4)
v_smfmac_f32_32x32x32_bf16 v[176:191], a[36:39], v[152:159], v26
buffer_store_dwordx4 v[224:227], v10, s[16:19], 0 offen sc1
v_exp_f32 v162, v162
v_exp_f32 v163, v163
v_exp_f32 v164, v164
v_mfma_f32_32x32x16_bf16 v[112:127], a[20:23], v[12:15], v[112:127]
s_mul_i32 s1, s1, 3
v_exp_f32 v165, v165
v_exp_f32 v166, v166
v_exp_f32 v167, v167
v_mfma_f32_32x32x16_bf16 v[128:143], a[20:23], v[16:19], v[128:143]
s_waitcnt lgkmcnt(0)
v_exp_f32 v168, v168
v_exp_f32 v169, v169
v_exp_f32 v170, v170
v_exp_f32 v171, v171
v_smfmac_f32_32x32x32_bf16 v[192:207], a[32:35], v[160:167], v26
s_min_u32 s1, s1, 16
v_exp_f32 v172, v172
v_exp_f32 v173, v173
v_exp_f32 v174, v174
v_exp_f32 v175, v175
v_exp_f32 v112, v112
v_exp_f32 v113, v113
v_smfmac_f32_32x32x32_bf16 v[192:207], a[36:39], v[168:175], v26
ds_read_b128 a[20:23], v22 offset:7296
v_exp_f32 v114, v114
v_exp_f32 v115, v115
v_exp_f32 v116, v116
v_mfma_f32_32x32x4_2b_bf16 v[144:175], a[26:27], v[20:21], 0 cbsz:1 abid:0
v_exp_f32 v117, v117
v_exp_f32 v118, v118
v_exp_f32 v119, v119
v_exp_f32 v120, v120
v_exp_f32 v121, v121
v_exp_f32 v122, v122
v_exp_f32 v123, v123
v_exp_f32 v124, v124
v_smfmac_f32_32x32x32_bf16 v[176:191], a[40:43], v[112:119], v26
s_add_u32 s16, s16, 16384
s_addc_u32 s17, s17, 0
ds_read_b128 a[32:35], v24 offset:4864
ds_read_b128 a[36:39], v25 offset:4864
v_exp_f32 v125, v125
v_exp_f32 v126, v126
v_exp_f32 v127, v127
v_exp_f32 v128, v128
v_exp_f32 v129, v129
v_smfmac_f32_32x32x32_bf16 v[176:191], a[44:47], v[120:127], v26
buffer_store_dwordx4 v[228:231], v10, s[16:19], 0 offen sc1
v_exp_f32 v130, v130
v_exp_f32 v131, v131
v_exp_f32 v132, v132
v_mfma_f32_32x32x16_bf16 v[144:159], a[16:19], v[12:15], v[144:159]
v_exp_f32 v133, v133
v_exp_f32 v134, v134
v_exp_f32 v135, v135
v_mfma_f32_32x32x16_bf16 v[160:175], a[16:19], v[16:19], v[160:175]
s_waitcnt lgkmcnt(0)
v_exp_f32 v136, v136
v_exp_f32 v137, v137
v_exp_f32 v138, v138
v_exp_f32 v139, v139
v_smfmac_f32_32x32x32_bf16 v[192:207], a[40:43], v[128:135], v26
v_exp_f32 v140, v140
v_exp_f32 v141, v141
v_exp_f32 v142, v142
v_exp_f32 v143, v143
v_exp_f32 v144, v144
v_exp_f32 v145, v145
v_smfmac_f32_32x32x32_bf16 v[192:207], a[44:47], v[136:143], v26
ds_read_b128 a[16:19], v22 offset:9728
ds_read_b32 a24, v23 offset:9728
v_exp_f32 v146, v146
v_exp_f32 v147, v147
v_exp_f32 v148, v148
v_mfma_f32_32x32x4_2b_bf16 v[112:143], a[26:27], v[20:21], 0 cbsz:1 abid:1
v_exp_f32 v149, v149
v_exp_f32 v150, v150
v_exp_f32 v151, v151
v_exp_f32 v152, v152
v_exp_f32 v153, v153
v_exp_f32 v154, v154
v_exp_f32 v155, v155
v_exp_f32 v156, v156
v_smfmac_f32_32x32x32_bf16 v[176:191], a[32:35], v[144:151], v26
s_add_u32 s16, s16, 16384
s_addc_u32 s17, s17, 0
ds_read_b128 a[40:43], v24 offset:7296
ds_read_b128 a[44:47], v25 offset:7296
v_exp_f32 v157, v157
v_exp_f32 v158, v158
v_exp_f32 v159, v159
v_exp_f32 v160, v160
v_exp_f32 v161, v161
v_smfmac_f32_32x32x32_bf16 v[176:191], a[36:39], v[152:159], v26
buffer_store_dwordx4 v[232:235], v10, s[16:19], 0 offen sc1
v_exp_f32 v162, v162
v_exp_f32 v163, v163
v_exp_f32 v164, v164
v_mfma_f32_32x32x16_bf16 v[112:127], a[20:23], v[12:15], v[112:127]
v_exp_f32 v165, v165
v_exp_f32 v166, v166
v_exp_f32 v167, v167
v_mfma_f32_32x32x16_bf16 v[128:143], a[20:23], v[16:19], v[128:143]
s_waitcnt lgkmcnt(0)
v_exp_f32 v168, v168
v_exp_f32 v169, v169
v_exp_f32 v170, v170
v_exp_f32 v171, v171
v_smfmac_f32_32x32x32_bf16 v[192:207], a[32:35], v[160:167], v26
v_exp_f32 v172, v172
v_exp_f32 v173, v173
v_exp_f32 v174, v174
v_exp_f32 v175, v175
v_exp_f32 v112, v112
v_exp_f32 v113, v113
v_smfmac_f32_32x32x32_bf16 v[192:207], a[36:39], v[168:175], v26
ds_read_b128 a[20:23], v22 offset:12160
v_exp_f32 v114, v114
v_exp_f32 v115, v115
v_exp_f32 v116, v116
v_mfma_f32_32x32x4_2b_bf16 v[144:175], a[24:25], v[20:21], 0 cbsz:1 abid:0
v_exp_f32 v117, v117
v_exp_f32 v118, v118
v_exp_f32 v119, v119
v_exp_f32 v120, v120
v_exp_f32 v121, v121
v_exp_f32 v122, v122
v_exp_f32 v123, v123
v_exp_f32 v124, v124
v_smfmac_f32_32x32x32_bf16 v[176:191], a[40:43], v[112:119], v26
s_add_u32 s16, s16, 16384
s_addc_u32 s17, s17, 0
ds_read_b128 a[32:35], v24 offset:9728
ds_read_b128 a[36:39], v25 offset:9728
v_exp_f32 v125, v125
v_exp_f32 v126, v126
v_exp_f32 v127, v127
v_exp_f32 v128, v128
v_exp_f32 v129, v129
v_smfmac_f32_32x32x32_bf16 v[176:191], a[44:47], v[120:127], v26
buffer_store_dwordx4 v[236:239], v10, s[16:19], 0 offen sc1
v_exp_f32 v130, v130
v_exp_f32 v131, v131
v_exp_f32 v132, v132
v_mfma_f32_32x32x16_bf16 v[144:159], a[16:19], v[12:15], v[144:159]
v_exp_f32 v133, v133
v_exp_f32 v134, v134
v_exp_f32 v135, v135
v_mfma_f32_32x32x16_bf16 v[160:175], a[16:19], v[16:19], v[160:175]
s_waitcnt lgkmcnt(0)
v_exp_f32 v136, v136
v_exp_f32 v137, v137
v_exp_f32 v138, v138
v_exp_f32 v139, v139
v_smfmac_f32_32x32x32_bf16 v[192:207], a[40:43], v[128:135], v26
v_exp_f32 v140, v140
v_exp_f32 v141, v141
v_exp_f32 v142, v142
v_exp_f32 v143, v143
v_exp_f32 v144, v144
v_exp_f32 v145, v145
v_smfmac_f32_32x32x32_bf16 v[192:207], a[44:47], v[136:143], v26
ds_read_b128 a[16:19], v22 offset:14592
ds_read_b32 a26, v23 offset:14592
v_exp_f32 v146, v146
v_exp_f32 v147, v147
v_exp_f32 v148, v148
v_mfma_f32_32x32x4_2b_bf16 v[112:143], a[24:25], v[20:21], 0 cbsz:1 abid:1
v_exp_f32 v149, v149
v_exp_f32 v150, v150
v_exp_f32 v151, v151
v_exp_f32 v152, v152
v_exp_f32 v153, v153
v_exp_f32 v154, v154
v_exp_f32 v155, v155
v_exp_f32 v156, v156
v_smfmac_f32_32x32x32_bf16 v[176:191], a[32:35], v[144:151], v26
s_add_u32 s16, s16, 16384
s_addc_u32 s17, s17, 0
ds_read_b128 a[40:43], v24 offset:12160
ds_read_b128 a[44:47], v25 offset:12160
v_exp_f32 v157, v157
v_exp_f32 v158, v158
v_exp_f32 v159, v159
v_exp_f32 v160, v160
v_exp_f32 v161, v161
v_smfmac_f32_32x32x32_bf16 v[176:191], a[36:39], v[152:159], v26
buffer_store_dwordx4 v[240:243], v10, s[16:19], 0 offen sc1
v_exp_f32 v162, v162
v_exp_f32 v163, v163
v_exp_f32 v164, v164
v_mfma_f32_32x32x16_bf16 v[112:127], a[20:23], v[12:15], v[112:127]
v_exp_f32 v165, v165
v_exp_f32 v166, v166
v_exp_f32 v167, v167
v_mfma_f32_32x32x16_bf16 v[128:143], a[20:23], v[16:19], v[128:143]
s_waitcnt lgkmcnt(0)
v_exp_f32 v168, v168
v_exp_f32 v169, v169
v_exp_f32 v170, v170
v_exp_f32 v171, v171
v_smfmac_f32_32x32x32_bf16 v[192:207], a[32:35], v[160:167], v26
v_exp_f32 v172, v172
v_exp_f32 v173, v173
v_exp_f32 v174, v174
v_exp_f32 v175, v175
v_exp_f32 v112, v112
v_exp_f32 v113, v113
v_smfmac_f32_32x32x32_bf16 v[192:207], a[36:39], v[168:175], v26
ds_read_b128 a[20:23], v22 offset:17024
v_exp_f32 v114, v114
v_exp_f32 v115, v115
v_exp_f32 v116, v116
v_mfma_f32_32x32x4_2b_bf16 v[144:175], a[26:27], v[20:21], 0 cbsz:1 abid:0
v_exp_f32 v117, v117
v_exp_f32 v118, v118
v_exp_f32 v119, v119
v_exp_f32 v120, v120
v_exp_f32 v121, v121
v_exp_f32 v122, v122
v_exp_f32 v123, v123
v_exp_f32 v124, v124
v_smfmac_f32_32x32x32_bf16 v[176:191], a[40:43], v[112:119], v26
s_add_u32 s16, s16, 16384
s_addc_u32 s17, s17, 0
ds_read_b128 a[32:35], v24 offset:14592
ds_read_b128 a[36:39], v25 offset:14592
v_exp_f32 v125, v125
v_exp_f32 v126, v126
v_exp_f32 v127, v127
v_exp_f32 v128, v128
v_exp_f32 v129, v129
v_smfmac_f32_32x32x32_bf16 v[176:191], a[44:47], v[120:127], v26
buffer_store_dwordx4 v[244:247], v10, s[16:19], 0 offen sc1
v_exp_f32 v130, v130
v_exp_f32 v131, v131
v_exp_f32 v132, v132
v_mfma_f32_32x32x16_bf16 v[144:159], a[16:19], v[12:15], v[144:159]
v_exp_f32 v133, v133
v_exp_f32 v134, v134
v_exp_f32 v135, v135
v_mfma_f32_32x32x16_bf16 v[160:175], a[16:19], v[16:19], v[160:175]
s_waitcnt lgkmcnt(0)
v_exp_f32 v136, v136
v_exp_f32 v137, v137
v_exp_f32 v138, v138
v_exp_f32 v139, v139
v_smfmac_f32_32x32x32_bf16 v[192:207], a[40:43], v[128:135], v26
v_exp_f32 v140, v140
v_exp_f32 v141, v141
v_exp_f32 v142, v142
v_exp_f32 v143, v143
v_exp_f32 v144, v144
v_exp_f32 v145, v145
v_smfmac_f32_32x32x32_bf16 v[192:207], a[44:47], v[136:143], v26
ds_read_b128 a[16:19], v22 offset:19456
ds_read_b32 a24, v23 offset:19456
v_exp_f32 v146, v146
v_exp_f32 v147, v147
v_exp_f32 v148, v148
v_mfma_f32_32x32x4_2b_bf16 v[112:143], a[26:27], v[20:21], 0 cbsz:1 abid:1
v_exp_f32 v149, v149
v_exp_f32 v150, v150
v_exp_f32 v151, v151
v_exp_f32 v152, v152
v_exp_f32 v153, v153
v_exp_f32 v154, v154
v_exp_f32 v155, v155
v_exp_f32 v156, v156
v_smfmac_f32_32x32x32_bf16 v[176:191], a[32:35], v[144:151], v26
s_add_u32 s16, s16, 16384
s_addc_u32 s17, s17, 0
ds_read_b128 a[40:43], v24 offset:17024
ds_read_b128 a[44:47], v25 offset:17024
v_exp_f32 v157, v157
v_exp_f32 v158, v158
v_exp_f32 v159, v159
v_exp_f32 v160, v160
v_exp_f32 v161, v161
v_smfmac_f32_32x32x32_bf16 v[176:191], a[36:39], v[152:159], v26
buffer_store_dwordx4 v[248:251], v10, s[16:19], 0 offen sc1
v_exp_f32 v162, v162
v_exp_f32 v163, v163
v_exp_f32 v164, v164
v_mfma_f32_32x32x16_bf16 v[112:127], a[20:23], v[12:15], v[112:127]
v_exp_f32 v165, v165
v_exp_f32 v166, v166
v_exp_f32 v167, v167
v_mfma_f32_32x32x16_bf16 v[128:143], a[20:23], v[16:19], v[128:143]
s_waitcnt lgkmcnt(0)
v_exp_f32 v168, v168
v_exp_f32 v169, v169
v_exp_f32 v170, v170
v_exp_f32 v171, v171
v_smfmac_f32_32x32x32_bf16 v[192:207], a[32:35], v[160:167], v26
v_exp_f32 v172, v172
v_exp_f32 v173, v173
v_exp_f32 v174, v174
v_exp_f32 v175, v175
v_exp_f32 v112, v112
v_exp_f32 v113, v113
v_smfmac_f32_32x32x32_bf16 v[192:207], a[36:39], v[168:175], v26
ds_read_b128 a[20:23], v22 offset:21888
v_exp_f32 v114, v114
v_exp_f32 v115, v115
v_exp_f32 v116, v116
v_mfma_f32_32x32x4_2b_bf16 v[144:175], a[24:25], v[20:21], 0 cbsz:1 abid:0
v_exp_f32 v117, v117
v_exp_f32 v118, v118
v_exp_f32 v119, v119
v_exp_f32 v120, v120
v_exp_f32 v121, v121
v_exp_f32 v122, v122
v_exp_f32 v123, v123
v_exp_f32 v124, v124
v_smfmac_f32_32x32x32_bf16 v[176:191], a[40:43], v[112:119], v26
s_add_u32 s16, s16, 16384
s_addc_u32 s17, s17, 0
ds_read_b128 a[32:35], v24 offset:19456
ds_read_b128 a[36:39], v25 offset:19456
v_exp_f32 v125, v125
v_exp_f32 v126, v126
v_exp_f32 v127, v127
v_exp_f32 v128, v128
v_exp_f32 v129, v129
v_smfmac_f32_32x32x32_bf16 v[176:191], a[44:47], v[120:127], v26
buffer_store_dwordx4 v[252:255], v10, s[16:19], 0 offen sc1
v_exp_f32 v130, v130
v_exp_f32 v131, v131
v_exp_f32 v132, v132
v_mfma_f32_32x32x16_bf16 v[144:159], a[16:19], v[12:15], v[144:159]
v_exp_f32 v133, v133
v_exp_f32 v134, v134
v_exp_f32 v135, v135
v_mfma_f32_32x32x16_bf16 v[160:175], a[16:19], v[16:19], v[160:175]
s_waitcnt lgkmcnt(0)
v_exp_f32 v136, v136
v_exp_f32 v137, v137
v_exp_f32 v138, v138
v_exp_f32 v139, v139
v_smfmac_f32_32x32x32_bf16 v[192:207], a[40:43], v[128:135], v26
v_exp_f32 v140, v140
v_exp_f32 v141, v141
v_exp_f32 v142, v142
v_exp_f32 v143, v143
v_exp_f32 v144, v144
v_exp_f32 v145, v145
v_smfmac_f32_32x32x32_bf16 v[192:207], a[44:47], v[136:143], v26
ds_read_b128 a[16:19], v22 offset:24320
ds_read_b32 a26, v23 offset:24320
v_exp_f32 v146, v146
v_exp_f32 v147, v147
v_exp_f32 v148, v148
v_mfma_f32_32x32x4_2b_bf16 v[112:143], a[24:25], v[20:21], 0 cbsz:1 abid:1
v_exp_f32 v149, v149
v_exp_f32 v150, v150
v_exp_f32 v151, v151
v_exp_f32 v152, v152
v_exp_f32 v153, v153
v_exp_f32 v154, v154
v_exp_f32 v155, v155
v_exp_f32 v156, v156
v_smfmac_f32_32x32x32_bf16 v[176:191], a[32:35], v[144:151], v26
s_add_u32 s20, s20, s5
s_addc_u32 s21, s21, 0
ds_read_b128 a[40:43], v24 offset:21888
ds_read_b128 a[44:47], v25 offset:21888
v_exp_f32 v157, v157
v_exp_f32 v158, v158
v_exp_f32 v159, v159
v_exp_f32 v160, v160
v_exp_f32 v161, v161
v_smfmac_f32_32x32x32_bf16 v[176:191], a[36:39], v[152:159], v26
buffer_store_dwordx4 v[80:83], v10, s[20:23], 0 offen sc1
v_exp_f32 v162, v162
v_exp_f32 v163, v163
v_exp_f32 v164, v164
v_mfma_f32_32x32x16_bf16 v[112:127], a[20:23], v[12:15], v[112:127]
v_exp_f32 v165, v165
v_exp_f32 v166, v166
v_exp_f32 v167, v167
v_mfma_f32_32x32x16_bf16 v[128:143], a[20:23], v[16:19], v[128:143]
s_waitcnt lgkmcnt(0)
v_exp_f32 v168, v168
v_exp_f32 v169, v169
v_exp_f32 v170, v170
v_exp_f32 v171, v171
v_smfmac_f32_32x32x32_bf16 v[192:207], a[32:35], v[160:167], v26
v_exp_f32 v172, v172
v_exp_f32 v173, v173
v_exp_f32 v174, v174
v_exp_f32 v175, v175
v_exp_f32 v112, v112
v_exp_f32 v113, v113
v_smfmac_f32_32x32x32_bf16 v[192:207], a[36:39], v[168:175], v26
ds_read_b128 a[20:23], v22 offset:26752
v_exp_f32 v114, v114
v_exp_f32 v115, v115
v_exp_f32 v116, v116
v_mfma_f32_32x32x4_2b_bf16 v[144:175], a[26:27], v[20:21], 0 cbsz:1 abid:0
v_exp_f32 v117, v117
v_exp_f32 v118, v118
v_exp_f32 v119, v119
v_exp_f32 v120, v120
v_exp_f32 v121, v121
v_exp_f32 v122, v122
v_exp_f32 v123, v123
v_exp_f32 v124, v124
v_smfmac_f32_32x32x32_bf16 v[176:191], a[40:43], v[112:119], v26
s_add_u32 s20, s20, 16384
s_addc_u32 s21, s21, 0
ds_read_b128 a[32:35], v24 offset:24320
ds_read_b128 a[36:39], v25 offset:24320
v_exp_f32 v125, v125
v_exp_f32 v126, v126
v_exp_f32 v127, v127
v_exp_f32 v128, v128
v_exp_f32 v129, v129
v_smfmac_f32_32x32x32_bf16 v[176:191], a[44:47], v[120:127], v26
s_waitcnt vmcnt(10)
s_barrier
buffer_store_dwordx4 v[84:87], v10, s[20:23], 0 offen sc1
v_exp_f32 v130, v130
v_exp_f32 v131, v131
v_exp_f32 v132, v132
v_mfma_f32_32x32x16_bf16 v[144:159], a[16:19], v[12:15], v[144:159]
v_exp_f32 v133, v133
v_exp_f32 v134, v134
v_exp_f32 v135, v135
v_mfma_f32_32x32x16_bf16 v[160:175], a[16:19], v[16:19], v[160:175]
s_waitcnt lgkmcnt(0)
s_mov_b32 s26, 67108864
v_exp_f32 v136, v136
v_exp_f32 v137, v137
v_exp_f32 v138, v138
v_exp_f32 v139, v139
v_smfmac_f32_32x32x32_bf16 v[192:207], a[40:43], v[128:135], v26
s_add_u32 s24, s28, 4096
s_addc_u32 s25, s29, 0
v_exp_f32 v140, v140
v_exp_f32 v141, v141
v_exp_f32 v142, v142
v_exp_f32 v143, v143
v_exp_f32 v144, v144
v_exp_f32 v145, v145
v_smfmac_f32_32x32x32_bf16 v[192:207], a[44:47], v[136:143], v26
s_add_u32 m0, s47, 114688
ds_read_b128 a[16:19], v22 offset:29184
ds_read_b32 a24, v23 offset:29184
buffer_load_dwordx4 v8, s[24:27], 0 offen sc1 lds
v_exp_f32 v146, v146
v_exp_f32 v147, v147
v_exp_f32 v148, v148
v_mfma_f32_32x32x4_2b_bf16 v[112:143], a[26:27], v[20:21], 0 cbsz:1 abid:1
v_exp_f32 v149, v149
v_exp_f32 v150, v150
v_exp_f32 v151, v151
v_exp_f32 v152, v152
v_exp_f32 v153, v153
v_exp_f32 v154, v154
v_exp_f32 v155, v155
v_exp_f32 v156, v156
v_smfmac_f32_32x32x32_bf16 v[176:191], a[32:35], v[144:151], v26
s_add_u32 s20, s20, 16384
s_addc_u32 s21, s21, 0
ds_read_b128 a[40:43], v24 offset:26752
ds_read_b128 a[44:47], v25 offset:26752
v_exp_f32 v157, v157
v_exp_f32 v158, v158
v_exp_f32 v159, v159
v_exp_f32 v160, v160
v_exp_f32 v161, v161
v_smfmac_f32_32x32x32_bf16 v[176:191], a[36:39], v[152:159], v26
buffer_store_dwordx4 v[88:91], v10, s[20:23], 0 offen sc1
v_exp_f32 v162, v162
v_exp_f32 v163, v163
v_exp_f32 v164, v164
v_mfma_f32_32x32x16_bf16 v[112:127], a[20:23], v[12:15], v[112:127]
v_exp_f32 v165, v165
v_exp_f32 v166, v166
v_exp_f32 v167, v167
v_mfma_f32_32x32x16_bf16 v[128:143], a[20:23], v[16:19], v[128:143]
s_waitcnt lgkmcnt(0)
v_exp_f32 v168, v168
v_exp_f32 v169, v169
v_exp_f32 v170, v170
v_exp_f32 v171, v171
v_smfmac_f32_32x32x32_bf16 v[192:207], a[32:35], v[160:167], v26
s_add_u32 s24, s28, 8192
s_addc_u32 s25, s29, 0
v_exp_f32 v172, v172
v_exp_f32 v173, v173
v_exp_f32 v174, v174
v_exp_f32 v175, v175
v_exp_f32 v112, v112
v_exp_f32 v113, v113
v_smfmac_f32_32x32x32_bf16 v[192:207], a[36:39], v[168:175], v26
s_add_u32 m0, s47, 118784
ds_read_b128 a[20:23], v22 offset:31616
buffer_load_dwordx4 v8, s[24:27], 0 offen sc1 lds
v_exp_f32 v114, v114
v_exp_f32 v115, v115
v_exp_f32 v116, v116
v_mfma_f32_32x32x4_2b_bf16 v[144:175], a[24:25], v[20:21], 0 cbsz:1 abid:0
v_exp_f32 v117, v117
v_exp_f32 v118, v118
v_exp_f32 v119, v119
v_exp_f32 v120, v120
v_exp_f32 v121, v121
v_exp_f32 v122, v122
v_exp_f32 v123, v123
v_exp_f32 v124, v124
v_smfmac_f32_32x32x32_bf16 v[176:191], a[40:43], v[112:119], v26
s_add_u32 s20, s20, 16384
s_addc_u32 s21, s21, 0
ds_read_b128 a[32:35], v24 offset:29184
ds_read_b128 a[36:39], v25 offset:29184
v_exp_f32 v125, v125
v_exp_f32 v126, v126
v_exp_f32 v127, v127
v_exp_f32 v128, v128
v_exp_f32 v129, v129
v_smfmac_f32_32x32x32_bf16 v[176:191], a[44:47], v[120:127], v26
buffer_store_dwordx4 v[92:95], v10, s[20:23], 0 offen sc1
v_exp_f32 v130, v130
v_exp_f32 v131, v131
v_exp_f32 v132, v132
v_mfma_f32_32x32x16_bf16 v[144:159], a[16:19], v[12:15], v[144:159]
v_exp_f32 v133, v133
v_exp_f32 v134, v134
v_exp_f32 v135, v135
v_mfma_f32_32x32x16_bf16 v[160:175], a[16:19], v[16:19], v[160:175]
s_waitcnt lgkmcnt(0)
v_exp_f32 v136, v136
v_exp_f32 v137, v137
v_exp_f32 v138, v138
v_exp_f32 v139, v139
v_smfmac_f32_32x32x32_bf16 v[192:207], a[40:43], v[128:135], v26
s_add_u32 s24, s28, 12288
s_addc_u32 s25, s29, 0
v_exp_f32 v140, v140
v_exp_f32 v141, v141
v_exp_f32 v142, v142
v_exp_f32 v143, v143
v_exp_f32 v144, v144
v_exp_f32 v145, v145
v_smfmac_f32_32x32x32_bf16 v[192:207], a[44:47], v[136:143], v26
s_add_u32 m0, s47, 122880
ds_read_b128 a[16:19], v22 offset:34048
ds_read_b32 a26, v23 offset:34048
buffer_load_dwordx4 v8, s[24:27], 0 offen sc1 lds
v_exp_f32 v146, v146
v_exp_f32 v147, v147
v_exp_f32 v148, v148
v_mfma_f32_32x32x4_2b_bf16 v[112:143], a[24:25], v[20:21], 0 cbsz:1 abid:1
v_exp_f32 v149, v149
v_exp_f32 v150, v150
v_exp_f32 v151, v151
v_exp_f32 v152, v152
v_exp_f32 v153, v153
v_exp_f32 v154, v154
v_exp_f32 v155, v155
v_exp_f32 v156, v156
v_smfmac_f32_32x32x32_bf16 v[176:191], a[32:35], v[144:151], v26
s_add_u32 s20, s20, 16384
s_addc_u32 s21, s21, 0
ds_read_b128 a[40:43], v24 offset:31616
ds_read_b128 a[44:47], v25 offset:31616
v_exp_f32 v157, v157
v_exp_f32 v158, v158
v_exp_f32 v159, v159
v_exp_f32 v160, v160
v_exp_f32 v161, v161
v_smfmac_f32_32x32x32_bf16 v[176:191], a[36:39], v[152:159], v26
buffer_store_dwordx4 v[96:99], v10, s[20:23], 0 offen sc1
v_exp_f32 v162, v162
v_exp_f32 v163, v163
v_exp_f32 v164, v164
v_mfma_f32_32x32x16_bf16 v[112:127], a[20:23], v[12:15], v[112:127]
v_exp_f32 v165, v165
v_exp_f32 v166, v166
v_exp_f32 v167, v167
v_mfma_f32_32x32x16_bf16 v[128:143], a[20:23], v[16:19], v[128:143]
s_waitcnt lgkmcnt(0)
v_exp_f32 v168, v168
v_exp_f32 v169, v169
v_exp_f32 v170, v170
v_exp_f32 v171, v171
v_smfmac_f32_32x32x32_bf16 v[192:207], a[32:35], v[160:167], v26
s_add_u32 s24, s28, 16384
s_addc_u32 s25, s29, 0
v_exp_f32 v172, v172
v_exp_f32 v173, v173
v_exp_f32 v174, v174
v_exp_f32 v175, v175
v_exp_f32 v112, v112
v_exp_f32 v113, v113
v_smfmac_f32_32x32x32_bf16 v[192:207], a[36:39], v[168:175], v26
s_add_u32 m0, s47, 126976
ds_read_b128 a[20:23], v22 offset:36480
buffer_load_dwordx4 v8, s[24:27], 0 offen sc1 lds
v_exp_f32 v114, v114
v_exp_f32 v115, v115
v_exp_f32 v116, v116
v_mfma_f32_32x32x4_2b_bf16 v[144:175], a[26:27], v[20:21], 0 cbsz:1 abid:0
v_exp_f32 v117, v117
v_exp_f32 v118, v118
v_exp_f32 v119, v119
v_exp_f32 v120, v120
v_exp_f32 v121, v121
v_exp_f32 v122, v122
v_exp_f32 v123, v123
v_exp_f32 v124, v124
v_smfmac_f32_32x32x32_bf16 v[176:191], a[40:43], v[112:119], v26
s_add_u32 s20, s20, 16384
s_addc_u32 s21, s21, 0
ds_read_b128 a[32:35], v24 offset:34048
ds_read_b128 a[36:39], v25 offset:34048
v_exp_f32 v125, v125
v_exp_f32 v126, v126
v_exp_f32 v127, v127
v_exp_f32 v128, v128
v_exp_f32 v129, v129
v_smfmac_f32_32x32x32_bf16 v[176:191], a[44:47], v[120:127], v26
buffer_store_dwordx4 v[100:103], v10, s[20:23], 0 offen sc1
v_exp_f32 v130, v130
v_exp_f32 v131, v131
v_exp_f32 v132, v132
v_mfma_f32_32x32x16_bf16 v[144:159], a[16:19], v[12:15], v[144:159]
v_exp_f32 v133, v133
v_exp_f32 v134, v134
v_exp_f32 v135, v135
v_mfma_f32_32x32x16_bf16 v[160:175], a[16:19], v[16:19], v[160:175]
s_waitcnt lgkmcnt(0)
v_exp_f32 v136, v136
v_exp_f32 v137, v137
v_exp_f32 v138, v138
v_exp_f32 v139, v139
v_smfmac_f32_32x32x32_bf16 v[192:207], a[40:43], v[128:135], v26
s_add_u32 s24, s28, 20480
s_addc_u32 s25, s29, 0
L_pad13:
s_cbranch_execz L_hret0
v_exp_f32 v140, v140
v_exp_f32 v141, v141
v_exp_f32 v142, v142
v_exp_f32 v143, v143
v_exp_f32 v144, v144
v_exp_f32 v145, v145
v_smfmac_f32_32x32x32_bf16 v[192:207], a[44:47], v[136:143], v26
s_add_u32 m0, s47, 131072
ds_read_b128 a[16:19], v22 offset:38912
ds_read_b32 a24, v23 offset:38912
buffer_load_dwordx4 v8, s[24:27], 0 offen sc1 lds
v_exp_f32 v146, v146
v_exp_f32 v147, v147
v_exp_f32 v148, v148
v_mfma_f32_32x32x4_2b_bf16 v[112:143], a[26:27], v[20:21], 0 cbsz:1 abid:1
v_exp_f32 v149, v149
v_exp_f32 v150, v150
v_exp_f32 v151, v151
v_exp_f32 v152, v152
v_exp_f32 v153, v153
v_exp_f32 v154, v154
v_exp_f32 v155, v155
v_exp_f32 v156, v156
v_smfmac_f32_32x32x32_bf16 v[176:191], a[32:35], v[144:151], v26
s_add_u32 s20, s20, 16384
s_addc_u32 s21, s21, 0
ds_read_b128 a[40:43], v24 offset:36480
ds_read_b128 a[44:47], v25 offset:36480
v_exp_f32 v157, v157
v_exp_f32 v158, v158
v_exp_f32 v159, v159
v_exp_f32 v160, v160
v_exp_f32 v161, v161
v_smfmac_f32_32x32x32_bf16 v[176:191], a[36:39], v[152:159], v26
s_waitcnt vmcnt(11)
s_barrier
buffer_store_dwordx4 v[104:107], v10, s[20:23], 0 offen sc1
buffer_atomic_add v29, v28, s[28:31], s63 offen sc1
v_exp_f32 v162, v162
v_exp_f32 v163, v163
v_exp_f32 v164, v164
v_mfma_f32_32x32x16_bf16 v[112:127], a[20:23], v[12:15], v[112:127]
v_exp_f32 v165, v165
v_exp_f32 v166, v166
v_exp_f32 v167, v167
v_mfma_f32_32x32x16_bf16 v[128:143], a[20:23], v[16:19], v[128:143]
s_waitcnt lgkmcnt(0)
v_exp_f32 v168, v168
v_exp_f32 v169, v169
v_exp_f32 v170, v170
v_exp_f32 v171, v171
v_smfmac_f32_32x32x32_bf16 v[192:207], a[32:35], v[160:167], v26
s_add_u32 s24, s28, 24576
s_addc_u32 s25, s29, 0
v_exp_f32 v172, v172
v_exp_f32 v173, v173
v_exp_f32 v174, v174
v_exp_f32 v175, v175
v_exp_f32 v112, v112
v_exp_f32 v113, v113
v_smfmac_f32_32x32x32_bf16 v[192:207], a[36:39], v[168:175], v26
s_add_u32 m0, s47, 135168
ds_read_b128 a[20:23], v22 offset:41344
buffer_load_dwordx4 v8, s[24:27], 0 offen sc1 lds
v_exp_f32 v114, v114
v_exp_f32 v115, v115
v_exp_f32 v116, v116
v_mfma_f32_32x32x4_2b_bf16 v[144:175], a[24:25], v[20:21], 0 cbsz:1 abid:0
v_exp_f32 v117, v117
v_exp_f32 v118, v118
v_exp_f32 v119, v119
v_exp_f32 v120, v120
v_exp_f32 v121, v121
v_exp_f32 v122, v122
v_exp_f32 v123, v123
v_exp_f32 v124, v124
v_smfmac_f32_32x32x32_bf16 v[176:191], a[40:43], v[112:119], v26
s_add_u32 s20, s20, 16384
s_addc_u32 s21, s21, 0
ds_read_b128 a[32:35], v24 offset:38912
ds_read_b128 a[36:39], v25 offset:38912
v_exp_f32 v125, v125
v_exp_f32 v126, v126
v_exp_f32 v127, v127
v_exp_f32 v128, v128
v_exp_f32 v129, v129
v_smfmac_f32_32x32x32_bf16 v[176:191], a[44:47], v[120:127], v26
buffer_store_dwordx4 v[108:111], v10, s[20:23], 0 offen sc1
v_exp_f32 v130, v130
v_exp_f32 v131, v131
v_exp_f32 v132, v132
v_mfma_f32_32x32x16_bf16 v[144:159], a[16:19], v[12:15], v[144:159]
v_exp_f32 v133, v133
v_exp_f32 v134, v134
v_exp_f32 v135, v135
v_mfma_f32_32x32x16_bf16 v[160:175], a[16:19], v[16:19], v[160:175]
s_waitcnt lgkmcnt(0)
v_exp_f32 v136, v136
v_exp_f32 v137, v137
v_exp_f32 v138, v138
v_exp_f32 v139, v139
v_smfmac_f32_32x32x32_bf16 v[192:207], a[40:43], v[128:135], v26
s_add_u32 s24, s28, 28672
s_addc_u32 s25, s29, 0
v_exp_f32 v140, v140
v_exp_f32 v141, v141
v_exp_f32 v142, v142
v_exp_f32 v143, v143
v_exp_f32 v144, v144
v_exp_f32 v145, v145
v_smfmac_f32_32x32x32_bf16 v[192:207], a[44:47], v[136:143], v26
s_add_u32 m0, s47, 139264
ds_read_b128 a[16:19], v22 offset:43776
ds_read_b32 a26, v23 offset:43776
buffer_load_dwordx4 v8, s[24:27], 0 offen sc1 lds
v_exp_f32 v146, v146
v_exp_f32 v147, v147
v_exp_f32 v148, v148
v_mfma_f32_32x32x4_2b_bf16 v[112:143], a[24:25], v[20:21], 0 cbsz:1 abid:1
v_exp_f32 v149, v149
v_exp_f32 v150, v150
v_exp_f32 v151, v151
v_exp_f32 v152, v152
v_exp_f32 v153, v153
v_exp_f32 v154, v154
v_exp_f32 v155, v155
v_exp_f32 v156, v156
v_smfmac_f32_32x32x32_bf16 v[176:191], a[32:35], v[144:151], v26
s_add_u32 s20, s20, 16384
s_addc_u32 s21, s21, 0
ds_read_b128 a[40:43], v24 offset:41344
ds_read_b128 a[44:47], v25 offset:41344
v_exp_f32 v157, v157
v_exp_f32 v158, v158
v_exp_f32 v159, v159
v_exp_f32 v160, v160
v_exp_f32 v161, v161
v_smfmac_f32_32x32x32_bf16 v[176:191], a[36:39], v[152:159], v26
buffer_store_dwordx4 v[48:51], v10, s[20:23], 0 offen sc1
v_exp_f32 v162, v162
v_exp_f32 v163, v163
v_exp_f32 v164, v164
v_mfma_f32_32x32x16_bf16 v[112:127], a[20:23], v[12:15], v[112:127]
v_exp_f32 v165, v165
v_exp_f32 v166, v166
v_exp_f32 v167, v167
v_mfma_f32_32x32x16_bf16 v[128:143], a[20:23], v[16:19], v[128:143]
s_waitcnt lgkmcnt(0)
v_exp_f32 v168, v168
v_exp_f32 v169, v169
v_exp_f32 v170, v170
v_exp_f32 v171, v171
v_smfmac_f32_32x32x32_bf16 v[192:207], a[32:35], v[160:167], v26
s_add_u32 s24, s28, 32768
s_addc_u32 s25, s29, 0
v_exp_f32 v172, v172
v_exp_f32 v173, v173
v_exp_f32 v174, v174
v_exp_f32 v175, v175
v_exp_f32 v112, v112
v_exp_f32 v113, v113
v_smfmac_f32_32x32x32_bf16 v[192:207], a[36:39], v[168:175], v26
s_add_u32 m0, s47, 143360
ds_read_b128 a[20:23], v22 offset:46208
buffer_load_dwordx4 v8, s[24:27], 0 offen sc1 lds
v_exp_f32 v114, v114
v_exp_f32 v115, v115
v_exp_f32 v116, v116
v_mfma_f32_32x32x4_2b_bf16 v[144:175], a[26:27], v[20:21], 0 cbsz:1 abid:0
v_exp_f32 v117, v117
v_exp_f32 v118, v118
v_exp_f32 v119, v119
v_exp_f32 v120, v120
v_exp_f32 v121, v121
v_exp_f32 v122, v122
v_exp_f32 v123, v123
v_exp_f32 v124, v124
v_smfmac_f32_32x32x32_bf16 v[176:191], a[40:43], v[112:119], v26
s_add_u32 s20, s20, 16384
s_addc_u32 s21, s21, 0
ds_read_b128 a[32:35], v24 offset:43776
ds_read_b128 a[36:39], v25 offset:43776
v_exp_f32 v125, v125
v_exp_f32 v126, v126
v_exp_f32 v127, v127
v_exp_f32 v128, v128
v_exp_f32 v129, v129
v_smfmac_f32_32x32x32_bf16 v[176:191], a[44:47], v[120:127], v26
buffer_store_dwordx4 v[52:55], v10, s[20:23], 0 offen sc1
v_exp_f32 v130, v130
v_exp_f32 v131, v131
v_exp_f32 v132, v132
v_mfma_f32_32x32x16_bf16 v[144:159], a[16:19], v[12:15], v[144:159]
v_exp_f32 v133, v133
v_exp_f32 v134, v134
v_exp_f32 v135, v135
v_mfma_f32_32x32x16_bf16 v[160:175], a[16:19], v[16:19], v[160:175]
s_waitcnt lgkmcnt(0)
v_exp_f32 v136, v136
v_exp_f32 v137, v137
v_exp_f32 v138, v138
v_exp_f32 v139, v139
v_smfmac_f32_32x32x32_bf16 v[192:207], a[40:43], v[128:135], v26
s_add_u32 s24, s28, 36864
s_addc_u32 s25, s29, 0
v_exp_f32 v140, v140
v_exp_f32 v141, v141
v_exp_f32 v142, v142
v_exp_f32 v143, v143
v_exp_f32 v144, v144
v_exp_f32 v145, v145
v_smfmac_f32_32x32x32_bf16 v[192:207], a[44:47], v[136:143], v26
s_add_u32 m0, s47, 147456
ds_read_b128 a[16:19], v22 offset:48640
ds_read_b32 a24, v23 offset:48640
buffer_load_dwordx4 v8, s[24:27], 0 offen sc1 lds
v_exp_f32 v146, v146
v_exp_f32 v147, v147
v_exp_f32 v148, v148
v_mfma_f32_32x32x4_2b_bf16 v[112:143], a[26:27], v[20:21], 0 cbsz:1 abid:1
v_exp_f32 v149, v149
v_exp_f32 v150, v150
v_exp_f32 v151, v151
v_exp_f32 v152, v152
v_exp_f32 v153, v153
v_exp_f32 v154, v154
v_exp_f32 v155, v155
v_exp_f32 v156, v156
v_smfmac_f32_32x32x32_bf16 v[176:191], a[32:35], v[144:151], v26
s_add_u32 s20, s20, 16384
s_addc_u32 s21, s21, 0
ds_read_b128 a[40:43], v24 offset:46208
ds_read_b128 a[44:47], v25 offset:46208
v_exp_f32 v157, v157
v_exp_f32 v158, v158
v_exp_f32 v159, v159
v_exp_f32 v160, v160
v_exp_f32 v161, v161
v_smfmac_f32_32x32x32_bf16 v[176:191], a[36:39], v[152:159], v26
buffer_store_dwordx4 v[56:59], v10, s[20:23], 0 offen sc1
v_exp_f32 v162, v162
v_exp_f32 v163, v163
v_exp_f32 v164, v164
v_mfma_f32_32x32x16_bf16 v[112:127], a[20:23], v[12:15], v[112:127]
v_exp_f32 v165, v165
v_exp_f32 v166, v166
v_exp_f32 v167, v167
v_mfma_f32_32x32x16_bf16 v[128:143], a[20:23], v[16:19], v[128:143]
s_waitcnt lgkmcnt(0)
v_exp_f32 v168, v168
v_exp_f32 v169, v169
v_exp_f32 v170, v170
v_exp_f32 v171, v171
v_smfmac_f32_32x32x32_bf16 v[192:207], a[32:35], v[160:167], v26
v_exp_f32 v172, v172
v_exp_f32 v173, v173
v_exp_f32 v174, v174
v_exp_f32 v175, v175
v_exp_f32 v112, v112
v_exp_f32 v113, v113
v_smfmac_f32_32x32x32_bf16 v[192:207], a[36:39], v[168:175], v26
ds_read_b128 a[20:23], v22 offset:51072
v_exp_f32 v114, v114
v_exp_f32 v115, v115
v_exp_f32 v116, v116
v_mfma_f32_32x32x4_2b_bf16 v[144:175], a[24:25], v[20:21], 0 cbsz:1 abid:0
v_exp_f32 v117, v117
v_exp_f32 v118, v118
v_exp_f32 v119, v119
v_exp_f32 v120, v120
v_exp_f32 v121, v121
v_exp_f32 v122, v122
v_exp_f32 v123, v123
v_exp_f32 v124, v124
v_smfmac_f32_32x32x32_bf16 v[176:191], a[40:43], v[112:119], v26
s_add_u32 s20, s20, 16384
s_addc_u32 s21, s21, 0
ds_read_b128 a[32:35], v24 offset:48640
ds_read_b128 a[36:39], v25 offset:48640
v_exp_f32 v125, v125
v_exp_f32 v126, v126
v_exp_f32 v127, v127
v_exp_f32 v128, v128
v_exp_f32 v129, v129
v_smfmac_f32_32x32x32_bf16 v[176:191], a[44:47], v[120:127], v26
buffer_store_dwordx4 v[60:63], v10, s[20:23], 0 offen sc1
v_exp_f32 v130, v130
v_exp_f32 v131, v131
v_exp_f32 v132, v132
v_mfma_f32_32x32x16_bf16 v[144:159], a[16:19], v[12:15], v[144:159]
v_exp_f32 v133, v133
v_exp_f32 v134, v134
v_exp_f32 v135, v135
v_mfma_f32_32x32x16_bf16 v[160:175], a[16:19], v[16:19], v[160:175]
s_waitcnt lgkmcnt(0)
s_mov_b32 s26, 663552
v_exp_f32 v136, v136
v_exp_f32 v137, v137
v_exp_f32 v138, v138
v_exp_f32 v139, v139
v_smfmac_f32_32x32x32_bf16 v[192:207], a[40:43], v[128:135], v26
s_add_u32 s24, s32, 0
s_addc_u32 s25, s33, 0
v_exp_f32 v140, v140
v_exp_f32 v141, v141
v_exp_f32 v142, v142
v_exp_f32 v143, v143
v_exp_f32 v144, v144
v_exp_f32 v145, v145
v_smfmac_f32_32x32x32_bf16 v[192:207], a[44:47], v[136:143], v26
s_add_u32 m0, s47, 0
ds_read_b128 a[16:19], v22 offset:53504
ds_read_b32 a26, v23 offset:53504
buffer_load_dwordx4 v34, s[24:27], 0 offen lds
v_exp_f32 v146, v146
v_exp_f32 v147, v147
v_exp_f32 v148, v148
v_mfma_f32_32x32x4_2b_bf16 v[112:143], a[24:25], v[20:21], 0 cbsz:1 abid:1
v_exp_f32 v149, v149
v_exp_f32 v150, v150
v_exp_f32 v151, v151
v_exp_f32 v152, v152
v_exp_f32 v153, v153
v_exp_f32 v154, v154
v_exp_f32 v155, v155
v_exp_f32 v156, v156
v_smfmac_f32_32x32x32_bf16 v[176:191], a[32:35], v[144:151], v26
s_add_u32 s20, s20, 16384
s_addc_u32 s21, s21, 0
ds_read_b128 a[40:43], v24 offset:51072
ds_read_b128 a[44:47], v25 offset:51072
v_exp_f32 v157, v157
v_exp_f32 v158, v158
v_exp_f32 v159, v159
v_exp_f32 v160, v160
v_exp_f32 v161, v161
v_smfmac_f32_32x32x32_bf16 v[176:191], a[36:39], v[152:159], v26
buffer_store_dwordx4 v[64:67], v10, s[20:23], 0 offen sc1
v_exp_f32 v162, v162
v_exp_f32 v163, v163
v_exp_f32 v164, v164
v_mfma_f32_32x32x16_bf16 v[112:127], a[20:23], v[12:15], v[112:127]
v_exp_f32 v165, v165
v_exp_f32 v166, v166
v_exp_f32 v167, v167
v_mfma_f32_32x32x16_bf16 v[128:143], a[20:23], v[16:19], v[128:143]
s_waitcnt lgkmcnt(0)
v_exp_f32 v168, v168
v_exp_f32 v169, v169
v_exp_f32 v170, v170
v_exp_f32 v171, v171
v_smfmac_f32_32x32x32_bf16 v[192:207], a[32:35], v[160:167], v26
v_exp_f32 v172, v172
v_exp_f32 v173, v173
v_exp_f32 v174, v174
v_exp_f32 v175, v175
v_exp_f32 v112, v112
v_exp_f32 v113, v113
v_smfmac_f32_32x32x32_bf16 v[192:207], a[36:39], v[168:175], v26
ds_read_b128 a[20:23], v22 offset:55936
v_exp_f32 v114, v114
v_exp_f32 v115, v115
v_exp_f32 v116, v116
v_mfma_f32_32x32x4_2b_bf16 v[144:175], a[26:27], v[20:21], 0 cbsz:1 abid:0
v_exp_f32 v117, v117
v_exp_f32 v118, v118
v_exp_f32 v119, v119
v_exp_f32 v120, v120
v_exp_f32 v121, v121
v_exp_f32 v122, v122
v_exp_f32 v123, v123
v_exp_f32 v124, v124
v_smfmac_f32_32x32x32_bf16 v[176:191], a[40:43], v[112:119], v26
s_add_u32 s20, s20, 16384
s_addc_u32 s21, s21, 0
ds_read_b128 a[32:35], v24 offset:53504
ds_read_b128 a[36:39], v25 offset:53504
v_exp_f32 v125, v125
v_exp_f32 v126, v126
v_exp_f32 v127, v127
v_exp_f32 v128, v128
v_exp_f32 v129, v129
v_smfmac_f32_32x32x32_bf16 v[176:191], a[44:47], v[120:127], v26
buffer_store_dwordx4 v[68:71], v10, s[20:23], 0 offen sc1
v_exp_f32 v130, v130
v_exp_f32 v131, v131
v_exp_f32 v132, v132
v_mfma_f32_32x32x16_bf16 v[144:159], a[16:19], v[12:15], v[144:159]
v_exp_f32 v133, v133
v_exp_f32 v134, v134
v_exp_f32 v135, v135
v_mfma_f32_32x32x16_bf16 v[160:175], a[16:19], v[16:19], v[160:175]
s_waitcnt lgkmcnt(0)
v_exp_f32 v136, v136
v_exp_f32 v137, v137
v_exp_f32 v138, v138
v_exp_f32 v139, v139
v_smfmac_f32_32x32x32_bf16 v[192:207], a[40:43], v[128:135], v26
s_add_u32 s24, s32, 165888
s_addc_u32 s25, s33, 0
v_exp_f32 v140, v140
v_exp_f32 v141, v141
v_exp_f32 v142, v142
v_exp_f32 v143, v143
v_exp_f32 v144, v144
v_exp_f32 v145, v145
v_smfmac_f32_32x32x32_bf16 v[192:207], a[44:47], v[136:143], v26
s_add_u32 m0, s47, 4096
ds_read_b128 a[16:19], v22 offset:58368
ds_read_b32 a24, v23 offset:58368
buffer_load_dwordx4 v34, s[24:27], 0 offen lds
v_exp_f32 v146, v146
v_exp_f32 v147, v147
v_exp_f32 v148, v148
v_mfma_f32_32x32x4_2b_bf16 v[112:143], a[26:27], v[20:21], 0 cbsz:1 abid:1
v_exp_f32 v149, v149
v_exp_f32 v150, v150
v_exp_f32 v151, v151
v_exp_f32 v152, v152
v_exp_f32 v153, v153
v_exp_f32 v154, v154
v_exp_f32 v155, v155
v_exp_f32 v156, v156
v_smfmac_f32_32x32x32_bf16 v[176:191], a[32:35], v[144:151], v26
s_add_u32 s20, s20, 16384
s_addc_u32 s21, s21, 0
ds_read_b128 a[40:43], v24 offset:55936
ds_read_b128 a[44:47], v25 offset:55936
v_exp_f32 v157, v157
v_exp_f32 v158, v158
v_exp_f32 v159, v159
v_exp_f32 v160, v160
v_exp_f32 v161, v161
v_smfmac_f32_32x32x32_bf16 v[176:191], a[36:39], v[152:159], v26
buffer_store_dwordx4 v[72:75], v10, s[20:23], 0 offen sc1
v_exp_f32 v162, v162
v_exp_f32 v163, v163
v_exp_f32 v164, v164
v_mfma_f32_32x32x16_bf16 v[112:127], a[20:23], v[12:15], v[112:127]
v_exp_f32 v165, v165
v_exp_f32 v166, v166
v_exp_f32 v167, v167
v_mfma_f32_32x32x16_bf16 v[128:143], a[20:23], v[16:19], v[128:143]
s_waitcnt lgkmcnt(0)
v_exp_f32 v168, v168
v_exp_f32 v169, v169
v_exp_f32 v170, v170
v_exp_f32 v171, v171
v_smfmac_f32_32x32x32_bf16 v[192:207], a[32:35], v[160:167], v26
v_exp_f32 v172, v172
v_exp_f32 v173, v173
v_exp_f32 v174, v174
v_exp_f32 v175, v175
v_exp_f32 v112, v112
v_exp_f32 v113, v113
v_smfmac_f32_32x32x32_bf16 v[192:207], a[36:39], v[168:175], v26
ds_read_b128 a[20:23], v22 offset:60800
v_exp_f32 v114, v114
v_exp_f32 v115, v115
v_exp_f32 v116, v116
v_mfma_f32_32x32x4_2b_bf16 v[144:175], a[24:25], v[20:21], 0 cbsz:1 abid:0
v_exp_f32 v117, v117
v_exp_f32 v118, v118
v_exp_f32 v119, v119
v_exp_f32 v120, v120
v_exp_f32 v121, v121
v_exp_f32 v122, v122
v_exp_f32 v123, v123
v_exp_f32 v124, v124
v_smfmac_f32_32x32x32_bf16 v[176:191], a[40:43], v[112:119], v26
s_add_u32 s20, s20, 16384
s_addc_u32 s21, s21, 0
ds_read_b128 a[32:35], v24 offset:58368
ds_read_b128 a[36:39], v25 offset:58368
v_exp_f32 v125, v125
v_exp_f32 v126, v126
v_exp_f32 v127, v127
v_exp_f32 v128, v128
v_exp_f32 v129, v129
v_smfmac_f32_32x32x32_bf16 v[176:191], a[44:47], v[120:127], v26
buffer_store_dwordx4 v[76:79], v10, s[20:23], 0 offen sc1
v_exp_f32 v130, v130
v_exp_f32 v131, v131
v_exp_f32 v132, v132
v_mfma_f32_32x32x16_bf16 v[144:159], a[16:19], v[12:15], v[144:159]
v_exp_f32 v133, v133
v_exp_f32 v134, v134
v_exp_f32 v135, v135
v_mfma_f32_32x32x16_bf16 v[160:175], a[16:19], v[16:19], v[160:175]
s_waitcnt lgkmcnt(0)
v_exp_f32 v136, v136
v_exp_f32 v137, v137
v_exp_f32 v138, v138
v_exp_f32 v139, v139
v_smfmac_f32_32x32x32_bf16 v[192:207], a[40:43], v[128:135], v26
s_add_u32 s24, s32, 331776
s_addc_u32 s25, s33, 0
v_add_u32 v22, 0xf700, v22
v_add_u32 v23, 0xf700, v23
v_exp_f32 v140, v140
v_exp_f32 v141, v141
v_exp_f32 v142, v142
v_exp_f32 v143, v143
v_exp_f32 v144, v144
v_exp_f32 v145, v145
v_smfmac_f32_32x32x32_bf16 v[192:207], a[44:47], v[136:143], v26
s_add_u32 m0, s47, 8192
ds_read_b128 a[16:19], v22
ds_read_b32 a26, v23
buffer_load_dwordx4 v34, s[24:27], 0 offen lds
v_exp_f32 v146, v146
v_exp_f32 v147, v147
v_exp_f32 v148, v148
v_mfma_f32_32x32x4_2b_bf16 v[112:143], a[24:25], v[20:21], 0 cbsz:1 abid:1
v_exp_f32 v149, v149
v_exp_f32 v150, v150
v_exp_f32 v151, v151
v_exp_f32 v152, v152
v_exp_f32 v153, v153
v_exp_f32 v154, v154
v_exp_f32 v155, v155
v_exp_f32 v156, v156
v_smfmac_f32_32x32x32_bf16 v[176:191], a[32:35], v[144:151], v26
ds_read_b128 a[40:43], v24 offset:60800
ds_read_b128 a[44:47], v25 offset:60800
v_exp_f32 v157, v157
v_exp_f32 v158, v158
v_exp_f32 v159, v159
v_exp_f32 v160, v160
v_exp_f32 v161, v161
v_smfmac_f32_32x32x32_bf16 v[176:191], a[36:39], v[152:159], v26
v_exp_f32 v162, v162
v_exp_f32 v163, v163
v_exp_f32 v164, v164
v_mfma_f32_32x32x16_bf16 v[112:127], a[20:23], v[12:15], v[112:127]
v_mov_b32 v0, 0
v_exp_f32 v165, v165
v_exp_f32 v166, v166
v_exp_f32 v167, v167
v_mfma_f32_32x32x16_bf16 v[128:143], a[20:23], v[16:19], v[128:143]
s_waitcnt lgkmcnt(0)
buffer_atomic_umax v0, v28, s[28:31], s53 offen sc0 sc1
v_exp_f32 v168, v168
v_exp_f32 v169, v169
v_exp_f32 v170, v170
v_exp_f32 v171, v171
v_smfmac_f32_32x32x32_bf16 v[192:207], a[32:35], v[160:167], v26
v_exp_f32 v172, v172
v_exp_f32 v173, v173
v_exp_f32 v174, v174
v_exp_f32 v175, v175
v_exp_f32 v112, v112
v_exp_f32 v113, v113
v_smfmac_f32_32x32x32_bf16 v[192:207], a[36:39], v[168:175], v26
ds_read_b128 a[20:23], v22 offset:2432
v_add_u32 v24, 0xf700, v24
v_add_u32 v25, 0xf700, v25
v_exp_f32 v114, v114
v_exp_f32 v115, v115
v_exp_f32 v116, v116
v_mfma_f32_32x32x4_2b_bf16 v[144:175], a[26:27], v[20:21], 0 cbsz:1 abid:0
v_exp_f32 v117, v117
v_exp_f32 v118, v118
v_exp_f32 v119, v119
v_exp_f32 v120, v120
v_exp_f32 v121, v121
v_exp_f32 v122, v122
v_exp_f32 v123, v123
v_exp_f32 v124, v124
v_smfmac_f32_32x32x32_bf16 v[176:191], a[40:43], v[112:119], v26
ds_read_b128 a[32:35], v24
ds_read_b128 a[36:39], v25
v_exp_f32 v125, v125
v_exp_f32 v126, v126
v_exp_f32 v127, v127
v_exp_f32 v128, v128
v_exp_f32 v129, v129
v_smfmac_f32_32x32x32_bf16 v[176:191], a[44:47], v[120:127], v26
v_exp_f32 v130, v130
v_exp_f32 v131, v131
v_exp_f32 v132, v132
v_mfma_f32_32x32x16_bf16 v[144:159], a[16:19], v[12:15], v[144:159]
v_exp_f32 v133, v133
v_exp_f32 v134, v134
v_exp_f32 v135, v135
v_mfma_f32_32x32x16_bf16 v[160:175], a[16:19], v[16:19], v[160:175]
s_waitcnt lgkmcnt(0)
buffer_load_dwordx2 v[244:245], v40, s[8:11], s69 offen
v_exp_f32 v136, v136
v_exp_f32 v137, v137
v_exp_f32 v138, v138
v_exp_f32 v139, v139
v_smfmac_f32_32x32x32_bf16 v[192:207], a[40:43], v[128:135], v26
s_add_u32 s24, s32, 497664
s_addc_u32 s25, s33, 0
v_exp_f32 v140, v140
v_exp_f32 v141, v141
v_exp_f32 v142, v142
v_exp_f32 v143, v143
v_exp_f32 v144, v144
v_exp_f32 v145, v145
v_smfmac_f32_32x32x32_bf16 v[192:207], a[44:47], v[136:143], v26
s_add_u32 m0, s47, 12288
ds_read_b128 a[16:19], v22 offset:4864
ds_read_b32 a24, v23 offset:4864
buffer_load_dwordx4 v34, s[24:27], 0 offen lds
v_exp_f32 v146, v146
v_exp_f32 v147, v147
v_exp_f32 v148, v148
v_mfma_f32_32x32x4_2b_bf16 v[112:143], a[26:27], v[20:21], 0 cbsz:1 abid:1
v_exp_f32 v149, v149
v_exp_f32 v150, v150
v_exp_f32 v151, v151
v_exp_f32 v152, v152
v_exp_f32 v153, v153
v_exp_f32 v154, v154
v_exp_f32 v155, v155
v_exp_f32 v156, v156
v_smfmac_f32_32x32x32_bf16 v[176:191], a[32:35], v[144:151], v26
ds_read_b128 a[40:43], v24 offset:2432
ds_read_b128 a[44:47], v25 offset:2432
v_exp_f32 v157, v157
v_exp_f32 v158, v158
v_exp_f32 v159, v159
v_exp_f32 v160, v160
v_exp_f32 v161, v161
v_smfmac_f32_32x32x32_bf16 v[176:191], a[36:39], v[152:159], v26
v_exp_f32 v162, v162
v_exp_f32 v163, v163
v_exp_f32 v164, v164
v_mfma_f32_32x32x16_bf16 v[112:127], a[20:23], v[12:15], v[112:127]
v_exp_f32 v165, v165
v_exp_f32 v166, v166
v_exp_f32 v167, v167
v_mfma_f32_32x32x16_bf16 v[128:143], a[20:23], v[16:19], v[128:143]
s_waitcnt lgkmcnt(0)
buffer_load_dwordx2 v[246:247], v40, s[8:11], s69 offen offset:32
v_exp_f32 v168, v168
v_exp_f32 v169, v169
v_exp_f32 v170, v170
v_exp_f32 v171, v171
v_smfmac_f32_32x32x32_bf16 v[192:207], a[32:35], v[160:167], v26
v_exp_f32 v172, v172
v_exp_f32 v173, v173
v_exp_f32 v174, v174
v_exp_f32 v175, v175
v_exp_f32 v112, v112
v_exp_f32 v113, v113
v_smfmac_f32_32x32x32_bf16 v[192:207], a[36:39], v[168:175], v26
ds_read_b128 a[20:23], v22 offset:7296
v_exp_f32 v114, v114
v_exp_f32 v115, v115
v_exp_f32 v116, v116
v_mfma_f32_32x32x4_2b_bf16 v[144:175], a[24:25], v[20:21], 0 cbsz:1 abid:0
v_exp_f32 v117, v117
v_exp_f32 v118, v118
v_exp_f32 v119, v119
v_exp_f32 v120, v120
v_exp_f32 v121, v121
v_exp_f32 v122, v122
v_exp_f32 v123, v123
v_exp_f32 v124, v124
v_smfmac_f32_32x32x32_bf16 v[176:191], a[40:43], v[112:119], v26
ds_read_b128 a[32:35], v24 offset:4864
ds_read_b128 a[36:39], v25 offset:4864
v_exp_f32 v125, v125
v_exp_f32 v126, v126
v_exp_f32 v127, v127
v_exp_f32 v128, v128
v_exp_f32 v129, v129
v_smfmac_f32_32x32x32_bf16 v[176:191], a[44:47], v[120:127], v26
v_exp_f32 v130, v130
v_exp_f32 v131, v131
v_exp_f32 v132, v132
v_mfma_f32_32x32x16_bf16 v[144:159], a[16:19], v[12:15], v[144:159]
v_exp_f32 v133, v133
v_exp_f32 v134, v134
v_exp_f32 v135, v135
v_mfma_f32_32x32x16_bf16 v[160:175], a[16:19], v[16:19], v[160:175]
s_waitcnt lgkmcnt(0)
buffer_load_dwordx2 v[248:249], v5, s[8:11], s69 offen
v_exp_f32 v136, v136
v_exp_f32 v137, v137
v_exp_f32 v138, v138
v_exp_f32 v139, v139
v_smfmac_f32_32x32x32_bf16 v[192:207], a[40:43], v[128:135], v26
s_add_u32 s24, s32, 0
s_addc_u32 s25, s33, 0
v_exp_f32 v140, v140
v_exp_f32 v141, v141
v_exp_f32 v142, v142
v_exp_f32 v143, v143
v_exp_f32 v144, v144
v_exp_f32 v145, v145
v_smfmac_f32_32x32x32_bf16 v[192:207], a[44:47], v[136:143], v26
s_add_u32 m0, s47, 16384
ds_read_b128 a[16:19], v22 offset:9728
ds_read_b32 a26, v23 offset:9728
buffer_load_dwordx4 v35, s[24:27], 0 offen lds
v_exp_f32 v146, v146
v_exp_f32 v147, v147
v_exp_f32 v148, v148
v_mfma_f32_32x32x4_2b_bf16 v[112:143], a[24:25], v[20:21], 0 cbsz:1 abid:1
v_exp_f32 v149, v149
v_exp_f32 v150, v150
v_exp_f32 v151, v151
v_exp_f32 v152, v152
v_exp_f32 v153, v153
v_exp_f32 v154, v154
v_exp_f32 v155, v155
v_exp_f32 v156, v156
v_smfmac_f32_32x32x32_bf16 v[176:191], a[32:35], v[144:151], v26
ds_read_b128 a[40:43], v24 offset:7296
ds_read_b128 a[44:47], v25 offset:7296
v_exp_f32 v157, v157
v_exp_f32 v158, v158
v_exp_f32 v159, v159
v_exp_f32 v160, v160
v_exp_f32 v161, v161
v_smfmac_f32_32x32x32_bf16 v[176:191], a[36:39], v[152:159], v26
v_exp_f32 v162, v162
v_exp_f32 v163, v163
v_exp_f32 v164, v164
v_mfma_f32_32x32x16_bf16 v[112:127], a[20:23], v[12:15], v[112:127]
v_exp_f32 v165, v165
v_exp_f32 v166, v166
v_exp_f32 v167, v167
v_mfma_f32_32x32x16_bf16 v[128:143], a[20:23], v[16:19], v[128:143]
s_waitcnt lgkmcnt(0)
buffer_load_dwordx2 v[250:251], v5, s[8:11], s69 offen offset:32
v_exp_f32 v168, v168
v_exp_f32 v169, v169
v_exp_f32 v170, v170
v_exp_f32 v171, v171
v_smfmac_f32_32x32x32_bf16 v[192:207], a[32:35], v[160:167], v26
v_exp_f32 v172, v172
v_exp_f32 v173, v173
v_exp_f32 v174, v174
v_exp_f32 v175, v175
v_exp_f32 v112, v112
v_exp_f32 v113, v113
v_smfmac_f32_32x32x32_bf16 v[192:207], a[36:39], v[168:175], v26
s_add_u32 m0, s47, 20480
ds_read_b128 a[20:23], v22 offset:12160
buffer_load_dwordx4 v32, s[24:27], 0 offen lds
v_exp_f32 v114, v114
v_exp_f32 v115, v115
v_exp_f32 v116, v116
v_mfma_f32_32x32x4_2b_bf16 v[144:175], a[26:27], v[20:21], 0 cbsz:1 abid:0
v_exp_f32 v117, v117
v_exp_f32 v118, v118
v_exp_f32 v119, v119
v_exp_f32 v120, v120
v_exp_f32 v121, v121
v_exp_f32 v122, v122
v_exp_f32 v123, v123
v_exp_f32 v124, v124
v_smfmac_f32_32x32x32_bf16 v[176:191], a[40:43], v[112:119], v26
ds_read_b128 a[32:35], v24 offset:9728
ds_read_b128 a[36:39], v25 offset:9728
v_exp_f32 v125, v125
v_exp_f32 v126, v126
v_exp_f32 v127, v127
v_exp_f32 v128, v128
v_exp_f32 v129, v129
v_smfmac_f32_32x32x32_bf16 v[176:191], a[44:47], v[120:127], v26
v_exp_f32 v130, v130
v_exp_f32 v131, v131
v_exp_f32 v132, v132
v_mfma_f32_32x32x16_bf16 v[144:159], a[16:19], v[12:15], v[144:159]
v_exp_f32 v133, v133
v_exp_f32 v134, v134
v_exp_f32 v135, v135
v_mfma_f32_32x32x16_bf16 v[160:175], a[16:19], v[16:19], v[160:175]
s_waitcnt lgkmcnt(0)
buffer_load_dwordx2 v[252:253], v41, s[8:11], s69 offen
v_exp_f32 v136, v136
v_exp_f32 v137, v137
v_exp_f32 v138, v138
v_exp_f32 v139, v139
v_smfmac_f32_32x32x32_bf16 v[192:207], a[40:43], v[128:135], v26
s_add_u32 s24, s32, 41472
s_addc_u32 s25, s33, 0
v_exp_f32 v140, v140
v_exp_f32 v141, v141
v_exp_f32 v142, v142
v_exp_f32 v143, v143
v_exp_f32 v144, v144
v_exp_f32 v145, v145
v_smfmac_f32_32x32x32_bf16 v[192:207], a[44:47], v[136:143], v26
s_waitcnt vmcnt(8)
v_readfirstlane_b32 s3, v0
s_add_u32 m0, s47, 24576
L_pad14:
s_cbranch_execz L_hret0
ds_read_b128 a[16:19], v22 offset:14592
ds_read_b32 a24, v23 offset:14592
buffer_load_dwordx4 v32, s[24:27], 0 offen lds
v_exp_f32 v146, v146
v_exp_f32 v147, v147
v_exp_f32 v148, v148
v_mfma_f32_32x32x4_2b_bf16 v[112:143], a[26:27], v[20:21], 0 cbsz:1 abid:1
v_exp_f32 v149, v149
v_exp_f32 v150, v150
v_exp_f32 v151, v151
v_exp_f32 v152, v152
v_exp_f32 v153, v153
v_exp_f32 v154, v154
v_exp_f32 v155, v155
v_exp_f32 v156, v156
v_smfmac_f32_32x32x32_bf16 v[176:191], a[32:35], v[144:151], v26
s_cmp_lt_u32 s3, s1
s_cbranch_scc1 L_spin2
L_back2:
ds_read_b128 a[40:43], v24 offset:12160
ds_read_b128 a[44:47], v25 offset:12160
v_exp_f32 v157, v157
v_exp_f32 v158, v158
v_exp_f32 v159, v159
v_exp_f32 v160, v160
v_exp_f32 v161, v161
v_smfmac_f32_32x32x32_bf16 v[176:191], a[36:39], v[152:159], v26
s_barrier
buffer_atomic_add v29, v28, s[28:31], s63 offen offset:2048 sc1
v_exp_f32 v162, v162
v_exp_f32 v163, v163
v_exp_f32 v164, v164
v_mfma_f32_32x32x16_bf16 v[112:127], a[20:23], v[12:15], v[112:127]
v_exp_f32 v165, v165
v_exp_f32 v166, v166
v_exp_f32 v167, v167
v_mfma_f32_32x32x16_bf16 v[128:143], a[20:23], v[16:19], v[128:143]
s_waitcnt lgkmcnt(0)
v_exp_f32 v168, v168
v_exp_f32 v169, v169
v_exp_f32 v170, v170
v_exp_f32 v171, v171
v_smfmac_f32_32x32x32_bf16 v[192:207], a[32:35], v[160:167], v26
s_add_u32 s24, s32, 82944
s_addc_u32 s25, s33, 0
v_exp_f32 v172, v172
v_exp_f32 v173, v173
v_exp_f32 v174, v174
v_exp_f32 v175, v175
v_exp_f32 v112, v112
v_exp_f32 v113, v113
v_smfmac_f32_32x32x32_bf16 v[192:207], a[36:39], v[168:175], v26
s_add_u32 m0, s47, 28672
ds_read_b128 a[20:23], v22 offset:17024
buffer_load_dwordx4 v32, s[24:27], 0 offen lds
v_exp_f32 v114, v114
v_exp_f32 v115, v115
v_exp_f32 v116, v116
v_mfma_f32_32x32x4_2b_bf16 v[144:175], a[24:25], v[20:21], 0 cbsz:1 abid:0
v_exp_f32 v117, v117
v_exp_f32 v118, v118
v_exp_f32 v119, v119
v_exp_f32 v120, v120
v_exp_f32 v121, v121
v_exp_f32 v122, v122
v_exp_f32 v123, v123
v_exp_f32 v124, v124
v_smfmac_f32_32x32x32_bf16 v[176:191], a[40:43], v[112:119], v26
ds_read_b128 a[32:35], v24 offset:14592
ds_read_b128 a[36:39], v25 offset:14592
v_exp_f32 v125, v125
v_exp_f32 v126, v126
v_exp_f32 v127, v127
v_exp_f32 v128, v128
v_exp_f32 v129, v129
v_smfmac_f32_32x32x32_bf16 v[176:191], a[44:47], v[120:127], v26
v_exp_f32 v130, v130
v_exp_f32 v131, v131
v_exp_f32 v132, v132
v_mfma_f32_32x32x16_bf16 v[144:159], a[16:19], v[12:15], v[144:159]
buffer_load_dwordx4 a[96:99], v36, s[12:15], 0 offen sc1
buffer_load_dwordx2 a[104:105], v37, s[12:15], 0 offen sc1
v_exp_f32 v133, v133
v_exp_f32 v134, v134
v_exp_f32 v135, v135
v_mfma_f32_32x32x16_bf16 v[160:175], a[16:19], v[16:19], v[160:175]
s_waitcnt lgkmcnt(0)
v_exp_f32 v136, v136
v_exp_f32 v137, v137
v_exp_f32 v138, v138
v_exp_f32 v139, v139
v_smfmac_f32_32x32x32_bf16 v[192:207], a[40:43], v[128:135], v26
s_add_u32 s24, s32, 124416
s_addc_u32 s25, s33, 0
v_exp_f32 v140, v140
v_exp_f32 v141, v141
v_exp_f32 v142, v142
v_exp_f32 v143, v143
s_nop 7
s_mov_b64 exec, 0
s_cmp_eq_u32 s44, 0
s_cbranch_scc1 L_pad15
s_cmp_eq_u32 s44, 1
s_cbranch_scc1 L_pad16
s_cmp_eq_u32 s44, 2
s_cbranch_scc1 L_pad17
s_branch L_hret2
L_hret2:
s_mov_b64 exec, -1
v_exp_f32 v144, v144
v_exp_f32 v145, v145
v_smfmac_f32_32x32x32_bf16 v[192:207], a[44:47], v[136:143], v26
s_add_u32 m0, s47, 32768
ds_read_b128 a[16:19], v22 offset:19456
ds_read_b32 a26, v23 offset:19456
buffer_load_dwordx4 v32, s[24:27], 0 offen lds
v_exp_f32 v146, v146
v_exp_f32 v147, v147
v_exp_f32 v148, v148
v_mfma_f32_32x32x4_2b_bf16 v[112:143], a[24:25], v[20:21], 0 cbsz:1 abid:1
v_exp_f32 v149, v149
v_exp_f32 v150, v150
v_exp_f32 v151, v151
v_exp_f32 v152, v152
v_exp_f32 v153, v153
v_exp_f32 v154, v154
v_exp_f32 v155, v155
v_exp_f32 v156, v156
v_smfmac_f32_32x32x32_bf16 v[176:191], a[32:35], v[144:151], v26
ds_read_b128 a[40:43], v24 offset:17024
ds_read_b128 a[44:47], v25 offset:17024
v_exp_f32 v157, v157
v_exp_f32 v158, v158
v_exp_f32 v159, v159
v_exp_f32 v160, v160
v_exp_f32 v161, v161
v_smfmac_f32_32x32x32_bf16 v[176:191], a[36:39], v[152:159], v26
buffer_load_dword v4, v4, s[28:31], 0 offen sc1
v_exp_f32 v162, v162
v_exp_f32 v163, v163
v_exp_f32 v164, v164
v_mfma_f32_32x32x16_bf16 v[112:127], a[20:23], v[12:15], v[112:127]
buffer_load_dwordx4 a[106:109], v36, s[12:15], 0 offen offset:1024 sc1
buffer_load_dwordx2 a[114:115], v37, s[12:15], 0 offen offset:1024 sc1
v_exp_f32 v165, v165
v_exp_f32 v166, v166
v_exp_f32 v167, v167
v_mfma_f32_32x32x16_bf16 v[128:143], a[20:23], v[16:19], v[128:143]
s_waitcnt lgkmcnt(0)
v_exp_f32 v168, v168
v_exp_f32 v169, v169
v_exp_f32 v170, v170
v_exp_f32 v171, v171
v_smfmac_f32_32x32x32_bf16 v[192:207], a[32:35], v[160:167], v26
s_add_u32 s24, s32, 165888
s_addc_u32 s25, s33, 0
v_exp_f32 v172, v172
v_exp_f32 v173, v173
v_exp_f32 v174, v174
v_exp_f32 v175, v175
v_exp_f32 v112, v112
v_exp_f32 v113, v113
v_smfmac_f32_32x32x32_bf16 v[192:207], a[36:39], v[168:175], v26
s_add_u32 m0, s47, 36864
ds_read_b128 a[20:23], v22 offset:21888
buffer_load_dwordx4 v32, s[24:27], 0 offen lds
v_exp_f32 v114, v114
v_exp_f32 v115, v115
v_exp_f32 v116, v116
v_mfma_f32_32x32x4_2b_bf16 v[144:175], a[26:27], v[20:21], 0 cbsz:1 abid:0
v_exp_f32 v117, v117
v_exp_f32 v118, v118
v_exp_f32 v119, v119
v_exp_f32 v120, v120
v_exp_f32 v121, v121
v_exp_f32 v122, v122
v_exp_f32 v123, v123
v_exp_f32 v124, v124
v_smfmac_f32_32x32x32_bf16 v[176:191], a[40:43], v[112:119], v26
ds_read_b128 a[32:35], v24 offset:19456
ds_read_b128 a[36:39], v25 offset:19456
v_exp_f32 v125, v125
v_exp_f32 v126, v126
v_exp_f32 v127, v127
v_exp_f32 v128, v128
v_exp_f32 v129, v129
v_smfmac_f32_32x32x32_bf16 v[176:191], a[44:47], v[120:127], v26
v_exp_f32 v130, v130
v_exp_f32 v131, v131
v_exp_f32 v132, v132
v_mfma_f32_32x32x16_bf16 v[144:159], a[16:19], v[12:15], v[144:159]
buffer_load_dwordx4 a[116:119], v36, s[12:15], 0 offen offset:2048 sc1
buffer_load_dwordx2 a[124:125], v37, s[12:15], 0 offen offset:2048 sc1
v_exp_f32 v133, v133
v_exp_f32 v134, v134
v_exp_f32 v135, v135
v_mfma_f32_32x32x16_bf16 v[160:175], a[16:19], v[16:19], v[160:175]
s_waitcnt lgkmcnt(0)
v_exp_f32 v136, v136
v_exp_f32 v137, v137
v_exp_f32 v138, v138
v_exp_f32 v139, v139
v_smfmac_f32_32x32x32_bf16 v[192:207], a[40:43], v[128:135], v26
s_add_u32 s24, s32, 207360
s_addc_u32 s25, s33, 0
v_exp_f32 v140, v140
v_exp_f32 v141, v141
v_exp_f32 v142, v142
v_exp_f32 v143, v143
v_exp_f32 v144, v144
v_exp_f32 v145, v145
v_smfmac_f32_32x32x32_bf16 v[192:207], a[44:47], v[136:143], v26
s_add_u32 m0, s47, 40960
ds_read_b128 a[16:19], v22 offset:24320
ds_read_b32 a24, v23 offset:24320
buffer_load_dwordx4 v32, s[24:27], 0 offen lds
v_exp_f32 v146, v146
v_exp_f32 v147, v147
v_exp_f32 v148, v148
v_mfma_f32_32x32x4_2b_bf16 v[112:143], a[26:27], v[20:21], 0 cbsz:1 abid:1
v_exp_f32 v149, v149
v_exp_f32 v150, v150
v_exp_f32 v151, v151
v_exp_f32 v152, v152
v_exp_f32 v153, v153
v_exp_f32 v154, v154
v_exp_f32 v155, v155
v_exp_f32 v156, v156
v_smfmac_f32_32x32x32_bf16 v[176:191], a[32:35], v[144:151], v26
ds_read_b128 a[40:43], v24 offset:21888
ds_read_b128 a[44:47], v25 offset:21888
v_exp_f32 v157, v157
v_exp_f32 v158, v158
v_exp_f32 v159, v159
v_exp_f32 v160, v160
v_exp_f32 v161, v161
v_smfmac_f32_32x32x32_bf16 v[176:191], a[36:39], v[152:159], v26
v_exp_f32 v162, v162
v_exp_f32 v163, v163
v_exp_f32 v164, v164
v_mfma_f32_32x32x16_bf16 v[112:127], a[20:23], v[12:15], v[112:127]
buffer_load_dwordx4 a[126:129], v36, s[12:15], 0 offen offset:3072 sc1
buffer_load_dwordx2 a[134:135], v37, s[12:15], 0 offen offset:3072 sc1
v_exp_f32 v165, v165
v_exp_f32 v166, v166
v_exp_f32 v167, v167
v_mfma_f32_32x32x16_bf16 v[128:143], a[20:23], v[16:19], v[128:143]
s_waitcnt lgkmcnt(0)
v_exp_f32 v168, v168
v_exp_f32 v169, v169
v_exp_f32 v170, v170
v_exp_f32 v171, v171
v_smfmac_f32_32x32x32_bf16 v[192:207], a[32:35], v[160:167], v26
s_add_u32 s24, s32, 248832
s_addc_u32 s25, s33, 0
v_exp_f32 v172, v172
v_exp_f32 v173, v173
v_exp_f32 v174, v174
v_exp_f32 v175, v175
v_exp_f32 v112, v112
v_exp_f32 v113, v113
v_smfmac_f32_32x32x32_bf16 v[192:207], a[36:39], v[168:175], v26
s_add_u32 m0, s47, 45056
ds_read_b128 a[20:23], v22 offset:26752
buffer_load_dwordx4 v32, s[24:27], 0 offen lds
v_exp_f32 v114, v114
v_exp_f32 v115, v115
v_exp_f32 v116, v116
v_mfma_f32_32x32x4_2b_bf16 v[144:175], a[24:25], v[20:21], 0 cbsz:1 abid:0
v_exp_f32 v117, v117
v_exp_f32 v118, v118
v_exp_f32 v119, v119
v_exp_f32 v120, v120
v_exp_f32 v121, v121
v_exp_f32 v122, v122
v_exp_f32 v123, v123
v_exp_f32 v124, v124
v_smfmac_f32_32x32x32_bf16 v[176:191], a[40:43], v[112:119], v26
ds_read_b128 a[32:35], v24 offset:24320
ds_read_b128 a[36:39], v25 offset:24320
v_exp_f32 v125, v125
v_exp_f32 v126, v126
v_exp_f32 v127, v127
v_exp_f32 v128, v128
v_exp_f32 v129, v129
v_smfmac_f32_32x32x32_bf16 v[176:191], a[44:47], v[120:127], v26
s_add_u32 s12, s28, 4096
s_addc_u32 s13, s29, 0
v_exp_f32 v130, v130
v_exp_f32 v131, v131
v_exp_f32 v132, v132
v_mfma_f32_32x32x16_bf16 v[144:159], a[16:19], v[12:15], v[144:159]
buffer_load_dwordx4 a[136:139], v36, s[12:15], 0 offen sc1
buffer_load_dwordx2 a[144:145], v37, s[12:15], 0 offen sc1
v_exp_f32 v133, v133
v_exp_f32 v134, v134
v_exp_f32 v135, v135
v_mfma_f32_32x32x16_bf16 v[160:175], a[16:19], v[16:19], v[160:175]
s_waitcnt lgkmcnt(0)
v_exp_f32 v136, v136
v_exp_f32 v137, v137
v_exp_f32 v138, v138
v_exp_f32 v139, v139
v_smfmac_f32_32x32x32_bf16 v[192:207], a[40:43], v[128:135], v26
s_add_u32 s24, s32, 290304
s_addc_u32 s25, s33, 0
v_exp_f32 v140, v140
v_exp_f32 v141, v141
v_exp_f32 v142, v142
v_exp_f32 v143, v143
v_exp_f32 v144, v144
v_exp_f32 v145, v145
v_smfmac_f32_32x32x32_bf16 v[192:207], a[44:47], v[136:143], v26
s_add_u32 m0, s47, 49152
ds_read_b128 a[16:19], v22 offset:29184
ds_read_b32 a26, v23 offset:29184
buffer_load_dwordx4 v32, s[24:27], 0 offen lds
v_exp_f32 v146, v146
v_exp_f32 v147, v147
v_exp_f32 v148, v148
v_mfma_f32_32x32x4_2b_bf16 v[112:143], a[24:25], v[20:21], 0 cbsz:1 abid:1
v_exp_f32 v149, v149
v_exp_f32 v150, v150
v_exp_f32 v151, v151
v_exp_f32 v152, v152
v_exp_f32 v153, v153
v_exp_f32 v154, v154
v_exp_f32 v155, v155
v_exp_f32 v156, v156
v_smfmac_f32_32x32x32_bf16 v[176:191], a[32:35], v[144:151], v26
ds_read_b128 a[40:43], v24 offset:26752
ds_read_b128 a[44:47], v25 offset:26752
v_exp_f32 v157, v157
v_exp_f32 v158, v158
v_exp_f32 v159, v159
v_exp_f32 v160, v160
v_exp_f32 v161, v161
v_smfmac_f32_32x32x32_bf16 v[176:191], a[36:39], v[152:159], v26
v_exp_f32 v162, v162
v_exp_f32 v163, v163
v_exp_f32 v164, v164
v_mfma_f32_32x32x16_bf16 v[112:127], a[20:23], v[12:15], v[112:127]
buffer_load_dwordx4 a[146:149], v36, s[12:15], 0 offen offset:1024 sc1
buffer_load_dwordx2 a[154:155], v37, s[12:15], 0 offen offset:1024 sc1
v_exp_f32 v165, v165
v_exp_f32 v166, v166
v_exp_f32 v167, v167
v_mfma_f32_32x32x16_bf16 v[128:143], a[20:23], v[16:19], v[128:143]
s_waitcnt lgkmcnt(0)
v_exp_f32 v168, v168
v_exp_f32 v169, v169
v_exp_f32 v170, v170
v_exp_f32 v171, v171
v_smfmac_f32_32x32x32_bf16 v[192:207], a[32:35], v[160:167], v26
s_add_u32 s24, s32, 331776
s_addc_u32 s25, s33, 0
v_exp_f32 v172, v172
v_exp_f32 v173, v173
v_exp_f32 v174, v174
v_exp_f32 v175, v175
v_exp_f32 v112, v112
v_exp_f32 v113, v113
v_smfmac_f32_32x32x32_bf16 v[192:207], a[36:39], v[168:175], v26
s_add_u32 m0, s47, 53248
ds_read_b128 a[20:23], v22 offset:31616
buffer_load_dwordx4 v32, s[24:27], 0 offen lds
v_exp_f32 v114, v114
v_exp_f32 v115, v115
v_exp_f32 v116, v116
v_mfma_f32_32x32x4_2b_bf16 v[144:175], a[26:27], v[20:21], 0 cbsz:1 abid:0
v_exp_f32 v117, v117
v_exp_f32 v118, v118
v_exp_f32 v119, v119
v_exp_f32 v120, v120
v_exp_f32 v121, v121
v_exp_f32 v122, v122
v_exp_f32 v123, v123
v_exp_f32 v124, v124
v_smfmac_f32_32x32x32_bf16 v[176:191], a[40:43], v[112:119], v26
ds_read_b128 a[32:35], v24 offset:29184
ds_read_b128 a[36:39], v25 offset:29184
v_exp_f32 v125, v125
v_exp_f32 v126, v126
v_exp_f32 v127, v127
v_exp_f32 v128, v128
v_exp_f32 v129, v129
v_smfmac_f32_32x32x32_bf16 v[176:191], a[44:47], v[120:127], v26
v_exp_f32 v130, v130
v_exp_f32 v131, v131
v_exp_f32 v132, v132
v_mfma_f32_32x32x16_bf16 v[144:159], a[16:19], v[12:15], v[144:159]
buffer_load_dwordx4 a[156:159], v36, s[12:15], 0 offen offset:2048 sc1
buffer_load_dwordx2 a[164:165], v37, s[12:15], 0 offen offset:2048 sc1
v_exp_f32 v133, v133
v_exp_f32 v134, v134
v_exp_f32 v135, v135
v_mfma_f32_32x32x16_bf16 v[160:175], a[16:19], v[16:19], v[160:175]
s_waitcnt lgkmcnt(0)
v_exp_f32 v136, v136
v_exp_f32 v137, v137
v_exp_f32 v138, v138
v_exp_f32 v139, v139
v_smfmac_f32_32x32x32_bf16 v[192:207], a[40:43], v[128:135], v26
s_add_u32 s24, s32, 373248
s_addc_u32 s25, s33, 0
v_exp_f32 v140, v140
v_exp_f32 v141, v141
v_exp_f32 v142, v142
v_exp_f32 v143, v143
v_exp_f32 v144, v144
v_exp_f32 v145, v145
v_smfmac_f32_32x32x32_bf16 v[192:207], a[44:47], v[136:143], v26
s_add_u32 m0, s47, 57344
ds_read_b128 a[16:19], v22 offset:34048
ds_read_b32 a24, v23 offset:34048
buffer_load_dwordx4 v32, s[24:27], 0 offen lds
v_exp_f32 v146, v146
v_exp_f32 v147, v147
v_exp_f32 v148, v148
v_mfma_f32_32x32x4_2b_bf16 v[112:143], a[26:27], v[20:21], 0 cbsz:1 abid:1
v_exp_f32 v149, v149
v_exp_f32 v150, v150
v_exp_f32 v151, v151
v_exp_f32 v152, v152
v_exp_f32 v153, v153
v_exp_f32 v154, v154
v_exp_f32 v155, v155
v_exp_f32 v156, v156
v_smfmac_f32_32x32x32_bf16 v[176:191], a[32:35], v[144:151], v26
ds_read_b128 a[40:43], v24 offset:31616
ds_read_b128 a[44:47], v25 offset:31616
v_exp_f32 v157, v157
v_exp_f32 v158, v158
v_exp_f32 v159, v159
v_exp_f32 v160, v160
v_exp_f32 v161, v161
v_smfmac_f32_32x32x32_bf16 v[176:191], a[36:39], v[152:159], v26
v_exp_f32 v162, v162
v_exp_f32 v163, v163
v_exp_f32 v164, v164
v_mfma_f32_32x32x16_bf16 v[112:127], a[20:23], v[12:15], v[112:127]
buffer_load_dwordx4 a[166:169], v36, s[12:15], 0 offen offset:3072 sc1
buffer_load_dwordx2 a[174:175], v37, s[12:15], 0 offen offset:3072 sc1
v_exp_f32 v165, v165
v_exp_f32 v166, v166
v_exp_f32 v167, v167
v_mfma_f32_32x32x16_bf16 v[128:143], a[20:23], v[16:19], v[128:143]
s_waitcnt lgkmcnt(0)
v_exp_f32 v168, v168
v_exp_f32 v169, v169
v_exp_f32 v170, v170
v_exp_f32 v171, v171
v_smfmac_f32_32x32x32_bf16 v[192:207], a[32:35], v[160:167], v26
s_add_u32 s24, s32, 414720
s_addc_u32 s25, s33, 0
v_exp_f32 v172, v172
v_exp_f32 v173, v173
v_exp_f32 v174, v174
v_exp_f32 v175, v175
v_exp_f32 v112, v112
v_exp_f32 v113, v113
v_smfmac_f32_32x32x32_bf16 v[192:207], a[36:39], v[168:175], v26
s_add_u32 m0, s47, 61440
ds_read_b128 a[20:23], v22 offset:36480
buffer_load_dwordx4 v32, s[24:27], 0 offen lds
v_exp_f32 v114, v114
v_exp_f32 v115, v115
v_exp_f32 v116, v116
v_mfma_f32_32x32x4_2b_bf16 v[144:175], a[24:25], v[20:21], 0 cbsz:1 abid:0
v_exp_f32 v117, v117
v_exp_f32 v118, v118
v_exp_f32 v119, v119
v_exp_f32 v120, v120
v_exp_f32 v121, v121
v_exp_f32 v122, v122
v_exp_f32 v123, v123
v_exp_f32 v124, v124
v_smfmac_f32_32x32x32_bf16 v[176:191], a[40:43], v[112:119], v26
ds_read_b128 a[32:35], v24 offset:34048
ds_read_b128 a[36:39], v25 offset:34048
v_exp_f32 v125, v125
v_exp_f32 v126, v126
v_exp_f32 v127, v127
v_exp_f32 v128, v128
v_exp_f32 v129, v129
v_smfmac_f32_32x32x32_bf16 v[176:191], a[44:47], v[120:127], v26
s_add_u32 s12, s28, 8192
s_addc_u32 s13, s29, 0
v_exp_f32 v130, v130
v_exp_f32 v131, v131
v_exp_f32 v132, v132
v_mfma_f32_32x32x16_bf16 v[144:159], a[16:19], v[12:15], v[144:159]
buffer_load_dwordx4 a[176:179], v36, s[12:15], 0 offen sc1
buffer_load_dwordx2 a[184:185], v37, s[12:15], 0 offen sc1
v_exp_f32 v133, v133
v_exp_f32 v134, v134
v_exp_f32 v135, v135
v_mfma_f32_32x32x16_bf16 v[160:175], a[16:19], v[16:19], v[160:175]
s_waitcnt lgkmcnt(0)
v_exp_f32 v136, v136
v_exp_f32 v137, v137
v_exp_f32 v138, v138
v_exp_f32 v139, v139
v_smfmac_f32_32x32x32_bf16 v[192:207], a[40:43], v[128:135], v26
s_add_u32 s24, s32, 456192
s_addc_u32 s25, s33, 0
v_exp_f32 v140, v140
v_exp_f32 v141, v141
v_exp_f32 v142, v142
v_exp_f32 v143, v143
v_exp_f32 v144, v144
v_exp_f32 v145, v145
v_smfmac_f32_32x32x32_bf16 v[192:207], a[44:47], v[136:143], v26
s_add_u32 m0, s47, 65536
ds_read_b128 a[16:19], v22 offset:38912
ds_read_b32 a26, v23 offset:38912
buffer_load_dwordx4 v32, s[24:27], 0 offen lds
v_exp_f32 v146, v146
v_exp_f32 v147, v147
v_exp_f32 v148, v148
v_mfma_f32_32x32x4_2b_bf16 v[112:143], a[24:25], v[20:21], 0 cbsz:1 abid:1
v_exp_f32 v149, v149
v_exp_f32 v150, v150
v_exp_f32 v151, v151
v_exp_f32 v152, v152
v_exp_f32 v153, v153
v_exp_f32 v154, v154
v_exp_f32 v155, v155
v_exp_f32 v156, v156
v_smfmac_f32_32x32x32_bf16 v[176:191], a[32:35], v[144:151], v26
ds_read_b128 a[40:43], v24 offset:36480
ds_read_b128 a[44:47], v25 offset:36480
v_exp_f32 v157, v157
v_exp_f32 v158, v158
v_exp_f32 v159, v159
v_exp_f32 v160, v160
v_exp_f32 v161, v161
v_smfmac_f32_32x32x32_bf16 v[176:191], a[36:39], v[152:159], v26
v_exp_f32 v162, v162
v_exp_f32 v163, v163
v_exp_f32 v164, v164
v_mfma_f32_32x32x16_bf16 v[112:127], a[20:23], v[12:15], v[112:127]
buffer_load_dwordx4 a[186:189], v36, s[12:15], 0 offen offset:1024 sc1
buffer_load_dwordx2 a[194:195], v37, s[12:15], 0 offen offset:1024 sc1
v_exp_f32 v165, v165
v_exp_f32 v166, v166
v_exp_f32 v167, v167
v_mfma_f32_32x32x16_bf16 v[128:143], a[20:23], v[16:19], v[128:143]
s_waitcnt lgkmcnt(0)
v_exp_f32 v168, v168
v_exp_f32 v169, v169
v_exp_f32 v170, v170
v_exp_f32 v171, v171
v_smfmac_f32_32x32x32_bf16 v[192:207], a[32:35], v[160:167], v26
v_exp_f32 v172, v172
v_exp_f32 v173, v173
v_exp_f32 v174, v174
v_exp_f32 v175, v175
v_exp_f32 v112, v112
v_exp_f32 v113, v113
v_smfmac_f32_32x32x32_bf16 v[192:207], a[36:39], v[168:175], v26
ds_read_b128 a[20:23], v22 offset:41344
v_exp_f32 v114, v114
v_exp_f32 v115, v115
v_exp_f32 v116, v116
v_mfma_f32_32x32x4_2b_bf16 v[144:175], a[26:27], v[20:21], 0 cbsz:1 abid:0
v_exp_f32 v117, v117
v_exp_f32 v118, v118
v_exp_f32 v119, v119
v_exp_f32 v120, v120
v_exp_f32 v121, v121
v_exp_f32 v122, v122
v_exp_f32 v123, v123
v_exp_f32 v124, v124
v_smfmac_f32_32x32x32_bf16 v[176:191], a[40:43], v[112:119], v26
ds_read_b128 a[32:35], v24 offset:38912
ds_read_b128 a[36:39], v25 offset:38912
v_exp_f32 v125, v125
v_exp_f32 v126, v126
v_exp_f32 v127, v127
v_exp_f32 v128, v128
v_exp_f32 v129, v129
v_smfmac_f32_32x32x32_bf16 v[176:191], a[44:47], v[120:127], v26
v_exp_f32 v130, v130
v_exp_f32 v131, v131
v_exp_f32 v132, v132
v_mfma_f32_32x32x16_bf16 v[144:159], a[16:19], v[12:15], v[144:159]
buffer_load_dwordx4 a[196:199], v36, s[12:15], 0 offen offset:2048 sc1
buffer_load_dwordx2 a[204:205], v37, s[12:15], 0 offen offset:2048 sc1
v_exp_f32 v133, v133
v_exp_f32 v134, v134
v_exp_f32 v135, v135
v_mfma_f32_32x32x16_bf16 v[160:175], a[16:19], v[16:19], v[160:175]
s_waitcnt lgkmcnt(0)
v_exp_f32 v136, v136
v_exp_f32 v137, v137
v_exp_f32 v138, v138
v_exp_f32 v139, v139
v_smfmac_f32_32x32x32_bf16 v[192:207], a[40:43], v[128:135], v26
v_exp_f32 v140, v140
v_exp_f32 v141, v141
v_exp_f32 v142, v142
v_exp_f32 v143, v143
v_exp_f32 v144, v144
v_exp_f32 v145, v145
v_smfmac_f32_32x32x32_bf16 v[192:207], a[44:47], v[136:143], v26
ds_read_b128 a[16:19], v22 offset:43776
ds_read_b32 a24, v23 offset:43776
v_exp_f32 v146, v146
v_exp_f32 v147, v147
v_exp_f32 v148, v148
v_mfma_f32_32x32x4_2b_bf16 v[112:143], a[26:27], v[20:21], 0 cbsz:1 abid:1
v_exp_f32 v149, v149
v_exp_f32 v150, v150
v_exp_f32 v151, v151
v_exp_f32 v152, v152
v_exp_f32 v153, v153
v_exp_f32 v154, v154
v_exp_f32 v155, v155
v_exp_f32 v156, v156
v_smfmac_f32_32x32x32_bf16 v[176:191], a[32:35], v[144:151], v26
ds_read_b128 a[40:43], v24 offset:41344
ds_read_b128 a[44:47], v25 offset:41344
v_exp_f32 v157, v157
v_exp_f32 v158, v158
v_exp_f32 v159, v159
v_exp_f32 v160, v160
v_exp_f32 v161, v161
v_smfmac_f32_32x32x32_bf16 v[176:191], a[36:39], v[152:159], v26
v_exp_f32 v162, v162
v_exp_f32 v163, v163
v_exp_f32 v164, v164
v_mfma_f32_32x32x16_bf16 v[112:127], a[20:23], v[12:15], v[112:127]
buffer_load_dwordx4 a[206:209], v36, s[12:15], 0 offen offset:3072 sc1
buffer_load_dwordx2 a[214:215], v37, s[12:15], 0 offen offset:3072 sc1
v_mov_b32 v0, 0
v_exp_f32 v165, v165
v_exp_f32 v166, v166
v_exp_f32 v167, v167
v_mfma_f32_32x32x16_bf16 v[128:143], a[20:23], v[16:19], v[128:143]
s_waitcnt lgkmcnt(0)
buffer_atomic_umax v0, v28, s[28:31], s54 offen sc0 sc1
v_exp_f32 v168, v168
v_exp_f32 v169, v169
v_exp_f32 v170, v170
v_exp_f32 v171, v171
v_smfmac_f32_32x32x32_bf16 v[192:207], a[32:35], v[160:167], v26
v_exp_f32 v172, v172
v_exp_f32 v173, v173
v_exp_f32 v174, v174
v_exp_f32 v175, v175
v_exp_f32 v112, v112
v_exp_f32 v113, v113
v_smfmac_f32_32x32x32_bf16 v[192:207], a[36:39], v[168:175], v26
ds_read_b128 a[20:23], v22 offset:46208
v_exp_f32 v114, v114
v_exp_f32 v115, v115
v_exp_f32 v116, v116
v_mfma_f32_32x32x4_2b_bf16 v[144:175], a[24:25], v[20:21], 0 cbsz:1 abid:0
v_exp_f32 v117, v117
v_exp_f32 v118, v118
v_exp_f32 v119, v119
v_exp_f32 v120, v120
v_exp_f32 v121, v121
v_exp_f32 v122, v122
v_exp_f32 v123, v123
v_exp_f32 v124, v124
v_smfmac_f32_32x32x32_bf16 v[176:191], a[40:43], v[112:119], v26
ds_read_b128 a[32:35], v24 offset:43776
ds_read_b128 a[36:39], v25 offset:43776
v_exp_f32 v125, v125
v_exp_f32 v126, v126
v_exp_f32 v127, v127
v_exp_f32 v128, v128
v_exp_f32 v129, v129
v_smfmac_f32_32x32x32_bf16 v[176:191], a[44:47], v[120:127], v26
s_add_u32 s12, s28, 12288
s_addc_u32 s13, s29, 0
v_exp_f32 v130, v130
v_exp_f32 v131, v131
v_exp_f32 v132, v132
v_mfma_f32_32x32x16_bf16 v[144:159], a[16:19], v[12:15], v[144:159]
buffer_load_dwordx4 a[216:219], v36, s[12:15], 0 offen sc1
buffer_load_dwordx2 a[224:225], v37, s[12:15], 0 offen sc1
v_exp_f32 v133, v133
v_exp_f32 v134, v134
v_exp_f32 v135, v135
v_mfma_f32_32x32x16_bf16 v[160:175], a[16:19], v[16:19], v[160:175]
s_waitcnt lgkmcnt(0)
v_exp_f32 v136, v136
v_exp_f32 v137, v137
v_exp_f32 v138, v138
v_exp_f32 v139, v139
v_smfmac_f32_32x32x32_bf16 v[192:207], a[40:43], v[128:135], v26
v_exp_f32 v140, v140
v_exp_f32 v141, v141
v_exp_f32 v142, v142
v_exp_f32 v143, v143
v_exp_f32 v144, v144
v_exp_f32 v145, v145
v_smfmac_f32_32x32x32_bf16 v[192:207], a[44:47], v[136:143], v26
ds_read_b128 a[16:19], v22 offset:48640
ds_read_b32 a26, v23 offset:48640
v_exp_f32 v146, v146
v_exp_f32 v147, v147
v_exp_f32 v148, v148
v_mfma_f32_32x32x4_2b_bf16 v[112:143], a[24:25], v[20:21], 0 cbsz:1 abid:1
v_exp_f32 v149, v149
v_exp_f32 v150, v150
v_exp_f32 v151, v151
v_exp_f32 v152, v152
v_exp_f32 v153, v153
v_exp_f32 v154, v154
v_exp_f32 v155, v155
v_exp_f32 v156, v156
v_smfmac_f32_32x32x32_bf16 v[176:191], a[32:35], v[144:151], v26
ds_read_b128 a[40:43], v24 offset:46208
ds_read_b128 a[44:47], v25 offset:46208
v_exp_f32 v157, v157
v_exp_f32 v158, v158
v_exp_f32 v159, v159
v_exp_f32 v160, v160
v_exp_f32 v161, v161
v_smfmac_f32_32x32x32_bf16 v[176:191], a[36:39], v[152:159], v26
v_exp_f32 v162, v162
v_exp_f32 v163, v163
v_exp_f32 v164, v164
v_mfma_f32_32x32x16_bf16 v[112:127], a[20:23], v[12:15], v[112:127]
buffer_load_dwordx4 a[226:229], v36, s[12:15], 0 offen offset:1024 sc1
buffer_load_dwordx2 a[234:235], v37, s[12:15], 0 offen offset:1024 sc1
v_exp_f32 v165, v165
v_exp_f32 v166, v166
v_exp_f32 v167, v167
v_mfma_f32_32x32x16_bf16 v[128:143], a[20:23], v[16:19], v[128:143]
s_waitcnt lgkmcnt(0)
v_exp_f32 v168, v168
v_exp_f32 v169, v169
v_exp_f32 v170, v170
v_exp_f32 v171, v171
v_smfmac_f32_32x32x32_bf16 v[192:207], a[32:35], v[160:167], v26
v_exp_f32 v172, v172
v_exp_f32 v173, v173
v_exp_f32 v174, v174
v_exp_f32 v175, v175
v_exp_f32 v112, v112
v_exp_f32 v113, v113
v_smfmac_f32_32x32x32_bf16 v[192:207], a[36:39], v[168:175], v26
ds_read_b128 a[20:23], v22 offset:51072
v_exp_f32 v114, v114
v_exp_f32 v115, v115
v_exp_f32 v116, v116
v_mfma_f32_32x32x4_2b_bf16 v[144:175], a[26:27], v[20:21], 0 cbsz:1 abid:0
v_exp_f32 v117, v117
v_exp_f32 v118, v118
v_exp_f32 v119, v119
v_exp_f32 v120, v120
v_exp_f32 v121, v121
v_exp_f32 v122, v122
v_exp_f32 v123, v123
v_exp_f32 v124, v124
v_smfmac_f32_32x32x32_bf16 v[176:191], a[40:43], v[112:119], v26
ds_read_b128 a[32:35], v24 offset:48640
ds_read_b128 a[36:39], v25 offset:48640
v_exp_f32 v125, v125
v_exp_f32 v126, v126
v_exp_f32 v127, v127
v_exp_f32 v128, v128
v_exp_f32 v129, v129
v_smfmac_f32_32x32x32_bf16 v[176:191], a[44:47], v[120:127], v26
v_exp_f32 v130, v130
v_exp_f32 v131, v131
v_exp_f32 v132, v132
v_mfma_f32_32x32x16_bf16 v[144:159], a[16:19], v[12:15], v[144:159]
buffer_load_dwordx4 a[236:239], v36, s[12:15], 0 offen offset:2048 sc1
buffer_load_dwordx2 a[244:245], v37, s[12:15], 0 offen offset:2048 sc1
v_exp_f32 v133, v133
v_exp_f32 v134, v134
v_exp_f32 v135, v135
v_mfma_f32_32x32x16_bf16 v[160:175], a[16:19], v[16:19], v[160:175]
s_waitcnt lgkmcnt(0)
v_exp_f32 v136, v136
v_exp_f32 v137, v137
v_exp_f32 v138, v138
v_exp_f32 v139, v139
v_smfmac_f32_32x32x32_bf16 v[192:207], a[40:43], v[128:135], v26
v_exp_f32 v140, v140
v_exp_f32 v141, v141
v_exp_f32 v142, v142
v_exp_f32 v143, v143
v_exp_f32 v144, v144
L_pad15:
s_cbranch_execz L_hret2
v_exp_f32 v145, v145
v_smfmac_f32_32x32x32_bf16 v[192:207], a[44:47], v[136:143], v26
s_waitcnt vmcnt(6)
v_readfirstlane_b32 s3, v0
ds_read_b128 a[16:19], v22 offset:53504
ds_read_b32 a24, v23 offset:53504
v_exp_f32 v146, v146
v_exp_f32 v147, v147
v_exp_f32 v148, v148
v_mfma_f32_32x32x4_2b_bf16 v[112:143], a[26:27], v[20:21], 0 cbsz:1 abid:1
v_exp_f32 v149, v149
v_exp_f32 v150, v150
v_exp_f32 v151, v151
v_exp_f32 v152, v152
v_exp_f32 v153, v153
v_exp_f32 v154, v154
v_exp_f32 v155, v155
v_exp_f32 v156, v156
v_smfmac_f32_32x32x32_bf16 v[176:191], a[32:35], v[144:151], v26
s_cmp_lt_u32 s3, s1
s_cbranch_scc1 L_spin3
L_back3:
ds_read_b128 a[40:43], v24 offset:51072
ds_read_b128 a[44:47], v25 offset:51072
v_exp_f32 v157, v157
v_exp_f32 v158, v158
v_exp_f32 v159, v159
v_exp_f32 v160, v160
v_exp_f32 v161, v161
v_smfmac_f32_32x32x32_bf16 v[176:191], a[36:39], v[152:159], v26
s_barrier
v_exp_f32 v162, v162
v_exp_f32 v163, v163
v_exp_f32 v164, v164
v_mfma_f32_32x32x16_bf16 v[112:127], a[20:23], v[12:15], v[112:127]
buffer_load_dwordx4 a[246:249], v36, s[12:15], 0 offen offset:3072 sc1
buffer_load_dwordx2 a[254:255], v37, s[12:15], 0 offen offset:3072 sc1
v_exp_f32 v165, v165
v_exp_f32 v166, v166
v_exp_f32 v167, v167
v_mfma_f32_32x32x16_bf16 v[128:143], a[20:23], v[16:19], v[128:143]
s_waitcnt lgkmcnt(0)
v_exp_f32 v168, v168
v_exp_f32 v169, v169
v_exp_f32 v170, v170
v_exp_f32 v171, v171
v_smfmac_f32_32x32x32_bf16 v[192:207], a[32:35], v[160:167], v26
s_add_u32 s24, s32, 497664
s_addc_u32 s25, s33, 0
v_exp_f32 v172, v172
v_exp_f32 v173, v173
v_exp_f32 v174, v174
v_exp_f32 v175, v175
v_exp_f32 v112, v112
v_exp_f32 v113, v113
v_smfmac_f32_32x32x32_bf16 v[192:207], a[36:39], v[168:175], v26
s_add_u32 m0, s47, 69632
ds_read_b128 a[20:23], v22 offset:55936
buffer_load_dwordx4 v32, s[24:27], 0 offen lds
v_exp_f32 v114, v114
v_exp_f32 v115, v115
v_exp_f32 v116, v116
v_mfma_f32_32x32x4_2b_bf16 v[144:175], a[24:25], v[20:21], 0 cbsz:1 abid:0
v_exp_f32 v117, v117
v_exp_f32 v118, v118
v_exp_f32 v119, v119
v_exp_f32 v120, v120
v_exp_f32 v121, v121
v_exp_f32 v122, v122
v_exp_f32 v123, v123
v_exp_f32 v124, v124
v_smfmac_f32_32x32x32_bf16 v[176:191], a[40:43], v[112:119], v26
ds_read_b128 a[32:35], v24 offset:53504
ds_read_b128 a[36:39], v25 offset:53504
v_exp_f32 v125, v125
v_exp_f32 v126, v126
v_exp_f32 v127, v127
v_exp_f32 v128, v128
v_exp_f32 v129, v129
v_smfmac_f32_32x32x32_bf16 v[176:191], a[44:47], v[120:127], v26
s_add_u32 s12, s28, 0
s_addc_u32 s13, s29, 0
v_exp_f32 v130, v130
v_exp_f32 v131, v131
v_exp_f32 v132, v132
v_mfma_f32_32x32x16_bf16 v[144:159], a[16:19], v[12:15], v[144:159]
buffer_load_dwordx4 a[100:103], v38, s[12:15], 0 offen sc1
v_exp_f32 v133, v133
v_exp_f32 v134, v134
v_exp_f32 v135, v135
v_mfma_f32_32x32x16_bf16 v[160:175], a[16:19], v[16:19], v[160:175]
s_waitcnt lgkmcnt(0)
v_exp_f32 v136, v136
v_exp_f32 v137, v137
v_exp_f32 v138, v138
v_exp_f32 v139, v139
v_smfmac_f32_32x32x32_bf16 v[192:207], a[40:43], v[128:135], v26
s_add_u32 s24, s32, 539136
s_addc_u32 s25, s33, 0
v_exp_f32 v140, v140
v_exp_f32 v141, v141
v_exp_f32 v142, v142
v_exp_f32 v143, v143
v_exp_f32 v144, v144
v_exp_f32 v145, v145
v_smfmac_f32_32x32x32_bf16 v[192:207], a[44:47], v[136:143], v26
s_add_u32 m0, s47, 73728
ds_read_b128 a[16:19], v22 offset:58368
ds_read_b32 a26, v23 offset:58368
buffer_load_dwordx4 v32, s[24:27], 0 offen lds
v_exp_f32 v146, v146
v_exp_f32 v147, v147
v_exp_f32 v148, v148
v_mfma_f32_32x32x4_2b_bf16 v[112:143], a[24:25], v[20:21], 0 cbsz:1 abid:1
v_exp_f32 v149, v149
v_exp_f32 v150, v150
v_exp_f32 v151, v151
v_exp_f32 v152, v152
v_exp_f32 v153, v153
v_exp_f32 v154, v154
v_exp_f32 v155, v155
v_exp_f32 v156, v156
v_smfmac_f32_32x32x32_bf16 v[176:191], a[32:35], v[144:151], v26
ds_read_b128 a[40:43], v24 offset:55936
ds_read_b128 a[44:47], v25 offset:55936
v_exp_f32 v157, v157
v_exp_f32 v158, v158
v_exp_f32 v159, v159
v_exp_f32 v160, v160
v_exp_f32 v161, v161
v_smfmac_f32_32x32x32_bf16 v[176:191], a[36:39], v[152:159], v26
v_exp_f32 v162, v162
v_exp_f32 v163, v163
v_exp_f32 v164, v164
v_mfma_f32_32x32x16_bf16 v[112:127], a[20:23], v[12:15], v[112:127]
buffer_load_dwordx4 a[110:113], v38, s[12:15], 0 offen offset:1024 sc1
v_exp_f32 v165, v165
v_exp_f32 v166, v166
v_exp_f32 v167, v167
v_mfma_f32_32x32x16_bf16 v[128:143], a[20:23], v[16:19], v[128:143]
s_waitcnt lgkmcnt(0)
v_exp_f32 v168, v168
v_exp_f32 v169, v169
v_exp_f32 v170, v170
v_exp_f32 v171, v171
v_smfmac_f32_32x32x32_bf16 v[192:207], a[32:35], v[160:167], v26
s_add_u32 s24, s32, 580608
s_addc_u32 s25, s33, 0
v_exp_f32 v172, v172
v_exp_f32 v173, v173
v_exp_f32 v174, v174
v_exp_f32 v175, v175
v_exp_f32 v112, v112
v_exp_f32 v113, v113
v_smfmac_f32_32x32x32_bf16 v[192:207], a[36:39], v[168:175], v26
s_add_u32 m0, s47, 77824
ds_read_b128 a[20:23], v22 offset:60800
buffer_load_dwordx4 v32, s[24:27], 0 offen lds
v_exp_f32 v114, v114
v_exp_f32 v115, v115
v_exp_f32 v116, v116
v_mfma_f32_32x32x4_2b_bf16 v[144:175], a[26:27], v[20:21], 0 cbsz:1 abid:0
v_exp_f32 v117, v117
v_exp_f32 v118, v118
v_exp_f32 v119, v119
v_exp_f32 v120, v120
v_exp_f32 v121, v121
v_exp_f32 v122, v122
v_exp_f32 v123, v123
v_exp_f32 v124, v124
v_smfmac_f32_32x32x32_bf16 v[176:191], a[40:43], v[112:119], v26
ds_read_b128 a[32:35], v24 offset:58368
ds_read_b128 a[36:39], v25 offset:58368
v_exp_f32 v125, v125
v_exp_f32 v126, v126
v_exp_f32 v127, v127
v_exp_f32 v128, v128
v_exp_f32 v129, v129
v_smfmac_f32_32x32x32_bf16 v[176:191], a[44:47], v[120:127], v26
v_exp_f32 v130, v130
v_exp_f32 v131, v131
v_exp_f32 v132, v132
v_mfma_f32_32x32x16_bf16 v[144:159], a[16:19], v[12:15], v[144:159]
buffer_load_dwordx4 a[120:123], v38, s[12:15], 0 offen offset:2048 sc1
v_exp_f32 v133, v133
v_exp_f32 v134, v134
v_exp_f32 v135, v135
v_mfma_f32_32x32x16_bf16 v[160:175], a[16:19], v[16:19], v[160:175]
s_waitcnt lgkmcnt(0)
v_exp_f32 v136, v136
v_exp_f32 v137, v137
v_exp_f32 v138, v138
v_exp_f32 v139, v139
v_smfmac_f32_32x32x32_bf16 v[192:207], a[40:43], v[128:135], v26
s_add_u32 s24, s32, 622080
s_addc_u32 s25, s33, 0
v_add_u32 v22, 0xf700, v22
v_add_u32 v23, 0xf700, v23
v_exp_f32 v140, v140
v_exp_f32 v141, v141
v_exp_f32 v142, v142
v_exp_f32 v143, v143
v_exp_f32 v144, v144
v_exp_f32 v145, v145
v_smfmac_f32_32x32x32_bf16 v[192:207], a[44:47], v[136:143], v26
s_add_u32 m0, s47, 81920
ds_read_b128 a[16:19], v22
ds_read_b32 a24, v23
buffer_load_dwordx4 v32, s[24:27], 0 offen lds
v_exp_f32 v146, v146
v_exp_f32 v147, v147
v_exp_f32 v148, v148
v_mfma_f32_32x32x4_2b_bf16 v[112:143], a[26:27], v[20:21], 0 cbsz:1 abid:1
v_exp_f32 v149, v149
v_exp_f32 v150, v150
v_exp_f32 v151, v151
v_exp_f32 v152, v152
v_exp_f32 v153, v153
v_exp_f32 v154, v154
v_exp_f32 v155, v155
v_exp_f32 v156, v156
v_smfmac_f32_32x32x32_bf16 v[176:191], a[32:35], v[144:151], v26
ds_read_b128 a[40:43], v24 offset:60800
ds_read_b128 a[44:47], v25 offset:60800
v_exp_f32 v157, v157
v_exp_f32 v158, v158
v_exp_f32 v159, v159
v_exp_f32 v160, v160
v_exp_f32 v161, v161
v_smfmac_f32_32x32x32_bf16 v[176:191], a[36:39], v[152:159], v26
v_exp_f32 v162, v162
v_exp_f32 v163, v163
v_exp_f32 v164, v164
v_mfma_f32_32x32x16_bf16 v[112:127], a[20:23], v[12:15], v[112:127]
buffer_load_dwordx4 a[130:133], v38, s[12:15], 0 offen offset:3072 sc1
v_exp_f32 v165, v165
v_exp_f32 v166, v166
v_exp_f32 v167, v167
v_mfma_f32_32x32x16_bf16 v[128:143], a[20:23], v[16:19], v[128:143]
s_waitcnt lgkmcnt(0)
v_exp_f32 v168, v168
v_exp_f32 v169, v169
v_exp_f32 v170, v170
v_exp_f32 v171, v171
v_smfmac_f32_32x32x32_bf16 v[192:207], a[32:35], v[160:167], v26
s_add_u32 s24, s32, 0
s_addc_u32 s25, s33, 0
v_exp_f32 v172, v172
v_exp_f32 v173, v173
v_exp_f32 v174, v174
v_exp_f32 v175, v175
v_exp_f32 v112, v112
v_exp_f32 v113, v113
v_smfmac_f32_32x32x32_bf16 v[192:207], a[36:39], v[168:175], v26
s_add_u32 m0, s47, 86016
ds_read_b128 a[20:23], v22 offset:2432
buffer_load_dwordx4 v33, s[24:27], 0 offen lds
v_add_u32 v24, 0xf700, v24
v_add_u32 v25, 0xf700, v25
v_exp_f32 v114, v114
v_exp_f32 v115, v115
v_exp_f32 v116, v116
v_mfma_f32_32x32x4_2b_bf16 v[144:175], a[24:25], v[20:21], 0 cbsz:1 abid:0
v_exp_f32 v117, v117
v_exp_f32 v118, v118
v_exp_f32 v119, v119
v_exp_f32 v120, v120
v_exp_f32 v121, v121
v_exp_f32 v122, v122
v_exp_f32 v123, v123
v_exp_f32 v124, v124
v_smfmac_f32_32x32x32_bf16 v[176:191], a[40:43], v[112:119], v26
ds_read_b128 a[32:35], v24
ds_read_b128 a[36:39], v25
v_exp_f32 v125, v125
v_exp_f32 v126, v126
v_exp_f32 v127, v127
v_exp_f32 v128, v128
v_exp_f32 v129, v129
v_smfmac_f32_32x32x32_bf16 v[176:191], a[44:47], v[120:127], v26
s_add_u32 s12, s28, 4096
s_addc_u32 s13, s29, 0
v_exp_f32 v130, v130
v_exp_f32 v131, v131
v_exp_f32 v132, v132
v_mfma_f32_32x32x16_bf16 v[144:159], a[16:19], v[12:15], v[144:159]
buffer_load_dwordx4 a[140:143], v38, s[12:15], 0 offen sc1
v_exp_f32 v133, v133
v_exp_f32 v134, v134
v_exp_f32 v135, v135
v_mfma_f32_32x32x16_bf16 v[160:175], a[16:19], v[16:19], v[160:175]
s_waitcnt lgkmcnt(0)
v_exp_f32 v136, v136
v_exp_f32 v137, v137
v_exp_f32 v138, v138
v_exp_f32 v139, v139
v_smfmac_f32_32x32x32_bf16 v[192:207], a[40:43], v[128:135], v26
s_add_u32 s24, s32, 331776
s_addc_u32 s25, s33, 0
v_exp_f32 v140, v140
v_exp_f32 v141, v141
v_exp_f32 v142, v142
v_exp_f32 v143, v143
v_exp_f32 v144, v144
v_exp_f32 v145, v145
v_smfmac_f32_32x32x32_bf16 v[192:207], a[44:47], v[136:143], v26
s_add_u32 m0, s47, 90112
ds_read_b128 a[16:19], v22 offset:4864
ds_read_b32 a26, v23 offset:4864
buffer_load_dwordx4 v33, s[24:27], 0 offen lds
v_exp_f32 v146, v146
v_exp_f32 v147, v147
v_exp_f32 v148, v148
v_mfma_f32_32x32x4_2b_bf16 v[112:143], a[24:25], v[20:21], 0 cbsz:1 abid:1
v_exp_f32 v149, v149
v_exp_f32 v150, v150
v_exp_f32 v151, v151
v_exp_f32 v152, v152
v_exp_f32 v153, v153
v_exp_f32 v154, v154
v_exp_f32 v155, v155
v_exp_f32 v156, v156
v_smfmac_f32_32x32x32_bf16 v[176:191], a[32:35], v[144:151], v26
ds_read_b128 a[40:43], v24 offset:2432
ds_read_b128 a[44:47], v25 offset:2432
v_exp_f32 v157, v157
v_exp_f32 v158, v158
v_exp_f32 v159, v159
v_exp_f32 v160, v160
v_exp_f32 v161, v161
v_smfmac_f32_32x32x32_bf16 v[176:191], a[36:39], v[152:159], v26
v_exp_f32 v162, v162
v_exp_f32 v163, v163
v_exp_f32 v164, v164
v_mfma_f32_32x32x16_bf16 v[112:127], a[20:23], v[12:15], v[112:127]
buffer_load_dwordx4 a[150:153], v38, s[12:15], 0 offen offset:1024 sc1
v_exp_f32 v165, v165
v_exp_f32 v166, v166
v_exp_f32 v167, v167
v_mfma_f32_32x32x16_bf16 v[128:143], a[20:23], v[16:19], v[128:143]
s_waitcnt lgkmcnt(0)
v_exp_f32 v168, v168
v_exp_f32 v169, v169
v_exp_f32 v170, v170
v_exp_f32 v171, v171
v_smfmac_f32_32x32x32_bf16 v[192:207], a[32:35], v[160:167], v26
v_exp_f32 v172, v172
v_exp_f32 v173, v173
v_exp_f32 v174, v174
v_exp_f32 v175, v175
v_exp_f32 v112, v112
v_exp_f32 v113, v113
v_smfmac_f32_32x32x32_bf16 v[192:207], a[36:39], v[168:175], v26
ds_read_b128 a[20:23], v22 offset:7296
v_exp_f32 v114, v114
v_exp_f32 v115, v115
v_exp_f32 v116, v116
v_mfma_f32_32x32x4_2b_bf16 v[144:175], a[26:27], v[20:21], 0 cbsz:1 abid:0
v_exp_f32 v117, v117
v_exp_f32 v118, v118
v_exp_f32 v119, v119
v_exp_f32 v120, v120
v_exp_f32 v121, v121
v_exp_f32 v122, v122
v_exp_f32 v123, v123
v_exp_f32 v124, v124
v_smfmac_f32_32x32x32_bf16 v[176:191], a[40:43], v[112:119], v26
ds_read_b128 a[32:35], v24 offset:4864
ds_read_b128 a[36:39], v25 offset:4864
v_exp_f32 v125, v125
v_exp_f32 v126, v126
v_exp_f32 v127, v127
v_exp_f32 v128, v128
v_exp_f32 v129, v129
v_smfmac_f32_32x32x32_bf16 v[176:191], a[44:47], v[120:127], v26
v_exp_f32 v130, v130
v_exp_f32 v131, v131
v_exp_f32 v132, v132
v_mfma_f32_32x32x16_bf16 v[144:159], a[16:19], v[12:15], v[144:159]
buffer_load_dwordx4 a[160:163], v38, s[12:15], 0 offen offset:2048 sc1
v_exp_f32 v133, v133
v_exp_f32 v134, v134
v_exp_f32 v135, v135
v_mfma_f32_32x32x16_bf16 v[160:175], a[16:19], v[16:19], v[160:175]
s_waitcnt lgkmcnt(0)
v_exp_f32 v136, v136
v_exp_f32 v137, v137
v_exp_f32 v138, v138
v_exp_f32 v139, v139
v_smfmac_f32_32x32x32_bf16 v[192:207], a[40:43], v[128:135], v26
v_exp_f32 v140, v140
v_exp_f32 v141, v141
v_exp_f32 v142, v142
v_exp_f32 v143, v143
v_exp_f32 v144, v144
v_exp_f32 v145, v145
v_smfmac_f32_32x32x32_bf16 v[192:207], a[44:47], v[136:143], v26
ds_read_b128 a[16:19], v22 offset:9728
ds_read_b32 a24, v23 offset:9728
v_exp_f32 v146, v146
v_exp_f32 v147, v147
v_exp_f32 v148, v148
v_mfma_f32_32x32x4_2b_bf16 v[112:143], a[26:27], v[20:21], 0 cbsz:1 abid:1
v_exp_f32 v149, v149
v_exp_f32 v150, v150
v_exp_f32 v151, v151
v_exp_f32 v152, v152
v_exp_f32 v153, v153
v_exp_f32 v154, v154
v_exp_f32 v155, v155
v_exp_f32 v156, v156
v_smfmac_f32_32x32x32_bf16 v[176:191], a[32:35], v[144:151], v26
ds_read_b128 a[40:43], v24 offset:7296
ds_read_b128 a[44:47], v25 offset:7296
v_exp_f32 v157, v157
v_exp_f32 v158, v158
v_exp_f32 v159, v159
v_exp_f32 v160, v160
v_exp_f32 v161, v161
v_smfmac_f32_32x32x32_bf16 v[176:191], a[36:39], v[152:159], v26
buffer_load_dword v0, v41, s[36:39], s69 offen
v_exp_f32 v162, v162
v_exp_f32 v163, v163
v_exp_f32 v164, v164
v_mfma_f32_32x32x16_bf16 v[112:127], a[20:23], v[12:15], v[112:127]
buffer_load_dwordx4 a[170:173], v38, s[12:15], 0 offen offset:3072 sc1
v_exp_f32 v165, v165
v_exp_f32 v166, v166
v_exp_f32 v167, v167
v_mfma_f32_32x32x16_bf16 v[128:143], a[20:23], v[16:19], v[128:143]
s_waitcnt lgkmcnt(0)
v_exp_f32 v168, v168
v_exp_f32 v169, v169
v_exp_f32 v170, v170
v_exp_f32 v171, v171
v_smfmac_f32_32x32x32_bf16 v[192:207], a[32:35], v[160:167], v26
v_exp_f32 v172, v172
v_exp_f32 v173, v173
v_exp_f32 v174, v174
v_exp_f32 v175, v175
v_exp_f32 v112, v112
v_exp_f32 v113, v113
v_smfmac_f32_32x32x32_bf16 v[192:207], a[36:39], v[168:175], v26
ds_read_b128 a[20:23], v22 offset:12160
v_exp_f32 v114, v114
v_exp_f32 v115, v115
v_exp_f32 v116, v116
v_mfma_f32_32x32x4_2b_bf16 v[144:175], a[24:25], v[20:21], 0 cbsz:1 abid:0
v_exp_f32 v117, v117
v_exp_f32 v118, v118
v_exp_f32 v119, v119
v_exp_f32 v120, v120
v_exp_f32 v121, v121
v_exp_f32 v122, v122
v_exp_f32 v123, v123
v_exp_f32 v124, v124
v_smfmac_f32_32x32x32_bf16 v[176:191], a[40:43], v[112:119], v26
ds_read_b128 a[32:35], v24 offset:9728
ds_read_b128 a[36:39], v25 offset:9728
v_exp_f32 v125, v125
v_exp_f32 v126, v126
v_exp_f32 v127, v127
v_exp_f32 v128, v128
v_exp_f32 v129, v129
v_smfmac_f32_32x32x32_bf16 v[176:191], a[44:47], v[120:127], v26
s_add_u32 s12, s28, 8192
s_addc_u32 s13, s29, 0
v_exp_f32 v130, v130
v_exp_f32 v131, v131
v_exp_f32 v132, v132
v_mfma_f32_32x32x16_bf16 v[144:159], a[16:19], v[12:15], v[144:159]
buffer_load_dwordx4 a[180:183], v38, s[12:15], 0 offen sc1
v_exp_f32 v133, v133
v_exp_f32 v134, v134
v_exp_f32 v135, v135
v_mfma_f32_32x32x16_bf16 v[160:175], a[16:19], v[16:19], v[160:175]
s_waitcnt lgkmcnt(0)
v_exp_f32 v136, v136
v_exp_f32 v137, v137
v_exp_f32 v138, v138
v_exp_f32 v139, v139
v_smfmac_f32_32x32x32_bf16 v[192:207], a[40:43], v[128:135], v26
v_exp_f32 v140, v140
v_exp_f32 v141, v141
v_exp_f32 v142, v142
v_exp_f32 v143, v143
v_exp_f32 v144, v144
v_exp_f32 v145, v145
v_smfmac_f32_32x32x32_bf16 v[192:207], a[44:47], v[136:143], v26
ds_read_b128 a[16:19], v22 offset:14592
ds_read_b32 a26, v23 offset:14592
v_exp_f32 v146, v146
v_exp_f32 v147, v147
v_exp_f32 v148, v148
v_mfma_f32_32x32x4_2b_bf16 v[112:143], a[24:25], v[20:21], 0 cbsz:1 abid:1
v_exp_f32 v149, v149
v_exp_f32 v150, v150
v_exp_f32 v151, v151
v_exp_f32 v152, v152
v_exp_f32 v153, v153
v_exp_f32 v154, v154
v_exp_f32 v155, v155
v_exp_f32 v156, v156
v_smfmac_f32_32x32x32_bf16 v[176:191], a[32:35], v[144:151], v26
ds_read_b128 a[40:43], v24 offset:12160
ds_read_b128 a[44:47], v25 offset:12160
v_exp_f32 v157, v157
v_exp_f32 v158, v158
v_exp_f32 v159, v159
v_exp_f32 v160, v160
v_exp_f32 v161, v161
v_smfmac_f32_32x32x32_bf16 v[176:191], a[36:39], v[152:159], v26
v_exp_f32 v162, v162
v_exp_f32 v163, v163
v_exp_f32 v164, v164
v_mfma_f32_32x32x16_bf16 v[112:127], a[20:23], v[12:15], v[112:127]
buffer_load_dwordx4 a[190:193], v38, s[12:15], 0 offen offset:1024 sc1
v_exp_f32 v165, v165
v_exp_f32 v166, v166
v_exp_f32 v167, v167
v_mfma_f32_32x32x16_bf16 v[128:143], a[20:23], v[16:19], v[128:143]
s_waitcnt lgkmcnt(0)
v_exp_f32 v168, v168
v_exp_f32 v169, v169
v_exp_f32 v170, v170
v_exp_f32 v171, v171
v_smfmac_f32_32x32x32_bf16 v[192:207], a[32:35], v[160:167], v26
v_exp_f32 v172, v172
v_exp_f32 v173, v173
v_exp_f32 v174, v174
v_exp_f32 v175, v175
v_exp_f32 v112, v112
v_exp_f32 v113, v113
v_smfmac_f32_32x32x32_bf16 v[192:207], a[36:39], v[168:175], v26
ds_read_b128 a[20:23], v22 offset:17024
v_exp_f32 v114, v114
v_exp_f32 v115, v115
v_exp_f32 v116, v116
v_mfma_f32_32x32x4_2b_bf16 v[144:175], a[26:27], v[20:21], 0 cbsz:1 abid:0
v_exp_f32 v117, v117
v_exp_f32 v118, v118
v_exp_f32 v119, v119
v_exp_f32 v120, v120
v_exp_f32 v121, v121
v_exp_f32 v122, v122
v_exp_f32 v123, v123
v_exp_f32 v124, v124
v_smfmac_f32_32x32x32_bf16 v[176:191], a[40:43], v[112:119], v26
ds_read_b128 a[32:35], v24 offset:14592
ds_read_b128 a[36:39], v25 offset:14592
v_exp_f32 v125, v125
v_exp_f32 v126, v126
v_exp_f32 v127, v127
v_exp_f32 v128, v128
v_exp_f32 v129, v129
v_smfmac_f32_32x32x32_bf16 v[176:191], a[44:47], v[120:127], v26
v_exp_f32 v130, v130
v_exp_f32 v131, v131
v_exp_f32 v132, v132
v_mfma_f32_32x32x16_bf16 v[144:159], a[16:19], v[12:15], v[144:159]
buffer_load_dwordx4 a[200:203], v38, s[12:15], 0 offen offset:2048 sc1
v_exp_f32 v133, v133
v_exp_f32 v134, v134
v_exp_f32 v135, v135
v_mfma_f32_32x32x16_bf16 v[160:175], a[16:19], v[16:19], v[160:175]
s_waitcnt lgkmcnt(0)
v_exp_f32 v136, v136
v_exp_f32 v137, v137
v_exp_f32 v138, v138
v_exp_f32 v139, v139
v_smfmac_f32_32x32x32_bf16 v[192:207], a[40:43], v[128:135], v26
v_exp_f32 v140, v140
v_exp_f32 v141, v141
v_exp_f32 v142, v142
v_exp_f32 v143, v143
v_exp_f32 v144, v144
v_exp_f32 v145, v145
v_smfmac_f32_32x32x32_bf16 v[192:207], a[44:47], v[136:143], v26
ds_read_b128 a[16:19], v22 offset:19456
ds_read_b32 a24, v23 offset:19456
v_exp_f32 v146, v146
v_exp_f32 v147, v147
v_exp_f32 v148, v148
v_mfma_f32_32x32x4_2b_bf16 v[112:143], a[26:27], v[20:21], 0 cbsz:1 abid:1
v_exp_f32 v149, v149
v_exp_f32 v150, v150
v_exp_f32 v151, v151
v_exp_f32 v152, v152
v_exp_f32 v153, v153
v_exp_f32 v154, v154
v_exp_f32 v155, v155
v_exp_f32 v156, v156
v_smfmac_f32_32x32x32_bf16 v[176:191], a[32:35], v[144:151], v26
ds_read_b128 a[40:43], v24 offset:17024
ds_read_b128 a[44:47], v25 offset:17024
v_exp_f32 v157, v157
v_exp_f32 v158, v158
v_exp_f32 v159, v159
v_exp_f32 v160, v160
v_exp_f32 v161, v161
v_smfmac_f32_32x32x32_bf16 v[176:191], a[36:39], v[152:159], v26
v_exp_f32 v162, v162
v_exp_f32 v163, v163
v_exp_f32 v164, v164
v_mfma_f32_32x32x16_bf16 v[112:127], a[20:23], v[12:15], v[112:127]
buffer_load_dwordx4 a[210:213], v38, s[12:15], 0 offen offset:3072 sc1
v_exp_f32 v165, v165
v_exp_f32 v166, v166
v_exp_f32 v167, v167
v_mfma_f32_32x32x16_bf16 v[128:143], a[20:23], v[16:19], v[128:143]
s_waitcnt lgkmcnt(0)
v_exp_f32 v168, v168
v_exp_f32 v169, v169
v_exp_f32 v170, v170
v_exp_f32 v171, v171
v_smfmac_f32_32x32x32_bf16 v[192:207], a[32:35], v[160:167], v26
v_exp_f32 v172, v172
v_exp_f32 v173, v173
v_exp_f32 v174, v174
v_exp_f32 v175, v175
v_exp_f32 v112, v112
v_exp_f32 v113, v113
v_smfmac_f32_32x32x32_bf16 v[192:207], a[36:39], v[168:175], v26
ds_read_b128 a[20:23], v22 offset:21888
v_exp_f32 v114, v114
v_exp_f32 v115, v115
v_exp_f32 v116, v116
v_mfma_f32_32x32x4_2b_bf16 v[144:175], a[24:25], v[20:21], 0 cbsz:1 abid:0
v_exp_f32 v117, v117
v_exp_f32 v118, v118
v_exp_f32 v119, v119
v_exp_f32 v120, v120
v_exp_f32 v121, v121
v_exp_f32 v122, v122
v_exp_f32 v123, v123
v_exp_f32 v124, v124
v_smfmac_f32_32x32x32_bf16 v[176:191], a[40:43], v[112:119], v26
ds_read_b128 a[32:35], v24 offset:19456
ds_read_b128 a[36:39], v25 offset:19456
v_exp_f32 v125, v125
v_exp_f32 v126, v126
v_exp_f32 v127, v127
v_exp_f32 v128, v128
v_exp_f32 v129, v129
v_smfmac_f32_32x32x32_bf16 v[176:191], a[44:47], v[120:127], v26
s_add_u32 s12, s28, 12288
s_addc_u32 s13, s29, 0
v_exp_f32 v130, v130
v_exp_f32 v131, v131
v_exp_f32 v132, v132
v_mfma_f32_32x32x16_bf16 v[144:159], a[16:19], v[12:15], v[144:159]
buffer_load_dwordx4 a[220:223], v38, s[12:15], 0 offen sc1
v_exp_f32 v133, v133
v_exp_f32 v134, v134
v_exp_f32 v135, v135
v_mfma_f32_32x32x16_bf16 v[160:175], a[16:19], v[16:19], v[160:175]
s_waitcnt lgkmcnt(0)
v_exp_f32 v136, v136
v_exp_f32 v137, v137
v_exp_f32 v138, v138
v_exp_f32 v139, v139
v_smfmac_f32_32x32x32_bf16 v[192:207], a[40:43], v[128:135], v26
v_exp_f32 v140, v140
v_exp_f32 v141, v141
v_exp_f32 v142, v142
v_exp_f32 v143, v143
v_exp_f32 v144, v144
v_exp_f32 v145, v145
v_smfmac_f32_32x32x32_bf16 v[192:207], a[44:47], v[136:143], v26
ds_read_b128 a[16:19], v22 offset:24320
ds_read_b32 a26, v23 offset:24320
v_exp_f32 v146, v146
v_exp_f32 v147, v147
v_exp_f32 v148, v148
v_mfma_f32_32x32x4_2b_bf16 v[112:143], a[24:25], v[20:21], 0 cbsz:1 abid:1
v_exp_f32 v149, v149
v_exp_f32 v150, v150
v_exp_f32 v151, v151
v_exp_f32 v152, v152
v_exp_f32 v153, v153
v_exp_f32 v154, v154
v_exp_f32 v155, v155
v_exp_f32 v156, v156
v_smfmac_f32_32x32x32_bf16 v[176:191], a[32:35], v[144:151], v26
ds_read_b128 a[40:43], v24 offset:21888
ds_read_b128 a[44:47], v25 offset:21888
v_exp_f32 v157, v157
v_exp_f32 v158, v158
v_exp_f32 v159, v159
v_exp_f32 v160, v160
v_exp_f32 v161, v161
v_smfmac_f32_32x32x32_bf16 v[176:191], a[36:39], v[152:159], v26
v_exp_f32 v162, v162
v_exp_f32 v163, v163
v_exp_f32 v164, v164
v_mfma_f32_32x32x16_bf16 v[112:127], a[20:23], v[12:15], v[112:127]
buffer_load_dwordx4 a[230:233], v38, s[12:15], 0 offen offset:1024 sc1
v_exp_f32 v165, v165
v_exp_f32 v166, v166
v_exp_f32 v167, v167
v_mfma_f32_32x32x16_bf16 v[128:143], a[20:23], v[16:19], v[128:143]
s_waitcnt lgkmcnt(0)
v_exp_f32 v168, v168
v_exp_f32 v169, v169
v_exp_f32 v170, v170
v_exp_f32 v171, v171
v_smfmac_f32_32x32x32_bf16 v[192:207], a[32:35], v[160:167], v26
v_exp_f32 v172, v172
v_exp_f32 v173, v173
v_exp_f32 v174, v174
v_exp_f32 v175, v175
v_exp_f32 v112, v112
v_exp_f32 v113, v113
v_smfmac_f32_32x32x32_bf16 v[192:207], a[36:39], v[168:175], v26
ds_read_b128 a[20:23], v22 offset:26752
v_exp_f32 v114, v114
v_exp_f32 v115, v115
v_exp_f32 v116, v116
v_mfma_f32_32x32x4_2b_bf16 v[144:175], a[26:27], v[20:21], 0 cbsz:1 abid:0
v_exp_f32 v117, v117
v_exp_f32 v118, v118
v_exp_f32 v119, v119
v_exp_f32 v120, v120
v_exp_f32 v121, v121
v_exp_f32 v122, v122
v_exp_f32 v123, v123
v_exp_f32 v124, v124
v_smfmac_f32_32x32x32_bf16 v[176:191], a[40:43], v[112:119], v26
ds_read_b128 a[32:35], v24 offset:24320
ds_read_b128 a[36:39], v25 offset:24320
v_exp_f32 v125, v125
v_exp_f32 v126, v126
v_exp_f32 v127, v127
v_exp_f32 v128, v128
v_exp_f32 v129, v129
v_smfmac_f32_32x32x32_bf16 v[176:191], a[44:47], v[120:127], v26
v_exp_f32 v130, v130
v_exp_f32 v131, v131
v_exp_f32 v132, v132
v_mfma_f32_32x32x16_bf16 v[144:159], a[16:19], v[12:15], v[144:159]
buffer_load_dwordx4 a[240:243], v38, s[12:15], 0 offen offset:2048 sc1
v_exp_f32 v133, v133
v_exp_f32 v134, v134
v_exp_f32 v135, v135
v_mfma_f32_32x32x16_bf16 v[160:175], a[16:19], v[16:19], v[160:175]
s_waitcnt lgkmcnt(0)
v_exp_f32 v136, v136
v_exp_f32 v137, v137
v_exp_f32 v138, v138
v_exp_f32 v139, v139
v_smfmac_f32_32x32x32_bf16 v[192:207], a[40:43], v[128:135], v26
v_exp_f32 v140, v140
v_exp_f32 v141, v141
v_exp_f32 v142, v142
v_exp_f32 v143, v143
v_exp_f32 v144, v144
v_exp_f32 v145, v145
v_smfmac_f32_32x32x32_bf16 v[192:207], a[44:47], v[136:143], v26
v_exp_f32 v146, v146
v_exp_f32 v147, v147
v_exp_f32 v148, v148
v_mfma_f32_32x32x4_2b_bf16 v[112:143], a[26:27], v[20:21], 0 cbsz:1 abid:1
v_exp_f32 v149, v149
v_exp_f32 v150, v150
v_exp_f32 v151, v151
v_exp_f32 v152, v152
v_exp_f32 v153, v153
v_exp_f32 v154, v154
v_exp_f32 v155, v155
v_exp_f32 v156, v156
v_smfmac_f32_32x32x32_bf16 v[176:191], a[32:35], v[144:151], v26
ds_read_b128 a[40:43], v24 offset:26752
ds_read_b128 a[44:47], v25 offset:26752
v_exp_f32 v157, v157
v_exp_f32 v158, v158
v_exp_f32 v159, v159
v_exp_f32 v160, v160
v_exp_f32 v161, v161
v_smfmac_f32_32x32x32_bf16 v[176:191], a[36:39], v[152:159], v26
v_exp_f32 v162, v162
v_exp_f32 v163, v163
v_exp_f32 v164, v164
v_mfma_f32_32x32x16_bf16 v[112:127], a[20:23], v[12:15], v[112:127]
buffer_load_dwordx4 a[250:253], v38, s[12:15], 0 offen offset:3072 sc1
v_exp_f32 v165, v165
v_exp_f32 v166, v166
v_exp_f32 v167, v167
v_mfma_f32_32x32x16_bf16 v[128:143], a[20:23], v[16:19], v[128:143]
s_waitcnt lgkmcnt(0)
v_exp_f32 v168, v168
v_exp_f32 v169, v169
v_exp_f32 v170, v170
v_exp_f32 v171, v171
v_smfmac_f32_32x32x32_bf16 v[192:207], a[32:35], v[160:167], v26
v_exp_f32 v172, v172
v_exp_f32 v173, v173
v_exp_f32 v174, v174
v_exp_f32 v175, v175
v_exp_f32 v112, v112
v_exp_f32 v113, v113
v_smfmac_f32_32x32x32_bf16 v[192:207], a[36:39], v[168:175], v26
v_exp_f32 v114, v114
v_exp_f32 v115, v115
L_pad16:
s_cbranch_execz L_hret2
v_exp_f32 v116, v116
v_exp_f32 v117, v117
v_exp_f32 v118, v118
v_exp_f32 v119, v119
v_exp_f32 v120, v120
v_exp_f32 v121, v121
v_exp_f32 v122, v122
v_exp_f32 v123, v123
v_exp_f32 v124, v124
v_smfmac_f32_32x32x32_bf16 v[176:191], a[40:43], v[112:119], v26
v_exp_f32 v125, v125
v_exp_f32 v126, v126
v_exp_f32 v127, v127
v_exp_f32 v128, v128
v_exp_f32 v129, v129
v_smfmac_f32_32x32x32_bf16 v[176:191], a[44:47], v[120:127], v26
v_exp_f32 v130, v130
v_exp_f32 v131, v131
v_exp_f32 v132, v132
v_exp_f32 v133, v133
v_exp_f32 v134, v134
v_exp_f32 v135, v135
v_exp_f32 v136, v136
v_exp_f32 v137, v137
v_exp_f32 v138, v138
v_exp_f32 v139, v139
v_smfmac_f32_32x32x32_bf16 v[192:207], a[40:43], v[128:135], v26
v_exp_f32 v140, v140
v_exp_f32 v141, v141
v_exp_f32 v142, v142
v_exp_f32 v143, v143
s_nop 1
v_smfmac_f32_32x32x32_bf16 v[192:207], a[44:47], v[136:143], v26
s_add_u32 s59, s65, 0x8000
L_att_fin:
v_rcp_f32 v70, v185
s_nop 0
v_mul_f32 v176, v70, v176
v_mul_f32 v177, v70, v177
v_mul_f32 v178, v70, v178
v_mul_f32 v179, v70, v179
v_mul_f32 v180, v70, v180
v_mul_f32 v181, v70, v181
v_mul_f32 v182, v70, v182
v_mul_f32 v183, v70, v183
v_mul_f32 v184, v70, v184
v_cvt_pk_bf16_f32 v76, v176, v177
v_cvt_pk_bf16_f32 v77, v178, v179
v_cvt_pk_bf16_f32 v78, v180, v181
v_cvt_pk_bf16_f32 v79, v182, v183
buffer_store_dwordx4 v[76:79], v42, s[28:31], s65 offen sc1
v_rcp_f32 v71, v201
s_nop 0
v_mul_f32 v192, v71, v192
v_mul_f32 v193, v71, v193
v_mul_f32 v194, v71, v194
v_mul_f32 v195, v71, v195
v_mul_f32 v196, v71, v196
v_mul_f32 v197, v71, v197
v_mul_f32 v198, v71, v198
v_mul_f32 v199, v71, v199
v_mul_f32 v200, v71, v200
v_cvt_pk_bf16_f32 v80, v192, v193
v_cvt_pk_bf16_f32 v81, v194, v195
v_cvt_pk_bf16_f32 v82, v196, v197
v_cvt_pk_bf16_f32 v83, v198, v199
v_permlane32_swap_b32 v184, v200
buffer_store_dwordx4 v[80:83], v42, s[28:31], s59 offen sc1
v_cvt_pk_bf16_f32 v84, v184, v200
buffer_store_dword v84, v43, s[28:31], s66 offen sc1
v_min_f32 v72, v185, v201
v_max_f32 v73, v185, v201
v_mul_f32 v73, 1132462080, v73
v_fma_f32 v72, 0, v73, v72
v_fma_f32 v72, 0, v176, v72
v_fma_f32 v72, 0, v177, v72
v_fma_f32 v72, 0, v178, v72
v_fma_f32 v72, 0, v179, v72
v_fma_f32 v72, 0, v180, v72
v_fma_f32 v72, 0, v181, v72
v_fma_f32 v72, 0, v182, v72
v_fma_f32 v72, 0, v183, v72
v_fma_f32 v72, 0, v184, v72
v_fma_f32 v72, 0, v192, v72
v_fma_f32 v72, 0, v193, v72
v_fma_f32 v72, 0, v194, v72
v_fma_f32 v72, 0, v195, v72
v_fma_f32 v72, 0, v196, v72
v_fma_f32 v72, 0, v197, v72
v_fma_f32 v72, 0, v198, v72
v_fma_f32 v72, 0, v199, v72
v_fma_f32 v72, 0, v200, v72
v_cmp_nle_f32 vcc, 226492416, v72
s_cmp_eq_u32 s52, 0
s_cselect_b64 s[60:61], -1, 0
s_and_b64 vcc, vcc, s[60:61]
s_cbranch_scc1 L_att_slow
s_waitcnt vmcnt(3)
s_barrier
v_mfma_f32_16x16x16_bf16 v[88:91], v[30:31], a[96:97], 0
v_and_b32 v232, 3, v1
v_bfe_u32 v233, v1, 2, 3
v_lshrrev_b32 v234, 5, v1
v_mfma_f32_16x16x16_bf16 v[92:95], v[30:31], a[98:99], 0
v_lshlrev_b32 v234, 10, v234
v_lshl_add_u32 v234, v233, 7, v234
v_lshl_add_u32 v234, v232, 3, v234
v_mfma_f32_16x16x16_bf16 v[96:99], v[30:31], a[100:101], 0
v_lshrrev_b32 v233, 1, v233
v_lshl_add_u32 v234, v233, 5, v234
v_mov_b32 v0, 0
v_mfma_f32_16x16x16_bf16 v[100:103], v[30:31], a[102:103], 0
s_lshr_b32 s58, s44, 1
s_lshl_b32 s58, s58, 6
v_mov_b32 v240, v234
v_xor_b32 v232, s58, v234
v_mfma_f32_16x16x16_bf16 v[104:107], v[30:31], a[104:105], 0
v_xor_b32 v233, 32, v232
v_xor_b32 v241, 32, v240
v_xor_b32 v234, 64, v232
v_mfma_f32_16x16x16_bf16 v[88:91], v[30:31], a[106:107], v[88:91]
v_xor_b32 v242, 64, v240
v_xor_b32 v235, 96, v232
v_xor_b32 v243, 96, v240
v_mfma_f32_16x16x16_bf16 v[92:95], v[30:31], a[108:109], v[92:95]
v_add_u32 v236, 0x10000, v232
v_add_u32 v237, 0x10000, v233
v_add_u32 v238, 0x10000, v234
v_mfma_f32_16x16x16_bf16 v[96:99], v[30:31], a[110:111], v[96:99]
v_add_u32 v239, 0x10000, v235
v_mfma_f32_16x16x16_bf16 v[100:103], v[30:31], a[112:113], v[100:103]
ds_read_b64_tr_b16 a[0:1], v232 offset:20480
ds_read_b64_tr_b16 a[2:3], v232 offset:22528
v_add_u32 v155, s67, v10
v_mfma_f32_16x16x16_bf16 v[104:107], v[30:31], a[114:115], v[104:107]
s_mul_i32 s59, s44, 2304
s_add_u32 s59, s59, 98304
ds_read_b64_tr_b16 a[4:5], v233 offset:20480
ds_read_b64_tr_b16 a[6:7], v233 offset:22528
v_mfma_f32_16x16x16_bf16 v[88:91], v[30:31], a[116:117], v[88:91]
s_add_u32 s60, s59, s58
s_xor_b32 s58, s58, 64
ds_read_b64_tr_b16 a[8:9], v234 offset:20480
ds_read_b64_tr_b16 a[10:11], v234 offset:22528
v_mfma_f32_16x16x16_bf16 v[92:95], v[30:31], a[118:119], v[92:95]
s_add_u32 s58, s59, s58
ds_read_b64_tr_b16 a[12:13], v235 offset:20480
ds_read_b64_tr_b16 a[14:15], v235 offset:22528
v_and_b32 v152, 15, v1
v_mfma_f32_16x16x16_bf16 v[96:99], v[30:31], a[120:121], v[96:99]
ds_read_b64_tr_b16 a[16:17], v240
ds_read_b64_tr_b16 a[18:19], v240 offset:2048
v_mul_u32_u24 v152, 144, v152
v_mfma_f32_16x16x16_bf16 v[100:103], v[30:31], a[122:123], v[100:103]
ds_read_b64_tr_b16 a[20:21], v232 offset:24576
ds_read_b64_tr_b16 a[22:23], v232 offset:26624
v_lshrrev_b32 v154, 4, v1
v_mfma_f32_16x16x16_bf16 v[104:107], v[30:31], a[124:125], v[104:107]
ds_read_b64_tr_b16 a[24:25], v233 offset:24576
ds_read_b64_tr_b16 a[26:27], v233 offset:26624
v_lshl_add_u32 v152, v154, 3, v152
v_mfma_f32_16x16x16_bf16 v[88:91], v[30:31], a[126:127], v[88:91]
ds_read_b64_tr_b16 a[28:29], v234 offset:24576
ds_read_b64_tr_b16 a[30:31], v234 offset:26624
v_add_u32 v153, s58, v152
v_mfma_f32_16x16x16_bf16 v[92:95], v[30:31], a[128:129], v[92:95]
ds_read_b64_tr_b16 a[32:33], v235 offset:24576
ds_read_b64_tr_b16 a[34:35], v235 offset:26624
v_add_u32 v152, s60, v152
v_mfma_f32_16x16x16_bf16 v[96:99], v[30:31], a[130:131], v[96:99]
ds_read_b64_tr_b16 a[36:37], v241
ds_read_b64_tr_b16 a[38:39], v241 offset:2048
v_lshrrev_b32 v156, 3, v1
v_mfma_f32_16x16x16_bf16 v[100:103], v[30:31], a[132:133], v[100:103]
ds_read_b64_tr_b16 a[40:41], v232 offset:28672
ds_read_b64_tr_b16 a[42:43], v232 offset:30720
v_lshl_add_u32 v154, v156, 4, v10
v_mfma_f32_16x16x16_bf16 v[104:107], v[30:31], a[134:135], v[104:107]
ds_read_b64_tr_b16 a[44:45], v233 offset:28672
ds_read_b64_tr_b16 a[46:47], v233 offset:30720
v_add_u32 v154, s59, v154
v_mfma_f32_16x16x16_bf16 v[88:91], v[30:31], a[136:137], v[88:91]
s_and_b32 s58, s71, 7
s_lshl_b32 s58, s58, 7
ds_read_b64_tr_b16 a[48:49], v234 offset:28672
ds_read_b64_tr_b16 a[50:51], v234 offset:30720
v_mfma_f32_16x16x16_bf16 v[92:95], v[30:31], a[138:139], v[92:95]
s_add_u32 s58, s58, s69
ds_read_b64_tr_b16 a[52:53], v235 offset:28672
ds_read_b64_tr_b16 a[54:55], v235 offset:30720
v_lshl_add_u32 v156, v156, 10, v10
v_mfma_f32_16x16x16_bf16 v[96:99], v[30:31], a[140:141], v[96:99]
s_waitcnt vmcnt(0)
buffer_atomic_add v29, v9, s[28:31], s64 offen sc1
v_mfma_f32_16x16x16_bf16 v[100:103], v[30:31], a[142:143], v[100:103]
ds_read_b64_tr_b16 a[56:57], v242
ds_read_b64_tr_b16 a[58:59], v242 offset:2048
v_add_u32 v156, s58, v156
v_mfma_f32_16x16x16_bf16 v[104:107], v[30:31], a[144:145], v[104:107]
ds_read_b64_tr_b16 a[60:61], v232 offset:32768
ds_read_b64_tr_b16 a[62:63], v232 offset:34816
v_add_u32 v157, 9216, v156
v_mfma_f32_16x16x16_bf16 v[88:91], v[30:31], a[146:147], v[88:91]
ds_read_b64_tr_b16 a[64:65], v233 offset:32768
ds_read_b64_tr_b16 a[66:67], v233 offset:34816
v_mfma_f32_16x16x16_bf16 v[92:95], v[30:31], a[148:149], v[92:95]
ds_read_b64_tr_b16 a[68:69], v234 offset:32768
ds_read_b64_tr_b16 a[70:71], v234 offset:34816
v_mfma_f32_16x16x16_bf16 v[96:99], v[30:31], a[150:151], v[96:99]
ds_read_b64_tr_b16 a[72:73], v235 offset:32768
ds_read_b64_tr_b16 a[74:75], v235 offset:34816
v_mfma_f32_16x16x16_bf16 v[100:103], v[30:31], a[152:153], v[100:103]
ds_read_b64_tr_b16 a[76:77], v243
ds_read_b64_tr_b16 a[78:79], v243 offset:2048
v_mfma_f32_16x16x16_bf16 v[104:107], v[30:31], a[154:155], v[104:107]
ds_read_b64_tr_b16 a[80:81], v232 offset:36864
ds_read_b64_tr_b16 a[82:83], v232 offset:38912
v_mfma_f32_16x16x16_bf16 v[88:91], v[30:31], a[156:157], v[88:91]
ds_read_b64_tr_b16 a[84:85], v233 offset:36864
ds_read_b64_tr_b16 a[86:87], v233 offset:38912
v_mfma_f32_16x16x16_bf16 v[92:95], v[30:31], a[158:159], v[92:95]
ds_read_b64_tr_b16 a[88:89], v234 offset:36864
ds_read_b64_tr_b16 a[90:91], v234 offset:38912
v_mfma_f32_16x16x16_bf16 v[96:99], v[30:31], a[160:161], v[96:99]
ds_read_b64_tr_b16 a[92:93], v235 offset:36864
ds_read_b64_tr_b16 a[94:95], v235 offset:38912
v_mfma_f32_16x16x16_bf16 v[100:103], v[30:31], a[162:163], v[100:103]
ds_read_b64_tr_b16 a[96:97], v240 offset:4096
ds_read_b64_tr_b16 a[98:99], v240 offset:6144
v_mfma_f32_16x16x16_bf16 v[104:107], v[30:31], a[164:165], v[104:107]
ds_read_b64_tr_b16 a[100:101], v232 offset:40960
ds_read_b64_tr_b16 a[102:103], v232 offset:43008
v_mfma_f32_16x16x16_bf16 v[88:91], v[30:31], a[166:167], v[88:91]
ds_read_b64_tr_b16 a[104:105], v233 offset:40960
ds_read_b64_tr_b16 a[106:107], v233 offset:43008
v_mfma_f32_16x16x16_bf16 v[92:95], v[30:31], a[168:169], v[92:95]
ds_read_b64_tr_b16 a[108:109], v234 offset:40960
ds_read_b64_tr_b16 a[110:111], v234 offset:43008
v_mfma_f32_16x16x16_bf16 v[96:99], v[30:31], a[170:171], v[96:99]
ds_read_b64_tr_b16 a[112:113], v235 offset:40960
ds_read_b64_tr_b16 a[114:115], v235 offset:43008
v_mfma_f32_16x16x16_bf16 v[100:103], v[30:31], a[172:173], v[100:103]
ds_read_b64_tr_b16 a[116:117], v241 offset:4096
ds_read_b64_tr_b16 a[118:119], v241 offset:6144
v_mfma_f32_16x16x16_bf16 v[104:107], v[30:31], a[174:175], v[104:107]
ds_read_b64_tr_b16 a[120:121], v232 offset:45056
ds_read_b64_tr_b16 a[122:123], v232 offset:47104
v_mfma_f32_16x16x16_bf16 v[88:91], v[30:31], a[176:177], v[88:91]
ds_read_b64_tr_b16 a[124:125], v233 offset:45056
ds_read_b64_tr_b16 a[126:127], v233 offset:47104
v_mfma_f32_16x16x16_bf16 v[92:95], v[30:31], a[178:179], v[92:95]
ds_read_b64_tr_b16 a[128:129], v234 offset:45056
ds_read_b64_tr_b16 a[130:131], v234 offset:47104
v_mfma_f32_16x16x16_bf16 v[96:99], v[30:31], a[180:181], v[96:99]
ds_read_b64_tr_b16 a[132:133], v235 offset:45056
ds_read_b64_tr_b16 a[134:135], v235 offset:47104
v_mfma_f32_16x16x16_bf16 v[100:103], v[30:31], a[182:183], v[100:103]
ds_read_b64_tr_b16 a[136:137], v242 offset:4096
ds_read_b64_tr_b16 a[138:139], v242 offset:6144
v_mfma_f32_16x16x16_bf16 v[104:107], v[30:31], a[184:185], v[104:107]
buffer_atomic_umax v0, v28, s[28:31], s62 offen sc0 sc1
v_mfma_f32_16x16x16_bf16 v[88:91], v[30:31], a[186:187], v[88:91]
ds_read_b64_tr_b16 a[140:141], v232 offset:49152
ds_read_b64_tr_b16 a[142:143], v232 offset:51200
v_mfma_f32_16x16x16_bf16 v[92:95], v[30:31], a[188:189], v[92:95]
ds_read_b64_tr_b16 a[144:145], v233 offset:49152
ds_read_b64_tr_b16 a[146:147], v233 offset:51200
v_mfma_f32_16x16x16_bf16 v[96:99], v[30:31], a[190:191], v[96:99]
ds_read_b64_tr_b16 a[148:149], v234 offset:49152
ds_read_b64_tr_b16 a[150:151], v234 offset:51200
v_mfma_f32_16x16x16_bf16 v[100:103], v[30:31], a[192:193], v[100:103]
ds_read_b64_tr_b16 a[152:153], v235 offset:49152
ds_read_b64_tr_b16 a[154:155], v235 offset:51200
v_mfma_f32_16x16x16_bf16 v[104:107], v[30:31], a[194:195], v[104:107]
ds_read_b64_tr_b16 a[156:157], v243 offset:4096
ds_read_b64_tr_b16 a[158:159], v243 offset:6144
v_mfma_f32_16x16x16_bf16 v[88:91], v[30:31], a[196:197], v[88:91]
ds_read_b64_tr_b16 a[160:161], v232 offset:53248
ds_read_b64_tr_b16 a[162:163], v232 offset:55296
v_mfma_f32_16x16x16_bf16 v[92:95], v[30:31], a[198:199], v[92:95]
ds_read_b64_tr_b16 a[164:165], v233 offset:53248
ds_read_b64_tr_b16 a[166:167], v233 offset:55296
v_mfma_f32_16x16x16_bf16 v[96:99], v[30:31], a[200:201], v[96:99]
ds_read_b64_tr_b16 a[168:169], v234 offset:53248
ds_read_b64_tr_b16 a[170:171], v234 offset:55296
v_mfma_f32_16x16x16_bf16 v[100:103], v[30:31], a[202:203], v[100:103]
ds_read_b64_tr_b16 a[172:173], v235 offset:53248
ds_read_b64_tr_b16 a[174:175], v235 offset:55296
v_mfma_f32_16x16x16_bf16 v[104:107], v[30:31], a[204:205], v[104:107]
ds_read_b64_tr_b16 a[176:177], v240 offset:8192
ds_read_b64_tr_b16 a[178:179], v240 offset:10240
v_mfma_f32_16x16x16_bf16 v[88:91], v[30:31], a[206:207], v[88:91]
ds_read_b64_tr_b16 a[180:181], v232 offset:57344
ds_read_b64_tr_b16 a[182:183], v232 offset:59392
v_mfma_f32_16x16x16_bf16 v[92:95], v[30:31], a[208:209], v[92:95]
ds_read_b64_tr_b16 a[184:185], v233 offset:57344
ds_read_b64_tr_b16 a[186:187], v233 offset:59392
v_mfma_f32_16x16x16_bf16 v[96:99], v[30:31], a[210:211], v[96:99]
ds_read_b64_tr_b16 a[188:189], v234 offset:57344
ds_read_b64_tr_b16 a[190:191], v234 offset:59392
v_mfma_f32_16x16x16_bf16 v[100:103], v[30:31], a[212:213], v[100:103]
ds_read_b64_tr_b16 a[192:193], v235 offset:57344
ds_read_b64_tr_b16 a[194:195], v235 offset:59392
v_mfma_f32_16x16x16_bf16 v[104:107], v[30:31], a[214:215], v[104:107]
ds_read_b64_tr_b16 a[196:197], v241 offset:8192
ds_read_b64_tr_b16 a[198:199], v241 offset:10240
v_mfma_f32_16x16x16_bf16 v[88:91], v[30:31], a[216:217], v[88:91]
ds_read_b64_tr_b16 a[200:201], v232 offset:61440
ds_read_b64_tr_b16 a[202:203], v232 offset:63488
v_mfma_f32_16x16x16_bf16 v[92:95], v[30:31], a[218:219], v[92:95]
buffer_atomic_umax v0, v28, s[28:31], s62 offen sc0 sc1
v_mfma_f32_16x16x16_bf16 v[96:99], v[30:31], a[220:221], v[96:99]
ds_read_b64_tr_b16 a[204:205], v233 offset:61440
ds_read_b64_tr_b16 a[206:207], v233 offset:63488
v_mfma_f32_16x16x16_bf16 v[100:103], v[30:31], a[222:223], v[100:103]
ds_read_b64_tr_b16 a[208:209], v234 offset:61440
ds_read_b64_tr_b16 a[210:211], v234 offset:63488
v_mfma_f32_16x16x16_bf16 v[104:107], v[30:31], a[224:225], v[104:107]
ds_read_b64_tr_b16 a[212:213], v235 offset:61440
ds_read_b64_tr_b16 a[214:215], v235 offset:63488
v_mfma_f32_16x16x16_bf16 v[88:91], v[30:31], a[226:227], v[88:91]
ds_read_b64_tr_b16 a[216:217], v242 offset:8192
ds_read_b64_tr_b16 a[218:219], v242 offset:10240
v_mfma_f32_16x16x16_bf16 v[92:95], v[30:31], a[228:229], v[92:95]
ds_read_b64_tr_b16 a[220:221], v236
ds_read_b64_tr_b16 a[222:223], v236 offset:2048
v_mfma_f32_16x16x16_bf16 v[96:99], v[30:31], a[230:231], v[96:99]
v_rcp_f32 v158, v4
v_mul_f32 v4, 3216550459, v4
v_mfma_f32_16x16x16_bf16 v[100:103], v[30:31], a[232:233], v[100:103]
v_lshlrev_b32 v48, 16, v244
v_and_b32 v49, 0xffff0000, v244
v_lshlrev_b32 v50, 16, v245
v_mfma_f32_16x16x16_bf16 v[104:107], v[30:31], a[234:235], v[104:107]
v_and_b32 v51, 0xffff0000, v245
v_lshlrev_b32 v52, 16, v246
v_and_b32 v53, 0xffff0000, v246
v_mfma_f32_16x16x16_bf16 v[88:91], v[30:31], a[236:237], v[88:91]
ds_read_b64_tr_b16 a[224:225], v237
ds_read_b64_tr_b16 a[226:227], v237 offset:2048
v_lshlrev_b32 v54, 16, v247
v_mfma_f32_16x16x16_bf16 v[92:95], v[30:31], a[238:239], v[92:95]
ds_read_b64_tr_b16 a[228:229], v238
ds_read_b64_tr_b16 a[230:231], v238 offset:2048
v_and_b32 v55, 0xffff0000, v247
v_mfma_f32_16x16x16_bf16 v[96:99], v[30:31], a[240:241], v[96:99]
ds_read_b64_tr_b16 a[232:233], v239
ds_read_b64_tr_b16 a[234:235], v239 offset:2048
v_lshlrev_b32 v56, 16, v248
v_mfma_f32_16x16x16_bf16 v[100:103], v[30:31], a[242:243], v[100:103]
v_and_b32 v57, 0xffff0000, v248
v_lshlrev_b32 v58, 16, v249
v_and_b32 v59, 0xffff0000, v249
v_mfma_f32_16x16x16_bf16 v[104:107], v[30:31], a[244:245], v[104:107]
v_lshlrev_b32 v60, 16, v250
v_and_b32 v61, 0xffff0000, v250
v_lshlrev_b32 v62, 16, v251
v_mfma_f32_16x16x16_bf16 v[88:91], v[30:31], a[246:247], v[88:91]
ds_read_b64_tr_b16 a[236:237], v243 offset:8192
ds_read_b64_tr_b16 a[238:239], v243 offset:10240
v_and_b32 v63, 0xffff0000, v251
v_mfma_f32_16x16x16_bf16 v[92:95], v[30:31], a[248:249], v[92:95]
ds_read_b64_tr_b16 a[240:241], v236 offset:4096
ds_read_b64_tr_b16 a[242:243], v236 offset:6144
v_lshlrev_b32 v64, 16, v252
v_mfma_f32_16x16x16_bf16 v[96:99], v[30:31], a[250:251], v[96:99]
v_and_b32 v65, 0xffff0000, v252
v_lshlrev_b32 v66, 16, v253
v_and_b32 v67, 0xffff0000, v253
v_mfma_f32_16x16x16_bf16 v[100:103], v[30:31], a[252:253], v[100:103]
v_mfma_f32_16x16x16_bf16 v[104:107], v[30:31], a[254:255], v[104:107]
buffer_atomic_umax v0, v28, s[28:31], s62 offen sc0 sc1
s_cmp_lg_u32 s44, 0
s_cbranch_scc1 L_back4
s_mov_b32 s6, 0x100000
L_poll4:
s_waitcnt vmcnt(2)
v_readfirstlane_b32 s3, v0
s_sub_u32 s6, s6, 1
s_cbranch_scc1 L_back4
s_nop 1
s_cmp_ge_u32 s3, 32
s_cbranch_scc1 L_back4
buffer_atomic_umax v0, v28, s[28:31], s62 offen sc0 sc1
s_sleep 2
s_branch L_poll4
L_back4:
s_barrier
buffer_load_dwordx4 v[160:163], v155, s[28:31], 0 offen sc1
buffer_load_dwordx4 v[164:167], v155, s[28:31], 0 offen offset:1024 sc1
buffer_load_dwordx4 v[168:171], v155, s[28:31], 0 offen offset:2048 sc1
buffer_load_dwordx4 v[172:175], v155, s[28:31], 0 offen offset:3072 sc1
v_add_u32 v155, 0x1000, v155
buffer_load_dwordx4 v[176:179], v155, s[28:31], 0 offen sc1
buffer_load_dwordx4 v[180:183], v155, s[28:31], 0 offen offset:1024 sc1
buffer_load_dwordx4 v[184:187], v155, s[28:31], 0 offen offset:2048 sc1
buffer_load_dwordx4 v[188:191], v155, s[28:31], 0 offen offset:3072 sc1
v_mul_f32 v132, v4, v88
v_mul_f32 v133, v4, v89
v_mul_f32 v134, v4, v90
v_mul_f32 v135, v4, v91
v_exp_f32 v132, v132
v_exp_f32 v133, v133
v_exp_f32 v134, v134
v_exp_f32 v135, v135
v_fma_f32 v132, v132, v158, v158
v_fma_f32 v133, v133, v158, v158
v_fma_f32 v134, v134, v158, v158
v_fma_f32 v135, v135, v158, v158
v_rcp_f32 v132, v132
v_rcp_f32 v133, v133
v_rcp_f32 v134, v134
v_rcp_f32 v135, v135
v_mul_f32 v88, v88, v132
v_mul_f32 v89, v89, v133
v_mul_f32 v90, v90, v134
v_mul_f32 v91, v91, v135
v_add_u32 v155, 0x1000, v155
buffer_load_dwordx4 v[192:195], v155, s[28:31], 0 offen sc1
v_mul_f32 v136, v4, v92
v_mul_f32 v137, v4, v93
v_mul_f32 v138, v4, v94
v_mul_f32 v139, v4, v95
v_exp_f32 v136, v136
v_exp_f32 v137, v137
v_exp_f32 v138, v138
v_exp_f32 v139, v139
v_fma_f32 v136, v136, v158, v158
v_fma_f32 v137, v137, v158, v158
v_fma_f32 v138, v138, v158, v158
v_fma_f32 v139, v139, v158, v158
v_rcp_f32 v136, v136
v_rcp_f32 v137, v137
v_rcp_f32 v138, v138
v_rcp_f32 v139, v139
v_mul_f32 v92, v92, v136
v_mul_f32 v93, v93, v137
v_mul_f32 v94, v94, v138
v_mul_f32 v95, v95, v139
buffer_load_dwordx4 v[196:199], v155, s[28:31], 0 offen offset:1024 sc1
v_mul_f32 v140, v4, v96
v_mul_f32 v141, v4, v97
v_mul_f32 v142, v4, v98
v_mul_f32 v143, v4, v99
v_exp_f32 v140, v140
v_exp_f32 v141, v141
v_exp_f32 v142, v142
v_exp_f32 v143, v143
v_fma_f32 v140, v140, v158, v158
v_fma_f32 v141, v141, v158, v158
v_fma_f32 v142, v142, v158, v158
v_fma_f32 v143, v143, v158, v158
v_rcp_f32 v140, v140
v_rcp_f32 v141, v141
v_rcp_f32 v142, v142
v_rcp_f32 v143, v143
v_mul_f32 v96, v96, v140
v_mul_f32 v97, v97, v141
v_mul_f32 v98, v98, v142
v_mul_f32 v99, v99, v143
buffer_load_dwordx4 v[200:203], v155, s[28:31], 0 offen offset:2048 sc1
s_waitcnt vmcnt(10) lgkmcnt(15)
v_mfma_f32_16x16x32_bf16 v[112:115], a[0:3], v[160:163], 0
buffer_load_dwordx4 v[204:207], v155, s[28:31], 0 offen offset:3072 sc1
v_mfma_f32_16x16x32_bf16 v[116:119], a[4:7], v[160:163], 0
v_mul_f32 v144, v4, v100
v_mul_f32 v145, v4, v101
v_mfma_f32_16x16x32_bf16 v[120:123], a[8:11], v[160:163], 0
v_mul_f32 v146, v4, v102
v_mul_f32 v147, v4, v103
v_mfma_f32_16x16x32_bf16 v[124:127], a[12:15], v[160:163], 0
v_exp_f32 v144, v144
v_mfma_f32_16x16x32_bf16 v[128:131], a[16:19], v[160:163], 0
s_waitcnt vmcnt(10)
v_add_u32 v155, 0x1000, v155
v_mfma_f32_16x16x32_bf16 v[112:115], a[20:23], v[164:167], v[112:115]
buffer_load_dwordx4 v[208:211], v155, s[28:31], 0 offen sc1
v_mfma_f32_16x16x32_bf16 v[116:119], a[24:27], v[164:167], v[116:119]
v_exp_f32 v145, v145
v_mfma_f32_16x16x32_bf16 v[120:123], a[28:31], v[164:167], v[120:123]
v_exp_f32 v146, v146
v_mfma_f32_16x16x32_bf16 v[124:127], a[32:35], v[164:167], v[124:127]
v_exp_f32 v147, v147
v_mfma_f32_16x16x32_bf16 v[128:131], a[36:39], v[164:167], v[128:131]
s_waitcnt vmcnt(10)
buffer_load_dwordx4 v[212:215], v155, s[28:31], 0 offen offset:1024 sc1
v_mfma_f32_16x16x32_bf16 v[112:115], a[40:43], v[168:171], v[112:115]
v_fma_f32 v144, v144, v158, v158
v_fma_f32 v145, v145, v158, v158
v_mfma_f32_16x16x32_bf16 v[116:119], a[44:47], v[168:171], v[116:119]
v_fma_f32 v146, v146, v158, v158
v_fma_f32 v147, v147, v158, v158
v_mfma_f32_16x16x32_bf16 v[120:123], a[48:51], v[168:171], v[120:123]
v_rcp_f32 v144, v144
v_mfma_f32_16x16x32_bf16 v[124:127], a[52:55], v[168:171], v[124:127]
buffer_load_dwordx4 v[216:219], v155, s[28:31], 0 offen offset:2048 sc1
v_mfma_f32_16x16x32_bf16 v[128:131], a[56:59], v[168:171], v[128:131]
s_waitcnt vmcnt(11)
v_rcp_f32 v145, v145
v_mfma_f32_16x16x32_bf16 v[112:115], a[60:63], v[172:175], v[112:115]
v_rcp_f32 v146, v146
v_mfma_f32_16x16x32_bf16 v[116:119], a[64:67], v[172:175], v[116:119]
v_rcp_f32 v147, v147
v_mfma_f32_16x16x32_bf16 v[120:123], a[68:71], v[172:175], v[120:123]
buffer_load_dwordx4 v[220:223], v155, s[28:31], 0 offen offset:3072 sc1
v_mfma_f32_16x16x32_bf16 v[124:127], a[72:75], v[172:175], v[124:127]
buffer_load_dword v224, v39, s[28:31], s68 offen sc1
v_mfma_f32_16x16x32_bf16 v[128:131], a[76:79], v[172:175], v[128:131]
s_waitcnt vmcnt(12)
buffer_load_dword v225, v39, s[28:31], s68 offen offset:128 sc1
v_mfma_f32_16x16x32_bf16 v[112:115], a[80:83], v[176:179], v[112:115]
buffer_load_dword v226, v39, s[28:31], s68 offen offset:256 sc1
v_mfma_f32_16x16x32_bf16 v[116:119], a[84:87], v[176:179], v[116:119]
buffer_load_dword v227, v39, s[28:31], s68 offen offset:384 sc1
v_mfma_f32_16x16x32_bf16 v[120:123], a[88:91], v[176:179], v[120:123]
buffer_load_dword v228, v39, s[28:31], s68 offen offset:2048 sc1
v_mfma_f32_16x16x32_bf16 v[124:127], a[92:95], v[176:179], v[124:127]
buffer_load_dword v229, v39, s[28:31], s68 offen offset:2176 sc1
v_mfma_f32_16x16x32_bf16 v[128:131], a[96:99], v[176:179], v[128:131]
s_waitcnt vmcnt(16)
buffer_load_dword v230, v39, s[28:31], s68 offen offset:2304 sc1
v_mfma_f32_16x16x32_bf16 v[112:115], a[100:103], v[180:183], v[112:115]
buffer_load_dword v231, v39, s[28:31], s68 offen offset:2432 sc1
v_mfma_f32_16x16x32_bf16 v[116:119], a[104:107], v[180:183], v[116:119]
v_mul_f32 v100, v100, v144
v_mul_f32 v101, v101, v145
v_mfma_f32_16x16x32_bf16 v[120:123], a[108:111], v[180:183], v[120:123]
v_mul_f32 v102, v102, v146
v_mul_f32 v103, v103, v147
v_mfma_f32_16x16x32_bf16 v[124:127], a[112:115], v[180:183], v[124:127]
v_mul_f32 v148, v4, v104
v_mul_f32 v149, v4, v105
v_mfma_f32_16x16x32_bf16 v[128:131], a[116:119], v[180:183], v[128:131]
s_waitcnt vmcnt(17)
v_mul_f32 v150, v4, v106
v_mul_f32 v151, v4, v107
v_mfma_f32_16x16x32_bf16 v[112:115], a[120:123], v[184:187], v[112:115]
v_exp_f32 v148, v148
v_mfma_f32_16x16x32_bf16 v[116:119], a[124:127], v[184:187], v[116:119]
v_exp_f32 v149, v149
v_mfma_f32_16x16x32_bf16 v[120:123], a[128:131], v[184:187], v[120:123]
v_exp_f32 v150, v150
v_mfma_f32_16x16x32_bf16 v[124:127], a[132:135], v[184:187], v[124:127]
v_exp_f32 v151, v151
v_mfma_f32_16x16x32_bf16 v[128:131], a[136:139], v[184:187], v[128:131]
s_waitcnt vmcnt(16)
v_fma_f32 v148, v148, v158, v158
v_fma_f32 v149, v149, v158, v158
v_mfma_f32_16x16x32_bf16 v[112:115], a[140:143], v[188:191], v[112:115]
v_fma_f32 v150, v150, v158, v158
v_fma_f32 v151, v151, v158, v158
v_mfma_f32_16x16x32_bf16 v[116:119], a[144:147], v[188:191], v[116:119]
v_rcp_f32 v148, v148
v_mfma_f32_16x16x32_bf16 v[120:123], a[148:151], v[188:191], v[120:123]
ds_read_b64_tr_b16 a[244:245], v237 offset:4096
ds_read_b64_tr_b16 a[246:247], v237 offset:6144
v_mfma_f32_16x16x32_bf16 v[124:127], a[152:155], v[188:191], v[124:127]
ds_read_b64_tr_b16 a[248:249], v238 offset:4096
ds_read_b64_tr_b16 a[250:251], v238 offset:6144
v_mfma_f32_16x16x32_bf16 v[128:131], a[156:159], v[188:191], v[128:131]
s_waitcnt vmcnt(15)
ds_read_b64_tr_b16 a[252:253], v239 offset:4096
ds_read_b64_tr_b16 a[254:255], v239 offset:6144
v_mfma_f32_16x16x32_bf16 v[112:115], a[160:163], v[192:195], v[112:115]
ds_read_b64_tr_b16 a[0:1], v240 offset:12288
ds_read_b64_tr_b16 a[2:3], v240 offset:14336
v_mfma_f32_16x16x32_bf16 v[116:119], a[164:167], v[192:195], v[116:119]
ds_read_b64_tr_b16 a[4:5], v236 offset:8192
ds_read_b64_tr_b16 a[6:7], v236 offset:10240
v_mfma_f32_16x16x32_bf16 v[120:123], a[168:171], v[192:195], v[120:123]
ds_read_b64_tr_b16 a[8:9], v237 offset:8192
ds_read_b64_tr_b16 a[10:11], v237 offset:10240
v_mfma_f32_16x16x32_bf16 v[124:127], a[172:175], v[192:195], v[124:127]
ds_read_b64_tr_b16 a[12:13], v238 offset:8192
ds_read_b64_tr_b16 a[14:15], v238 offset:10240
v_mfma_f32_16x16x32_bf16 v[128:131], a[176:179], v[192:195], v[128:131]
s_waitcnt vmcnt(14)
ds_read_b64_tr_b16 a[16:17], v239 offset:8192
ds_read_b64_tr_b16 a[18:19], v239 offset:10240
v_mfma_f32_16x16x32_bf16 v[112:115], a[180:183], v[196:199], v[112:115]
ds_read_b64_tr_b16 a[20:21], v241 offset:12288
ds_read_b64_tr_b16 a[22:23], v241 offset:14336
v_mfma_f32_16x16x32_bf16 v[116:119], a[184:187], v[196:199], v[116:119]
ds_read_b64_tr_b16 a[24:25], v242 offset:12288
ds_read_b64_tr_b16 a[26:27], v242 offset:14336
v_mfma_f32_16x16x32_bf16 v[120:123], a[188:191], v[196:199], v[120:123]
ds_read_b64_tr_b16 a[28:29], v243 offset:12288
ds_read_b64_tr_b16 a[30:31], v243 offset:14336
v_mfma_f32_16x16x32_bf16 v[124:127], a[192:195], v[196:199], v[124:127]
ds_read_b64_tr_b16 a[32:33], v240 offset:16384
ds_read_b64_tr_b16 a[34:35], v240 offset:18432
v_mfma_f32_16x16x32_bf16 v[128:131], a[196:199], v[196:199], v[128:131]
s_waitcnt vmcnt(13)
ds_read_b64_tr_b16 a[36:37], v241 offset:16384
ds_read_b64_tr_b16 a[38:39], v241 offset:18432
v_mfma_f32_16x16x32_bf16 v[112:115], a[200:203], v[200:203], v[112:115]
ds_read_b64_tr_b16 a[40:41], v236 offset:12288
ds_read_b64_tr_b16 a[42:43], v236 offset:14336
v_mfma_f32_16x16x32_bf16 v[116:119], a[204:207], v[200:203], v[116:119]
ds_read_b64_tr_b16 a[44:45], v236 offset:16384
ds_read_b64_tr_b16 a[46:47], v236 offset:18432
v_mfma_f32_16x16x32_bf16 v[120:123], a[208:211], v[200:203], v[120:123]
s_waitcnt lgkmcnt(15)
ds_read_b64_tr_b16 a[48:49], v236 offset:20480
ds_read_b64_tr_b16 a[50:51], v236 offset:22528
v_mfma_f32_16x16x32_bf16 v[124:127], a[212:215], v[200:203], v[124:127]
ds_read_b64_tr_b16 a[52:53], v236 offset:24576
ds_read_b64_tr_b16 a[54:55], v236 offset:26624
v_mfma_f32_16x16x32_bf16 v[128:131], a[216:219], v[200:203], v[128:131]
s_waitcnt vmcnt(12)
ds_read_b64_tr_b16 a[56:57], v237 offset:12288
ds_read_b64_tr_b16 a[58:59], v237 offset:14336
v_mfma_f32_16x16x32_bf16 v[112:115], a[220:223], v[204:207], v[112:115]
L_pad17:
s_cbranch_execz L_hret2
ds_read_b64_tr_b16 a[60:61], v237 offset:16384
ds_read_b64_tr_b16 a[62:63], v237 offset:18432
v_mfma_f32_16x16x32_bf16 v[116:119], a[224:227], v[204:207], v[116:119]
ds_read_b64_tr_b16 a[64:65], v237 offset:20480
ds_read_b64_tr_b16 a[66:67], v237 offset:22528
v_mfma_f32_16x16x32_bf16 v[120:123], a[228:231], v[204:207], v[120:123]
ds_read_b64_tr_b16 a[68:69], v237 offset:24576
ds_read_b64_tr_b16 a[70:71], v237 offset:26624
v_mfma_f32_16x16x32_bf16 v[124:127], a[232:235], v[204:207], v[124:127]
ds_read_b64_tr_b16 a[72:73], v238 offset:12288
ds_read_b64_tr_b16 a[74:75], v238 offset:14336
v_mfma_f32_16x16x32_bf16 v[128:131], a[236:239], v[204:207], v[128:131]
s_waitcnt vmcnt(11)
ds_read_b64_tr_b16 a[76:77], v238 offset:16384
ds_read_b64_tr_b16 a[78:79], v238 offset:18432
v_mfma_f32_16x16x32_bf16 v[112:115], a[240:243], v[208:211], v[112:115]
ds_read_b64_tr_b16 a[80:81], v238 offset:20480
ds_read_b64_tr_b16 a[82:83], v238 offset:22528
v_mfma_f32_16x16x32_bf16 v[116:119], a[244:247], v[208:211], v[116:119]
ds_read_b64_tr_b16 a[84:85], v238 offset:24576
ds_read_b64_tr_b16 a[86:87], v238 offset:26624
v_mfma_f32_16x16x32_bf16 v[120:123], a[248:251], v[208:211], v[120:123]
ds_read_b64_tr_b16 a[88:89], v239 offset:12288
ds_read_b64_tr_b16 a[90:91], v239 offset:14336
v_mfma_f32_16x16x32_bf16 v[124:127], a[252:255], v[208:211], v[124:127]
ds_read_b64_tr_b16 a[92:93], v239 offset:16384
ds_read_b64_tr_b16 a[94:95], v239 offset:18432
v_mfma_f32_16x16x32_bf16 v[128:131], a[0:3], v[208:211], v[128:131]
s_waitcnt vmcnt(10)
ds_read_b64_tr_b16 a[96:97], v239 offset:20480
ds_read_b64_tr_b16 a[98:99], v239 offset:22528
v_mfma_f32_16x16x32_bf16 v[112:115], a[4:7], v[212:215], v[112:115]
ds_read_b64_tr_b16 a[100:101], v239 offset:24576
ds_read_b64_tr_b16 a[102:103], v239 offset:26624
v_mfma_f32_16x16x32_bf16 v[116:119], a[8:11], v[212:215], v[116:119]
v_rcp_f32 v149, v149
v_mfma_f32_16x16x32_bf16 v[120:123], a[12:15], v[212:215], v[120:123]
s_waitcnt lgkmcnt(15)
v_rcp_f32 v150, v150
v_mfma_f32_16x16x32_bf16 v[124:127], a[16:19], v[212:215], v[124:127]
v_rcp_f32 v151, v151
v_mfma_f32_16x16x32_bf16 v[128:131], a[20:23], v[212:215], v[128:131]
s_waitcnt vmcnt(9)
v_mul_f32 v104, v104, v148
v_mul_f32 v105, v105, v149
v_mfma_f32_16x16x32_bf16 v[128:131], a[24:27], v[216:219], v[128:131]
s_waitcnt vmcnt(8)
v_mul_f32 v106, v106, v150
v_mul_f32 v107, v107, v151
v_mfma_f32_16x16x32_bf16 v[128:131], a[28:31], v[220:223], v[128:131]
s_waitcnt vmcnt(4)
v_mfma_f32_16x16x32_bf16 v[128:131], a[32:35], v[224:227], v[128:131]
s_waitcnt vmcnt(0)
v_mfma_f32_16x16x32_bf16 v[128:131], a[36:39], v[228:231], v[128:131]
v_mfma_f32_16x16x32_bf16 v[112:115], a[40:43], v[216:219], v[112:115]
v_mfma_f32_16x16x32_bf16 v[112:115], a[44:47], v[220:223], v[112:115]
v_mfma_f32_16x16x32_bf16 v[112:115], a[48:51], v[224:227], v[112:115]
v_mfma_f32_16x16x32_bf16 v[112:115], a[52:55], v[228:231], v[112:115]
v_mfma_f32_16x16x32_bf16 v[116:119], a[56:59], v[216:219], v[116:119]
s_nop 2
v_fma_f32 v64, v128, v104, v64
v_fma_f32 v65, v129, v105, v65
v_mfma_f32_16x16x32_bf16 v[116:119], a[60:63], v[220:223], v[116:119]
v_fma_f32 v66, v130, v106, v66
v_fma_f32 v67, v131, v107, v67
v_mfma_f32_16x16x32_bf16 v[116:119], a[64:67], v[224:227], v[116:119]
v_cvt_pk_bf16_f32 v252, v64, v65
v_cvt_pk_bf16_f32 v253, v66, v67
v_mfma_f32_16x16x32_bf16 v[116:119], a[68:71], v[228:231], v[116:119]
s_waitcnt lgkmcnt(14)
buffer_store_dwordx2 v[252:253], v41, s[36:39], s69 offen sc1
v_mfma_f32_16x16x32_bf16 v[120:123], a[72:75], v[216:219], v[120:123]
s_waitcnt lgkmcnt(12)
v_fma_f32 v48, v112, v88, v48
v_fma_f32 v49, v113, v89, v49
v_mfma_f32_16x16x32_bf16 v[120:123], a[76:79], v[220:223], v[120:123]
s_waitcnt lgkmcnt(10)
v_fma_f32 v50, v114, v90, v50
v_fma_f32 v51, v115, v91, v51
v_mfma_f32_16x16x32_bf16 v[120:123], a[80:83], v[224:227], v[120:123]
s_waitcnt lgkmcnt(8)
v_cvt_pk_bf16_f32 v244, v48, v49
v_cvt_pk_bf16_f32 v245, v50, v51
v_mfma_f32_16x16x32_bf16 v[120:123], a[84:87], v[228:231], v[120:123]
s_waitcnt lgkmcnt(6)
ds_write_b64 v152, v[244:245]
v_mfma_f32_16x16x32_bf16 v[124:127], a[88:91], v[216:219], v[124:127]
s_waitcnt lgkmcnt(5)
v_fma_f32 v52, v116, v92, v52
v_fma_f32 v53, v117, v93, v53
v_mfma_f32_16x16x32_bf16 v[124:127], a[92:95], v[220:223], v[124:127]
s_waitcnt lgkmcnt(3)
v_fma_f32 v54, v118, v94, v54
v_fma_f32 v55, v119, v95, v55
v_mfma_f32_16x16x32_bf16 v[124:127], a[96:99], v[224:227], v[124:127]
s_waitcnt lgkmcnt(1)
v_cvt_pk_bf16_f32 v246, v52, v53
v_cvt_pk_bf16_f32 v247, v54, v55
v_mfma_f32_16x16x32_bf16 v[124:127], a[100:103], v[228:231], v[124:127]
ds_write_b64 v152, v[246:247] offset:32
v_fma_f32 v56, v120, v96, v56
v_fma_f32 v57, v121, v97, v57
v_fma_f32 v58, v122, v98, v58
v_fma_f32 v59, v123, v99, v59
v_cvt_pk_bf16_f32 v248, v56, v57
v_cvt_pk_bf16_f32 v249, v58, v59
ds_write_b64 v153, v[248:249]
v_fma_f32 v60, v124, v100, v60
v_fma_f32 v61, v125, v101, v61
v_fma_f32 v62, v126, v102, v62
v_fma_f32 v63, v127, v103, v63
v_cvt_pk_bf16_f32 v250, v60, v61
v_cvt_pk_bf16_f32 v251, v62, v63
ds_write_b64 v153, v[250:251] offset:32
s_waitcnt lgkmcnt(0)
ds_read_b128 v[76:79], v154
ds_read_b128 v[80:83], v154 offset:1152
s_waitcnt lgkmcnt(1)
buffer_store_dwordx4 v[76:79], v156, s[36:39], 0 offen sc1
s_waitcnt lgkmcnt(0)
buffer_store_dwordx4 v[80:83], v157, s[36:39], 0 offen sc1
L_end:
s_endpgm
L_spin0:
s_mov_b32 s6, 0x40000
L_spinl0:
s_sleep 4
buffer_load_dword v0, off, s[40:43], 0 sc1
s_waitcnt vmcnt(0)
v_readfirstlane_b32 s3, v0
s_nop 3
s_cmp_lt_u32 s3, 1
s_cbranch_scc0 L_back0
s_sub_u32 s6, s6, 1
s_cbranch_scc0 L_spinl0
s_branch L_back0
L_spin1:
s_mov_b32 s6, 0x40000
L_spinl1:
s_sleep 4
buffer_atomic_umax v46, v20, s[28:31], 0 offen sc0 sc1
s_waitcnt vmcnt(0)
v_cmp_gt_u32 vcc, 16, v46
s_nop 3
s_and_b32 s3, vcc_lo, s1
s_cbranch_scc0 L_back1
s_sub_u32 s6, s6, 1
s_cbranch_scc0 L_spinl1
s_branch L_back1
L_spin2:
s_mov_b32 s6, 0x40000
L_spinl2:
s_sleep 4
buffer_atomic_umax v0, v28, s[28:31], s53 offen sc0 sc1
s_waitcnt vmcnt(0)
v_readfirstlane_b32 s3, v0
s_nop 3
s_cmp_lt_u32 s3, s1
s_cbranch_scc0 L_back2
s_sub_u32 s6, s6, 1
s_cbranch_scc0 L_spinl2
s_branch L_back2
L_spin3:
s_mov_b32 s6, 0x40000
L_spinl3:
s_sleep 4
buffer_atomic_umax v0, v28, s[28:31], s54 offen sc0 sc1
s_waitcnt vmcnt(0)
v_readfirstlane_b32 s3, v0
s_nop 3
s_cmp_lt_u32 s3, s1
s_cbranch_scc0 L_back3
s_sub_u32 s6, s6, 1
s_cbranch_scc0 L_spinl3
s_branch L_back3
L_att_slow:
s_waitcnt vmcnt(0) lgkmcnt(0)
s_mov_b32 s52, 1
v_mov_b32 v21, 0
v_mov_b32 v68, 0xff800000
v_mov_b32 v69, 0xff800000
v_subrev_u32 v23, 0x1ee00, v23
v_subrev_u32 v24, 0x1ee00, v24
v_subrev_u32 v25, 0x1ee00, v25
s_mov_b32 s61, s50
s_mov_b32 s60, 64
L_slow0:
buffer_load_dword a24, v23, s[28:31], s61 offen sc1
buffer_load_dwordx4 a[16:19], v10, s[28:31], s61 offen sc1
s_waitcnt vmcnt(0)
v_mfma_f32_32x32x4_2b_bf16 v[112:143], a[24:25], v[20:21], 0 cbsz:1 abid:0
s_nop 15
s_nop 1
v_mfma_f32_32x32x16_bf16 v[112:127], a[16:19], v[12:15], v[112:127]
v_mfma_f32_32x32x16_bf16 v[128:143], a[16:19], v[16:19], v[128:143]
s_nop 10
v_max3_f32 v68, v112, v113, v68
v_max3_f32 v68, v114, v115, v68
v_max3_f32 v68, v116, v117, v68
v_max3_f32 v68, v118, v119, v68
v_max3_f32 v68, v120, v121, v68
v_max3_f32 v68, v122, v123, v68
v_max3_f32 v68, v124, v125, v68
v_max3_f32 v68, v126, v127, v68
v_max3_f32 v69, v128, v129, v69
v_max3_f32 v69, v130, v131, v69
v_max3_f32 v69, v132, v133, v69
v_max3_f32 v69, v134, v135, v69
v_max3_f32 v69, v136, v137, v69
v_max3_f32 v69, v138, v139, v69
v_max3_f32 v69, v140, v141, v69
v_max3_f32 v69, v142, v143, v69
s_add_u32 s61, s61, 2432
s_sub_u32 s60, s60, 1
s_cmp_lg_u32 s60, 0
s_nop 15
s_cbranch_scc1 L_slow0
v_mov_b32 v70, v68
s_nop 1
v_permlane32_swap_b32 v68, v70
v_max_f32 v68, v68, v70
v_mov_b32 v70, v69
s_nop 1
v_permlane32_swap_b32 v69, v70
v_max_f32 v69, v69, v70
v_mov_b32 v176, 0
v_mov_b32 v177, 0
v_mov_b32 v178, 0
v_mov_b32 v179, 0
v_mov_b32 v180, 0
v_mov_b32 v181, 0
v_mov_b32 v182, 0
v_mov_b32 v183, 0
v_mov_b32 v184, 0
v_mov_b32 v185, 0
v_mov_b32 v186, 0
v_mov_b32 v187, 0
v_mov_b32 v188, 0
v_mov_b32 v189, 0
v_mov_b32 v190, 0
v_mov_b32 v191, 0
v_mov_b32 v192, 0
v_mov_b32 v193, 0
v_mov_b32 v194, 0
v_mov_b32 v195, 0
v_mov_b32 v196, 0
v_mov_b32 v197, 0
v_mov_b32 v198, 0
v_mov_b32 v199, 0
v_mov_b32 v200, 0
v_mov_b32 v201, 0
v_mov_b32 v202, 0
v_mov_b32 v203, 0
v_mov_b32 v204, 0
v_mov_b32 v205, 0
v_mov_b32 v206, 0
v_mov_b32 v207, 0
s_mov_b32 s61, s50
s_mov_b32 s60, 64
L_slow1:
buffer_load_dword a24, v23, s[28:31], s61 offen sc1
buffer_load_dwordx4 a[16:19], v10, s[28:31], s61 offen sc1
buffer_load_dwordx4 a[32:35], v24, s[28:31], s61 offen sc1
buffer_load_dwordx4 a[36:39], v25, s[28:31], s61 offen sc1
s_waitcnt vmcnt(0)
v_mfma_f32_32x32x4_2b_bf16 v[112:143], a[24:25], v[20:21], 0 cbsz:1 abid:0
s_nop 15
s_nop 1
v_mfma_f32_32x32x16_bf16 v[112:127], a[16:19], v[12:15], v[112:127]
v_mfma_f32_32x32x16_bf16 v[128:143], a[16:19], v[16:19], v[128:143]
s_nop 10
v_sub_f32 v112, v112, v68
v_sub_f32 v113, v113, v68
v_sub_f32 v114, v114, v68
v_sub_f32 v115, v115, v68
v_sub_f32 v116, v116, v68
v_sub_f32 v117, v117, v68
v_sub_f32 v118, v118, v68
v_sub_f32 v119, v119, v68
v_sub_f32 v120, v120, v68
v_sub_f32 v121, v121, v68
v_sub_f32 v122, v122, v68
v_sub_f32 v123, v123, v68
v_sub_f32 v124, v124, v68
v_sub_f32 v125, v125, v68
v_sub_f32 v126, v126, v68
v_sub_f32 v127, v127, v68
v_exp_f32 v112, v112
v_exp_f32 v113, v113
v_exp_f32 v114, v114
v_exp_f32 v115, v115
v_exp_f32 v116, v116
v_exp_f32 v117, v117
v_exp_f32 v118, v118
v_exp_f32 v119, v119
v_exp_f32 v120, v120
v_exp_f32 v121, v121
v_exp_f32 v122, v122
v_exp_f32 v123, v123
v_exp_f32 v124, v124
v_exp_f32 v125, v125
v_exp_f32 v126, v126
v_exp_f32 v127, v127
v_smfmac_f32_32x32x32_bf16 v[176:191], a[32:35], v[112:119], v26
s_nop 0
v_smfmac_f32_32x32x32_bf16 v[176:191], a[36:39], v[120:127], v26
v_sub_f32 v128, v128, v69
v_sub_f32 v129, v129, v69
v_sub_f32 v130, v130, v69
v_sub_f32 v131, v131, v69
v_sub_f32 v132, v132, v69
v_sub_f32 v133, v133, v69
v_sub_f32 v134, v134, v69
v_sub_f32 v135, v135, v69
v_sub_f32 v136, v136, v69
v_sub_f32 v137, v137, v69
v_sub_f32 v138, v138, v69
v_sub_f32 v139, v139, v69
v_sub_f32 v140, v140, v69
v_sub_f32 v141, v141, v69
v_sub_f32 v142, v142, v69
v_sub_f32 v143, v143, v69
v_exp_f32 v128, v128
v_exp_f32 v129, v129
v_exp_f32 v130, v130
v_exp_f32 v131, v131
v_exp_f32 v132, v132
v_exp_f32 v133, v133
v_exp_f32 v134, v134
v_exp_f32 v135, v135
v_exp_f32 v136, v136
v_exp_f32 v137, v137
v_exp_f32 v138, v138
v_exp_f32 v139, v139
v_exp_f32 v140, v140
v_exp_f32 v141, v141
v_exp_f32 v142, v142
v_exp_f32 v143, v143
v_smfmac_f32_32x32x32_bf16 v[192:207], a[32:35], v[128:135], v26
s_nop 0
v_smfmac_f32_32x32x32_bf16 v[192:207], a[36:39], v[136:143], v26
s_add_u32 s61, s61, 2432
s_sub_u32 s60, s60, 1
s_cmp_lg_u32 s60, 0
s_nop 15
s_cbranch_scc1 L_slow1
s_nop 15
s_branch L_att_fin
.section .rodata,"a"
.p2align 6
.amdhsa_kernel recurrent_scan__mha_block__glu_gated_reglu__prompt_kernel
  .amdhsa_next_free_vgpr 512
  .amdhsa_next_free_sgpr 102
  .amdhsa_accum_offset 256
  .amdhsa_group_segment_fixed_size 0
  .amdhsa_kernarg_size 80
  .amdhsa_user_sgpr_count 2
  .amdhsa_user_sgpr_kernarg_segment_ptr 1
  .amdhsa_system_sgpr_workgroup_id_x 1
.end_amdhsa_kernel
```
